```python
import torch

def _softmax(x, axis=-1):
    return torch.softmax(x, dim=axis)
def _gelu(x):
    return torch.nn.functional.gelu(x, approximate="tanh")
def _silu(x):
    return torch.nn.functional.silu(x)
def _sigmoid(x):
    return torch.sigmoid(x)
def _layernorm(x, axis=-1, eps=1e-5):
    m = x.mean(dim=axis, keepdim=True)
    v = x.var(dim=axis, keepdim=True, unbiased=False)
    return (x - m) / torch.sqrt(v + eps)
def _scatter_add(tgt, idx, src, axis=0):
    return tgt.clone().index_add_(axis, idx, src)
def _segment_sum(src, seg, n):
    out = torch.zeros((n,) + src.shape[1:], dtype=src.dtype)
    return out.index_add_(0, seg, src)
def _pad(x, pw):
    flat = tuple(v for pair in reversed(pw) for v in pair)
    return torch.nn.functional.pad(x, flat)

kernel_name = 'recurrent_scan__sliding_block_cached__mixer_s_mlp__prompt'

def setup_inputs():

    _w = (lambda a: (lambda t: t.to(torch.bfloat16) if t.is_floating_point() else t)(torch.as_tensor(a)))
    def _A_setup():
        B, Sq, D = 1, 2048, 512
        Hq, Hkv, Sk, Dh = 32, 32, 2048, 128
        assert Hq % Hkv == 0, (Hq, Hkv)
        return {
            "x": _w((lambda *s: torch.randn(*s, dtype=torch.bfloat16) * 0.05)(B, Sq, D)),
            "k_cache": _w((lambda *s: torch.randn(*s, dtype=torch.bfloat16) * 0.8)(B, Hkv, Sk, Dh)),
            "v_cache": _w((lambda *s: torch.randn(*s, dtype=torch.bfloat16) * 0.8)(B, Hkv, Sk, Dh)),
            "wq": _w((lambda *s: torch.randn(*s, dtype=torch.bfloat16) * 0.8)(D, Hq * Dh) * (D ** -0.5)),
            "wo": _w((lambda *s: torch.randn(*s, dtype=torch.bfloat16) * 0.8)(Hq * Dh, D) * ((Hq * Dh) ** -0.5)),
        }
    _A_in = _A_setup()

    def _B_setup():
        B, S, D, F = 1, 2048, 512, 1376
        return {
            "x":  _w((lambda *s: torch.randn(*s, dtype=torch.bfloat16) * 0.05)(B, S, D)),
            "w1": _w((lambda *s: torch.randn(*s, dtype=torch.bfloat16) * 3.2)(D, D) * (D ** -0.5)),
            "w2": _w((lambda *s: torch.randn(*s, dtype=torch.bfloat16) * 3.2)(D, D) * (D ** -0.5)),
            "w3": _w((lambda *s: torch.randn(*s, dtype=torch.bfloat16) * 3.2)(D, F) * (D ** -0.5)),
            "w4": _w((lambda *s: torch.randn(*s, dtype=torch.bfloat16) * 3.2)(F, D) * (F ** -0.5)),
        }
    _B_in = _B_setup()

    return {
        "A_x": _A_in["x"],
        "A_k_cache": _A_in["k_cache"],
        "A_v_cache": _A_in["v_cache"],
        "A_wq": _A_in["wq"],
        "A_wo": _A_in["wo"],
        "B_x": _B_in["x"],
        "B_w1": _B_in["w1"],
        "B_w2": _B_in["w2"],
        "B_w3": _B_in["w3"],
        "B_w4": _B_in["w4"],
    }

def reference(A_x, A_k_cache, A_v_cache, A_wq, A_wo, B_x, B_w1, B_w2, B_w3, B_w4):
    def _A_ref(x, k_cache, v_cache, wq, wo):
        B, Sq, D = x.shape
        Hq, Dh = 32, 128
        Hkv, Sk = k_cache.shape[1], k_cache.shape[2]
        W = min(4096, max(256, Sk // 4))
        rep = Hq // Hkv
        q = (lambda x, *d: x.permute(*d))((x @ wq).reshape(B, Sq, Hq, Dh), 0, 2, 1, 3)
        k = (lambda x, n, axis: torch.repeat_interleave(x, n, dim=axis))(k_cache[:, :, Sk - W:, :], rep, axis=1)
        v = (lambda x, n, axis: torch.repeat_interleave(x, n, dim=axis))(v_cache[:, :, Sk - W:, :], rep, axis=1)
        scores = torch.einsum("bhqd,bhkd->bhqk", q, k) * (Dh ** -0.5)
        p = _softmax(scores, axis=-1)
        o = torch.einsum("bhqk,bhkd->bhqd", p, v)
        return (lambda x, *d: x.permute(*d))(o, 0, 2, 1, 3).reshape(B, Sq, Hq * Dh) @ wo

    def _B_ref(x, w1, w2, w3, w4):
        B, S, D = x.shape
        h = _gelu(_layernorm(x, axis=-1) @ w1)
        c = D // 4
        g0 = _pad(h[:, :, 0*c:1*c], ((0, 0), (1, 0), (0, 0)))[:, :S, :]
        g1 = _pad(h[:, :, 1*c:2*c], ((0, 0), (0, 1), (0, 0)))[:, 1:, :]
        g2 = _pad(h[:, :, 2*c:3*c], ((0, 0), (2, 0), (0, 0)))[:, :S, :]
        g3 = _pad(h[:, :, 3*c:   ], ((0, 0), (0, 2), (0, 0)))[:, 2:, :]
        hs = torch.concatenate([g0, g1, g2, g3], axis=-1) @ w2
        x1 = x + hs
        h2 = _gelu(_layernorm(x1, axis=-1) @ w3) @ w4
        return x1 + h2

    x = A_x
    xn = _layernorm(x, axis=-1)
    s = _A_ref(xn, A_k_cache, A_v_cache, A_wq, A_wo)
    g = _silu(_B_ref(xn, B_w1, B_w2, B_w3, B_w4))
    return x + s * g
```

```asm
; @launch grid=(256,1,1) block=(256,1,1) lds=163840
.amdgcn_target "amdgcn-amd-amdhsa--gfx950"
.text
.globl recurrent_scan__sliding_block_cached__mixer_s_mlp__prompt_kernel
.p2align 8
.type recurrent_scan__sliding_block_cached__mixer_s_mlp__prompt_kernel,@function
recurrent_scan__sliding_block_cached__mixer_s_mlp__prompt_kernel:
s_cmp_ge_u32 s2, 256
s_cbranch_scc1 recurrent_scan__sliding_block_cached__mixer_s_mlp__prompt_kernel_end
s_load_dwordx16 s[8:23], s[0:1], 0
s_load_dwordx8 s[24:31], s[0:1], 64
s_load_dwordx2 s[32:33], s[0:1], 96
s_getpc_b64 s[72:73]
recurrent_scan__sliding_block_cached__mixer_s_mlp__prompt_kernel_pc:
s_and_b32 s73, s73, 0xffff
s_mov_b32 s74, recurrent_scan__sliding_block_cached__mixer_s_mlp__prompt_kernel_last-recurrent_scan__sliding_block_cached__mixer_s_mlp__prompt_kernel_pc
s_mov_b32 s75, 0x20000
s_bfe_u32 s95, s2, 0x20003
s_lshl_b32 s95, s95, 15
v_lshlrev_b32 v1, 7, v0
buffer_load_dword v253, v1, s[72:75], s95 offen
v_lshlrev_b32 v3, 6, v0
v_lshrrev_b32 v1, 6, v0
v_and_b32 v0, 63, v0
v_readfirstlane_b32 s3, v1
s_and_b32 s6, s2, 7
s_bfe_u32 s7, s2, 0x20003
s_lshl_b32 s5, s6, 2
s_add_u32 s5, s5, s7
s_lshr_b32 s4, s2, 5
v_bfe_u32 v228, v0, 4, 1
v_mul_u32_u24 v228, 4, v228
v_lshrrev_b32 v229, 5, v0
v_mul_u32_u24 v229, 16, v229
v_add_u32 v228, v228, v229
s_and_b32 s88, s3, 1
s_mul_i32 s88, s88, 8
s_lshr_b32 s89, s3, 1
s_lshl_b32 s89, s89, 5
s_add_u32 s88, s88, s89
v_add_u32 v228, s88, v228
s_mov_b32 s89, 8192
v_mul_lo_u32 v228, v228, s89
v_and_b32 v229, 15, v0
v_lshl_add_u32 v172, v229, 4, v228
v_add_u32 v173, 7136, v172
v_add_u32 v174, 14272, v172
v_add_u32 v175, 21408, v172
v_lshrrev_b32 v228, 3, v0
v_lshrrev_b32 v229, 4, v0
v_xor_b32 v229, v229, v0
v_and_b32 v229, 7, v229
v_lshlrev_b32 v229, 4, v229
v_lshl_add_u32 v176, v228, 10, v229
v_xor_b32 v177, 64, v176
v_add_u32 v177, 7168, v177
v_add_u32 v178, 14336, v176
v_add_u32 v179, 14336, v177
v_bfe_u32 v228, v0, 1, 2
v_bfe_u32 v229, v0, 4, 1
v_lshl_add_u32 v228, v229, 2, v228
v_bfe_u32 v229, v0, 3, 1
v_lshl_add_u32 v228, v229, 3, v228
v_lshrrev_b32 v229, 5, v0
v_lshl_add_u32 v228, v229, 4, v228
s_and_b32 s88, s3, 1
s_lshl_b32 s89, s88, 5
v_add_u32 v228, s89, v228
v_and_b32 v229, 1, v0
v_lshlrev_b32 v229, 4, v229
v_lshl_add_u32 v180, v228, 10, v229
s_lshl_b32 s90, s5, 8
s_lshl_b32 s91, s5, 5
s_lshl_b32 s92, s4, 2
s_add_u32 s92, s92, s3
s_lshl_b32 s92, s92, 16
s_add_u32 s93, s92, 32768
s_mul_i32 s96, s3, 4224
s_lshl_b32 s97, s88, 10
s_add_u32 s97, s97, 16896
s_lshl_b32 s98, s3, 13
s_add_u32 s98, s98, 18944
s_lshr_b32 s88, s3, 1
s_lshl_b32 s89, s88, 14
v_add_u32 v180, s89, v180
s_lshl_b32 s88, s88, 9
s_add_u32 s97, s97, s88
s_add_u32 s95, s4, s6
s_mul_i32 s95, s95, 2
s_and_b32 s95, s95, 7
s_lshl_b32 s88, s95, 19
s_add_u32 s90, s90, s88
s_lshl_b32 s88, s95, 16
s_add_u32 s91, s91, s88
s_lshl_b32 s88, s95, 7
s_add_u32 s92, s92, s88
s_add_u32 s93, s93, s88
v_lshlrev_b32 v246, 5, v0
v_lshlrev_b32 v240, 1, v3
s_waitcnt lgkmcnt(0)
s_mov_b32 s76, s32
s_and_b32 s77, s33, 0xffff
s_mov_b32 s78, 268435456
s_mov_b32 s79, 0x20000
s_mov_b32 s36, s8
s_and_b32 s37, s9, 0xffff
s_mov_b32 s38, 2097152
s_mov_b32 s39, 0x20000
s_mov_b32 s48, s14
s_and_b32 s49, s15, 0xffff
s_mov_b32 s50, 4194304
s_mov_b32 s51, 0x20000
s_mov_b32 s56, s20
s_and_b32 s57, s21, 0xffff
s_mov_b32 s58, 524288
s_mov_b32 s59, 0x20000
s_mov_b32 s101, 131072
s_cmp_lg_u32 s2, 0
s_cbranch_scc1 reld0_1
buffer_load_dwordx4 v[16:19], v240, s[76:79], s101 offen offset:0 sc1
buffer_load_dwordx4 v[20:23], v240, s[76:79], s101 offen offset:16 sc1
buffer_load_dwordx4 v[24:27], v240, s[76:79], s101 offen offset:32 sc1
buffer_load_dwordx4 v[28:31], v240, s[76:79], s101 offen offset:48 sc1
buffer_load_dwordx4 v[32:35], v240, s[76:79], s101 offen offset:64 sc1
buffer_load_dwordx4 v[36:39], v240, s[76:79], s101 offen offset:80 sc1
reld0_1:
s_lshl_b32 s94, s4, 7
s_lshl_b32 s88, s5, 2
s_add_u32 s94, s94, s88
s_add_u32 s94, s94, s3
s_lshl_b32 s88, s94, 11
buffer_load_dwordx4 v[232:235], v246, s[36:39], s88 offen
buffer_load_dwordx4 v[236:239], v246, s[36:39], s88 offen offset:16
s_add_u32 m0, s98, 0
s_nop 0
buffer_load_dwordx4 v176, s[36:39], s92 offen offset:0 lds
buffer_load_dwordx4 v177, s[36:39], s92 offen offset:1024 lds
buffer_load_dwordx4 v178, s[36:39], s92 offen offset:2048 lds
buffer_load_dwordx4 v179, s[36:39], s92 offen offset:3072 lds
s_add_u32 m0, s96, 0
s_nop 0
buffer_load_dwordx4 v172, s[48:51], s90 offen offset:0 lds
buffer_load_dwordx4 v173, s[48:51], s90 offen offset:1056 lds
buffer_load_dwordx4 v174, s[48:51], s90 offen offset:2112 lds
buffer_load_dwordx4 v175, s[48:51], s90 offen offset:3168 lds
s_add_u32 m0, s98, 4096
s_nop 0
buffer_load_dwordx4 v176, s[36:39], s93 offen offset:0 lds
buffer_load_dwordx4 v177, s[36:39], s93 offen offset:1024 lds
buffer_load_dwordx4 v178, s[36:39], s93 offen offset:2048 lds
buffer_load_dwordx4 v179, s[36:39], s93 offen offset:3072 lds
s_add_u32 m0, s97, 0
s_mov_b32 exec_hi, 0
buffer_load_dwordx4 v180, s[56:59], s91 offen lds
s_mov_b32 exec_hi, -1
s_add_u32 s90, s90, 524288
s_and_b32 s90, s90, 0x3fffff
s_add_u32 s91, s91, 65536
s_and_b32 s91, s91, 0x7ffff
s_add_u32 s92, s92, 128
s_and_b32 s92, s92, 0xffffbbff
s_or_b32 s93, s92, 32768
s_mov_b32 s40, s10
s_and_b32 s41, s11, 0xffff
s_mov_b32 s42, 16777216
s_mov_b32 s43, 0x20000
s_mov_b32 s44, s12
s_and_b32 s45, s13, 0xffff
s_mov_b32 s46, 16777216
s_mov_b32 s47, 0x20000
s_mov_b32 s84, s30
s_and_b32 s85, s31, 0xffff
s_mov_b32 s86, 256
s_mov_b32 s87, 0x20000
s_add_u32 s80, s32, 2097152
s_addc_u32 s81, s33, 0
s_and_b32 s81, s81, 0xffff
s_mov_b32 s82, 2097152
s_mov_b32 s83, 0x20000
s_sub_u32 s52, s16, 128
s_subb_u32 s53, s17, 0
s_and_b32 s53, s53, 0xffff
s_mov_b32 s54, 4194432
s_mov_b32 s55, 0x20000
s_sub_u32 s60, s22, 128
s_subb_u32 s61, s23, 0
s_and_b32 s61, s61, 0xffff
s_mov_b32 s62, 524416
s_mov_b32 s63, 0x20000
s_mov_b32 s64, s24
s_and_b32 s65, s25, 0xffff
s_mov_b32 s66, 1409024
s_mov_b32 s67, 0x20000
s_sub_u32 s68, s26, 128
s_subb_u32 s69, s27, 0
s_and_b32 s69, s69, 0xffff
s_mov_b32 s70, 1409152
s_mov_b32 s71, 0x20000
s_mov_b32 s24, 131072
s_mov_b32 s27, s94
s_add_u32 m0, s98, 51712
s_nop 0
buffer_load_dwordx4 v176, s[36:39], s92 offen offset:0 lds
buffer_load_dwordx4 v177, s[36:39], s92 offen offset:1024 lds
buffer_load_dwordx4 v178, s[36:39], s92 offen offset:2048 lds
buffer_load_dwordx4 v179, s[36:39], s92 offen offset:3072 lds
s_add_u32 m0, s96, 51712
s_nop 0
buffer_load_dwordx4 v172, s[48:51], s90 offen offset:0 lds
buffer_load_dwordx4 v173, s[48:51], s90 offen offset:1056 lds
buffer_load_dwordx4 v174, s[48:51], s90 offen offset:2112 lds
buffer_load_dwordx4 v175, s[48:51], s90 offen offset:3168 lds
s_add_u32 m0, s98, 55808
s_nop 0
buffer_load_dwordx4 v176, s[36:39], s93 offen offset:0 lds
v_mov_b32 v250, v3
v_mov_b32 v15, 0x3f803f80
v_accvgpr_write_b32 a72, v15
v_accvgpr_write_b32 a73, v15
v_accvgpr_write_b32 a74, v15
v_accvgpr_write_b32 a75, v15
v_mov_b32 v15, 0
v_mov_b32 v252, 159744
ds_write_b32 v252, v15
s_mov_b32 s16, 0
v_bfe_u32 v228, v0, 2, 3
v_mul_u32_u24 v228, 1056, v228
v_lshrrev_b32 v229, 5, v0
v_lshl_add_u32 v228, v229, 9, v228
v_and_b32 v229, 3, v0
v_lshl_add_u32 v160, v229, 3, v228
v_add_u32 v161, 51712, v160
v_add_u32 v162, 103424, v160
v_bfe_u32 v228, v0, 2, 3
v_lshlrev_b32 v228, 5, v228
v_lshrrev_b32 v229, 5, v0
v_lshl_add_u32 v228, v229, 9, v228
v_and_b32 v229, 3, v0
v_lshl_add_u32 v228, v229, 3, v228
v_add_u32 v163, 16896, v228
v_add_u32 v164, 68608, v228
v_add_u32 v165, 120320, v228
v_and_b32 v228, 15, v0
v_lshrrev_b32 v229, 1, v228
v_lshlrev_b32 v228, 7, v228
v_lshrrev_b32 v166, 4, v0
v_xor_b32 v229, v229, v166
v_lshl_add_u32 v228, v229, 4, v228
v_add_u32 v166, s98, v228
v_xor_b32 v167, 64, v166
v_add_u32 v168, 51712, v166
v_add_u32 v169, 51712, v167
v_add_u32 v170, 103424, v166
v_add_u32 v171, 103424, v167
s_sub_u32 s26, s6, s95
s_and_b32 s26, s26, 7
s_lshl_b32 s88, s7, 1
v_lshrrev_b32 v228, 5, v0
v_add_u32 v228, s88, v228
v_bfe_u32 v229, v0, 1, 3
v_xor_b32 v228, v228, v229
v_lshlrev_b32 v228, 4, v228
v_and_b32 v229, 15, v0
v_lshl_add_u32 v228, v229, 7, v228
v_bfe_u32 v229, v0, 4, 1
v_lshl_add_u32 v228, v229, 3, v228
v_add_u32 v181, s98, v228
v_lshrrev_b32 v228, 4, v0
v_and_b32 v229, 15, v0
s_lshr_b32 s88, s3, 1
s_lshl_b32 s88, s88, 3
s_and_b32 s89, s3, 1
s_add_u32 s88, s88, s89
s_lshl_b32 s88, s88, 10
s_add_u32 s88, s88, 393216
v_lshlrev_b32 v8, 11, v228
v_lshl_add_u32 v8, v229, 4, v8
v_add_u32 v8, s88, v8
s_lshl_b32 s88, s3, 12
s_add_u32 s88, s88, 393216
v_xor_b32 v229, v229, v228
v_lshlrev_b32 v228, 8, v228
v_lshl_add_u32 v228, v229, 4, v228
v_add_u32 v4, s88, v228
v_subrev_u32 v5, 64, v4
v_subrev_u32 v9, 800, v8
v_subrev_u32 v6, 128, v4
v_subrev_u32 v10, 1600, v8
v_subrev_u32 v7, 192, v4
v_subrev_u32 v11, 2400, v8
s_lshl_b32 s94, s5, 19
s_mul_i32 s99, s3, 4352
v_bfe_u32 v228, v0, 2, 2
v_mul_u32_u24 v228, 1088, v228
v_and_b32 v229, 3, v0
v_lshl_add_u32 v228, v229, 8, v228
v_bfe_u32 v1, v0, 4, 1
v_lshlrev_b32 v1, 1, v1
v_xor_b32 v229, v229, v1
v_lshrrev_b32 v1, 5, v0
v_xor_b32 v229, v229, v1
v_lshl_add_u32 v228, v229, 4, v228
v_add_u32 v1, 103424, v228
v_bfe_u32 v228, v0, 2, 3
v_mul_u32_u24 v228, 1056, v228
v_lshrrev_b32 v229, 5, v0
v_lshl_add_u32 v228, v229, 8, v228
v_and_b32 v229, 3, v0
v_lshl_add_u32 v228, v229, 3, v228
v_add_u32 v3, 86016, v228
v_mov_b32 v228, 0x3f803f80
v_accvgpr_write_b32 a124, v228
v_accvgpr_write_b32 a125, v228
v_accvgpr_write_b32 a126, v228
v_accvgpr_write_b32 a127, v228
v_lshlrev_b32 v251, 4, v0
s_mov_b32 s89, 0xffff0000
s_waitcnt vmcnt(23)
v_lshlrev_b32 v240, 16, v232
v_and_b32 v241, s89, v232
v_add_f32 v242, v240, v241
v_mul_f32 v243, v240, v240
v_fmac_f32 v243, v241, v241
v_lshlrev_b32 v240, 16, v233
v_and_b32 v241, s89, v233
v_add_f32 v242, v242, v240
v_fmac_f32 v243, v240, v240
v_add_f32 v242, v242, v241
v_fmac_f32 v243, v241, v241
v_lshlrev_b32 v240, 16, v234
v_and_b32 v241, s89, v234
v_add_f32 v242, v242, v240
v_fmac_f32 v243, v240, v240
v_add_f32 v242, v242, v241
v_fmac_f32 v243, v241, v241
v_lshlrev_b32 v240, 16, v235
v_and_b32 v241, s89, v235
v_add_f32 v242, v242, v240
v_fmac_f32 v243, v240, v240
v_add_f32 v242, v242, v241
v_fmac_f32 v243, v241, v241
s_waitcnt vmcnt(22)
v_lshlrev_b32 v240, 16, v236
v_and_b32 v241, s89, v236
v_add_f32 v242, v242, v240
v_fmac_f32 v243, v240, v240
v_add_f32 v242, v242, v241
v_fmac_f32 v243, v241, v241
v_lshlrev_b32 v240, 16, v237
v_and_b32 v241, s89, v237
v_add_f32 v242, v242, v240
v_fmac_f32 v243, v240, v240
v_add_f32 v242, v242, v241
v_fmac_f32 v243, v241, v241
v_lshlrev_b32 v240, 16, v238
v_and_b32 v241, s89, v238
v_add_f32 v242, v242, v240
v_fmac_f32 v243, v240, v240
v_add_f32 v242, v242, v241
v_fmac_f32 v243, v241, v241
v_lshlrev_b32 v240, 16, v239
v_and_b32 v241, s89, v239
v_add_f32 v242, v242, v240
v_fmac_f32 v243, v240, v240
v_add_f32 v242, v242, v241
v_fmac_f32 v243, v241, v241
s_nop 0
v_add_f32_dpp v242, v242, v242 row_ror:8 row_mask:0xf bank_mask:0xf
v_add_f32_dpp v243, v243, v243 row_ror:8 row_mask:0xf bank_mask:0xf
s_nop 0
v_add_f32_dpp v242, v242, v242 row_ror:4 row_mask:0xf bank_mask:0xf
v_add_f32_dpp v243, v243, v243 row_ror:4 row_mask:0xf bank_mask:0xf
s_nop 0
v_add_f32_dpp v242, v242, v242 row_ror:2 row_mask:0xf bank_mask:0xf
v_add_f32_dpp v243, v243, v243 row_ror:2 row_mask:0xf bank_mask:0xf
s_nop 0
v_add_f32_dpp v242, v242, v242 row_ror:1 row_mask:0xf bank_mask:0xf
v_add_f32_dpp v243, v243, v243 row_ror:1 row_mask:0xf bank_mask:0xf
v_mov_b32 v244, v242
v_mov_b32 v245, v243
v_and_b32 v240, 31, v0
v_cmp_eq_u32 vcc, 0, v240
v_permlane16_swap_b32 v244, v242
v_permlane16_swap_b32 v245, v243
v_lshrrev_b32 v240, 2, v0
v_mov_b32 v241, 1073741824
v_cndmask_b32 v246, v241, v240, vcc
v_add_f32 v242, v242, v244
v_add_f32 v243, v243, v245
v_mul_f32 v242, 0x3b000000, v242
v_mul_f32 v243, 0x3b000000, v243
v_fma_f32 v243, -v242, v242, v243
v_max_f32 v243, 0, v243
v_add_f32 v243, 0x3727c5ac, v243
v_rsq_f32 v243, v243
s_lshl_b32 s88, s27, 4
s_nop 0
s_waitcnt vmcnt(9) lgkmcnt(0)
s_cmp_lg_u32 s2, 0
s_cbranch_scc1 reld1_2
v_max3_i32 v40, v16, v17, 0
v_max3_i32 v40, v18, v19, v40
v_max3_i32 v40, v20, v21, v40
v_max3_i32 v40, v22, v23, v40
v_max3_i32 v40, v24, v25, v40
v_max3_i32 v40, v26, v27, v40
v_max3_i32 v40, v28, v29, v40
v_max3_i32 v40, v30, v31, v40
v_max3_i32 v40, v32, v33, v40
v_max3_i32 v40, v34, v35, v40
v_max3_i32 v40, v36, v37, v40
v_max3_i32 v40, v38, v39, v40
s_nop 1
v_max_i32_dpp v40, v40, v40 row_ror:8 row_mask:0xf bank_mask:0xf
s_nop 1
v_max_i32_dpp v40, v40, v40 row_ror:4 row_mask:0xf bank_mask:0xf
s_nop 1
v_max_i32_dpp v40, v40, v40 row_ror:2 row_mask:0xf bank_mask:0xf
s_nop 1
v_max_i32_dpp v40, v40, v40 row_ror:1 row_mask:0xf bank_mask:0xf
v_mov_b32 v41, v40
s_nop 1
v_permlane16_swap_b32 v41, v40
v_max_i32 v40, v40, v41
v_mov_b32 v41, v40
s_nop 1
v_permlane32_swap_b32 v41, v40
v_max_i32 v40, v40, v41
s_nop 0
v_readfirstlane_b32 s88, v40
s_nop 0
s_add_i32 s88, s88, 1
s_cbranch_scc0 reldd_4
s_mov_b32 s88, 0
reldl_3:
s_add_u32 s88, s88, 1
s_mov_b64 s[32:33], 0
v_cmp_eq_u32 vcc, s88, v16
s_nop 0
s_or_b64 s[32:33], s[32:33], vcc
v_cmp_eq_u32 vcc, s88, v17
s_nop 0
s_or_b64 s[32:33], s[32:33], vcc
v_cmp_eq_u32 vcc, s88, v18
s_nop 0
s_or_b64 s[32:33], s[32:33], vcc
v_cmp_eq_u32 vcc, s88, v19
s_nop 0
s_or_b64 s[32:33], s[32:33], vcc
v_cmp_eq_u32 vcc, s88, v20
s_nop 0
s_or_b64 s[32:33], s[32:33], vcc
v_cmp_eq_u32 vcc, s88, v21
s_nop 0
s_or_b64 s[32:33], s[32:33], vcc
v_cmp_eq_u32 vcc, s88, v22
s_nop 0
s_or_b64 s[32:33], s[32:33], vcc
v_cmp_eq_u32 vcc, s88, v23
s_nop 0
s_or_b64 s[32:33], s[32:33], vcc
v_cmp_eq_u32 vcc, s88, v24
s_nop 0
s_or_b64 s[32:33], s[32:33], vcc
v_cmp_eq_u32 vcc, s88, v25
s_nop 0
s_or_b64 s[32:33], s[32:33], vcc
v_cmp_eq_u32 vcc, s88, v26
s_nop 0
s_or_b64 s[32:33], s[32:33], vcc
v_cmp_eq_u32 vcc, s88, v27
s_nop 0
s_or_b64 s[32:33], s[32:33], vcc
v_cmp_eq_u32 vcc, s88, v28
s_nop 0
s_or_b64 s[32:33], s[32:33], vcc
v_cmp_eq_u32 vcc, s88, v29
s_nop 0
s_or_b64 s[32:33], s[32:33], vcc
v_cmp_eq_u32 vcc, s88, v30
s_nop 0
s_or_b64 s[32:33], s[32:33], vcc
v_cmp_eq_u32 vcc, s88, v31
s_nop 0
s_or_b64 s[32:33], s[32:33], vcc
v_cmp_eq_u32 vcc, s88, v32
s_nop 0
s_or_b64 s[32:33], s[32:33], vcc
v_cmp_eq_u32 vcc, s88, v33
s_nop 0
s_or_b64 s[32:33], s[32:33], vcc
v_cmp_eq_u32 vcc, s88, v34
s_nop 0
s_or_b64 s[32:33], s[32:33], vcc
v_cmp_eq_u32 vcc, s88, v35
s_nop 0
s_or_b64 s[32:33], s[32:33], vcc
v_cmp_eq_u32 vcc, s88, v36
s_nop 0
s_or_b64 s[32:33], s[32:33], vcc
v_cmp_eq_u32 vcc, s88, v37
s_nop 0
s_or_b64 s[32:33], s[32:33], vcc
v_cmp_eq_u32 vcc, s88, v38
s_nop 0
s_or_b64 s[32:33], s[32:33], vcc
v_cmp_eq_u32 vcc, s88, v39
s_nop 0
s_or_b64 s[32:33], s[32:33], vcc
s_cbranch_scc1 reldl_3
reldd_4:
v_mov_b32 v16, s88
s_lshl_b32 s88, s3, 2
s_mov_b64 exec, 1
buffer_store_dword v16, off, s[84:87], s88 sc1
s_mov_b64 exec, -1
s_nop 1
reld1_2:
s_barrier
ds_read_b128 a[40:43], v166 offset:0
ds_read_b128 a[44:47], v166 offset:2048
ds_read_b128 a[48:51], v166 offset:4096
ds_read_b128 a[52:55], v166 offset:6144
ds_read_b64_tr_b16 a[0:1], v160 offset:0
ds_read_b64_tr_b16 a[2:3], v160 offset:256
ds_read_b64_tr_b16 a[4:5], v160 offset:32
ds_read_b64_tr_b16 a[6:7], v160 offset:288
ds_read_b64_tr_b16 a[8:9], v160 offset:64
ds_read_b64_tr_b16 a[10:11], v160 offset:320
ds_read_b64_tr_b16 a[12:13], v160 offset:96
ds_read_b64_tr_b16 a[14:15], v160 offset:352
ds_read_b64_tr_b16 a[16:17], v160 offset:128
ds_read_b64_tr_b16 a[18:19], v160 offset:384
ds_read_b64_tr_b16 a[20:21], v160 offset:160
ds_read_b64_tr_b16 a[22:23], v160 offset:416
ds_read_b64_tr_b16 a[24:25], v160 offset:192
ds_read_b64_tr_b16 a[26:27], v160 offset:448
ds_read_b64_tr_b16 a[28:29], v160 offset:224
ds_read_b64_tr_b16 a[30:31], v160 offset:480
ds_read_b64_tr_b16 a[32:33], v163 offset:0
ds_read_b64_tr_b16 a[34:35], v163 offset:256
s_waitcnt lgkmcnt(6)
v_mfma_f32_16x16x32_bf16 v[16:19], a[0:3], a[40:43], 0
buffer_load_dwordx4 v177, s[36:39], s93 offen offset:1024 lds
v_mfma_f32_16x16x32_bf16 v[20:23], a[0:3], a[44:47], 0
v_mfma_f32_16x16x32_bf16 v[24:27], a[0:3], a[48:51], 0
s_cmp_eq_u32 s26, 0
s_cbranch_scc1 rexs_5
rexsb_6:
v_mfma_f32_16x16x32_bf16 v[28:31], a[0:3], a[52:55], 0
v_mfma_f32_16x16x32_bf16 v[192:195], a[0:3], a[72:75], 0
ds_read_b64_tr_b16 a[0:1], v160 offset:8448
buffer_load_dwordx4 v178, s[36:39], s93 offen offset:2048 lds
v_mfma_f32_16x16x32_bf16 v[44:47], a[4:7], a[52:55], 0
ds_read_b64_tr_b16 a[2:3], v160 offset:8704
v_mfma_f32_16x16x32_bf16 v[40:43], a[4:7], a[48:51], 0
ds_read_b128 a[56:59], v167 offset:0
v_mfma_f32_16x16x32_bf16 v[36:39], a[4:7], a[44:47], 0
v_mfma_f32_16x16x32_bf16 v[32:35], a[4:7], a[40:43], 0
v_mfma_f32_16x16x32_bf16 v[196:199], a[4:7], a[72:75], 0
ds_read_b64_tr_b16 a[4:5], v160 offset:8480
buffer_load_dwordx4 v179, s[36:39], s93 offen offset:3072 lds
v_mfma_f32_16x16x32_bf16 v[48:51], a[8:11], a[40:43], 0
ds_read_b64_tr_b16 a[6:7], v160 offset:8736
v_mfma_f32_16x16x32_bf16 v[52:55], a[8:11], a[44:47], 0
ds_read_b128 a[60:63], v167 offset:2048
v_mfma_f32_16x16x32_bf16 v[56:59], a[8:11], a[48:51], 0
v_mfma_f32_16x16x32_bf16 v[60:63], a[8:11], a[52:55], 0
v_mfma_f32_16x16x32_bf16 v[200:203], a[8:11], a[72:75], 0
ds_read_b64_tr_b16 a[8:9], v160 offset:8512
s_add_u32 m0, s97, 51712
v_mfma_f32_16x16x32_bf16 v[76:79], a[12:15], a[52:55], 0
ds_read_b64_tr_b16 a[10:11], v160 offset:8768
s_mov_b32 exec_hi, 0
buffer_load_dwordx4 v180, s[56:59], s91 offen lds
s_mov_b32 exec_hi, -1
v_mfma_f32_16x16x32_bf16 v[72:75], a[12:15], a[48:51], 0
ds_read_b128 a[64:67], v167 offset:4096
v_mfma_f32_16x16x32_bf16 v[68:71], a[12:15], a[44:47], 0
v_mfma_f32_16x16x32_bf16 v[64:67], a[12:15], a[40:43], 0
v_mfma_f32_16x16x32_bf16 v[204:207], a[12:15], a[72:75], 0
ds_read_b64_tr_b16 a[12:13], v160 offset:8544
s_add_u32 s90, s90, 524288
v_mfma_f32_16x16x32_bf16 v[80:83], a[16:19], a[40:43], 0
ds_read_b64_tr_b16 a[14:15], v160 offset:8800
v_mfma_f32_16x16x32_bf16 v[84:87], a[16:19], a[44:47], 0
ds_read_b128 a[68:71], v167 offset:6144
v_mfma_f32_16x16x32_bf16 v[88:91], a[16:19], a[48:51], 0
s_and_b32 s90, s90, 0x3fffff
v_mfma_f32_16x16x32_bf16 v[92:95], a[16:19], a[52:55], 0
s_add_u32 s91, s91, 65536
s_and_b32 s91, s91, 0x7ffff
v_mfma_f32_16x16x32_bf16 v[208:211], a[16:19], a[72:75], 0
ds_read_b64_tr_b16 a[16:17], v160 offset:8576
s_add_u32 s92, s92, 128
s_waitcnt lgkmcnt(8)
v_mfma_f32_16x16x32_bf16 v[108:111], a[20:23], a[52:55], 0
ds_read_b64_tr_b16 a[18:19], v160 offset:8832
v_mfma_f32_16x16x32_bf16 v[104:107], a[20:23], a[48:51], 0
s_and_b32 s92, s92, 0xffffbbff
v_mfma_f32_16x16x32_bf16 v[100:103], a[20:23], a[44:47], 0
s_or_b32 s93, s92, 32768
v_mfma_f32_16x16x32_bf16 v[96:99], a[20:23], a[40:43], 0
s_add_u32 m0, s98, 103424
s_nop 0
buffer_load_dwordx4 v176, s[36:39], s92 offen offset:0 lds
v_mfma_f32_16x16x32_bf16 v[212:215], a[20:23], a[72:75], 0
ds_read_b64_tr_b16 a[20:21], v160 offset:8608
v_mfma_f32_16x16x32_bf16 v[112:115], a[24:27], a[40:43], 0
ds_read_b64_tr_b16 a[22:23], v160 offset:8864
v_mfma_f32_16x16x32_bf16 v[116:119], a[24:27], a[44:47], 0
buffer_load_dwordx4 v177, s[36:39], s92 offen offset:1024 lds
v_mfma_f32_16x16x32_bf16 v[120:123], a[24:27], a[48:51], 0
v_mfma_f32_16x16x32_bf16 v[124:127], a[24:27], a[52:55], 0
buffer_load_dwordx4 v178, s[36:39], s92 offen offset:2048 lds
v_mfma_f32_16x16x32_bf16 v[216:219], a[24:27], a[72:75], 0
ds_read_b64_tr_b16 a[24:25], v160 offset:8640
v_mfma_f32_16x16x32_bf16 v[140:143], a[28:31], a[52:55], 0
ds_read_b64_tr_b16 a[26:27], v160 offset:8896
v_mfma_f32_16x16x32_bf16 v[136:139], a[28:31], a[48:51], 0
v_mfma_f32_16x16x32_bf16 v[132:135], a[28:31], a[44:47], 0
v_mfma_f32_16x16x32_bf16 v[128:131], a[28:31], a[40:43], 0
buffer_load_dwordx4 v179, s[36:39], s92 offen offset:3072 lds
v_mfma_f32_16x16x32_bf16 v[220:223], a[28:31], a[72:75], 0
ds_read_b64_tr_b16 a[28:29], v160 offset:8672
v_mfma_f32_16x16x32_bf16 v[144:147], a[32:35], a[40:43], 0
ds_read_b64_tr_b16 a[30:31], v160 offset:8928
v_mfma_f32_16x16x32_bf16 v[148:151], a[32:35], a[44:47], 0
v_mfma_f32_16x16x32_bf16 v[152:155], a[32:35], a[48:51], 0
s_add_u32 m0, s96, 103424
v_mfma_f32_16x16x32_bf16 v[156:159], a[32:35], a[52:55], 0
buffer_load_dwordx4 v172, s[48:51], s90 offen offset:0 lds
v_mfma_f32_16x16x32_bf16 v[224:227], a[32:35], a[72:75], 0
ds_read_b64_tr_b16 a[32:33], v163 offset:1024
ds_read_b64_tr_b16 a[34:35], v163 offset:1280
s_waitcnt lgkmcnt(6)
v_mfma_f32_16x16x32_bf16 v[16:19], a[0:3], a[56:59], v[16:19]
v_mfma_f32_16x16x32_bf16 v[20:23], a[0:3], a[60:63], v[20:23]
v_mfma_f32_16x16x32_bf16 v[24:27], a[0:3], a[64:67], v[24:27]
v_mfma_f32_16x16x32_bf16 v[28:31], a[0:3], a[68:71], v[28:31]
buffer_load_dwordx4 v173, s[48:51], s90 offen offset:1056 lds
v_mfma_f32_16x16x32_bf16 v[192:195], a[0:3], a[72:75], v[192:195]
v_mfma_f32_16x16x32_bf16 v[44:47], a[4:7], a[68:71], v[44:47]
v_mfma_f32_16x16x32_bf16 v[40:43], a[4:7], a[64:67], v[40:43]
v_mfma_f32_16x16x32_bf16 v[36:39], a[4:7], a[60:63], v[36:39]
buffer_load_dwordx4 v174, s[48:51], s90 offen offset:2112 lds
v_mfma_f32_16x16x32_bf16 v[32:35], a[4:7], a[56:59], v[32:35]
v_mfma_f32_16x16x32_bf16 v[196:199], a[4:7], a[72:75], v[196:199]
s_waitcnt vmcnt(7) lgkmcnt(0)
s_barrier
ds_read_b64_tr_b16 a[0:1], v161 offset:0
v_mfma_f32_16x16x32_bf16 v[48:51], a[8:11], a[56:59], v[48:51]
ds_read_b64_tr_b16 a[2:3], v161 offset:256
ds_read_b64_tr_b16 a[4:5], v161 offset:32
v_mfma_f32_16x16x32_bf16 v[52:55], a[8:11], a[60:63], v[52:55]
ds_read_b64_tr_b16 a[6:7], v161 offset:288
v_mfma_f32_16x16x32_bf16 v[56:59], a[8:11], a[64:67], v[56:59]
ds_read_b128 a[40:43], v168 offset:0
v_mfma_f32_16x16x32_bf16 v[60:63], a[8:11], a[68:71], v[60:63]
buffer_load_dwordx4 v175, s[48:51], s90 offen offset:3168 lds
v_mfma_f32_16x16x32_bf16 v[200:203], a[8:11], a[72:75], v[200:203]
ds_read_b64_tr_b16 a[8:9], v161 offset:64
v_mfma_f32_16x16x32_bf16 v[76:79], a[12:15], a[68:71], v[76:79]
ds_read_b64_tr_b16 a[10:11], v161 offset:320
v_mfma_f32_16x16x32_bf16 v[72:75], a[12:15], a[64:67], v[72:75]
s_add_u32 m0, s98, 107520
v_mfma_f32_16x16x32_bf16 v[68:71], a[12:15], a[60:63], v[68:71]
ds_read_b128 a[44:47], v168 offset:2048
v_mfma_f32_16x16x32_bf16 v[64:67], a[12:15], a[56:59], v[64:67]
buffer_load_dwordx4 v176, s[36:39], s93 offen offset:0 lds
v_mfma_f32_16x16x32_bf16 v[204:207], a[12:15], a[72:75], v[204:207]
ds_read_b64_tr_b16 a[12:13], v161 offset:96
v_mfma_f32_16x16x32_bf16 v[80:83], a[16:19], a[56:59], v[80:83]
ds_read_b64_tr_b16 a[14:15], v161 offset:352
v_mfma_f32_16x16x32_bf16 v[84:87], a[16:19], a[60:63], v[84:87]
v_mfma_f32_16x16x32_bf16 v[88:91], a[16:19], a[64:67], v[88:91]
ds_read_b128 a[48:51], v168 offset:4096
v_mfma_f32_16x16x32_bf16 v[92:95], a[16:19], a[68:71], v[92:95]
buffer_load_dwordx4 v177, s[36:39], s93 offen offset:1024 lds
v_mfma_f32_16x16x32_bf16 v[208:211], a[16:19], a[72:75], v[208:211]
ds_read_b64_tr_b16 a[16:17], v161 offset:128
s_waitcnt lgkmcnt(8)
v_mfma_f32_16x16x32_bf16 v[108:111], a[20:23], a[68:71], v[108:111]
ds_read_b64_tr_b16 a[18:19], v161 offset:384
v_mfma_f32_16x16x32_bf16 v[104:107], a[20:23], a[64:67], v[104:107]
buffer_load_dwordx4 v178, s[36:39], s93 offen offset:2048 lds
v_mfma_f32_16x16x32_bf16 v[100:103], a[20:23], a[60:63], v[100:103]
ds_read_b128 a[52:55], v168 offset:6144
v_mfma_f32_16x16x32_bf16 v[96:99], a[20:23], a[56:59], v[96:99]
v_mfma_f32_16x16x32_bf16 v[212:215], a[20:23], a[72:75], v[212:215]
ds_read_b64_tr_b16 a[20:21], v161 offset:160
v_mfma_f32_16x16x32_bf16 v[112:115], a[24:27], a[56:59], v[112:115]
ds_read_b64_tr_b16 a[22:23], v161 offset:416
v_mfma_f32_16x16x32_bf16 v[116:119], a[24:27], a[60:63], v[116:119]
buffer_load_dwordx4 v179, s[36:39], s93 offen offset:3072 lds
v_mfma_f32_16x16x32_bf16 v[120:123], a[24:27], a[64:67], v[120:123]
v_mfma_f32_16x16x32_bf16 v[124:127], a[24:27], a[68:71], v[124:127]
v_mfma_f32_16x16x32_bf16 v[216:219], a[24:27], a[72:75], v[216:219]
ds_read_b64_tr_b16 a[24:25], v161 offset:192
v_mfma_f32_16x16x32_bf16 v[140:143], a[28:31], a[68:71], v[140:143]
ds_read_b64_tr_b16 a[26:27], v161 offset:448
v_mfma_f32_16x16x32_bf16 v[136:139], a[28:31], a[64:67], v[136:139]
s_add_u32 m0, s97, 103424
s_mov_b32 exec_hi, 0
buffer_load_dwordx4 v180, s[56:59], s91 offen lds
s_mov_b32 exec_hi, -1
v_mfma_f32_16x16x32_bf16 v[132:135], a[28:31], a[60:63], v[132:135]
v_mfma_f32_16x16x32_bf16 v[128:131], a[28:31], a[56:59], v[128:131]
v_mfma_f32_16x16x32_bf16 v[220:223], a[28:31], a[72:75], v[220:223]
ds_read_b64_tr_b16 a[28:29], v161 offset:224
v_mfma_f32_16x16x32_bf16 v[144:147], a[32:35], a[56:59], v[144:147]
ds_read_b64_tr_b16 a[30:31], v161 offset:480
v_mfma_f32_16x16x32_bf16 v[148:151], a[32:35], a[60:63], v[148:151]
s_add_u32 s90, s90, 524288
v_mfma_f32_16x16x32_bf16 v[152:155], a[32:35], a[64:67], v[152:155]
s_and_b32 s90, s90, 0x3fffff
v_mfma_f32_16x16x32_bf16 v[156:159], a[32:35], a[68:71], v[156:159]
s_add_u32 s91, s91, 65536
v_mfma_f32_16x16x32_bf16 v[224:227], a[32:35], a[72:75], v[224:227]
ds_read_b64_tr_b16 a[32:33], v164 offset:0
ds_read_b64_tr_b16 a[34:35], v164 offset:256
s_waitcnt lgkmcnt(6)
v_mfma_f32_16x16x32_bf16 v[16:19], a[0:3], a[40:43], v[16:19]
s_and_b32 s91, s91, 0x7ffff
v_mfma_f32_16x16x32_bf16 v[20:23], a[0:3], a[44:47], v[20:23]
s_add_u32 s92, s92, 128
v_mfma_f32_16x16x32_bf16 v[24:27], a[0:3], a[48:51], v[24:27]
s_and_b32 s92, s92, 0xffffbbff
v_mfma_f32_16x16x32_bf16 v[28:31], a[0:3], a[52:55], v[28:31]
s_or_b32 s93, s92, 32768
s_cmp_eq_u32 s26, 1
s_cbranch_scc1 rexs_7
rexsb_8:
v_mfma_f32_16x16x32_bf16 v[192:195], a[0:3], a[72:75], v[192:195]
ds_read_b64_tr_b16 a[0:1], v161 offset:8448
v_mfma_f32_16x16x32_bf16 v[44:47], a[4:7], a[52:55], v[44:47]
ds_read_b64_tr_b16 a[2:3], v161 offset:8704
v_mfma_f32_16x16x32_bf16 v[40:43], a[4:7], a[48:51], v[40:43]
ds_read_b128 a[56:59], v169 offset:0
v_mfma_f32_16x16x32_bf16 v[36:39], a[4:7], a[44:47], v[36:39]
v_mfma_f32_16x16x32_bf16 v[32:35], a[4:7], a[40:43], v[32:35]
v_mfma_f32_16x16x32_bf16 v[196:199], a[4:7], a[72:75], v[196:199]
ds_read_b64_tr_b16 a[4:5], v161 offset:8480
v_mfma_f32_16x16x32_bf16 v[48:51], a[8:11], a[40:43], v[48:51]
ds_read_b64_tr_b16 a[6:7], v161 offset:8736
v_mfma_f32_16x16x32_bf16 v[52:55], a[8:11], a[44:47], v[52:55]
ds_read_b128 a[60:63], v169 offset:2048
v_mfma_f32_16x16x32_bf16 v[56:59], a[8:11], a[48:51], v[56:59]
v_mfma_f32_16x16x32_bf16 v[60:63], a[8:11], a[52:55], v[60:63]
v_mfma_f32_16x16x32_bf16 v[200:203], a[8:11], a[72:75], v[200:203]
ds_read_b64_tr_b16 a[8:9], v161 offset:8512
v_mfma_f32_16x16x32_bf16 v[76:79], a[12:15], a[52:55], v[76:79]
ds_read_b64_tr_b16 a[10:11], v161 offset:8768
v_mfma_f32_16x16x32_bf16 v[72:75], a[12:15], a[48:51], v[72:75]
ds_read_b128 a[64:67], v169 offset:4096
v_mfma_f32_16x16x32_bf16 v[68:71], a[12:15], a[44:47], v[68:71]
v_mfma_f32_16x16x32_bf16 v[64:67], a[12:15], a[40:43], v[64:67]
s_add_u32 m0, s98, 0
s_nop 0
buffer_load_dwordx4 v176, s[36:39], s92 offen offset:0 lds
v_mfma_f32_16x16x32_bf16 v[204:207], a[12:15], a[72:75], v[204:207]
ds_read_b64_tr_b16 a[12:13], v161 offset:8544
v_mfma_f32_16x16x32_bf16 v[80:83], a[16:19], a[40:43], v[80:83]
ds_read_b64_tr_b16 a[14:15], v161 offset:8800
v_mfma_f32_16x16x32_bf16 v[84:87], a[16:19], a[44:47], v[84:87]
ds_read_b128 a[68:71], v169 offset:6144
v_mfma_f32_16x16x32_bf16 v[88:91], a[16:19], a[48:51], v[88:91]
v_mfma_f32_16x16x32_bf16 v[92:95], a[16:19], a[52:55], v[92:95]
buffer_load_dwordx4 v177, s[36:39], s92 offen offset:1024 lds
v_mfma_f32_16x16x32_bf16 v[208:211], a[16:19], a[72:75], v[208:211]
ds_read_b64_tr_b16 a[16:17], v161 offset:8576
s_waitcnt lgkmcnt(8)
v_mfma_f32_16x16x32_bf16 v[108:111], a[20:23], a[52:55], v[108:111]
ds_read_b64_tr_b16 a[18:19], v161 offset:8832
v_mfma_f32_16x16x32_bf16 v[104:107], a[20:23], a[48:51], v[104:107]
v_mfma_f32_16x16x32_bf16 v[100:103], a[20:23], a[44:47], v[100:103]
v_mfma_f32_16x16x32_bf16 v[96:99], a[20:23], a[40:43], v[96:99]
buffer_load_dwordx4 v178, s[36:39], s92 offen offset:2048 lds
v_mfma_f32_16x16x32_bf16 v[212:215], a[20:23], a[72:75], v[212:215]
ds_read_b64_tr_b16 a[20:21], v161 offset:8608
v_mfma_f32_16x16x32_bf16 v[112:115], a[24:27], a[40:43], v[112:115]
ds_read_b64_tr_b16 a[22:23], v161 offset:8864
v_mfma_f32_16x16x32_bf16 v[116:119], a[24:27], a[44:47], v[116:119]
v_mfma_f32_16x16x32_bf16 v[120:123], a[24:27], a[48:51], v[120:123]
v_mfma_f32_16x16x32_bf16 v[124:127], a[24:27], a[52:55], v[124:127]
buffer_load_dwordx4 v179, s[36:39], s92 offen offset:3072 lds
v_mfma_f32_16x16x32_bf16 v[216:219], a[24:27], a[72:75], v[216:219]
ds_read_b64_tr_b16 a[24:25], v161 offset:8640
v_mfma_f32_16x16x32_bf16 v[140:143], a[28:31], a[52:55], v[140:143]
ds_read_b64_tr_b16 a[26:27], v161 offset:8896
v_mfma_f32_16x16x32_bf16 v[136:139], a[28:31], a[48:51], v[136:139]
v_mfma_f32_16x16x32_bf16 v[132:135], a[28:31], a[44:47], v[132:135]
v_mfma_f32_16x16x32_bf16 v[128:131], a[28:31], a[40:43], v[128:131]
s_add_u32 m0, s96, 0
v_mfma_f32_16x16x32_bf16 v[220:223], a[28:31], a[72:75], v[220:223]
ds_read_b64_tr_b16 a[28:29], v161 offset:8672
v_mfma_f32_16x16x32_bf16 v[144:147], a[32:35], a[40:43], v[144:147]
ds_read_b64_tr_b16 a[30:31], v161 offset:8928
v_mfma_f32_16x16x32_bf16 v[148:151], a[32:35], a[44:47], v[148:151]
buffer_load_dwordx4 v172, s[48:51], s90 offen offset:0 lds
v_mfma_f32_16x16x32_bf16 v[152:155], a[32:35], a[48:51], v[152:155]
v_mfma_f32_16x16x32_bf16 v[156:159], a[32:35], a[52:55], v[156:159]
v_mfma_f32_16x16x32_bf16 v[224:227], a[32:35], a[72:75], v[224:227]
ds_read_b64_tr_b16 a[32:33], v164 offset:1024
ds_read_b64_tr_b16 a[34:35], v164 offset:1280
s_waitcnt lgkmcnt(6)
v_mfma_f32_16x16x32_bf16 v[16:19], a[0:3], a[56:59], v[16:19]
buffer_load_dwordx4 v173, s[48:51], s90 offen offset:1056 lds
v_mfma_f32_16x16x32_bf16 v[20:23], a[0:3], a[60:63], v[20:23]
v_mfma_f32_16x16x32_bf16 v[24:27], a[0:3], a[64:67], v[24:27]
v_mfma_f32_16x16x32_bf16 v[28:31], a[0:3], a[68:71], v[28:31]
v_mfma_f32_16x16x32_bf16 v[192:195], a[0:3], a[72:75], v[192:195]
buffer_load_dwordx4 v174, s[48:51], s90 offen offset:2112 lds
v_mfma_f32_16x16x32_bf16 v[44:47], a[4:7], a[68:71], v[44:47]
v_mfma_f32_16x16x32_bf16 v[40:43], a[4:7], a[64:67], v[40:43]
v_mfma_f32_16x16x32_bf16 v[36:39], a[4:7], a[60:63], v[36:39]
v_mfma_f32_16x16x32_bf16 v[32:35], a[4:7], a[56:59], v[32:35]
v_mfma_f32_16x16x32_bf16 v[196:199], a[4:7], a[72:75], v[196:199]
s_waitcnt vmcnt(7) lgkmcnt(0)
s_barrier
ds_read_b64_tr_b16 a[0:1], v162 offset:0
v_mfma_f32_16x16x32_bf16 v[48:51], a[8:11], a[56:59], v[48:51]
ds_read_b64_tr_b16 a[2:3], v162 offset:256
ds_read_b64_tr_b16 a[4:5], v162 offset:32
v_mfma_f32_16x16x32_bf16 v[52:55], a[8:11], a[60:63], v[52:55]
ds_read_b64_tr_b16 a[6:7], v162 offset:288
buffer_load_dwordx4 v175, s[48:51], s90 offen offset:3168 lds
v_mfma_f32_16x16x32_bf16 v[56:59], a[8:11], a[64:67], v[56:59]
ds_read_b128 a[40:43], v170 offset:0
v_mfma_f32_16x16x32_bf16 v[60:63], a[8:11], a[68:71], v[60:63]
v_mfma_f32_16x16x32_bf16 v[200:203], a[8:11], a[72:75], v[200:203]
ds_read_b64_tr_b16 a[8:9], v162 offset:64
v_mfma_f32_16x16x32_bf16 v[76:79], a[12:15], a[68:71], v[76:79]
ds_read_b64_tr_b16 a[10:11], v162 offset:320
v_mfma_f32_16x16x32_bf16 v[72:75], a[12:15], a[64:67], v[72:75]
s_add_u32 m0, s98, 4096
v_mfma_f32_16x16x32_bf16 v[68:71], a[12:15], a[60:63], v[68:71]
ds_read_b128 a[44:47], v170 offset:2048
v_mfma_f32_16x16x32_bf16 v[64:67], a[12:15], a[56:59], v[64:67]
buffer_load_dwordx4 v176, s[36:39], s93 offen offset:0 lds
v_mfma_f32_16x16x32_bf16 v[204:207], a[12:15], a[72:75], v[204:207]
ds_read_b64_tr_b16 a[12:13], v162 offset:96
v_mfma_f32_16x16x32_bf16 v[80:83], a[16:19], a[56:59], v[80:83]
ds_read_b64_tr_b16 a[14:15], v162 offset:352
v_mfma_f32_16x16x32_bf16 v[84:87], a[16:19], a[60:63], v[84:87]
buffer_load_dwordx4 v177, s[36:39], s93 offen offset:1024 lds
v_mfma_f32_16x16x32_bf16 v[88:91], a[16:19], a[64:67], v[88:91]
ds_read_b128 a[48:51], v170 offset:4096
v_mfma_f32_16x16x32_bf16 v[92:95], a[16:19], a[68:71], v[92:95]
v_mfma_f32_16x16x32_bf16 v[208:211], a[16:19], a[72:75], v[208:211]
ds_read_b64_tr_b16 a[16:17], v162 offset:128
s_waitcnt lgkmcnt(8)
v_mfma_f32_16x16x32_bf16 v[108:111], a[20:23], a[68:71], v[108:111]
ds_read_b64_tr_b16 a[18:19], v162 offset:384
v_mfma_f32_16x16x32_bf16 v[104:107], a[20:23], a[64:67], v[104:107]
buffer_load_dwordx4 v178, s[36:39], s93 offen offset:2048 lds
v_mfma_f32_16x16x32_bf16 v[100:103], a[20:23], a[60:63], v[100:103]
ds_read_b128 a[52:55], v170 offset:6144
v_mfma_f32_16x16x32_bf16 v[96:99], a[20:23], a[56:59], v[96:99]
v_mfma_f32_16x16x32_bf16 v[212:215], a[20:23], a[72:75], v[212:215]
ds_read_b64_tr_b16 a[20:21], v162 offset:160
v_mfma_f32_16x16x32_bf16 v[112:115], a[24:27], a[56:59], v[112:115]
ds_read_b64_tr_b16 a[22:23], v162 offset:416
v_mfma_f32_16x16x32_bf16 v[116:119], a[24:27], a[60:63], v[116:119]
buffer_load_dwordx4 v179, s[36:39], s93 offen offset:3072 lds
v_mfma_f32_16x16x32_bf16 v[120:123], a[24:27], a[64:67], v[120:123]
v_mfma_f32_16x16x32_bf16 v[124:127], a[24:27], a[68:71], v[124:127]
v_mfma_f32_16x16x32_bf16 v[216:219], a[24:27], a[72:75], v[216:219]
ds_read_b64_tr_b16 a[24:25], v162 offset:192
v_mfma_f32_16x16x32_bf16 v[140:143], a[28:31], a[68:71], v[140:143]
ds_read_b64_tr_b16 a[26:27], v162 offset:448
v_mfma_f32_16x16x32_bf16 v[136:139], a[28:31], a[64:67], v[136:139]
s_add_u32 m0, s97, 0
s_mov_b32 exec_hi, 0
buffer_load_dwordx4 v180, s[56:59], s91 offen lds
s_mov_b32 exec_hi, -1
v_mfma_f32_16x16x32_bf16 v[132:135], a[28:31], a[60:63], v[132:135]
v_mfma_f32_16x16x32_bf16 v[128:131], a[28:31], a[56:59], v[128:131]
v_mfma_f32_16x16x32_bf16 v[220:223], a[28:31], a[72:75], v[220:223]
ds_read_b64_tr_b16 a[28:29], v162 offset:224
v_mfma_f32_16x16x32_bf16 v[144:147], a[32:35], a[56:59], v[144:147]
ds_read_b64_tr_b16 a[30:31], v162 offset:480
v_mfma_f32_16x16x32_bf16 v[148:151], a[32:35], a[60:63], v[148:151]
s_add_u32 s90, s90, 524288
v_mfma_f32_16x16x32_bf16 v[152:155], a[32:35], a[64:67], v[152:155]
s_and_b32 s90, s90, 0x3fffff
v_mfma_f32_16x16x32_bf16 v[156:159], a[32:35], a[68:71], v[156:159]
s_add_u32 s91, s91, 65536
v_mfma_f32_16x16x32_bf16 v[224:227], a[32:35], a[72:75], v[224:227]
ds_read_b64_tr_b16 a[32:33], v165 offset:0
ds_read_b64_tr_b16 a[34:35], v165 offset:256
s_waitcnt lgkmcnt(6)
v_mfma_f32_16x16x32_bf16 v[16:19], a[0:3], a[40:43], v[16:19]
s_and_b32 s91, s91, 0x7ffff
v_mfma_f32_16x16x32_bf16 v[20:23], a[0:3], a[44:47], v[20:23]
s_add_u32 s92, s92, 128
v_mfma_f32_16x16x32_bf16 v[24:27], a[0:3], a[48:51], v[24:27]
s_and_b32 s92, s92, 0xffffbbff
s_or_b32 s93, s92, 32768
v_mfma_f32_16x16x32_bf16 v[28:31], a[0:3], a[52:55], v[28:31]
ds_read_b64_tr_b16 a[0:1], v162 offset:8448
s_add_u32 m0, s98, 51712
v_mfma_f32_16x16x32_bf16 v[44:47], a[4:7], a[52:55], v[44:47]
ds_read_b64_tr_b16 a[2:3], v162 offset:8704
buffer_load_dwordx4 v176, s[36:39], s92 offen offset:0 lds
s_cmp_eq_u32 s26, 2
s_cbranch_scc1 rexs_9
rexsb_10:
v_mfma_f32_16x16x32_bf16 v[40:43], a[4:7], a[48:51], v[40:43]
ds_read_b128 a[56:59], v171 offset:0
v_mfma_f32_16x16x32_bf16 v[36:39], a[4:7], a[44:47], v[36:39]
buffer_load_dwordx4 v177, s[36:39], s92 offen offset:1024 lds
s_lshl_b32 s88, s5, 3
v_mfma_f32_16x16x32_bf16 v[32:35], a[4:7], a[40:43], v[32:35]
ds_read_b64_tr_b16 a[4:5], v162 offset:8480
v_mfma_f32_16x16x32_bf16 v[48:51], a[8:11], a[40:43], v[48:51]
ds_read_b64_tr_b16 a[6:7], v162 offset:8736
v_mfma_f32_16x16x32_bf16 v[52:55], a[8:11], a[44:47], v[52:55]
ds_read_b128 a[60:63], v171 offset:2048
v_mfma_f32_16x16x32_bf16 v[56:59], a[8:11], a[48:51], v[56:59]
buffer_load_dwordx4 v178, s[36:39], s92 offen offset:2048 lds
s_add_u32 s88, s88, s4
v_mfma_f32_16x16x32_bf16 v[60:63], a[8:11], a[52:55], v[60:63]
ds_read_b64_tr_b16 a[8:9], v162 offset:8512
s_mul_i32 s88, s88, 576
v_mfma_f32_16x16x32_bf16 v[76:79], a[12:15], a[52:55], v[76:79]
ds_read_b64_tr_b16 a[10:11], v162 offset:8768
v_mfma_f32_16x16x32_bf16 v[72:75], a[12:15], a[48:51], v[72:75]
ds_read_b128 a[64:67], v171 offset:4096
v_mfma_f32_16x16x32_bf16 v[68:71], a[12:15], a[44:47], v[68:71]
buffer_load_dwordx4 v179, s[36:39], s92 offen offset:3072 lds
s_add_u32 s88, s88, 262144
s_cmp_lg_u32 s3, 0
s_cbranch_scc1 recsk_11
s_mov_b32 exec_lo, 0x10001
s_mov_b32 exec_hi, 0x10001
buffer_store_dwordx4 v[192:195], v0, s[76:79], s88 offen offset:0 sc1
buffer_store_dwordx4 v[196:199], v0, s[76:79], s88 offen offset:64 sc1
buffer_store_dwordx4 v[200:203], v0, s[76:79], s88 offen offset:128 sc1
buffer_store_dwordx4 v[204:207], v0, s[76:79], s88 offen offset:192 sc1
buffer_store_dwordx4 v[208:211], v0, s[76:79], s88 offen offset:256 sc1
buffer_store_dwordx4 v[212:215], v0, s[76:79], s88 offen offset:320 sc1
buffer_store_dwordx4 v[216:219], v0, s[76:79], s88 offen offset:384 sc1
buffer_store_dwordx4 v[220:223], v0, s[76:79], s88 offen offset:448 sc1
buffer_store_dwordx4 v[224:227], v0, s[76:79], s88 offen offset:512 sc1
s_mov_b64 exec, -1
recsk_11:
v_mfma_f32_16x16x32_bf16 v[64:67], a[12:15], a[40:43], v[64:67]
ds_read_b64_tr_b16 a[12:13], v162 offset:8544
v_mfma_f32_16x16x32_bf16 v[80:83], a[16:19], a[40:43], v[80:83]
ds_read_b64_tr_b16 a[14:15], v162 offset:8800
v_mfma_f32_16x16x32_bf16 v[84:87], a[16:19], a[44:47], v[84:87]
ds_read_b128 a[68:71], v171 offset:6144
v_mfma_f32_16x16x32_bf16 v[88:91], a[16:19], a[48:51], v[88:91]
s_add_u32 m0, s96, 51712
s_nop 0
buffer_load_dwordx4 v172, s[48:51], s90 offen offset:0 lds
v_mfma_f32_16x16x32_bf16 v[92:95], a[16:19], a[52:55], v[92:95]
ds_read_b64_tr_b16 a[16:17], v162 offset:8576
s_waitcnt lgkmcnt(8)
v_mfma_f32_16x16x32_bf16 v[108:111], a[20:23], a[52:55], v[108:111]
ds_read_b64_tr_b16 a[18:19], v162 offset:8832
v_mfma_f32_16x16x32_bf16 v[104:107], a[20:23], a[48:51], v[104:107]
buffer_load_dwordx4 v173, s[48:51], s90 offen offset:1056 lds
v_mfma_f32_16x16x32_bf16 v[100:103], a[20:23], a[44:47], v[100:103]
v_and_b32 v248, 3, v0
v_mfma_f32_16x16x32_bf16 v[96:99], a[20:23], a[40:43], v[96:99]
ds_read_b64_tr_b16 a[20:21], v162 offset:8608
v_mfma_f32_16x16x32_bf16 v[112:115], a[24:27], a[40:43], v[112:115]
ds_read_b64_tr_b16 a[22:23], v162 offset:8864
v_mfma_f32_16x16x32_bf16 v[116:119], a[24:27], a[44:47], v[116:119]
v_lshlrev_b32 v248, 2, v248
v_mfma_f32_16x16x32_bf16 v[120:123], a[24:27], a[48:51], v[120:123]
buffer_load_dwordx4 v174, s[48:51], s90 offen offset:2112 lds
buffer_load_dword v247, v248, s[84:87], 0 offen sc1
v_mfma_f32_16x16x32_bf16 v[124:127], a[24:27], a[52:55], v[124:127]
ds_read_b64_tr_b16 a[24:25], v162 offset:8640
v_mfma_f32_16x16x32_bf16 v[140:143], a[28:31], a[52:55], v[140:143]
ds_read_b64_tr_b16 a[26:27], v162 offset:8896
v_mfma_f32_16x16x32_bf16 v[136:139], a[28:31], a[48:51], v[136:139]
buffer_load_dwordx4 v175, s[48:51], s90 offen offset:3168 lds
v_mfma_f32_16x16x32_bf16 v[132:135], a[28:31], a[44:47], v[132:135]
v_mfma_f32_16x16x32_bf16 v[128:131], a[28:31], a[40:43], v[128:131]
ds_read_b64_tr_b16 a[28:29], v162 offset:8672
v_mfma_f32_16x16x32_bf16 v[144:147], a[32:35], a[40:43], v[144:147]
ds_read_b64_tr_b16 a[30:31], v162 offset:8928
v_mfma_f32_16x16x32_bf16 v[148:151], a[32:35], a[44:47], v[148:151]
s_add_u32 m0, s98, 55808
v_mfma_f32_16x16x32_bf16 v[152:155], a[32:35], a[48:51], v[152:155]
buffer_load_dwordx4 v176, s[36:39], s93 offen offset:0 lds
v_mfma_f32_16x16x32_bf16 v[156:159], a[32:35], a[52:55], v[156:159]
ds_read_b64_tr_b16 a[32:33], v165 offset:1024
ds_read_b64_tr_b16 a[34:35], v165 offset:1280
s_waitcnt lgkmcnt(6)
v_mfma_f32_16x16x32_bf16 v[16:19], a[0:3], a[56:59], v[16:19]
buffer_load_dwordx4 v177, s[36:39], s93 offen offset:1024 lds
v_mfma_f32_16x16x32_bf16 v[20:23], a[0:3], a[60:63], v[20:23]
s_lshl_b32 s88, s27, 4
v_mfma_f32_16x16x32_bf16 v[24:27], a[0:3], a[64:67], v[24:27]
buffer_store_dwordx2 v[242:243], v246, s[76:79], s88 offen sc1
v_mfma_f32_16x16x32_bf16 v[28:31], a[0:3], a[68:71], v[28:31]
v_mfma_f32_16x16x32_bf16 v[44:47], a[4:7], a[68:71], v[44:47]
buffer_load_dwordx4 v178, s[36:39], s93 offen offset:2048 lds
v_mfma_f32_16x16x32_bf16 v[40:43], a[4:7], a[64:67], v[40:43]
v_mfma_f32_16x16x32_bf16 v[36:39], a[4:7], a[60:63], v[36:39]
v_mfma_f32_16x16x32_bf16 v[32:35], a[4:7], a[56:59], v[32:35]
s_waitcnt vmcnt(13) lgkmcnt(0)
s_barrier
ds_read_b64_tr_b16 a[0:1], v160 offset:0
v_mfma_f32_16x16x32_bf16 v[48:51], a[8:11], a[56:59], v[48:51]
ds_read_b64_tr_b16 a[2:3], v160 offset:256
ds_read_b64_tr_b16 a[4:5], v160 offset:32
v_mfma_f32_16x16x32_bf16 v[52:55], a[8:11], a[60:63], v[52:55]
ds_read_b64_tr_b16 a[6:7], v160 offset:288
buffer_load_dwordx4 v179, s[36:39], s93 offen offset:3072 lds
v_mfma_f32_16x16x32_bf16 v[56:59], a[8:11], a[64:67], v[56:59]
ds_read_b128 a[40:43], v166 offset:0
v_mfma_f32_16x16x32_bf16 v[60:63], a[8:11], a[68:71], v[60:63]
ds_read_b64_tr_b16 a[8:9], v160 offset:64
v_mfma_f32_16x16x32_bf16 v[76:79], a[12:15], a[68:71], v[76:79]
ds_read_b64_tr_b16 a[10:11], v160 offset:320
v_mfma_f32_16x16x32_bf16 v[72:75], a[12:15], a[64:67], v[72:75]
s_add_u32 m0, s97, 51712
s_mov_b32 exec_hi, 0
buffer_load_dwordx4 v180, s[56:59], s91 offen lds
s_mov_b32 exec_hi, -1
v_mfma_f32_16x16x32_bf16 v[68:71], a[12:15], a[60:63], v[68:71]
ds_read_b128 a[44:47], v166 offset:2048
v_mfma_f32_16x16x32_bf16 v[64:67], a[12:15], a[56:59], v[64:67]
ds_read_b64_tr_b16 a[12:13], v160 offset:96
v_mfma_f32_16x16x32_bf16 v[80:83], a[16:19], a[56:59], v[80:83]
ds_read_b64_tr_b16 a[14:15], v160 offset:352
v_mfma_f32_16x16x32_bf16 v[84:87], a[16:19], a[60:63], v[84:87]
s_add_u32 s90, s90, 524288
s_and_b32 s90, s90, 0x3fffff
v_mfma_f32_16x16x32_bf16 v[88:91], a[16:19], a[64:67], v[88:91]
ds_read_b128 a[48:51], v166 offset:4096
s_add_u32 s91, s91, 65536
v_mfma_f32_16x16x32_bf16 v[92:95], a[16:19], a[68:71], v[92:95]
ds_read_b64_tr_b16 a[16:17], v160 offset:128
s_and_b32 s91, s91, 0x7ffff
s_waitcnt lgkmcnt(8)
v_mfma_f32_16x16x32_bf16 v[108:111], a[20:23], a[68:71], v[108:111]
ds_read_b64_tr_b16 a[18:19], v160 offset:384
v_mfma_f32_16x16x32_bf16 v[104:107], a[20:23], a[64:67], v[104:107]
s_add_u32 s92, s92, 128
s_and_b32 s92, s92, 0xffffbbff
v_mfma_f32_16x16x32_bf16 v[100:103], a[20:23], a[60:63], v[100:103]
ds_read_b128 a[52:55], v166 offset:6144
s_or_b32 s93, s92, 32768
v_mfma_f32_16x16x32_bf16 v[96:99], a[20:23], a[56:59], v[96:99]
ds_read_b64_tr_b16 a[20:21], v160 offset:160
s_add_u32 m0, s98, 103424
v_mfma_f32_16x16x32_bf16 v[112:115], a[24:27], a[56:59], v[112:115]
ds_read_b64_tr_b16 a[22:23], v160 offset:416
buffer_load_dwordx4 v176, s[36:39], s92 offen offset:0 lds
v_mfma_f32_16x16x32_bf16 v[116:119], a[24:27], a[60:63], v[116:119]
buffer_load_dwordx4 v177, s[36:39], s92 offen offset:1024 lds
v_mfma_f32_16x16x32_bf16 v[120:123], a[24:27], a[64:67], v[120:123]
v_mfma_f32_16x16x32_bf16 v[124:127], a[24:27], a[68:71], v[124:127]
ds_read_b64_tr_b16 a[24:25], v160 offset:192
v_mfma_f32_16x16x32_bf16 v[140:143], a[28:31], a[68:71], v[140:143]
ds_read_b64_tr_b16 a[26:27], v160 offset:448
v_mfma_f32_16x16x32_bf16 v[136:139], a[28:31], a[64:67], v[136:139]
buffer_load_dwordx4 v178, s[36:39], s92 offen offset:2048 lds
v_mfma_f32_16x16x32_bf16 v[132:135], a[28:31], a[60:63], v[132:135]
s_lshr_b32 s88, s2, 6
s_waitcnt vmcnt(10)
v_cmp_eq_u32 vcc, 0, v247
s_cbranch_vccnz reslow_12
reback_13:
v_readlane_b32 s8, v247, s88
v_mfma_f32_16x16x32_bf16 v[128:131], a[28:31], a[56:59], v[128:131]
ds_read_b64_tr_b16 a[28:29], v160 offset:224
v_mfma_f32_16x16x32_bf16 v[144:147], a[32:35], a[56:59], v[144:147]
ds_read_b64_tr_b16 a[30:31], v160 offset:480
v_mfma_f32_16x16x32_bf16 v[148:151], a[32:35], a[60:63], v[148:151]
buffer_load_dwordx4 v179, s[36:39], s92 offen offset:3072 lds
v_mfma_f32_16x16x32_bf16 v[152:155], a[32:35], a[64:67], v[152:155]
v_mfma_f32_16x16x32_bf16 v[156:159], a[32:35], a[68:71], v[156:159]
ds_read_b64_tr_b16 a[32:33], v163 offset:0
ds_read_b64_tr_b16 a[34:35], v163 offset:256
s_waitcnt lgkmcnt(6)
v_mfma_f32_16x16x32_bf16 v[16:19], a[0:3], a[40:43], v[16:19]
s_add_u32 m0, s96, 103424
v_mfma_f32_16x16x32_bf16 v[20:23], a[0:3], a[44:47], v[20:23]
buffer_load_dwordx4 v172, s[48:51], s90 offen offset:0 lds
v_mfma_f32_16x16x32_bf16 v[24:27], a[0:3], a[48:51], v[24:27]
s_cmp_eq_u32 s26, 3
s_cbranch_scc1 rexs_15
rexsb_16:
v_mfma_f32_16x16x32_bf16 v[28:31], a[0:3], a[52:55], v[28:31]
ds_read_b64_tr_b16 a[0:1], v160 offset:8448
v_mfma_f32_16x16x32_bf16 v[44:47], a[4:7], a[52:55], v[44:47]
ds_read_b64_tr_b16 a[2:3], v160 offset:8704
v_mfma_f32_16x16x32_bf16 v[40:43], a[4:7], a[48:51], v[40:43]
ds_read_b128 a[56:59], v167 offset:0
v_mfma_f32_16x16x32_bf16 v[36:39], a[4:7], a[44:47], v[36:39]
buffer_load_dwordx4 v173, s[48:51], s90 offen offset:1056 lds
v_mfma_f32_16x16x32_bf16 v[32:35], a[4:7], a[40:43], v[32:35]
ds_read_b64_tr_b16 a[4:5], v160 offset:8480
v_mfma_f32_16x16x32_bf16 v[48:51], a[8:11], a[40:43], v[48:51]
ds_read_b64_tr_b16 a[6:7], v160 offset:8736
v_mfma_f32_16x16x32_bf16 v[52:55], a[8:11], a[44:47], v[52:55]
ds_read_b128 a[60:63], v167 offset:2048
v_mfma_f32_16x16x32_bf16 v[56:59], a[8:11], a[48:51], v[56:59]
buffer_load_dwordx4 v174, s[48:51], s90 offen offset:2112 lds
v_mfma_f32_16x16x32_bf16 v[60:63], a[8:11], a[52:55], v[60:63]
ds_read_b64_tr_b16 a[8:9], v160 offset:8512
v_mfma_f32_16x16x32_bf16 v[76:79], a[12:15], a[52:55], v[76:79]
ds_read_b64_tr_b16 a[10:11], v160 offset:8768
v_mfma_f32_16x16x32_bf16 v[72:75], a[12:15], a[48:51], v[72:75]
ds_read_b128 a[64:67], v167 offset:4096
v_mfma_f32_16x16x32_bf16 v[68:71], a[12:15], a[44:47], v[68:71]
buffer_load_dwordx4 v175, s[48:51], s90 offen offset:3168 lds
v_mfma_f32_16x16x32_bf16 v[64:67], a[12:15], a[40:43], v[64:67]
ds_read_b64_tr_b16 a[12:13], v160 offset:8544
v_mfma_f32_16x16x32_bf16 v[80:83], a[16:19], a[40:43], v[80:83]
ds_read_b64_tr_b16 a[14:15], v160 offset:8800
v_mfma_f32_16x16x32_bf16 v[84:87], a[16:19], a[44:47], v[84:87]
ds_read_b128 a[68:71], v167 offset:6144
v_mfma_f32_16x16x32_bf16 v[88:91], a[16:19], a[48:51], v[88:91]
s_add_u32 m0, s98, 107520
s_nop 0
buffer_load_dwordx4 v176, s[36:39], s93 offen offset:0 lds
v_mfma_f32_16x16x32_bf16 v[92:95], a[16:19], a[52:55], v[92:95]
ds_read_b64_tr_b16 a[16:17], v160 offset:8576
s_waitcnt lgkmcnt(8)
v_mfma_f32_16x16x32_bf16 v[108:111], a[20:23], a[52:55], v[108:111]
ds_read_b64_tr_b16 a[18:19], v160 offset:8832
v_mfma_f32_16x16x32_bf16 v[104:107], a[20:23], a[48:51], v[104:107]
buffer_load_dwordx4 v177, s[36:39], s93 offen offset:1024 lds
v_mfma_f32_16x16x32_bf16 v[100:103], a[20:23], a[44:47], v[100:103]
v_mfma_f32_16x16x32_bf16 v[96:99], a[20:23], a[40:43], v[96:99]
ds_read_b64_tr_b16 a[20:21], v160 offset:8608
v_mfma_f32_16x16x32_bf16 v[112:115], a[24:27], a[40:43], v[112:115]
ds_read_b64_tr_b16 a[22:23], v160 offset:8864
v_mfma_f32_16x16x32_bf16 v[116:119], a[24:27], a[44:47], v[116:119]
buffer_load_dwordx4 v178, s[36:39], s93 offen offset:2048 lds
v_mfma_f32_16x16x32_bf16 v[120:123], a[24:27], a[48:51], v[120:123]
v_mfma_f32_16x16x32_bf16 v[124:127], a[24:27], a[52:55], v[124:127]
ds_read_b64_tr_b16 a[24:25], v160 offset:8640
v_mfma_f32_16x16x32_bf16 v[140:143], a[28:31], a[52:55], v[140:143]
ds_read_b64_tr_b16 a[26:27], v160 offset:8896
v_mfma_f32_16x16x32_bf16 v[136:139], a[28:31], a[48:51], v[136:139]
v_mfma_f32_16x16x32_bf16 v[132:135], a[28:31], a[44:47], v[132:135]
buffer_load_dwordx4 v179, s[36:39], s93 offen offset:3072 lds
v_mov_b32 v14, s8
s_lshl_b32 s100, s2, 5
s_add_u32 s100, s100, s3
s_lshl_b32 s100, s100, 2
s_add_u32 s100, s100, 131136
s_waitcnt vmcnt(15)
s_mov_b64 exec, 1
buffer_store_dword v14, off, s[76:79], s100 sc1
s_mov_b64 exec, -1
v_mfma_f32_16x16x32_bf16 v[128:131], a[28:31], a[40:43], v[128:131]
ds_read_b64_tr_b16 a[28:29], v160 offset:8672
v_mfma_f32_16x16x32_bf16 v[144:147], a[32:35], a[40:43], v[144:147]
ds_read_b64_tr_b16 a[30:31], v160 offset:8928
v_mfma_f32_16x16x32_bf16 v[148:151], a[32:35], a[44:47], v[148:151]
v_mfma_f32_16x16x32_bf16 v[152:155], a[32:35], a[48:51], v[152:155]
s_add_u32 m0, s97, 103424
s_mov_b32 exec_hi, 0
buffer_load_dwordx4 v180, s[56:59], s91 offen lds
s_mov_b32 exec_hi, -1
v_mfma_f32_16x16x32_bf16 v[156:159], a[32:35], a[52:55], v[156:159]
ds_read_b64_tr_b16 a[32:33], v163 offset:1024
ds_read_b64_tr_b16 a[34:35], v163 offset:1280
s_waitcnt lgkmcnt(6)
v_mfma_f32_16x16x32_bf16 v[16:19], a[0:3], a[56:59], v[16:19]
v_mfma_f32_16x16x32_bf16 v[20:23], a[0:3], a[60:63], v[20:23]
v_mfma_f32_16x16x32_bf16 v[24:27], a[0:3], a[64:67], v[24:27]
s_add_u32 s90, s90, 524288
v_mfma_f32_16x16x32_bf16 v[28:31], a[0:3], a[68:71], v[28:31]
s_and_b32 s90, s90, 0x3fffff
v_mfma_f32_16x16x32_bf16 v[44:47], a[4:7], a[68:71], v[44:47]
s_add_u32 s91, s91, 65536
v_mfma_f32_16x16x32_bf16 v[40:43], a[4:7], a[64:67], v[40:43]
s_and_b32 s91, s91, 0x7ffff
v_mfma_f32_16x16x32_bf16 v[36:39], a[4:7], a[60:63], v[36:39]
s_add_u32 s92, s92, 128
s_and_b32 s92, s92, 0xffffbbff
s_or_b32 s93, s92, 32768
v_mfma_f32_16x16x32_bf16 v[32:35], a[4:7], a[56:59], v[32:35]
s_waitcnt vmcnt(14) lgkmcnt(0)
s_barrier
ds_read_b64_tr_b16 a[0:1], v161 offset:0
v_mfma_f32_16x16x32_bf16 v[48:51], a[8:11], a[56:59], v[48:51]
ds_read_b64_tr_b16 a[2:3], v161 offset:256
ds_read_b64_tr_b16 a[4:5], v161 offset:32
v_mfma_f32_16x16x32_bf16 v[52:55], a[8:11], a[60:63], v[52:55]
ds_read_b64_tr_b16 a[6:7], v161 offset:288
s_add_u32 m0, s98, 0
v_mfma_f32_16x16x32_bf16 v[56:59], a[8:11], a[64:67], v[56:59]
ds_read_b128 a[40:43], v168 offset:0
buffer_load_dwordx4 v176, s[36:39], s92 offen offset:0 lds
v_mfma_f32_16x16x32_bf16 v[60:63], a[8:11], a[68:71], v[60:63]
ds_read_b64_tr_b16 a[8:9], v161 offset:64
v_mfma_f32_16x16x32_bf16 v[76:79], a[12:15], a[68:71], v[76:79]
ds_read_b64_tr_b16 a[10:11], v161 offset:320
v_mfma_f32_16x16x32_bf16 v[72:75], a[12:15], a[64:67], v[72:75]
buffer_load_dwordx4 v177, s[36:39], s92 offen offset:1024 lds
v_mfma_f32_16x16x32_bf16 v[68:71], a[12:15], a[60:63], v[68:71]
ds_read_b128 a[44:47], v168 offset:2048
v_mfma_f32_16x16x32_bf16 v[64:67], a[12:15], a[56:59], v[64:67]
ds_read_b64_tr_b16 a[12:13], v161 offset:96
v_mfma_f32_16x16x32_bf16 v[80:83], a[16:19], a[56:59], v[80:83]
ds_read_b64_tr_b16 a[14:15], v161 offset:352
v_mfma_f32_16x16x32_bf16 v[84:87], a[16:19], a[60:63], v[84:87]
v_mfma_f32_16x16x32_bf16 v[88:91], a[16:19], a[64:67], v[88:91]
ds_read_b128 a[48:51], v168 offset:4096
buffer_load_dwordx4 v178, s[36:39], s92 offen offset:2048 lds
v_mfma_f32_16x16x32_bf16 v[92:95], a[16:19], a[68:71], v[92:95]
ds_read_b64_tr_b16 a[16:17], v161 offset:128
s_waitcnt lgkmcnt(8)
v_mfma_f32_16x16x32_bf16 v[108:111], a[20:23], a[68:71], v[108:111]
ds_read_b64_tr_b16 a[18:19], v161 offset:384
v_mfma_f32_16x16x32_bf16 v[104:107], a[20:23], a[64:67], v[104:107]
v_mfma_f32_16x16x32_bf16 v[100:103], a[20:23], a[60:63], v[100:103]
ds_read_b128 a[52:55], v168 offset:6144
v_mfma_f32_16x16x32_bf16 v[96:99], a[20:23], a[56:59], v[96:99]
ds_read_b64_tr_b16 a[20:21], v161 offset:160
v_mfma_f32_16x16x32_bf16 v[112:115], a[24:27], a[56:59], v[112:115]
ds_read_b64_tr_b16 a[22:23], v161 offset:416
v_mfma_f32_16x16x32_bf16 v[116:119], a[24:27], a[60:63], v[116:119]
buffer_load_dwordx4 v179, s[36:39], s92 offen offset:3072 lds
v_mfma_f32_16x16x32_bf16 v[120:123], a[24:27], a[64:67], v[120:123]
v_mfma_f32_16x16x32_bf16 v[124:127], a[24:27], a[68:71], v[124:127]
ds_read_b64_tr_b16 a[24:25], v161 offset:192
v_mfma_f32_16x16x32_bf16 v[140:143], a[28:31], a[68:71], v[140:143]
ds_read_b64_tr_b16 a[26:27], v161 offset:448
v_mfma_f32_16x16x32_bf16 v[136:139], a[28:31], a[64:67], v[136:139]
s_add_u32 m0, s96, 0
v_mfma_f32_16x16x32_bf16 v[132:135], a[28:31], a[60:63], v[132:135]
buffer_load_dwordx4 v172, s[48:51], s90 offen offset:0 lds
v_mfma_f32_16x16x32_bf16 v[128:131], a[28:31], a[56:59], v[128:131]
ds_read_b64_tr_b16 a[28:29], v161 offset:224
v_mfma_f32_16x16x32_bf16 v[144:147], a[32:35], a[56:59], v[144:147]
ds_read_b64_tr_b16 a[30:31], v161 offset:480
v_mfma_f32_16x16x32_bf16 v[148:151], a[32:35], a[60:63], v[148:151]
buffer_load_dwordx4 v173, s[48:51], s90 offen offset:1056 lds
v_mfma_f32_16x16x32_bf16 v[152:155], a[32:35], a[64:67], v[152:155]
v_mfma_f32_16x16x32_bf16 v[156:159], a[32:35], a[68:71], v[156:159]
ds_read_b64_tr_b16 a[32:33], v164 offset:0
ds_read_b64_tr_b16 a[34:35], v164 offset:256
s_waitcnt lgkmcnt(6)
v_mfma_f32_16x16x32_bf16 v[16:19], a[0:3], a[40:43], v[16:19]
v_mfma_f32_16x16x32_bf16 v[20:23], a[0:3], a[44:47], v[20:23]
v_mfma_f32_16x16x32_bf16 v[24:27], a[0:3], a[48:51], v[24:27]
buffer_load_dwordx4 v174, s[48:51], s90 offen offset:2112 lds
s_cmp_eq_u32 s26, 4
s_cbranch_scc1 rexs_17
rexsb_18:
v_mfma_f32_16x16x32_bf16 v[28:31], a[0:3], a[52:55], v[28:31]
ds_read_b64_tr_b16 a[0:1], v161 offset:8448
v_mfma_f32_16x16x32_bf16 v[44:47], a[4:7], a[52:55], v[44:47]
ds_read_b64_tr_b16 a[2:3], v161 offset:8704
v_mfma_f32_16x16x32_bf16 v[40:43], a[4:7], a[48:51], v[40:43]
ds_read_b128 a[56:59], v169 offset:0
v_mfma_f32_16x16x32_bf16 v[36:39], a[4:7], a[44:47], v[36:39]
v_mfma_f32_16x16x32_bf16 v[32:35], a[4:7], a[40:43], v[32:35]
ds_read_b64_tr_b16 a[4:5], v161 offset:8480
buffer_load_dwordx4 v175, s[48:51], s90 offen offset:3168 lds
v_mfma_f32_16x16x32_bf16 v[48:51], a[8:11], a[40:43], v[48:51]
ds_read_b64_tr_b16 a[6:7], v161 offset:8736
v_mfma_f32_16x16x32_bf16 v[52:55], a[8:11], a[44:47], v[52:55]
ds_read_b128 a[60:63], v169 offset:2048
v_mfma_f32_16x16x32_bf16 v[56:59], a[8:11], a[48:51], v[56:59]
v_mfma_f32_16x16x32_bf16 v[60:63], a[8:11], a[52:55], v[60:63]
ds_read_b64_tr_b16 a[8:9], v161 offset:8512
v_mfma_f32_16x16x32_bf16 v[76:79], a[12:15], a[52:55], v[76:79]
ds_read_b64_tr_b16 a[10:11], v161 offset:8768
v_mfma_f32_16x16x32_bf16 v[72:75], a[12:15], a[48:51], v[72:75]
ds_read_b128 a[64:67], v169 offset:4096
v_mfma_f32_16x16x32_bf16 v[68:71], a[12:15], a[44:47], v[68:71]
s_add_u32 m0, s98, 4096
s_nop 0
buffer_load_dwordx4 v176, s[36:39], s93 offen offset:0 lds
v_mfma_f32_16x16x32_bf16 v[64:67], a[12:15], a[40:43], v[64:67]
ds_read_b64_tr_b16 a[12:13], v161 offset:8544
v_mfma_f32_16x16x32_bf16 v[80:83], a[16:19], a[40:43], v[80:83]
ds_read_b64_tr_b16 a[14:15], v161 offset:8800
v_mfma_f32_16x16x32_bf16 v[84:87], a[16:19], a[44:47], v[84:87]
ds_read_b128 a[68:71], v169 offset:6144
v_mfma_f32_16x16x32_bf16 v[88:91], a[16:19], a[48:51], v[88:91]
v_bfe_u32 v15, v0, 2, 3
buffer_load_dwordx4 v177, s[36:39], s93 offen offset:1024 lds
v_mfma_f32_16x16x32_bf16 v[92:95], a[16:19], a[52:55], v[92:95]
ds_read_b64_tr_b16 a[16:17], v161 offset:8576
s_and_b32 s88, s2, 31
s_waitcnt lgkmcnt(8)
v_mfma_f32_16x16x32_bf16 v[108:111], a[20:23], a[52:55], v[108:111]
ds_read_b64_tr_b16 a[18:19], v161 offset:8832
v_mfma_f32_16x16x32_bf16 v[104:107], a[20:23], a[48:51], v[104:107]
v_lshl_add_u32 v14, v15, 5, s88
v_mfma_f32_16x16x32_bf16 v[100:103], a[20:23], a[44:47], v[100:103]
s_lshl_b32 s88, s3, 1
s_lshl_b32 s89, s4, 5
v_mfma_f32_16x16x32_bf16 v[96:99], a[20:23], a[40:43], v[96:99]
ds_read_b64_tr_b16 a[20:21], v161 offset:8608
buffer_load_dwordx4 v178, s[36:39], s93 offen offset:2048 lds
v_mfma_f32_16x16x32_bf16 v[112:115], a[24:27], a[40:43], v[112:115]
ds_read_b64_tr_b16 a[22:23], v161 offset:8864
v_mfma_f32_16x16x32_bf16 v[116:119], a[24:27], a[44:47], v[116:119]
s_add_u32 s88, s88, s89
v_mfma_f32_16x16x32_bf16 v[120:123], a[24:27], a[48:51], v[120:123]
v_lshrrev_b32 v252, 2, v15
v_and_b32 v15, 3, v15
v_mfma_f32_16x16x32_bf16 v[124:127], a[24:27], a[52:55], v[124:127]
ds_read_b64_tr_b16 a[24:25], v161 offset:8640
v_lshlrev_b32 v15, 3, v15
v_mfma_f32_16x16x32_bf16 v[140:143], a[28:31], a[52:55], v[140:143]
ds_read_b64_tr_b16 a[26:27], v161 offset:8896
v_mfma_f32_16x16x32_bf16 v[136:139], a[28:31], a[48:51], v[136:139]
buffer_load_dwordx4 v179, s[36:39], s93 offen offset:3072 lds
v_mfma_f32_16x16x32_bf16 v[132:135], a[28:31], a[44:47], v[132:135]
v_add3_u32 v15, v15, v252, s88
v_cmp_gt_u32 vcc, 32, v0
v_mfma_f32_16x16x32_bf16 v[128:131], a[28:31], a[40:43], v[128:131]
ds_read_b64_tr_b16 a[28:29], v161 offset:8672
v_mfma_f32_16x16x32_bf16 v[144:147], a[32:35], a[40:43], v[144:147]
ds_read_b64_tr_b16 a[30:31], v161 offset:8928
v_mfma_f32_16x16x32_bf16 v[148:151], a[32:35], a[44:47], v[148:151]
v_cndmask_b32 v14, v14, v15, vcc
v_mfma_f32_16x16x32_bf16 v[152:155], a[32:35], a[48:51], v[152:155]
s_add_u32 m0, s97, 0
v_mfma_f32_16x16x32_bf16 v[156:159], a[32:35], a[52:55], v[156:159]
ds_read_b64_tr_b16 a[32:33], v164 offset:1024
ds_read_b64_tr_b16 a[34:35], v164 offset:1280
s_waitcnt lgkmcnt(6)
v_mfma_f32_16x16x32_bf16 v[16:19], a[0:3], a[56:59], v[16:19]
v_and_b32 v15, 3, v0
s_mov_b32 exec_hi, 0
buffer_load_dwordx4 v180, s[56:59], s91 offen lds
s_mov_b32 exec_hi, -1
v_mfma_f32_16x16x32_bf16 v[20:23], a[0:3], a[60:63], v[20:23]
v_lshlrev_b32 v15, 2, v15
v_mfma_f32_16x16x32_bf16 v[24:27], a[0:3], a[64:67], v[24:27]
v_lshrrev_b32 v252, 4, v14
v_mfma_f32_16x16x32_bf16 v[28:31], a[0:3], a[68:71], v[28:31]
v_and_b32 v252, 12, v252
v_mfma_f32_16x16x32_bf16 v[44:47], a[4:7], a[68:71], v[44:47]
s_add_u32 s90, s90, 524288
v_mfma_f32_16x16x32_bf16 v[40:43], a[4:7], a[64:67], v[40:43]
buffer_load_dword v252, v252, s[84:87], 0 offen sc1
v_mfma_f32_16x16x32_bf16 v[36:39], a[4:7], a[60:63], v[36:39]
s_and_b32 s90, s90, 0x3fffff
s_add_u32 s91, s91, 65536
s_and_b32 s91, s91, 0x7ffff
v_lshl_add_u32 v14, v14, 7, v15
s_add_u32 s92, s92, 128
s_and_b32 s92, s92, 0xffffbbff
buffer_load_dword v15, v14, s[76:79], s24 offen offset:64 sc1
s_or_b32 s93, s92, 32768
v_mfma_f32_16x16x32_bf16 v[32:35], a[4:7], a[56:59], v[32:35]
s_waitcnt vmcnt(15) lgkmcnt(0)
s_barrier
ds_read_b64_tr_b16 a[0:1], v162 offset:0
v_mfma_f32_16x16x32_bf16 v[48:51], a[8:11], a[56:59], v[48:51]
ds_read_b64_tr_b16 a[2:3], v162 offset:256
ds_read_b64_tr_b16 a[4:5], v162 offset:32
v_mfma_f32_16x16x32_bf16 v[52:55], a[8:11], a[60:63], v[52:55]
ds_read_b64_tr_b16 a[6:7], v162 offset:288
s_add_u32 m0, s98, 51712
v_mfma_f32_16x16x32_bf16 v[56:59], a[8:11], a[64:67], v[56:59]
ds_read_b128 a[40:43], v170 offset:0
buffer_load_dwordx4 v176, s[36:39], s92 offen offset:0 lds
v_mfma_f32_16x16x32_bf16 v[60:63], a[8:11], a[68:71], v[60:63]
ds_read_b64_tr_b16 a[8:9], v162 offset:64
v_mfma_f32_16x16x32_bf16 v[76:79], a[12:15], a[68:71], v[76:79]
ds_read_b64_tr_b16 a[10:11], v162 offset:320
v_mfma_f32_16x16x32_bf16 v[72:75], a[12:15], a[64:67], v[72:75]
buffer_load_dwordx4 v177, s[36:39], s92 offen offset:1024 lds
v_mfma_f32_16x16x32_bf16 v[68:71], a[12:15], a[60:63], v[68:71]
ds_read_b128 a[44:47], v170 offset:2048
v_mfma_f32_16x16x32_bf16 v[64:67], a[12:15], a[56:59], v[64:67]
ds_read_b64_tr_b16 a[12:13], v162 offset:96
v_mfma_f32_16x16x32_bf16 v[80:83], a[16:19], a[56:59], v[80:83]
ds_read_b64_tr_b16 a[14:15], v162 offset:352
v_mfma_f32_16x16x32_bf16 v[84:87], a[16:19], a[60:63], v[84:87]
v_mfma_f32_16x16x32_bf16 v[88:91], a[16:19], a[64:67], v[88:91]
ds_read_b128 a[48:51], v170 offset:4096
v_mfma_f32_16x16x32_bf16 v[92:95], a[16:19], a[68:71], v[92:95]
ds_read_b64_tr_b16 a[16:17], v162 offset:128
s_waitcnt lgkmcnt(8)
v_mfma_f32_16x16x32_bf16 v[108:111], a[20:23], a[68:71], v[108:111]
ds_read_b64_tr_b16 a[18:19], v162 offset:384
v_mfma_f32_16x16x32_bf16 v[104:107], a[20:23], a[64:67], v[104:107]
buffer_load_dwordx4 v178, s[36:39], s92 offen offset:2048 lds
v_mfma_f32_16x16x32_bf16 v[100:103], a[20:23], a[60:63], v[100:103]
ds_read_b128 a[52:55], v170 offset:6144
v_mfma_f32_16x16x32_bf16 v[96:99], a[20:23], a[56:59], v[96:99]
ds_read_b64_tr_b16 a[20:21], v162 offset:160
v_mfma_f32_16x16x32_bf16 v[112:115], a[24:27], a[56:59], v[112:115]
ds_read_b64_tr_b16 a[22:23], v162 offset:416
v_mfma_f32_16x16x32_bf16 v[116:119], a[24:27], a[60:63], v[116:119]
buffer_load_dwordx4 v179, s[36:39], s92 offen offset:3072 lds
v_mfma_f32_16x16x32_bf16 v[120:123], a[24:27], a[64:67], v[120:123]
v_mfma_f32_16x16x32_bf16 v[124:127], a[24:27], a[68:71], v[124:127]
ds_read_b64_tr_b16 a[24:25], v162 offset:192
v_mfma_f32_16x16x32_bf16 v[140:143], a[28:31], a[68:71], v[140:143]
ds_read_b64_tr_b16 a[26:27], v162 offset:448
v_mfma_f32_16x16x32_bf16 v[136:139], a[28:31], a[64:67], v[136:139]
s_add_u32 m0, s96, 51712
v_mfma_f32_16x16x32_bf16 v[132:135], a[28:31], a[60:63], v[132:135]
buffer_load_dwordx4 v172, s[48:51], s90 offen offset:0 lds
v_mfma_f32_16x16x32_bf16 v[128:131], a[28:31], a[56:59], v[128:131]
ds_read_b64_tr_b16 a[28:29], v162 offset:224
v_mfma_f32_16x16x32_bf16 v[144:147], a[32:35], a[56:59], v[144:147]
ds_read_b64_tr_b16 a[30:31], v162 offset:480
v_mfma_f32_16x16x32_bf16 v[148:151], a[32:35], a[60:63], v[148:151]
v_mfma_f32_16x16x32_bf16 v[152:155], a[32:35], a[64:67], v[152:155]
v_mfma_f32_16x16x32_bf16 v[156:159], a[32:35], a[68:71], v[156:159]
ds_read_b64_tr_b16 a[32:33], v165 offset:0
ds_read_b64_tr_b16 a[34:35], v165 offset:256
s_waitcnt lgkmcnt(6)
v_mfma_f32_16x16x32_bf16 v[16:19], a[0:3], a[40:43], v[16:19]
buffer_load_dwordx4 v173, s[48:51], s90 offen offset:1056 lds
v_mfma_f32_16x16x32_bf16 v[20:23], a[0:3], a[44:47], v[20:23]
v_mfma_f32_16x16x32_bf16 v[24:27], a[0:3], a[48:51], v[24:27]
s_cmp_eq_u32 s26, 5
s_cbranch_scc1 rexs_19
rexsb_20:
v_mfma_f32_16x16x32_bf16 v[28:31], a[0:3], a[52:55], v[28:31]
ds_read_b64_tr_b16 a[0:1], v162 offset:8448
v_mfma_f32_16x16x32_bf16 v[44:47], a[4:7], a[52:55], v[44:47]
ds_read_b64_tr_b16 a[2:3], v162 offset:8704
v_mfma_f32_16x16x32_bf16 v[40:43], a[4:7], a[48:51], v[40:43]
ds_read_b128 a[56:59], v171 offset:0
v_mfma_f32_16x16x32_bf16 v[36:39], a[4:7], a[44:47], v[36:39]
buffer_load_dwordx4 v174, s[48:51], s90 offen offset:2112 lds
s_waitcnt vmcnt(7)
v_cmp_ne_u32 vcc, v252, v15
s_cbranch_vccnz reslow_21
reback_22:
v_mfma_f32_16x16x32_bf16 v[32:35], a[4:7], a[40:43], v[32:35]
ds_read_b64_tr_b16 a[4:5], v162 offset:8480
s_lshl_b32 s88, s3, 6
v_mfma_f32_16x16x32_bf16 v[48:51], a[8:11], a[40:43], v[48:51]
ds_read_b64_tr_b16 a[6:7], v162 offset:8736
v_add_u32 v244, s88, v0
v_mfma_f32_16x16x32_bf16 v[52:55], a[8:11], a[44:47], v[52:55]
ds_read_b128 a[60:63], v171 offset:2048
v_mfma_f32_16x16x32_bf16 v[56:59], a[8:11], a[48:51], v[56:59]
s_movk_i32 s89, 144
buffer_load_dwordx4 v175, s[48:51], s90 offen offset:3168 lds
v_mfma_f32_16x16x32_bf16 v[60:63], a[8:11], a[52:55], v[60:63]
ds_read_b64_tr_b16 a[8:9], v162 offset:8512
v_cmp_gt_u32 vcc, s89, v244
v_mfma_f32_16x16x32_bf16 v[76:79], a[12:15], a[52:55], v[76:79]
ds_read_b64_tr_b16 a[10:11], v162 offset:8768
v_lshlrev_b32 v240, 2, v244
v_mfma_f32_16x16x32_bf16 v[72:75], a[12:15], a[48:51], v[72:75]
ds_read_b128 a[64:67], v171 offset:4096
v_mfma_f32_16x16x32_bf16 v[68:71], a[12:15], a[44:47], v[68:71]
v_mov_b32 v245, 1073741824
s_add_u32 m0, s98, 55808
v_mfma_f32_16x16x32_bf16 v[64:67], a[12:15], a[40:43], v[64:67]
ds_read_b64_tr_b16 a[12:13], v162 offset:8544
v_cndmask_b32 v245, v245, v240, vcc
v_mfma_f32_16x16x32_bf16 v[80:83], a[16:19], a[40:43], v[80:83]
ds_read_b64_tr_b16 a[14:15], v162 offset:8800
buffer_load_dwordx4 v176, s[36:39], s93 offen offset:0 lds
v_mfma_f32_16x16x32_bf16 v[84:87], a[16:19], a[44:47], v[84:87]
ds_read_b128 a[68:71], v171 offset:6144
v_mfma_f32_16x16x32_bf16 v[88:91], a[16:19], a[48:51], v[88:91]
s_mul_i32 s89, s5, 4608
s_add_u32 s89, s89, 262144
v_mfma_f32_16x16x32_bf16 v[92:95], a[16:19], a[52:55], v[92:95]
ds_read_b64_tr_b16 a[16:17], v162 offset:8576
s_waitcnt lgkmcnt(8)
v_mfma_f32_16x16x32_bf16 v[108:111], a[20:23], a[52:55], v[108:111]
ds_read_b64_tr_b16 a[18:19], v162 offset:8832
v_mfma_f32_16x16x32_bf16 v[104:107], a[20:23], a[48:51], v[104:107]
buffer_load_dword v232, v245, s[76:79], s89 offen offset:0 sc1
v_mfma_f32_16x16x32_bf16 v[100:103], a[20:23], a[44:47], v[100:103]
buffer_load_dwordx4 v177, s[36:39], s93 offen offset:1024 lds
buffer_load_dword v233, v245, s[76:79], s89 offen offset:576 sc1
v_mfma_f32_16x16x32_bf16 v[96:99], a[20:23], a[40:43], v[96:99]
ds_read_b64_tr_b16 a[20:21], v162 offset:8608
v_mfma_f32_16x16x32_bf16 v[112:115], a[24:27], a[40:43], v[112:115]
ds_read_b64_tr_b16 a[22:23], v162 offset:8864
v_mfma_f32_16x16x32_bf16 v[116:119], a[24:27], a[44:47], v[116:119]
buffer_load_dword v234, v245, s[76:79], s89 offen offset:1152 sc1
v_mfma_f32_16x16x32_bf16 v[120:123], a[24:27], a[48:51], v[120:123]
buffer_load_dword v235, v245, s[76:79], s89 offen offset:1728 sc1
buffer_load_dwordx4 v178, s[36:39], s93 offen offset:2048 lds
v_mfma_f32_16x16x32_bf16 v[124:127], a[24:27], a[52:55], v[124:127]
ds_read_b64_tr_b16 a[24:25], v162 offset:8640
v_and_b32 v244, 15, v0
v_mfma_f32_16x16x32_bf16 v[140:143], a[28:31], a[52:55], v[140:143]
ds_read_b64_tr_b16 a[26:27], v162 offset:8896
v_mfma_f32_16x16x32_bf16 v[136:139], a[28:31], a[48:51], v[136:139]
v_lshlrev_b32 v244, 3, v244
v_mfma_f32_16x16x32_bf16 v[132:135], a[28:31], a[44:47], v[132:135]
s_lshl_b32 s88, s4, 2
buffer_load_dwordx4 v179, s[36:39], s93 offen offset:3072 lds
v_mfma_f32_16x16x32_bf16 v[128:131], a[28:31], a[40:43], v[128:131]
ds_read_b64_tr_b16 a[28:29], v162 offset:8672
v_mfma_f32_16x16x32_bf16 v[144:147], a[32:35], a[40:43], v[144:147]
ds_read_b64_tr_b16 a[30:31], v162 offset:8928
v_mfma_f32_16x16x32_bf16 v[148:151], a[32:35], a[44:47], v[148:151]
s_add_u32 s88, s88, s3
v_mfma_f32_16x16x32_bf16 v[152:155], a[32:35], a[48:51], v[152:155]
s_lshl_b32 s88, s88, 9
v_mfma_f32_16x16x32_bf16 v[156:159], a[32:35], a[52:55], v[156:159]
ds_read_b64_tr_b16 a[32:33], v165 offset:1024
ds_read_b64_tr_b16 a[34:35], v165 offset:1280
s_waitcnt lgkmcnt(6)
v_mfma_f32_16x16x32_bf16 v[16:19], a[0:3], a[56:59], v[16:19]
buffer_load_dwordx2 v[182:183], v244, s[76:79], s88 offen offset:0 sc1
v_mfma_f32_16x16x32_bf16 v[20:23], a[0:3], a[60:63], v[20:23]
s_add_u32 m0, s97, 51712
s_mov_b32 exec_hi, 0
buffer_load_dwordx4 v180, s[56:59], s91 offen lds
s_mov_b32 exec_hi, -1
v_mfma_f32_16x16x32_bf16 v[24:27], a[0:3], a[64:67], v[24:27]
buffer_load_dwordx2 v[184:185], v244, s[76:79], s88 offen offset:128 sc1
v_mfma_f32_16x16x32_bf16 v[28:31], a[0:3], a[68:71], v[28:31]
buffer_load_dwordx2 v[186:187], v244, s[76:79], s88 offen offset:256 sc1
v_mfma_f32_16x16x32_bf16 v[44:47], a[4:7], a[68:71], v[44:47]
buffer_load_dwordx2 v[188:189], v244, s[76:79], s88 offen offset:384 sc1
v_mfma_f32_16x16x32_bf16 v[40:43], a[4:7], a[64:67], v[40:43]
v_mfma_f32_16x16x32_bf16 v[36:39], a[4:7], a[60:63], v[36:39]
v_mfma_f32_16x16x32_bf16 v[32:35], a[4:7], a[56:59], v[32:35]
s_waitcnt lgkmcnt(0)
s_barrier
ds_read_b64_tr_b16 a[0:1], v160 offset:0
v_mfma_f32_16x16x32_bf16 v[48:51], a[8:11], a[56:59], v[48:51]
ds_read_b64_tr_b16 a[2:3], v160 offset:256
ds_read_b64_tr_b16 a[4:5], v160 offset:32
v_mfma_f32_16x16x32_bf16 v[52:55], a[8:11], a[60:63], v[52:55]
ds_read_b64_tr_b16 a[6:7], v160 offset:288
s_add_u32 m0, s99, 103424
v_mfma_f32_16x16x32_bf16 v[56:59], a[8:11], a[64:67], v[56:59]
ds_read_b128 a[40:43], v166 offset:0
v_mfma_f32_16x16x32_bf16 v[60:63], a[8:11], a[68:71], v[60:63]
ds_read_b64_tr_b16 a[8:9], v160 offset:64
v_mfma_f32_16x16x32_bf16 v[76:79], a[12:15], a[68:71], v[76:79]
ds_read_b64_tr_b16 a[10:11], v160 offset:320
v_mfma_f32_16x16x32_bf16 v[72:75], a[12:15], a[64:67], v[72:75]
s_add_u32 s95, s94, 0
v_mfma_f32_16x16x32_bf16 v[68:71], a[12:15], a[60:63], v[68:71]
ds_read_b128 a[44:47], v166 offset:2048
v_mfma_f32_16x16x32_bf16 v[64:67], a[12:15], a[56:59], v[64:67]
ds_read_b64_tr_b16 a[12:13], v160 offset:96
v_mfma_f32_16x16x32_bf16 v[80:83], a[16:19], a[56:59], v[80:83]
ds_read_b64_tr_b16 a[14:15], v160 offset:352
v_mfma_f32_16x16x32_bf16 v[84:87], a[16:19], a[60:63], v[84:87]
buffer_load_dwordx4 v4, s[40:43], s95 offen offset:0 lds
v_mfma_f32_16x16x32_bf16 v[88:91], a[16:19], a[64:67], v[88:91]
ds_read_b128 a[48:51], v166 offset:4096
v_mfma_f32_16x16x32_bf16 v[92:95], a[16:19], a[68:71], v[92:95]
ds_read_b64_tr_b16 a[16:17], v160 offset:128
s_waitcnt lgkmcnt(8)
v_mfma_f32_16x16x32_bf16 v[108:111], a[20:23], a[68:71], v[108:111]
ds_read_b64_tr_b16 a[18:19], v160 offset:384
v_mfma_f32_16x16x32_bf16 v[104:107], a[20:23], a[64:67], v[104:107]
buffer_load_dwordx4 v5, s[40:43], s95 offen offset:1088 lds
v_mfma_f32_16x16x32_bf16 v[100:103], a[20:23], a[60:63], v[100:103]
ds_read_b128 a[52:55], v166 offset:6144
v_mfma_f32_16x16x32_bf16 v[96:99], a[20:23], a[56:59], v[96:99]
ds_read_b64_tr_b16 a[20:21], v160 offset:160
v_mfma_f32_16x16x32_bf16 v[112:115], a[24:27], a[56:59], v[112:115]
ds_read_b64_tr_b16 a[22:23], v160 offset:416
v_mfma_f32_16x16x32_bf16 v[116:119], a[24:27], a[60:63], v[116:119]
buffer_load_dwordx4 v6, s[40:43], s95 offen offset:2176 lds
v_mfma_f32_16x16x32_bf16 v[120:123], a[24:27], a[64:67], v[120:123]
v_mfma_f32_16x16x32_bf16 v[124:127], a[24:27], a[68:71], v[124:127]
ds_read_b64_tr_b16 a[24:25], v160 offset:192
v_mfma_f32_16x16x32_bf16 v[140:143], a[28:31], a[68:71], v[140:143]
ds_read_b64_tr_b16 a[26:27], v160 offset:448
v_mfma_f32_16x16x32_bf16 v[136:139], a[28:31], a[64:67], v[136:139]
buffer_load_dwordx4 v7, s[40:43], s95 offen offset:3264 lds
v_mfma_f32_16x16x32_bf16 v[132:135], a[28:31], a[60:63], v[132:135]
v_mfma_f32_16x16x32_bf16 v[128:131], a[28:31], a[56:59], v[128:131]
ds_read_b64_tr_b16 a[28:29], v160 offset:224
v_mfma_f32_16x16x32_bf16 v[144:147], a[32:35], a[56:59], v[144:147]
ds_read_b64_tr_b16 a[30:31], v160 offset:480
v_mfma_f32_16x16x32_bf16 v[148:151], a[32:35], a[60:63], v[148:151]
s_add_u32 m0, s96, 120832
v_mfma_f32_16x16x32_bf16 v[152:155], a[32:35], a[64:67], v[152:155]
v_mfma_f32_16x16x32_bf16 v[156:159], a[32:35], a[68:71], v[156:159]
ds_read_b64_tr_b16 a[32:33], v163 offset:0
ds_read_b64_tr_b16 a[34:35], v163 offset:256
s_waitcnt lgkmcnt(6)
v_mfma_f32_16x16x32_bf16 v[16:19], a[0:3], a[40:43], v[16:19]
s_add_u32 s95, s94, 0
v_mfma_f32_16x16x32_bf16 v[20:23], a[0:3], a[44:47], v[20:23]
v_mfma_f32_16x16x32_bf16 v[24:27], a[0:3], a[48:51], v[24:27]
s_cmp_eq_u32 s26, 6
s_cbranch_scc1 rexs_24
rexsb_25:
v_mfma_f32_16x16x32_bf16 v[28:31], a[0:3], a[52:55], v[28:31]
ds_read_b64_tr_b16 a[0:1], v160 offset:8448
buffer_load_dwordx4 v8, s[44:47], s95 offen offset:0 lds
v_mfma_f32_16x16x32_bf16 v[44:47], a[4:7], a[52:55], v[44:47]
ds_read_b64_tr_b16 a[2:3], v160 offset:8704
v_mfma_f32_16x16x32_bf16 v[40:43], a[4:7], a[48:51], v[40:43]
ds_read_b128 a[56:59], v167 offset:0
v_mfma_f32_16x16x32_bf16 v[36:39], a[4:7], a[44:47], v[36:39]
v_mfma_f32_16x16x32_bf16 v[32:35], a[4:7], a[40:43], v[32:35]
ds_read_b64_tr_b16 a[4:5], v160 offset:8480
buffer_load_dwordx4 v9, s[44:47], s95 offen offset:1056 lds
v_mfma_f32_16x16x32_bf16 v[48:51], a[8:11], a[40:43], v[48:51]
ds_read_b64_tr_b16 a[6:7], v160 offset:8736
v_mfma_f32_16x16x32_bf16 v[52:55], a[8:11], a[44:47], v[52:55]
ds_read_b128 a[60:63], v167 offset:2048
v_mfma_f32_16x16x32_bf16 v[56:59], a[8:11], a[48:51], v[56:59]
s_waitcnt vmcnt(10)
v_mul_f32 v172, v183, v183
v_mul_f32 v172, 0xb727c5ac, v172
v_mfma_f32_16x16x32_bf16 v[60:63], a[8:11], a[52:55], v[60:63]
ds_read_b64_tr_b16 a[8:9], v160 offset:8512
buffer_load_dwordx4 v10, s[44:47], s95 offen offset:2112 lds
v_mfma_f32_16x16x32_bf16 v[76:79], a[12:15], a[52:55], v[76:79]
ds_read_b64_tr_b16 a[10:11], v160 offset:8768
v_add_f32 v172, 0x3f800054, v172
v_mfma_f32_16x16x32_bf16 v[72:75], a[12:15], a[48:51], v[72:75]
ds_read_b128 a[64:67], v167 offset:4096
v_mfma_f32_16x16x32_bf16 v[68:71], a[12:15], a[44:47], v[68:71]
v_rsq_f32 v172, v172
buffer_load_dwordx4 v11, s[44:47], s95 offen offset:3168 lds
v_mfma_f32_16x16x32_bf16 v[64:67], a[12:15], a[40:43], v[64:67]
ds_read_b64_tr_b16 a[12:13], v160 offset:8544
v_mov_b32 v190, v182
v_mfma_f32_16x16x32_bf16 v[80:83], a[16:19], a[40:43], v[80:83]
ds_read_b64_tr_b16 a[14:15], v160 offset:8800
v_mfma_f32_16x16x32_bf16 v[84:87], a[16:19], a[44:47], v[84:87]
ds_read_b128 a[68:71], v167 offset:6144
v_mfma_f32_16x16x32_bf16 v[88:91], a[16:19], a[48:51], v[88:91]
v_mul_f32 v172, v172, v183
s_add_u32 m0, s99, 138240
v_mfma_f32_16x16x32_bf16 v[92:95], a[16:19], a[52:55], v[92:95]
ds_read_b64_tr_b16 a[16:17], v160 offset:8576
s_waitcnt lgkmcnt(8)
v_mfma_f32_16x16x32_bf16 v[108:111], a[20:23], a[52:55], v[108:111]
ds_read_b64_tr_b16 a[18:19], v160 offset:8832
v_mfma_f32_16x16x32_bf16 v[104:107], a[20:23], a[48:51], v[104:107]
v_rcp_f32 v191, v172
v_mfma_f32_16x16x32_bf16 v[100:103], a[20:23], a[44:47], v[100:103]
v_mul_f32 v173, v172, v172
s_add_u32 s95, s94, 16384
v_mfma_f32_16x16x32_bf16 v[96:99], a[20:23], a[40:43], v[96:99]
ds_read_b64_tr_b16 a[20:21], v160 offset:8608
v_mul_f32 v173, v173, v172
v_mfma_f32_16x16x32_bf16 v[112:115], a[24:27], a[40:43], v[112:115]
ds_read_b64_tr_b16 a[22:23], v160 offset:8864
v_mfma_f32_16x16x32_bf16 v[116:119], a[24:27], a[44:47], v[116:119]
v_mul_f32 v172, 0xc0135761, v172
v_mfma_f32_16x16x32_bf16 v[120:123], a[24:27], a[48:51], v[120:123]
buffer_load_dwordx4 v4, s[40:43], s95 offen offset:0 lds
v_mul_f32 v173, 0xbdd2d3e8, v173
v_mfma_f32_16x16x32_bf16 v[124:127], a[24:27], a[52:55], v[124:127]
ds_read_b64_tr_b16 a[24:25], v160 offset:8640
v_mfma_f32_16x16x32_bf16 v[140:143], a[28:31], a[52:55], v[140:143]
ds_read_b64_tr_b16 a[26:27], v160 offset:8896
v_mfma_f32_16x16x32_bf16 v[136:139], a[28:31], a[48:51], v[136:139]
s_waitcnt vmcnt(11)
v_mul_f32 v174, v185, v185
v_mfma_f32_16x16x32_bf16 v[132:135], a[28:31], a[44:47], v[132:135]
buffer_load_dwordx4 v5, s[40:43], s95 offen offset:1088 lds
v_mul_f32 v174, 0xb727c5ac, v174
v_mfma_f32_16x16x32_bf16 v[128:131], a[28:31], a[40:43], v[128:131]
ds_read_b64_tr_b16 a[28:29], v160 offset:8672
v_mfma_f32_16x16x32_bf16 v[144:147], a[32:35], a[40:43], v[144:147]
ds_read_b64_tr_b16 a[30:31], v160 offset:8928
v_mfma_f32_16x16x32_bf16 v[148:151], a[32:35], a[44:47], v[148:151]
v_add_f32 v174, 0x3f800054, v174
v_mfma_f32_16x16x32_bf16 v[152:155], a[32:35], a[48:51], v[152:155]
buffer_load_dwordx4 v6, s[40:43], s95 offen offset:2176 lds
v_mfma_f32_16x16x32_bf16 v[156:159], a[32:35], a[52:55], v[156:159]
ds_read_b64_tr_b16 a[32:33], v163 offset:1024
ds_read_b64_tr_b16 a[34:35], v163 offset:1280
s_waitcnt lgkmcnt(6)
v_mfma_f32_16x16x32_bf16 v[16:19], a[0:3], a[56:59], v[16:19]
v_rsq_f32 v174, v174
v_mfma_f32_16x16x32_bf16 v[20:23], a[0:3], a[60:63], v[20:23]
v_mov_b32 v230, v184
v_mfma_f32_16x16x32_bf16 v[24:27], a[0:3], a[64:67], v[24:27]
v_mul_f32 v174, v174, v185
v_mfma_f32_16x16x32_bf16 v[28:31], a[0:3], a[68:71], v[28:31]
buffer_load_dwordx4 v7, s[40:43], s95 offen offset:3264 lds
v_mfma_f32_16x16x32_bf16 v[44:47], a[4:7], a[68:71], v[44:47]
v_rcp_f32 v231, v174
v_mfma_f32_16x16x32_bf16 v[40:43], a[4:7], a[64:67], v[40:43]
v_mul_f32 v175, v174, v174
v_mfma_f32_16x16x32_bf16 v[36:39], a[4:7], a[60:63], v[36:39]
v_mfma_f32_16x16x32_bf16 v[32:35], a[4:7], a[56:59], v[32:35]
s_waitcnt lgkmcnt(0)
s_barrier
ds_read_b64_tr_b16 a[0:1], v161 offset:0
s_mul_i32 s88, s2, 43
s_lshr_b32 s89, s88, 8
s_and_b32 s88, s88, 255
s_lshl_b32 s100, s3, 8
s_add_u32 s88, s88, s100
s_cmp_ge_u32 s88, 43
s_cbranch_scc1 repkl_26
s_lshl_b32 s89, s89, 15
v_lshrrev_b32 v248, 3, v0
v_lshlrev_b32 v248, 10, v248
v_and_b32 v249, 7, v0
v_lshl_add_u32 v248, v249, 4, v248
buffer_load_dwordx4 a[84:87], v248, s[68:71], s89 offen offset:512
s_add_u32 s89, s89, 8192
buffer_load_dwordx4 a[88:91], v248, s[68:71], s89 offen offset:512
s_add_u32 s89, s89, 8192
buffer_load_dwordx4 a[92:95], v248, s[68:71], s89 offen offset:512
s_add_u32 s89, s89, 8192
buffer_load_dwordx4 a[96:99], v248, s[68:71], s89 offen offset:512
s_add_u32 s89, s89, 8192
repkl_26:
v_mfma_f32_16x16x32_bf16 v[48:51], a[8:11], a[56:59], v[48:51]
ds_read_b64_tr_b16 a[2:3], v161 offset:256
ds_read_b64_tr_b16 a[4:5], v161 offset:32
v_mfma_f32_16x16x32_bf16 v[52:55], a[8:11], a[60:63], v[52:55]
ds_read_b64_tr_b16 a[6:7], v161 offset:288
v_mul_f32 v175, v175, v174
v_mfma_f32_16x16x32_bf16 v[56:59], a[8:11], a[64:67], v[56:59]
ds_read_b128 a[40:43], v168 offset:0
s_lshl_b32 s88, s4, 2
v_mfma_f32_16x16x32_bf16 v[60:63], a[8:11], a[68:71], v[60:63]
ds_read_b64_tr_b16 a[8:9], v161 offset:64
v_mul_f32 v174, 0xc0135761, v174
v_mfma_f32_16x16x32_bf16 v[76:79], a[12:15], a[68:71], v[76:79]
ds_read_b64_tr_b16 a[10:11], v161 offset:320
v_mfma_f32_16x16x32_bf16 v[72:75], a[12:15], a[64:67], v[72:75]
s_add_u32 s88, s88, s3
v_mul_f32 v175, 0xbdd2d3e8, v175
v_mfma_f32_16x16x32_bf16 v[68:71], a[12:15], a[60:63], v[68:71]
ds_read_b128 a[44:47], v168 offset:2048
s_and_b32 s88, s88, 15
v_mfma_f32_16x16x32_bf16 v[64:67], a[12:15], a[56:59], v[64:67]
ds_read_b64_tr_b16 a[12:13], v161 offset:96
s_waitcnt vmcnt(13)
v_mul_f32 v176, v187, v187
v_mfma_f32_16x16x32_bf16 v[80:83], a[16:19], a[56:59], v[80:83]
ds_read_b64_tr_b16 a[14:15], v161 offset:352
v_mfma_f32_16x16x32_bf16 v[84:87], a[16:19], a[60:63], v[84:87]
v_mul_f32 v176, 0xb727c5ac, v176
s_lshl_b32 s88, s88, 10
v_mfma_f32_16x16x32_bf16 v[88:91], a[16:19], a[64:67], v[88:91]
ds_read_b128 a[48:51], v168 offset:4096
v_add_f32 v176, 0x3f800054, v176
v_mfma_f32_16x16x32_bf16 v[92:95], a[16:19], a[68:71], v[92:95]
ds_read_b64_tr_b16 a[16:17], v161 offset:128
v_lshlrev_b32 v248, 4, v0
s_waitcnt lgkmcnt(8)
v_mfma_f32_16x16x32_bf16 v[108:111], a[20:23], a[68:71], v[108:111]
ds_read_b64_tr_b16 a[18:19], v161 offset:384
v_mfma_f32_16x16x32_bf16 v[104:107], a[20:23], a[64:67], v[104:107]
v_rsq_f32 v176, v176
s_add_u32 s88, s88, recurrent_scan__sliding_block_cached__mixer_s_mlp__prompt_kernel_qe-recurrent_scan__sliding_block_cached__mixer_s_mlp__prompt_kernel_pc
v_mfma_f32_16x16x32_bf16 v[100:103], a[20:23], a[60:63], v[100:103]
ds_read_b128 a[52:55], v168 offset:6144
v_mov_b32 v236, v186
v_mfma_f32_16x16x32_bf16 v[96:99], a[20:23], a[56:59], v[96:99]
ds_read_b64_tr_b16 a[20:21], v161 offset:160
buffer_load_dword v253, v248, s[72:75], s88 offen
v_mfma_f32_16x16x32_bf16 v[112:115], a[24:27], a[56:59], v[112:115]
ds_read_b64_tr_b16 a[22:23], v161 offset:416
v_mfma_f32_16x16x32_bf16 v[116:119], a[24:27], a[60:63], v[116:119]
v_mul_f32 v176, v176, v187
v_mfma_f32_16x16x32_bf16 v[120:123], a[24:27], a[64:67], v[120:123]
s_lshl_b32 s88, s4, 2
v_rcp_f32 v237, v176
v_mfma_f32_16x16x32_bf16 v[124:127], a[24:27], a[68:71], v[124:127]
ds_read_b64_tr_b16 a[24:25], v161 offset:192
v_mul_f32 v177, v176, v176
v_mfma_f32_16x16x32_bf16 v[140:143], a[28:31], a[68:71], v[140:143]
ds_read_b64_tr_b16 a[26:27], v161 offset:448
v_mfma_f32_16x16x32_bf16 v[136:139], a[28:31], a[64:67], v[136:139]
s_add_u32 s88, s88, s3
v_mfma_f32_16x16x32_bf16 v[132:135], a[28:31], a[60:63], v[132:135]
v_mul_f32 v177, v177, v176
s_and_b32 s88, s88, 15
v_mfma_f32_16x16x32_bf16 v[128:131], a[28:31], a[56:59], v[128:131]
ds_read_b64_tr_b16 a[28:29], v161 offset:224
v_mul_f32 v176, 0xc0135761, v176
v_mfma_f32_16x16x32_bf16 v[144:147], a[32:35], a[56:59], v[144:147]
ds_read_b64_tr_b16 a[30:31], v161 offset:480
v_mfma_f32_16x16x32_bf16 v[148:151], a[32:35], a[60:63], v[148:151]
v_mul_f32 v177, 0xbdd2d3e8, v177
v_mfma_f32_16x16x32_bf16 v[152:155], a[32:35], a[64:67], v[152:155]
s_lshl_b32 s88, s88, 10
v_mfma_f32_16x16x32_bf16 v[156:159], a[32:35], a[68:71], v[156:159]
ds_read_b64_tr_b16 a[32:33], v164 offset:0
ds_read_b64_tr_b16 a[34:35], v164 offset:256
s_waitcnt lgkmcnt(6)
v_mfma_f32_16x16x32_bf16 v[16:19], a[0:3], a[40:43], v[16:19]
s_waitcnt vmcnt(13)
v_mul_f32 v178, v189, v189
v_mfma_f32_16x16x32_bf16 v[20:23], a[0:3], a[44:47], v[20:23]
v_lshlrev_b32 v248, 4, v0
v_mfma_f32_16x16x32_bf16 v[24:27], a[0:3], a[48:51], v[24:27]
v_mul_f32 v178, 0xb727c5ac, v178
s_cmp_eq_u32 s7, 0
s_cselect_b32 s89, 0, recurrent_scan__sliding_block_cached__mixer_s_mlp__prompt_kernel_c-recurrent_scan__sliding_block_cached__mixer_s_mlp__prompt_kernel_b
s_add_u32 s88, s88, s89
v_mfma_f32_16x16x32_bf16 v[28:31], a[0:3], a[52:55], v[28:31]
ds_read_b64_tr_b16 a[0:1], v161 offset:8448
v_add_f32 v178, 0x3f800054, v178
s_cmp_eq_u32 s26, 7
s_cbranch_scc1 rexs_27
rexsb_28:
v_mfma_f32_16x16x32_bf16 v[44:47], a[4:7], a[52:55], v[44:47]
ds_read_b64_tr_b16 a[2:3], v161 offset:8704
v_rsq_f32 v178, v178
s_add_u32 s88, s88, recurrent_scan__sliding_block_cached__mixer_s_mlp__prompt_kernel_b-recurrent_scan__sliding_block_cached__mixer_s_mlp__prompt_kernel_pc
v_mfma_f32_16x16x32_bf16 v[40:43], a[4:7], a[48:51], v[40:43]
ds_read_b128 a[56:59], v169 offset:0
v_mfma_f32_16x16x32_bf16 v[36:39], a[4:7], a[44:47], v[36:39]
v_mov_b32 v238, v188
buffer_load_dword v253, v248, s[72:75], s88 offen
v_mfma_f32_16x16x32_bf16 v[32:35], a[4:7], a[40:43], v[32:35]
ds_read_b64_tr_b16 a[4:5], v161 offset:8480
v_mul_f32 v178, v178, v189
v_mfma_f32_16x16x32_bf16 v[48:51], a[8:11], a[40:43], v[48:51]
ds_read_b64_tr_b16 a[6:7], v161 offset:8736
v_mfma_f32_16x16x32_bf16 v[52:55], a[8:11], a[44:47], v[52:55]
ds_read_b128 a[60:63], v169 offset:2048
v_mfma_f32_16x16x32_bf16 v[56:59], a[8:11], a[48:51], v[56:59]
v_rcp_f32 v239, v178
v_mul_f32 v179, v178, v178
v_mfma_f32_16x16x32_bf16 v[60:63], a[8:11], a[52:55], v[60:63]
ds_read_b64_tr_b16 a[8:9], v161 offset:8512
v_add_f32 v232, v232, v233
v_mfma_f32_16x16x32_bf16 v[76:79], a[12:15], a[52:55], v[76:79]
ds_read_b64_tr_b16 a[10:11], v161 offset:8768
v_mfma_f32_16x16x32_bf16 v[72:75], a[12:15], a[48:51], v[72:75]
ds_read_b128 a[64:67], v169 offset:4096
v_mfma_f32_16x16x32_bf16 v[68:71], a[12:15], a[44:47], v[68:71]
v_mul_f32 v179, v179, v178
v_mul_f32 v178, 0xc0135761, v178
v_mfma_f32_16x16x32_bf16 v[64:67], a[12:15], a[40:43], v[64:67]
ds_read_b64_tr_b16 a[12:13], v161 offset:8544
v_add_f32 v234, v234, v235
v_mfma_f32_16x16x32_bf16 v[80:83], a[16:19], a[40:43], v[80:83]
ds_read_b64_tr_b16 a[14:15], v161 offset:8800
v_mul_f32 v179, 0xbdd2d3e8, v179
v_mfma_f32_16x16x32_bf16 v[84:87], a[16:19], a[44:47], v[84:87]
ds_read_b128 a[68:71], v169 offset:6144
v_mfma_f32_16x16x32_bf16 v[88:91], a[16:19], a[48:51], v[88:91]
v_bfe_u32 v180, v0, 4, 1
v_add_f32 v232, v232, v234
v_mfma_f32_16x16x32_bf16 v[92:95], a[16:19], a[52:55], v[92:95]
ds_read_b64_tr_b16 a[16:17], v161 offset:8576
s_waitcnt lgkmcnt(8)
v_mfma_f32_16x16x32_bf16 v[108:111], a[20:23], a[52:55], v[108:111]
ds_read_b64_tr_b16 a[18:19], v161 offset:8832
v_mfma_f32_16x16x32_bf16 v[104:107], a[20:23], a[48:51], v[104:107]
v_lshlrev_b32 v180, 14, v180
v_mfma_f32_16x16x32_bf16 v[100:103], a[20:23], a[44:47], v[100:103]
v_lshrrev_b32 v229, 5, v0
v_add_u32 v240, 155648, v240
v_mfma_f32_16x16x32_bf16 v[96:99], a[20:23], a[40:43], v[96:99]
ds_read_b64_tr_b16 a[20:21], v161 offset:8608
v_mfma_f32_16x16x32_bf16 v[112:115], a[24:27], a[40:43], v[112:115]
ds_read_b64_tr_b16 a[22:23], v161 offset:8864
v_mfma_f32_16x16x32_bf16 v[116:119], a[24:27], a[44:47], v[116:119]
v_lshl_add_u32 v180, v229, 8, v180
v_mfma_f32_16x16x32_bf16 v[120:123], a[24:27], a[48:51], v[120:123]
v_and_b32 v229, 15, v0
v_mfma_f32_16x16x32_bf16 v[124:127], a[24:27], a[52:55], v[124:127]
ds_read_b64_tr_b16 a[24:25], v161 offset:8640
v_mfma_f32_16x16x32_bf16 v[140:143], a[28:31], a[52:55], v[140:143]
ds_read_b64_tr_b16 a[26:27], v161 offset:8896
v_mfma_f32_16x16x32_bf16 v[136:139], a[28:31], a[48:51], v[136:139]
v_lshl_add_u32 v180, v229, 4, v180
v_mfma_f32_16x16x32_bf16 v[132:135], a[28:31], a[44:47], v[132:135]
v_and_b32 v244, 48, v0
s_lshl_b32 s28, s4, 2
v_mfma_f32_16x16x32_bf16 v[128:131], a[28:31], a[40:43], v[128:131]
ds_read_b64_tr_b16 a[28:29], v161 offset:8672
s_add_u32 s28, s28, s3
v_mfma_f32_16x16x32_bf16 v[144:147], a[32:35], a[40:43], v[144:147]
ds_read_b64_tr_b16 a[30:31], v161 offset:8928
v_mfma_f32_16x16x32_bf16 v[148:151], a[32:35], a[44:47], v[148:151]
v_add_u32 v244, 155648, v244
v_mfma_f32_16x16x32_bf16 v[152:155], a[32:35], a[48:51], v[152:155]
s_lshl_b32 s28, s28, 16
v_mfma_f32_16x16x32_bf16 v[156:159], a[32:35], a[52:55], v[156:159]
ds_read_b64_tr_b16 a[32:33], v164 offset:1024
ds_read_b64_tr_b16 a[34:35], v164 offset:1280
s_waitcnt lgkmcnt(6)
v_mfma_f32_16x16x32_bf16 v[16:19], a[0:3], a[56:59], v[16:19]
s_lshl_b32 s29, s5, 9
v_mfma_f32_16x16x32_bf16 v[20:23], a[0:3], a[60:63], v[20:23]
ds_write_b32 v240, v232
v_mfma_f32_16x16x32_bf16 v[24:27], a[0:3], a[64:67], v[24:27]
s_add_u32 s28, s28, s29
v_mfma_f32_16x16x32_bf16 v[28:31], a[0:3], a[68:71], v[28:31]
s_add_u32 s29, s28, 32768
v_mfma_f32_16x16x32_bf16 v[44:47], a[4:7], a[68:71], v[44:47]
v_mfma_f32_16x16x32_bf16 v[40:43], a[4:7], a[64:67], v[40:43]
v_mfma_f32_16x16x32_bf16 v[36:39], a[4:7], a[60:63], v[36:39]
v_mfma_f32_16x16x32_bf16 v[32:35], a[4:7], a[56:59], v[32:35]
s_waitcnt vmcnt(10) lgkmcnt(0)
s_barrier
v_mfma_f32_16x16x32_bf16 v[48:51], a[8:11], a[56:59], v[48:51]
ds_read_b128 a[192:195], v1 offset:0
v_mfma_f32_16x16x32_bf16 v[52:55], a[8:11], a[60:63], v[52:55]
v_lshrrev_b32 v250, 3, v250
v_mfma_f32_16x16x32_bf16 v[56:59], a[8:11], a[64:67], v[56:59]
ds_read_b128 a[196:199], v1 offset:64
v_mfma_f32_16x16x32_bf16 v[60:63], a[8:11], a[68:71], v[60:63]
ds_read_b128 v[192:195], v244 offset:0
v_mfma_f32_16x16x32_bf16 v[76:79], a[12:15], a[68:71], v[76:79]
ds_read_b128 a[200:203], v1 offset:128
v_mfma_f32_16x16x32_bf16 v[72:75], a[12:15], a[64:67], v[72:75]
s_lshl_b32 s88, s2, 11
v_mfma_f32_16x16x32_bf16 v[68:71], a[12:15], a[60:63], v[68:71]
ds_read_b128 a[204:207], v1 offset:192
v_mfma_f32_16x16x32_bf16 v[64:67], a[12:15], a[56:59], v[64:67]
buffer_load_dword v253, v250, s[60:63], s88 offen offset:128
ds_read_b128 v[196:199], v244 offset:64
v_mfma_f32_16x16x32_bf16 v[80:83], a[16:19], a[56:59], v[80:83]
ds_read_b128 a[208:211], v1 offset:4352
s_lshl_b32 s88, s3, 6
v_mfma_f32_16x16x32_bf16 v[84:87], a[16:19], a[60:63], v[84:87]
v_add_u32 v248, s88, v0
ds_read_b128 v[200:203], v244 offset:128
v_mfma_f32_16x16x32_bf16 v[88:91], a[16:19], a[64:67], v[88:91]
ds_read_b128 a[212:215], v1 offset:4416
v_lshlrev_b32 v248, 3, v248
v_mfma_f32_16x16x32_bf16 v[92:95], a[16:19], a[68:71], v[92:95]
s_lshl_b32 s88, s4, 11
s_add_u32 s88, s88, s94
s_waitcnt lgkmcnt(8)
v_mfma_f32_16x16x32_bf16 v[108:111], a[20:23], a[68:71], v[108:111]
ds_read_b128 a[216:219], v1 offset:4480
ds_read_b128 v[204:207], v244 offset:192
v_mfma_f32_16x16x32_bf16 v[104:107], a[20:23], a[64:67], v[104:107]
s_add_u32 s88, s88, 409600
buffer_load_dword v253, v248, s[40:43], s88 offen
v_mfma_f32_16x16x32_bf16 v[100:103], a[20:23], a[60:63], v[100:103]
ds_read_b128 a[220:223], v1 offset:4544
ds_read_b128 v[208:211], v244 offset:256
v_mfma_f32_16x16x32_bf16 v[96:99], a[20:23], a[56:59], v[96:99]
buffer_load_dword v253, v248, s[44:47], s88 offen
v_mfma_f32_16x16x32_bf16 v[112:115], a[24:27], a[56:59], v[112:115]
s_lshl_b32 s88, s3, 6
ds_read_b128 v[212:215], v244 offset:320
v_mfma_f32_16x16x32_bf16 v[116:119], a[24:27], a[60:63], v[116:119]
v_add_u32 v248, s88, v0
v_mfma_f32_16x16x32_bf16 v[120:123], a[24:27], a[64:67], v[120:123]
v_lshlrev_b32 v248, 3, v248
v_mfma_f32_16x16x32_bf16 v[124:127], a[24:27], a[68:71], v[124:127]
s_lshl_b32 s88, s4, 11
ds_read_b128 v[216:219], v244 offset:384
v_mfma_f32_16x16x32_bf16 v[140:143], a[28:31], a[68:71], v[140:143]
s_add_u32 s88, s88, s94
v_mfma_f32_16x16x32_bf16 v[136:139], a[28:31], a[64:67], v[136:139]
s_add_u32 s88, s88, 425984
ds_read_b128 v[220:223], v244 offset:448
v_mfma_f32_16x16x32_bf16 v[132:135], a[28:31], a[60:63], v[132:135]
buffer_load_dword v253, v248, s[40:43], s88 offen
v_mfma_f32_16x16x32_bf16 v[128:131], a[28:31], a[56:59], v[128:131]
buffer_load_dword v253, v248, s[44:47], s88 offen
ds_read_b128 v[224:227], v244 offset:512
v_mfma_f32_16x16x32_bf16 v[144:147], a[32:35], a[56:59], v[144:147]
s_lshl_b32 s88, s3, 6
v_mfma_f32_16x16x32_bf16 v[148:151], a[32:35], a[60:63], v[148:151]
v_add_u32 v248, s88, v0
v_mfma_f32_16x16x32_bf16 v[152:155], a[32:35], a[64:67], v[152:155]
v_lshlrev_b32 v248, 3, v248
v_mfma_f32_16x16x32_bf16 v[156:159], a[32:35], a[68:71], v[156:159]
s_lshl_b32 s88, s4, 11
s_add_u32 s88, s88, s94
s_add_u32 s88, s88, 442368
buffer_load_dword v253, v248, s[40:43], s88 offen
buffer_load_dword v253, v248, s[44:47], s88 offen
recurrent_scan__sliding_block_cached__mixer_s_mlp__prompt_kernel_qe:
s_waitcnt lgkmcnt(0)
v_pk_fma_f32 v[144:145], v[190:191], v[224:225], v[144:145] op_sel_hi:[0,1,1] neg_lo:[1,0,0] neg_hi:[1,0,0]
v_pk_fma_f32 v[146:147], v[190:191], v[226:227], v[146:147] op_sel_hi:[0,1,1] neg_lo:[1,0,0] neg_hi:[1,0,0]
v_pk_fma_f32 v[148:149], v[230:231], v[224:225], v[148:149] op_sel_hi:[0,1,1] neg_lo:[1,0,0] neg_hi:[1,0,0]
v_pk_fma_f32 v[150:151], v[230:231], v[226:227], v[150:151] op_sel_hi:[0,1,1] neg_lo:[1,0,0] neg_hi:[1,0,0]
v_pk_mul_f32 v[240:241], v[144:145], v[144:145]
v_pk_mul_f32 v[242:243], v[146:147], v[146:147]
v_pk_mul_f32 v[244:245], v[148:149], v[148:149]
v_pk_mul_f32 v[246:247], v[150:151], v[150:151]
v_pk_fma_f32 v[240:241], v[240:241], v[172:173], v[172:173] op_sel:[0,1,0] op_sel_hi:[1,1,0]
v_pk_fma_f32 v[242:243], v[242:243], v[172:173], v[172:173] op_sel:[0,1,0] op_sel_hi:[1,1,0]
v_pk_fma_f32 v[244:245], v[244:245], v[174:175], v[174:175] op_sel:[0,1,0] op_sel_hi:[1,1,0]
v_pk_fma_f32 v[246:247], v[246:247], v[174:175], v[174:175] op_sel:[0,1,0] op_sel_hi:[1,1,0]
v_pk_mul_f32 v[240:241], v[240:241], v[144:145]
v_pk_mul_f32 v[242:243], v[242:243], v[146:147]
v_pk_mul_f32 v[244:245], v[244:245], v[148:149]
v_pk_mul_f32 v[246:247], v[246:247], v[150:151]
v_exp_f32 v240, v240
v_exp_f32 v241, v241
v_exp_f32 v242, v242
v_exp_f32 v243, v243
v_exp_f32 v244, v244
v_exp_f32 v245, v245
v_exp_f32 v246, v246
v_exp_f32 v247, v247
v_pk_fma_f32 v[240:241], v[240:241], v[190:191], v[190:191] op_sel:[0,1,1] op_sel_hi:[1,1,1]
v_pk_fma_f32 v[242:243], v[242:243], v[190:191], v[190:191] op_sel:[0,1,1] op_sel_hi:[1,1,1]
v_pk_fma_f32 v[244:245], v[244:245], v[230:231], v[230:231] op_sel:[0,1,1] op_sel_hi:[1,1,1]
v_pk_fma_f32 v[246:247], v[246:247], v[230:231], v[230:231] op_sel:[0,1,1] op_sel_hi:[1,1,1]
v_rcp_f32 v240, v240
v_rcp_f32 v241, v241
v_rcp_f32 v242, v242
v_rcp_f32 v243, v243
v_rcp_f32 v244, v244
v_rcp_f32 v245, v245
v_rcp_f32 v246, v246
v_rcp_f32 v247, v247
v_pk_mul_f32 v[144:145], v[144:145], v[240:241]
v_pk_mul_f32 v[146:147], v[146:147], v[242:243]
v_pk_mul_f32 v[148:149], v[148:149], v[244:245]
v_pk_mul_f32 v[150:151], v[150:151], v[246:247]
v_pk_fma_f32 v[152:153], v[236:237], v[224:225], v[152:153] op_sel_hi:[0,1,1] neg_lo:[1,0,0] neg_hi:[1,0,0]
v_pk_fma_f32 v[154:155], v[236:237], v[226:227], v[154:155] op_sel_hi:[0,1,1] neg_lo:[1,0,0] neg_hi:[1,0,0]
v_pk_fma_f32 v[156:157], v[238:239], v[224:225], v[156:157] op_sel_hi:[0,1,1] neg_lo:[1,0,0] neg_hi:[1,0,0]
v_pk_fma_f32 v[158:159], v[238:239], v[226:227], v[158:159] op_sel_hi:[0,1,1] neg_lo:[1,0,0] neg_hi:[1,0,0]
v_pk_mul_f32 v[240:241], v[152:153], v[152:153]
v_pk_mul_f32 v[242:243], v[154:155], v[154:155]
v_pk_mul_f32 v[244:245], v[156:157], v[156:157]
v_pk_mul_f32 v[246:247], v[158:159], v[158:159]
v_pk_fma_f32 v[240:241], v[240:241], v[176:177], v[176:177] op_sel:[0,1,0] op_sel_hi:[1,1,0]
v_pk_fma_f32 v[242:243], v[242:243], v[176:177], v[176:177] op_sel:[0,1,0] op_sel_hi:[1,1,0]
v_pk_fma_f32 v[244:245], v[244:245], v[178:179], v[178:179] op_sel:[0,1,0] op_sel_hi:[1,1,0]
v_pk_fma_f32 v[246:247], v[246:247], v[178:179], v[178:179] op_sel:[0,1,0] op_sel_hi:[1,1,0]
v_pk_mul_f32 v[240:241], v[240:241], v[152:153]
v_pk_mul_f32 v[242:243], v[242:243], v[154:155]
v_pk_mul_f32 v[244:245], v[244:245], v[156:157]
v_pk_mul_f32 v[246:247], v[246:247], v[158:159]
v_exp_f32 v240, v240
v_exp_f32 v241, v241
v_exp_f32 v242, v242
v_exp_f32 v243, v243
v_exp_f32 v244, v244
v_exp_f32 v245, v245
v_exp_f32 v246, v246
v_exp_f32 v247, v247
v_pk_fma_f32 v[240:241], v[240:241], v[236:237], v[236:237] op_sel:[0,1,1] op_sel_hi:[1,1,1]
v_pk_fma_f32 v[242:243], v[242:243], v[236:237], v[236:237] op_sel:[0,1,1] op_sel_hi:[1,1,1]
v_pk_fma_f32 v[244:245], v[244:245], v[238:239], v[238:239] op_sel:[0,1,1] op_sel_hi:[1,1,1]
v_pk_fma_f32 v[246:247], v[246:247], v[238:239], v[238:239] op_sel:[0,1,1] op_sel_hi:[1,1,1]
v_rcp_f32 v240, v240
v_rcp_f32 v241, v241
v_rcp_f32 v242, v242
v_rcp_f32 v243, v243
v_rcp_f32 v244, v244
v_rcp_f32 v245, v245
v_rcp_f32 v246, v246
v_rcp_f32 v247, v247
v_pk_mul_f32 v[152:153], v[152:153], v[240:241]
v_pk_mul_f32 v[154:155], v[154:155], v[242:243]
v_pk_mul_f32 v[156:157], v[156:157], v[244:245]
v_pk_mul_f32 v[158:159], v[158:159], v[246:247]
v_cvt_pk_bf16_f32 v236, v144, v145
v_cvt_pk_bf16_f32 v237, v146, v147
v_cvt_pk_bf16_f32 v238, v148, v149
v_cvt_pk_bf16_f32 v239, v150, v151
v_cvt_pk_bf16_f32 v240, v152, v153
v_cvt_pk_bf16_f32 v241, v154, v155
v_cvt_pk_bf16_f32 v242, v156, v157
v_cvt_pk_bf16_f32 v243, v158, v159
v_accvgpr_read_b32 v228, a76
v_accvgpr_read_b32 v229, a77
v_accvgpr_read_b32 v230, a78
v_accvgpr_read_b32 v231, a79
v_accvgpr_read_b32 v232, a80
v_accvgpr_read_b32 v233, a81
v_accvgpr_read_b32 v234, a82
v_accvgpr_read_b32 v235, a83
v_permlane16_swap_b32 v236, v238
v_permlane16_swap_b32 v237, v239
v_permlane16_swap_b32 v240, v242
v_permlane16_swap_b32 v241, v243
buffer_store_dwordx4 v[236:239], v180, s[80:83], s28 offen sc1
buffer_store_dwordx4 v[240:243], v180, s[80:83], s29 offen sc1
s_mov_b32 s27, 0xffff0000
v_lshlrev_b32 v144, 16, v228
v_and_b32 v145, s27, v228
v_lshlrev_b32 v146, 16, v229
v_and_b32 v147, s27, v229
v_pk_add_f32 v[144:145], v[144:145], v[182:183] op_sel_hi:[1,0] neg_lo:[0,1] neg_hi:[0,1]
v_pk_add_f32 v[146:147], v[146:147], v[182:183] op_sel_hi:[1,0] neg_lo:[0,1] neg_hi:[0,1]
v_pk_mul_f32 v[144:145], v[144:145], v[182:183] op_sel:[0,1] op_sel_hi:[1,1]
v_pk_mul_f32 v[146:147], v[146:147], v[182:183] op_sel:[0,1] op_sel_hi:[1,1]
v_cvt_pk_bf16_f32 v228, v144, v145
v_cvt_pk_bf16_f32 v229, v146, v147
v_lshlrev_b32 v148, 16, v230
v_and_b32 v149, s27, v230
v_lshlrev_b32 v150, 16, v231
v_and_b32 v151, s27, v231
v_pk_add_f32 v[148:149], v[148:149], v[184:185] op_sel_hi:[1,0] neg_lo:[0,1] neg_hi:[0,1]
v_pk_add_f32 v[150:151], v[150:151], v[184:185] op_sel_hi:[1,0] neg_lo:[0,1] neg_hi:[0,1]
v_pk_mul_f32 v[148:149], v[148:149], v[184:185] op_sel:[0,1] op_sel_hi:[1,1]
v_pk_mul_f32 v[150:151], v[150:151], v[184:185] op_sel:[0,1] op_sel_hi:[1,1]
v_cvt_pk_bf16_f32 v230, v148, v149
v_cvt_pk_bf16_f32 v231, v150, v151
v_lshlrev_b32 v152, 16, v232
v_and_b32 v153, s27, v232
v_lshlrev_b32 v154, 16, v233
v_and_b32 v155, s27, v233
v_pk_add_f32 v[152:153], v[152:153], v[186:187] op_sel_hi:[1,0] neg_lo:[0,1] neg_hi:[0,1]
v_pk_add_f32 v[154:155], v[154:155], v[186:187] op_sel_hi:[1,0] neg_lo:[0,1] neg_hi:[0,1]
v_pk_mul_f32 v[152:153], v[152:153], v[186:187] op_sel:[0,1] op_sel_hi:[1,1]
v_pk_mul_f32 v[154:155], v[154:155], v[186:187] op_sel:[0,1] op_sel_hi:[1,1]
v_cvt_pk_bf16_f32 v232, v152, v153
v_cvt_pk_bf16_f32 v233, v154, v155
v_lshlrev_b32 v156, 16, v234
v_and_b32 v157, s27, v234
v_lshlrev_b32 v158, 16, v235
v_and_b32 v159, s27, v235
v_pk_add_f32 v[156:157], v[156:157], v[188:189] op_sel_hi:[1,0] neg_lo:[0,1] neg_hi:[0,1]
v_pk_add_f32 v[158:159], v[158:159], v[188:189] op_sel_hi:[1,0] neg_lo:[0,1] neg_hi:[0,1]
v_pk_mul_f32 v[156:157], v[156:157], v[188:189] op_sel:[0,1] op_sel_hi:[1,1]
v_pk_mul_f32 v[158:159], v[158:159], v[188:189] op_sel:[0,1] op_sel_hi:[1,1]
v_cvt_pk_bf16_f32 v234, v156, v157
v_cvt_pk_bf16_f32 v235, v158, v159
s_mul_i32 s88, s2, 43
s_lshr_b32 s89, s88, 8
s_and_b32 s88, s88, 255
s_lshl_b32 s100, s3, 8
s_add_u32 s88, s88, s100
s_cmp_ge_u32 s88, 43
s_cbranch_scc1 repks_29
s_lshl_b32 s89, s89, 12
s_add_u32 s89, s89, 1048576
s_waitcnt vmcnt(2)
buffer_store_dwordx4 a[84:87], v251, s[76:79], s89 offen offset:0 sc1
buffer_store_dwordx4 a[88:91], v251, s[76:79], s89 offen offset:1024 sc1
buffer_store_dwordx4 a[92:95], v251, s[76:79], s89 offen offset:2048 sc1
buffer_store_dwordx4 a[96:99], v251, s[76:79], s89 offen offset:3072 sc1
repks_29:
s_add_u32 s88, s28, 12582912
s_add_u32 s89, s29, 12582912
v_permlane16_swap_b32 v228, v230
v_permlane16_swap_b32 v229, v231
v_permlane16_swap_b32 v232, v234
v_permlane16_swap_b32 v233, v235
buffer_store_dwordx4 v[228:231], v180, s[76:79], s88 offen sc1
buffer_store_dwordx4 v[232:235], v180, s[76:79], s89 offen sc1
v_mul_f32 v176, 0x3e0293ee, v183
v_mul_f32 v177, 0x3e0293ee, v185
v_mul_f32 v178, 0x3e0293ee, v187
v_mul_f32 v179, 0x3e0293ee, v189
v_pk_fma_f32 v[16:17], v[182:183], v[192:193], v[16:17] op_sel_hi:[0,1,1] neg_lo:[1,0,0] neg_hi:[1,0,0]
v_pk_fma_f32 v[18:19], v[182:183], v[194:195], v[18:19] op_sel_hi:[0,1,1] neg_lo:[1,0,0] neg_hi:[1,0,0]
v_pk_mul_f32 v[16:17], v[16:17], v[176:177] op_sel:[0,0] op_sel_hi:[1,0]
v_pk_mul_f32 v[18:19], v[18:19], v[176:177] op_sel:[0,0] op_sel_hi:[1,0]
v_pk_fma_f32 v[32:33], v[182:183], v[196:197], v[32:33] op_sel_hi:[0,1,1] neg_lo:[1,0,0] neg_hi:[1,0,0]
v_pk_fma_f32 v[34:35], v[182:183], v[198:199], v[34:35] op_sel_hi:[0,1,1] neg_lo:[1,0,0] neg_hi:[1,0,0]
v_pk_mul_f32 v[32:33], v[32:33], v[176:177] op_sel:[0,0] op_sel_hi:[1,0]
v_pk_mul_f32 v[34:35], v[34:35], v[176:177] op_sel:[0,0] op_sel_hi:[1,0]
v_cvt_pk_bf16_f32 v16, v16, v17
v_cvt_pk_bf16_f32 v17, v18, v19
v_cvt_pk_bf16_f32 v18, v32, v33
v_cvt_pk_bf16_f32 v19, v34, v35
s_nop 0
v_permlane16_swap_b32 v16, v18
v_permlane16_swap_b32 v17, v19
v_pk_fma_f32 v[48:49], v[182:183], v[200:201], v[48:49] op_sel_hi:[0,1,1] neg_lo:[1,0,0] neg_hi:[1,0,0]
v_pk_fma_f32 v[50:51], v[182:183], v[202:203], v[50:51] op_sel_hi:[0,1,1] neg_lo:[1,0,0] neg_hi:[1,0,0]
v_pk_mul_f32 v[48:49], v[48:49], v[176:177] op_sel:[0,0] op_sel_hi:[1,0]
v_pk_mul_f32 v[50:51], v[50:51], v[176:177] op_sel:[0,0] op_sel_hi:[1,0]
v_pk_fma_f32 v[64:65], v[182:183], v[204:205], v[64:65] op_sel_hi:[0,1,1] neg_lo:[1,0,0] neg_hi:[1,0,0]
v_pk_fma_f32 v[66:67], v[182:183], v[206:207], v[66:67] op_sel_hi:[0,1,1] neg_lo:[1,0,0] neg_hi:[1,0,0]
v_pk_mul_f32 v[64:65], v[64:65], v[176:177] op_sel:[0,0] op_sel_hi:[1,0]
v_pk_mul_f32 v[66:67], v[66:67], v[176:177] op_sel:[0,0] op_sel_hi:[1,0]
v_cvt_pk_bf16_f32 v48, v48, v49
v_cvt_pk_bf16_f32 v49, v50, v51
v_cvt_pk_bf16_f32 v50, v64, v65
v_cvt_pk_bf16_f32 v51, v66, v67
v_accvgpr_write_b32 a128, v16
v_accvgpr_write_b32 a129, v17
v_accvgpr_write_b32 a130, v18
v_accvgpr_write_b32 a131, v19
v_permlane16_swap_b32 v48, v50
v_permlane16_swap_b32 v49, v51
v_pk_fma_f32 v[80:81], v[182:183], v[208:209], v[80:81] op_sel_hi:[0,1,1] neg_lo:[1,0,0] neg_hi:[1,0,0]
v_pk_fma_f32 v[82:83], v[182:183], v[210:211], v[82:83] op_sel_hi:[0,1,1] neg_lo:[1,0,0] neg_hi:[1,0,0]
v_pk_mul_f32 v[80:81], v[80:81], v[176:177] op_sel:[0,0] op_sel_hi:[1,0]
v_pk_mul_f32 v[82:83], v[82:83], v[176:177] op_sel:[0,0] op_sel_hi:[1,0]
v_pk_fma_f32 v[96:97], v[182:183], v[212:213], v[96:97] op_sel_hi:[0,1,1] neg_lo:[1,0,0] neg_hi:[1,0,0]
v_pk_fma_f32 v[98:99], v[182:183], v[214:215], v[98:99] op_sel_hi:[0,1,1] neg_lo:[1,0,0] neg_hi:[1,0,0]
v_pk_mul_f32 v[96:97], v[96:97], v[176:177] op_sel:[0,0] op_sel_hi:[1,0]
v_pk_mul_f32 v[98:99], v[98:99], v[176:177] op_sel:[0,0] op_sel_hi:[1,0]
v_cvt_pk_bf16_f32 v80, v80, v81
v_cvt_pk_bf16_f32 v81, v82, v83
v_cvt_pk_bf16_f32 v82, v96, v97
v_cvt_pk_bf16_f32 v83, v98, v99
v_accvgpr_write_b32 a132, v48
v_accvgpr_write_b32 a133, v49
v_accvgpr_write_b32 a134, v50
v_accvgpr_write_b32 a135, v51
v_permlane16_swap_b32 v80, v82
v_permlane16_swap_b32 v81, v83
v_pk_fma_f32 v[112:113], v[182:183], v[216:217], v[112:113] op_sel_hi:[0,1,1] neg_lo:[1,0,0] neg_hi:[1,0,0]
v_pk_fma_f32 v[114:115], v[182:183], v[218:219], v[114:115] op_sel_hi:[0,1,1] neg_lo:[1,0,0] neg_hi:[1,0,0]
v_pk_mul_f32 v[112:113], v[112:113], v[176:177] op_sel:[0,0] op_sel_hi:[1,0]
v_pk_mul_f32 v[114:115], v[114:115], v[176:177] op_sel:[0,0] op_sel_hi:[1,0]
v_pk_fma_f32 v[128:129], v[182:183], v[220:221], v[128:129] op_sel_hi:[0,1,1] neg_lo:[1,0,0] neg_hi:[1,0,0]
v_pk_fma_f32 v[130:131], v[182:183], v[222:223], v[130:131] op_sel_hi:[0,1,1] neg_lo:[1,0,0] neg_hi:[1,0,0]
v_pk_mul_f32 v[128:129], v[128:129], v[176:177] op_sel:[0,0] op_sel_hi:[1,0]
v_pk_mul_f32 v[130:131], v[130:131], v[176:177] op_sel:[0,0] op_sel_hi:[1,0]
v_cvt_pk_bf16_f32 v112, v112, v113
v_cvt_pk_bf16_f32 v113, v114, v115
v_cvt_pk_bf16_f32 v114, v128, v129
v_cvt_pk_bf16_f32 v115, v130, v131
v_accvgpr_write_b32 a136, v80
v_accvgpr_write_b32 a137, v81
v_accvgpr_write_b32 a138, v82
v_accvgpr_write_b32 a139, v83
v_permlane16_swap_b32 v112, v114
v_permlane16_swap_b32 v113, v115
v_pk_fma_f32 v[20:21], v[184:185], v[192:193], v[20:21] op_sel_hi:[0,1,1] neg_lo:[1,0,0] neg_hi:[1,0,0]
v_pk_fma_f32 v[22:23], v[184:185], v[194:195], v[22:23] op_sel_hi:[0,1,1] neg_lo:[1,0,0] neg_hi:[1,0,0]
v_pk_mul_f32 v[20:21], v[20:21], v[176:177] op_sel:[0,1] op_sel_hi:[1,1]
v_pk_mul_f32 v[22:23], v[22:23], v[176:177] op_sel:[0,1] op_sel_hi:[1,1]
v_pk_fma_f32 v[36:37], v[184:185], v[196:197], v[36:37] op_sel_hi:[0,1,1] neg_lo:[1,0,0] neg_hi:[1,0,0]
v_pk_fma_f32 v[38:39], v[184:185], v[198:199], v[38:39] op_sel_hi:[0,1,1] neg_lo:[1,0,0] neg_hi:[1,0,0]
v_pk_mul_f32 v[36:37], v[36:37], v[176:177] op_sel:[0,1] op_sel_hi:[1,1]
v_pk_mul_f32 v[38:39], v[38:39], v[176:177] op_sel:[0,1] op_sel_hi:[1,1]
v_mfma_f32_16x16x32_bf16 v[144:147], a[192:195], a[128:131], 0
v_cvt_pk_bf16_f32 v20, v20, v21
v_cvt_pk_bf16_f32 v21, v22, v23
v_mfma_f32_16x16x32_bf16 v[148:151], a[208:211], a[128:131], 0
v_cvt_pk_bf16_f32 v22, v36, v37
v_cvt_pk_bf16_f32 v23, v38, v39
v_accvgpr_write_b32 a140, v112
v_accvgpr_write_b32 a141, v113
v_accvgpr_write_b32 a142, v114
v_accvgpr_write_b32 a143, v115
v_permlane16_swap_b32 v20, v22
v_permlane16_swap_b32 v21, v23
v_pk_fma_f32 v[52:53], v[184:185], v[200:201], v[52:53] op_sel_hi:[0,1,1] neg_lo:[1,0,0] neg_hi:[1,0,0]
v_pk_fma_f32 v[54:55], v[184:185], v[202:203], v[54:55] op_sel_hi:[0,1,1] neg_lo:[1,0,0] neg_hi:[1,0,0]
v_pk_mul_f32 v[52:53], v[52:53], v[176:177] op_sel:[0,1] op_sel_hi:[1,1]
v_pk_mul_f32 v[54:55], v[54:55], v[176:177] op_sel:[0,1] op_sel_hi:[1,1]
v_pk_fma_f32 v[68:69], v[184:185], v[204:205], v[68:69] op_sel_hi:[0,1,1] neg_lo:[1,0,0] neg_hi:[1,0,0]
v_pk_fma_f32 v[70:71], v[184:185], v[206:207], v[70:71] op_sel_hi:[0,1,1] neg_lo:[1,0,0] neg_hi:[1,0,0]
v_pk_mul_f32 v[68:69], v[68:69], v[176:177] op_sel:[0,1] op_sel_hi:[1,1]
v_pk_mul_f32 v[70:71], v[70:71], v[176:177] op_sel:[0,1] op_sel_hi:[1,1]
v_mfma_f32_16x16x32_bf16 v[144:147], a[196:199], a[132:135], v[144:147]
v_cvt_pk_bf16_f32 v52, v52, v53
v_cvt_pk_bf16_f32 v53, v54, v55
v_mfma_f32_16x16x32_bf16 v[148:151], a[212:215], a[132:135], v[148:151]
v_cvt_pk_bf16_f32 v54, v68, v69
v_cvt_pk_bf16_f32 v55, v70, v71
v_accvgpr_write_b32 a144, v20
v_accvgpr_write_b32 a145, v21
v_accvgpr_write_b32 a146, v22
v_accvgpr_write_b32 a147, v23
v_permlane16_swap_b32 v52, v54
v_permlane16_swap_b32 v53, v55
v_pk_fma_f32 v[84:85], v[184:185], v[208:209], v[84:85] op_sel_hi:[0,1,1] neg_lo:[1,0,0] neg_hi:[1,0,0]
v_pk_fma_f32 v[86:87], v[184:185], v[210:211], v[86:87] op_sel_hi:[0,1,1] neg_lo:[1,0,0] neg_hi:[1,0,0]
v_pk_mul_f32 v[84:85], v[84:85], v[176:177] op_sel:[0,1] op_sel_hi:[1,1]
v_pk_mul_f32 v[86:87], v[86:87], v[176:177] op_sel:[0,1] op_sel_hi:[1,1]
v_pk_fma_f32 v[100:101], v[184:185], v[212:213], v[100:101] op_sel_hi:[0,1,1] neg_lo:[1,0,0] neg_hi:[1,0,0]
v_pk_fma_f32 v[102:103], v[184:185], v[214:215], v[102:103] op_sel_hi:[0,1,1] neg_lo:[1,0,0] neg_hi:[1,0,0]
v_pk_mul_f32 v[100:101], v[100:101], v[176:177] op_sel:[0,1] op_sel_hi:[1,1]
v_pk_mul_f32 v[102:103], v[102:103], v[176:177] op_sel:[0,1] op_sel_hi:[1,1]
v_mfma_f32_16x16x32_bf16 v[144:147], a[200:203], a[136:139], v[144:147]
v_cvt_pk_bf16_f32 v84, v84, v85
v_cvt_pk_bf16_f32 v85, v86, v87
v_mfma_f32_16x16x32_bf16 v[148:151], a[216:219], a[136:139], v[148:151]
v_cvt_pk_bf16_f32 v86, v100, v101
v_cvt_pk_bf16_f32 v87, v102, v103
v_accvgpr_write_b32 a148, v52
v_accvgpr_write_b32 a149, v53
v_accvgpr_write_b32 a150, v54
v_accvgpr_write_b32 a151, v55
v_permlane16_swap_b32 v84, v86
v_permlane16_swap_b32 v85, v87
v_pk_fma_f32 v[116:117], v[184:185], v[216:217], v[116:117] op_sel_hi:[0,1,1] neg_lo:[1,0,0] neg_hi:[1,0,0]
v_pk_fma_f32 v[118:119], v[184:185], v[218:219], v[118:119] op_sel_hi:[0,1,1] neg_lo:[1,0,0] neg_hi:[1,0,0]
v_pk_mul_f32 v[116:117], v[116:117], v[176:177] op_sel:[0,1] op_sel_hi:[1,1]
v_pk_mul_f32 v[118:119], v[118:119], v[176:177] op_sel:[0,1] op_sel_hi:[1,1]
v_pk_fma_f32 v[132:133], v[184:185], v[220:221], v[132:133] op_sel_hi:[0,1,1] neg_lo:[1,0,0] neg_hi:[1,0,0]
v_pk_fma_f32 v[134:135], v[184:185], v[222:223], v[134:135] op_sel_hi:[0,1,1] neg_lo:[1,0,0] neg_hi:[1,0,0]
v_pk_mul_f32 v[132:133], v[132:133], v[176:177] op_sel:[0,1] op_sel_hi:[1,1]
v_pk_mul_f32 v[134:135], v[134:135], v[176:177] op_sel:[0,1] op_sel_hi:[1,1]
v_mfma_f32_16x16x32_bf16 v[144:147], a[204:207], a[140:143], v[144:147]
v_cvt_pk_bf16_f32 v116, v116, v117
v_cvt_pk_bf16_f32 v117, v118, v119
v_mfma_f32_16x16x32_bf16 v[148:151], a[220:223], a[140:143], v[148:151]
v_cvt_pk_bf16_f32 v118, v132, v133
v_cvt_pk_bf16_f32 v119, v134, v135
v_accvgpr_write_b32 a152, v84
v_accvgpr_write_b32 a153, v85
v_accvgpr_write_b32 a154, v86
v_accvgpr_write_b32 a155, v87
v_permlane16_swap_b32 v116, v118
v_permlane16_swap_b32 v117, v119
v_pk_fma_f32 v[24:25], v[186:187], v[192:193], v[24:25] op_sel_hi:[0,1,1] neg_lo:[1,0,0] neg_hi:[1,0,0]
v_pk_fma_f32 v[26:27], v[186:187], v[194:195], v[26:27] op_sel_hi:[0,1,1] neg_lo:[1,0,0] neg_hi:[1,0,0]
v_pk_mul_f32 v[24:25], v[24:25], v[178:179] op_sel:[0,0] op_sel_hi:[1,0]
v_pk_mul_f32 v[26:27], v[26:27], v[178:179] op_sel:[0,0] op_sel_hi:[1,0]
v_pk_fma_f32 v[40:41], v[186:187], v[196:197], v[40:41] op_sel_hi:[0,1,1] neg_lo:[1,0,0] neg_hi:[1,0,0]
v_pk_fma_f32 v[42:43], v[186:187], v[198:199], v[42:43] op_sel_hi:[0,1,1] neg_lo:[1,0,0] neg_hi:[1,0,0]
v_pk_mul_f32 v[40:41], v[40:41], v[178:179] op_sel:[0,0] op_sel_hi:[1,0]
v_pk_mul_f32 v[42:43], v[42:43], v[178:179] op_sel:[0,0] op_sel_hi:[1,0]
v_mfma_f32_16x16x32_bf16 v[152:155], a[192:195], a[144:147], 0
v_cvt_pk_bf16_f32 v24, v24, v25
v_cvt_pk_bf16_f32 v25, v26, v27
v_mfma_f32_16x16x32_bf16 v[156:159], a[208:211], a[144:147], 0
v_cvt_pk_bf16_f32 v26, v40, v41
v_cvt_pk_bf16_f32 v27, v42, v43
v_accvgpr_write_b32 a156, v116
v_accvgpr_write_b32 a157, v117
v_accvgpr_write_b32 a158, v118
v_accvgpr_write_b32 a159, v119
v_permlane16_swap_b32 v24, v26
v_permlane16_swap_b32 v25, v27
v_pk_fma_f32 v[56:57], v[186:187], v[200:201], v[56:57] op_sel_hi:[0,1,1] neg_lo:[1,0,0] neg_hi:[1,0,0]
v_pk_fma_f32 v[58:59], v[186:187], v[202:203], v[58:59] op_sel_hi:[0,1,1] neg_lo:[1,0,0] neg_hi:[1,0,0]
v_pk_mul_f32 v[56:57], v[56:57], v[178:179] op_sel:[0,0] op_sel_hi:[1,0]
v_pk_mul_f32 v[58:59], v[58:59], v[178:179] op_sel:[0,0] op_sel_hi:[1,0]
v_pk_fma_f32 v[72:73], v[186:187], v[204:205], v[72:73] op_sel_hi:[0,1,1] neg_lo:[1,0,0] neg_hi:[1,0,0]
v_pk_fma_f32 v[74:75], v[186:187], v[206:207], v[74:75] op_sel_hi:[0,1,1] neg_lo:[1,0,0] neg_hi:[1,0,0]
v_pk_mul_f32 v[72:73], v[72:73], v[178:179] op_sel:[0,0] op_sel_hi:[1,0]
v_pk_mul_f32 v[74:75], v[74:75], v[178:179] op_sel:[0,0] op_sel_hi:[1,0]
v_mfma_f32_16x16x32_bf16 v[152:155], a[196:199], a[148:151], v[152:155]
v_cvt_pk_bf16_f32 v56, v56, v57
v_cvt_pk_bf16_f32 v57, v58, v59
v_mfma_f32_16x16x32_bf16 v[156:159], a[212:215], a[148:151], v[156:159]
v_cvt_pk_bf16_f32 v58, v72, v73
v_cvt_pk_bf16_f32 v59, v74, v75
v_accvgpr_write_b32 a160, v24
v_accvgpr_write_b32 a161, v25
v_accvgpr_write_b32 a162, v26
v_accvgpr_write_b32 a163, v27
v_permlane16_swap_b32 v56, v58
v_permlane16_swap_b32 v57, v59
v_pk_fma_f32 v[88:89], v[186:187], v[208:209], v[88:89] op_sel_hi:[0,1,1] neg_lo:[1,0,0] neg_hi:[1,0,0]
v_pk_fma_f32 v[90:91], v[186:187], v[210:211], v[90:91] op_sel_hi:[0,1,1] neg_lo:[1,0,0] neg_hi:[1,0,0]
v_pk_mul_f32 v[88:89], v[88:89], v[178:179] op_sel:[0,0] op_sel_hi:[1,0]
v_pk_mul_f32 v[90:91], v[90:91], v[178:179] op_sel:[0,0] op_sel_hi:[1,0]
v_pk_fma_f32 v[104:105], v[186:187], v[212:213], v[104:105] op_sel_hi:[0,1,1] neg_lo:[1,0,0] neg_hi:[1,0,0]
v_pk_fma_f32 v[106:107], v[186:187], v[214:215], v[106:107] op_sel_hi:[0,1,1] neg_lo:[1,0,0] neg_hi:[1,0,0]
v_pk_mul_f32 v[104:105], v[104:105], v[178:179] op_sel:[0,0] op_sel_hi:[1,0]
v_pk_mul_f32 v[106:107], v[106:107], v[178:179] op_sel:[0,0] op_sel_hi:[1,0]
v_mfma_f32_16x16x32_bf16 v[152:155], a[200:203], a[152:155], v[152:155]
v_cvt_pk_bf16_f32 v88, v88, v89
v_cvt_pk_bf16_f32 v89, v90, v91
v_mfma_f32_16x16x32_bf16 v[156:159], a[216:219], a[152:155], v[156:159]
v_cvt_pk_bf16_f32 v90, v104, v105
v_cvt_pk_bf16_f32 v91, v106, v107
v_accvgpr_write_b32 a164, v56
v_accvgpr_write_b32 a165, v57
v_accvgpr_write_b32 a166, v58
v_accvgpr_write_b32 a167, v59
v_permlane16_swap_b32 v88, v90
v_permlane16_swap_b32 v89, v91
v_pk_fma_f32 v[120:121], v[186:187], v[216:217], v[120:121] op_sel_hi:[0,1,1] neg_lo:[1,0,0] neg_hi:[1,0,0]
v_pk_fma_f32 v[122:123], v[186:187], v[218:219], v[122:123] op_sel_hi:[0,1,1] neg_lo:[1,0,0] neg_hi:[1,0,0]
v_pk_mul_f32 v[120:121], v[120:121], v[178:179] op_sel:[0,0] op_sel_hi:[1,0]
v_pk_mul_f32 v[122:123], v[122:123], v[178:179] op_sel:[0,0] op_sel_hi:[1,0]
v_pk_fma_f32 v[136:137], v[186:187], v[220:221], v[136:137] op_sel_hi:[0,1,1] neg_lo:[1,0,0] neg_hi:[1,0,0]
v_pk_fma_f32 v[138:139], v[186:187], v[222:223], v[138:139] op_sel_hi:[0,1,1] neg_lo:[1,0,0] neg_hi:[1,0,0]
v_pk_mul_f32 v[136:137], v[136:137], v[178:179] op_sel:[0,0] op_sel_hi:[1,0]
v_pk_mul_f32 v[138:139], v[138:139], v[178:179] op_sel:[0,0] op_sel_hi:[1,0]
v_mfma_f32_16x16x32_bf16 v[152:155], a[204:207], a[156:159], v[152:155]
v_cvt_pk_bf16_f32 v120, v120, v121
v_cvt_pk_bf16_f32 v121, v122, v123
v_mfma_f32_16x16x32_bf16 v[156:159], a[220:223], a[156:159], v[156:159]
v_cvt_pk_bf16_f32 v122, v136, v137
v_cvt_pk_bf16_f32 v123, v138, v139
v_accvgpr_write_b32 a168, v88
v_accvgpr_write_b32 a169, v89
v_accvgpr_write_b32 a170, v90
v_accvgpr_write_b32 a171, v91
v_permlane16_swap_b32 v120, v122
v_permlane16_swap_b32 v121, v123
v_pk_fma_f32 v[28:29], v[188:189], v[192:193], v[28:29] op_sel_hi:[0,1,1] neg_lo:[1,0,0] neg_hi:[1,0,0]
v_pk_fma_f32 v[30:31], v[188:189], v[194:195], v[30:31] op_sel_hi:[0,1,1] neg_lo:[1,0,0] neg_hi:[1,0,0]
v_pk_mul_f32 v[28:29], v[28:29], v[178:179] op_sel:[0,1] op_sel_hi:[1,1]
v_pk_mul_f32 v[30:31], v[30:31], v[178:179] op_sel:[0,1] op_sel_hi:[1,1]
v_pk_fma_f32 v[44:45], v[188:189], v[196:197], v[44:45] op_sel_hi:[0,1,1] neg_lo:[1,0,0] neg_hi:[1,0,0]
v_pk_fma_f32 v[46:47], v[188:189], v[198:199], v[46:47] op_sel_hi:[0,1,1] neg_lo:[1,0,0] neg_hi:[1,0,0]
v_pk_mul_f32 v[44:45], v[44:45], v[178:179] op_sel:[0,1] op_sel_hi:[1,1]
v_pk_mul_f32 v[46:47], v[46:47], v[178:179] op_sel:[0,1] op_sel_hi:[1,1]
v_mfma_f32_16x16x32_bf16 v[160:163], a[192:195], a[160:163], 0
v_cvt_pk_bf16_f32 v28, v28, v29
v_cvt_pk_bf16_f32 v29, v30, v31
v_mfma_f32_16x16x32_bf16 v[164:167], a[208:211], a[160:163], 0
v_cvt_pk_bf16_f32 v30, v44, v45
v_cvt_pk_bf16_f32 v31, v46, v47
v_accvgpr_write_b32 a172, v120
v_accvgpr_write_b32 a173, v121
v_accvgpr_write_b32 a174, v122
v_accvgpr_write_b32 a175, v123
v_permlane16_swap_b32 v28, v30
v_permlane16_swap_b32 v29, v31
v_pk_fma_f32 v[60:61], v[188:189], v[200:201], v[60:61] op_sel_hi:[0,1,1] neg_lo:[1,0,0] neg_hi:[1,0,0]
v_pk_fma_f32 v[62:63], v[188:189], v[202:203], v[62:63] op_sel_hi:[0,1,1] neg_lo:[1,0,0] neg_hi:[1,0,0]
v_pk_mul_f32 v[60:61], v[60:61], v[178:179] op_sel:[0,1] op_sel_hi:[1,1]
v_pk_mul_f32 v[62:63], v[62:63], v[178:179] op_sel:[0,1] op_sel_hi:[1,1]
v_pk_fma_f32 v[76:77], v[188:189], v[204:205], v[76:77] op_sel_hi:[0,1,1] neg_lo:[1,0,0] neg_hi:[1,0,0]
v_pk_fma_f32 v[78:79], v[188:189], v[206:207], v[78:79] op_sel_hi:[0,1,1] neg_lo:[1,0,0] neg_hi:[1,0,0]
v_pk_mul_f32 v[76:77], v[76:77], v[178:179] op_sel:[0,1] op_sel_hi:[1,1]
v_pk_mul_f32 v[78:79], v[78:79], v[178:179] op_sel:[0,1] op_sel_hi:[1,1]
v_mfma_f32_16x16x32_bf16 v[160:163], a[196:199], a[164:167], v[160:163]
v_cvt_pk_bf16_f32 v60, v60, v61
v_cvt_pk_bf16_f32 v61, v62, v63
v_mfma_f32_16x16x32_bf16 v[164:167], a[212:215], a[164:167], v[164:167]
v_cvt_pk_bf16_f32 v62, v76, v77
v_cvt_pk_bf16_f32 v63, v78, v79
v_accvgpr_write_b32 a176, v28
v_accvgpr_write_b32 a177, v29
v_accvgpr_write_b32 a178, v30
v_accvgpr_write_b32 a179, v31
v_permlane16_swap_b32 v60, v62
v_permlane16_swap_b32 v61, v63
v_pk_fma_f32 v[92:93], v[188:189], v[208:209], v[92:93] op_sel_hi:[0,1,1] neg_lo:[1,0,0] neg_hi:[1,0,0]
v_pk_fma_f32 v[94:95], v[188:189], v[210:211], v[94:95] op_sel_hi:[0,1,1] neg_lo:[1,0,0] neg_hi:[1,0,0]
v_pk_mul_f32 v[92:93], v[92:93], v[178:179] op_sel:[0,1] op_sel_hi:[1,1]
v_pk_mul_f32 v[94:95], v[94:95], v[178:179] op_sel:[0,1] op_sel_hi:[1,1]
v_pk_fma_f32 v[108:109], v[188:189], v[212:213], v[108:109] op_sel_hi:[0,1,1] neg_lo:[1,0,0] neg_hi:[1,0,0]
v_pk_fma_f32 v[110:111], v[188:189], v[214:215], v[110:111] op_sel_hi:[0,1,1] neg_lo:[1,0,0] neg_hi:[1,0,0]
v_pk_mul_f32 v[108:109], v[108:109], v[178:179] op_sel:[0,1] op_sel_hi:[1,1]
v_pk_mul_f32 v[110:111], v[110:111], v[178:179] op_sel:[0,1] op_sel_hi:[1,1]
v_mfma_f32_16x16x32_bf16 v[160:163], a[200:203], a[168:171], v[160:163]
v_cvt_pk_bf16_f32 v92, v92, v93
v_cvt_pk_bf16_f32 v93, v94, v95
v_mfma_f32_16x16x32_bf16 v[164:167], a[216:219], a[168:171], v[164:167]
v_cvt_pk_bf16_f32 v94, v108, v109
v_cvt_pk_bf16_f32 v95, v110, v111
v_accvgpr_write_b32 a180, v60
v_accvgpr_write_b32 a181, v61
v_accvgpr_write_b32 a182, v62
v_accvgpr_write_b32 a183, v63
v_permlane16_swap_b32 v92, v94
v_permlane16_swap_b32 v93, v95
v_pk_fma_f32 v[124:125], v[188:189], v[216:217], v[124:125] op_sel_hi:[0,1,1] neg_lo:[1,0,0] neg_hi:[1,0,0]
v_pk_fma_f32 v[126:127], v[188:189], v[218:219], v[126:127] op_sel_hi:[0,1,1] neg_lo:[1,0,0] neg_hi:[1,0,0]
v_pk_mul_f32 v[124:125], v[124:125], v[178:179] op_sel:[0,1] op_sel_hi:[1,1]
v_pk_mul_f32 v[126:127], v[126:127], v[178:179] op_sel:[0,1] op_sel_hi:[1,1]
v_pk_fma_f32 v[140:141], v[188:189], v[220:221], v[140:141] op_sel_hi:[0,1,1] neg_lo:[1,0,0] neg_hi:[1,0,0]
v_pk_fma_f32 v[142:143], v[188:189], v[222:223], v[142:143] op_sel_hi:[0,1,1] neg_lo:[1,0,0] neg_hi:[1,0,0]
v_pk_mul_f32 v[140:141], v[140:141], v[178:179] op_sel:[0,1] op_sel_hi:[1,1]
v_pk_mul_f32 v[142:143], v[142:143], v[178:179] op_sel:[0,1] op_sel_hi:[1,1]
v_mfma_f32_16x16x32_bf16 v[160:163], a[204:207], a[172:175], v[160:163]
v_cvt_pk_bf16_f32 v124, v124, v125
v_cvt_pk_bf16_f32 v125, v126, v127
v_mfma_f32_16x16x32_bf16 v[164:167], a[220:223], a[172:175], v[164:167]
v_cvt_pk_bf16_f32 v126, v140, v141
v_cvt_pk_bf16_f32 v127, v142, v143
v_accvgpr_write_b32 a184, v92
v_accvgpr_write_b32 a185, v93
v_accvgpr_write_b32 a186, v94
v_accvgpr_write_b32 a187, v95
v_permlane16_swap_b32 v124, v126
v_permlane16_swap_b32 v125, v127
v_accvgpr_write_b32 a188, v124
v_accvgpr_write_b32 a189, v125
v_accvgpr_write_b32 a190, v126
v_accvgpr_write_b32 a191, v127
s_cmp_lg_u32 s7, 0
s_cbranch_scc1 recurrent_scan__sliding_block_cached__mixer_s_mlp__prompt_kernel_c
recurrent_scan__sliding_block_cached__mixer_s_mlp__prompt_kernel_b:
v_mfma_f32_16x16x32_bf16 v[168:171], a[192:195], a[176:179], 0
ds_read_b128 a[192:195], v1 offset:8704
v_mov_b32 v14, s8
s_lshl_b32 s100, s2, 5
s_add_u32 s100, s100, s3
s_lshl_b32 s100, s100, 2
s_add_u32 s100, s100, 131072
s_waitcnt vmcnt(0)
s_mov_b64 exec, 1
buffer_store_dword v14, off, s[76:79], s100 sc1
s_mov_b64 exec, -1
v_mfma_f32_16x16x32_bf16 v[168:171], a[196:199], a[180:183], v[168:171]
ds_read_b128 a[196:199], v1 offset:8768
s_lshr_b32 s88, s4, 2
v_mfma_f32_16x16x32_bf16 v[168:171], a[200:203], a[184:187], v[168:171]
ds_read_b128 a[200:203], v1 offset:8832
s_lshl_b32 s9, s6, 1
v_mfma_f32_16x16x32_bf16 v[168:171], a[204:207], a[188:191], v[168:171]
ds_read_b128 a[204:207], v1 offset:8896
s_add_u32 s9, s9, s88
v_mfma_f32_16x16x32_bf16 v[172:175], a[208:211], a[176:179], 0
ds_read_b128 a[208:211], v1 offset:13056
s_and_b32 s10, s4, 3
v_mfma_f32_16x16x32_bf16 v[172:175], a[212:215], a[180:183], v[172:175]
ds_read_b128 a[212:215], v1 offset:13120
s_lshl_b32 s12, s10, 8
v_mfma_f32_16x16x32_bf16 v[172:175], a[216:219], a[184:187], v[172:175]
ds_read_b128 a[216:219], v1 offset:13184
s_lshl_b32 s11, s9, 2
v_mfma_f32_16x16x32_bf16 v[172:175], a[220:223], a[188:191], v[172:175]
ds_read_b128 a[220:223], v1 offset:13248
s_add_u32 s11, s11, s3
s_lshl_b32 s11, s11, 5
v_bfe_u32 v14, v0, 4, 1
v_mul_u32_u24 v14, 4, v14
v_lshrrev_b32 v15, 5, v0
v_mul_u32_u24 v15, 16, v15
v_add_u32 v14, v14, v15
s_and_b32 s88, s3, 1
s_mul_i32 s88, s88, 8
s_lshr_b32 s89, s3, 1
s_lshl_b32 s89, s89, 5
s_add_u32 s88, s88, s89
v_add_u32 v14, s88, v14
s_mov_b32 s89, 1024
v_mul_lo_u32 v14, v14, s89
v_and_b32 v15, 15, v0
v_lshl_add_u32 v240, v15, 4, v14
v_add_u32 v240, 128, v240
v_subrev_u32 v241, 32, v240
v_subrev_u32 v242, 64, v240
v_subrev_u32 v243, 96, v240
v_bfe_u32 v14, v0, 2, 3
v_mul_u32_u24 v14, 1056, v14
v_lshrrev_b32 v15, 5, v0
v_lshl_add_u32 v14, v15, 9, v14
v_and_b32 v15, 3, v0
v_lshl_add_u32 v248, v15, 3, v14
v_add_u32 v249, 50688, v248
s_waitcnt lgkmcnt(7)
v_mfma_f32_16x16x32_bf16 v[176:179], a[192:195], a[128:131], 0
v_exp_f32 v144, v144
v_mfma_f32_16x16x32_bf16 v[184:187], a[192:195], a[144:147], 0
v_exp_f32 v145, v145
v_mfma_f32_16x16x32_bf16 v[192:195], a[192:195], a[160:163], 0
v_cvt_pk_bf16_f32 v208, v144, v145
v_exp_f32 v146, v146
v_mfma_f32_16x16x32_bf16 v[200:203], a[192:195], a[176:179], 0
s_waitcnt lgkmcnt(0)
s_barrier
ds_read_b128 a[192:195], v1 offset:34816
v_exp_f32 v147, v147
v_mfma_f32_16x16x32_bf16 v[200:203], a[196:199], a[180:183], v[200:203]
v_cvt_pk_bf16_f32 v209, v146, v147
v_exp_f32 v148, v148
v_mfma_f32_16x16x32_bf16 v[192:195], a[196:199], a[164:167], v[192:195]
s_add_u32 m0, s99, 103424
s_add_u32 s95, s94, 32768
v_exp_f32 v149, v149
v_mfma_f32_16x16x32_bf16 v[184:187], a[196:199], a[148:151], v[184:187]
buffer_load_dwordx4 v4, s[40:43], s95 offen offset:0 lds
v_cvt_pk_bf16_f32 v210, v148, v149
v_exp_f32 v150, v150
v_mfma_f32_16x16x32_bf16 v[176:179], a[196:199], a[132:135], v[176:179]
ds_read_b128 a[196:199], v1 offset:34880
buffer_load_dwordx4 v5, s[40:43], s95 offen offset:1088 lds
v_exp_f32 v151, v151
v_mfma_f32_16x16x32_bf16 v[176:179], a[200:203], a[136:139], v[176:179]
buffer_load_dwordx4 v6, s[40:43], s95 offen offset:2176 lds
v_cvt_pk_bf16_f32 v211, v150, v151
v_exp_f32 v152, v152
v_mfma_f32_16x16x32_bf16 v[184:187], a[200:203], a[152:155], v[184:187]
buffer_load_dwordx4 v7, s[40:43], s95 offen offset:3264 lds
v_exp_f32 v153, v153
v_mfma_f32_16x16x32_bf16 v[192:195], a[200:203], a[168:171], v[192:195]
v_cvt_pk_bf16_f32 v212, v152, v153
v_exp_f32 v154, v154
v_mfma_f32_16x16x32_bf16 v[200:203], a[200:203], a[184:187], v[200:203]
ds_read_b128 a[200:203], v1 offset:34944
s_add_u32 m0, s96, 86016
v_exp_f32 v155, v155
v_mfma_f32_16x16x32_bf16 v[200:203], a[204:207], a[188:191], v[200:203]
s_add_u32 s95, s94, 16384
v_cvt_pk_bf16_f32 v213, v154, v155
v_exp_f32 v156, v156
v_mfma_f32_16x16x32_bf16 v[192:195], a[204:207], a[172:175], v[192:195]
buffer_load_dwordx4 v8, s[44:47], s95 offen offset:0 lds
buffer_load_dwordx4 v9, s[44:47], s95 offen offset:1056 lds
v_exp_f32 v157, v157
v_mfma_f32_16x16x32_bf16 v[184:187], a[204:207], a[156:159], v[184:187]
buffer_load_dwordx4 v10, s[44:47], s95 offen offset:2112 lds
v_cvt_pk_bf16_f32 v214, v156, v157
v_exp_f32 v158, v158
v_mfma_f32_16x16x32_bf16 v[176:179], a[204:207], a[140:143], v[176:179]
ds_read_b128 a[204:207], v1 offset:35008
v_exp_f32 v159, v159
v_mfma_f32_16x16x32_bf16 v[180:183], a[208:211], a[128:131], 0
v_cvt_pk_bf16_f32 v215, v158, v159
v_exp_f32 v160, v160
v_mfma_f32_16x16x32_bf16 v[188:191], a[208:211], a[144:147], 0
buffer_load_dwordx4 v11, s[44:47], s95 offen offset:3168 lds
v_exp_f32 v161, v161
v_mfma_f32_16x16x32_bf16 v[196:199], a[208:211], a[160:163], 0
s_add_u32 s31, s12, 0
v_cvt_pk_bf16_f32 v216, v160, v161
v_exp_f32 v162, v162
v_mfma_f32_16x16x32_bf16 v[204:207], a[208:211], a[176:179], 0
ds_read_b128 a[208:211], v1 offset:39168
s_add_u32 m0, s96, 0
v_exp_f32 v163, v163
v_mfma_f32_16x16x32_bf16 v[204:207], a[212:215], a[180:183], v[204:207]
buffer_load_dwordx4 v240, s[60:63], s31 offen offset:0 lds
v_cvt_pk_bf16_f32 v217, v162, v163
v_exp_f32 v164, v164
v_mfma_f32_16x16x32_bf16 v[196:199], a[212:215], a[164:167], v[196:199]
buffer_load_dwordx4 v241, s[60:63], s31 offen offset:1056 lds
buffer_load_dwordx4 v242, s[60:63], s31 offen offset:2112 lds
v_exp_f32 v165, v165
v_mfma_f32_16x16x32_bf16 v[188:191], a[212:215], a[148:151], v[188:191]
v_cvt_pk_bf16_f32 v218, v164, v165
v_exp_f32 v166, v166
v_mfma_f32_16x16x32_bf16 v[180:183], a[212:215], a[132:135], v[180:183]
ds_read_b128 a[212:215], v1 offset:39232
buffer_load_dwordx4 v243, s[60:63], s31 offen offset:3168 lds
v_exp_f32 v167, v167
v_mfma_f32_16x16x32_bf16 v[180:183], a[216:219], a[136:139], v[180:183]
v_cvt_pk_bf16_f32 v219, v166, v167
v_exp_f32 v168, v168
v_mfma_f32_16x16x32_bf16 v[188:191], a[216:219], a[152:155], v[188:191]
s_add_u32 s31, s12, 65536
s_add_u32 m0, s96, 16896
v_exp_f32 v169, v169
v_mfma_f32_16x16x32_bf16 v[196:199], a[216:219], a[168:171], v[196:199]
buffer_load_dwordx4 v240, s[60:63], s31 offen offset:0 lds
v_cvt_pk_bf16_f32 v220, v168, v169
v_exp_f32 v170, v170
v_mfma_f32_16x16x32_bf16 v[204:207], a[216:219], a[184:187], v[204:207]
ds_read_b128 a[216:219], v1 offset:39296
buffer_load_dwordx4 v241, s[60:63], s31 offen offset:1056 lds
v_exp_f32 v171, v171
v_mfma_f32_16x16x32_bf16 v[204:207], a[220:223], a[188:191], v[204:207]
v_cvt_pk_bf16_f32 v221, v170, v171
v_exp_f32 v172, v172
v_mfma_f32_16x16x32_bf16 v[196:199], a[220:223], a[172:175], v[196:199]
buffer_load_dwordx4 v242, s[60:63], s31 offen offset:2112 lds
v_exp_f32 v173, v173
v_mfma_f32_16x16x32_bf16 v[188:191], a[220:223], a[156:159], v[188:191]
buffer_load_dwordx4 v243, s[60:63], s31 offen offset:3168 lds
v_cvt_pk_bf16_f32 v222, v172, v173
v_exp_f32 v174, v174
v_mfma_f32_16x16x32_bf16 v[180:183], a[220:223], a[140:143], v[180:183]
ds_read_b128 a[220:223], v1 offset:39360
v_exp_f32 v175, v175
s_nop 0
v_cvt_pk_bf16_f32 v223, v174, v175
s_waitcnt lgkmcnt(0)
v_mfma_f32_16x16x32_bf16 v[144:147], a[192:195], a[128:131], 0
v_exp_f32 v176, v176
v_mfma_f32_16x16x32_bf16 v[152:155], a[192:195], a[144:147], 0
ds_read_b64_tr_b16 a[224:225], v3 offset:34816
s_lshl_b32 s88, s4, 2
s_add_u32 s88, s88, s3
v_mfma_f32_16x16x32_bf16 v[160:163], a[192:195], a[160:163], 0
s_and_b32 s88, s88, 15
v_exp_f32 v177, v177
v_mfma_f32_16x16x32_bf16 v[168:171], a[192:195], a[176:179], 0
ds_read_b64_tr_b16 a[226:227], v3 offset:35328
s_lshl_b32 s88, s88, 10
v_cvt_pk_bf16_f32 v224, v176, v177
v_mfma_f32_16x16x32_bf16 v[168:171], a[196:199], a[180:183], v[168:171]
v_lshlrev_b32 v252, 4, v0
v_exp_f32 v178, v178
v_mfma_f32_16x16x32_bf16 v[160:163], a[196:199], a[164:167], v[160:163]
ds_read_b64_tr_b16 a[228:229], v3 offset:34848
s_add_u32 s88, s88, recurrent_scan__sliding_block_cached__mixer_s_mlp__prompt_kernel_bm2-recurrent_scan__sliding_block_cached__mixer_s_mlp__prompt_kernel_pc
buffer_load_dword v253, v252, s[72:75], s88 offen
v_mfma_f32_16x16x32_bf16 v[152:155], a[196:199], a[148:151], v[152:155]
v_exp_f32 v179, v179
v_mfma_f32_16x16x32_bf16 v[144:147], a[196:199], a[132:135], v[144:147]
ds_read_b64_tr_b16 a[230:231], v3 offset:35360
v_cvt_pk_bf16_f32 v225, v178, v179
v_mfma_f32_16x16x32_bf16 v[144:147], a[200:203], a[136:139], v[144:147]
v_exp_f32 v180, v180
v_mfma_f32_16x16x32_bf16 v[152:155], a[200:203], a[152:155], v[152:155]
ds_read_b64_tr_b16 a[232:233], v3 offset:34880
s_add_u32 s88, s88, 16384
buffer_load_dword v253, v252, s[72:75], s88 offen
v_mfma_f32_16x16x32_bf16 v[160:163], a[200:203], a[168:171], v[160:163]
v_exp_f32 v181, v181
v_mfma_f32_16x16x32_bf16 v[168:171], a[200:203], a[184:187], v[168:171]
ds_read_b64_tr_b16 a[234:235], v3 offset:35392
v_cvt_pk_bf16_f32 v226, v180, v181
v_mfma_f32_16x16x32_bf16 v[168:171], a[204:207], a[188:191], v[168:171]
v_exp_f32 v182, v182
v_mfma_f32_16x16x32_bf16 v[160:163], a[204:207], a[172:175], v[160:163]
ds_read_b64_tr_b16 a[236:237], v3 offset:34912
s_add_u32 s31, s12, 131072
s_add_u32 m0, s96, 33792
v_mfma_f32_16x16x32_bf16 v[152:155], a[204:207], a[156:159], v[152:155]
buffer_load_dwordx4 v240, s[60:63], s31 offen offset:0 lds
v_exp_f32 v183, v183
v_mfma_f32_16x16x32_bf16 v[144:147], a[204:207], a[140:143], v[144:147]
ds_read_b64_tr_b16 a[238:239], v3 offset:35424
v_cvt_pk_bf16_f32 v227, v182, v183
v_mfma_f32_16x16x32_bf16 v[148:151], a[208:211], a[128:131], 0
v_mfma_f32_16x16x32_bf16 v[156:159], a[208:211], a[144:147], 0
v_exp_f32 v184, v184
v_mfma_f32_16x16x32_bf16 v[164:167], a[208:211], a[160:163], 0
ds_read_b64_tr_b16 a[240:241], v3 offset:34944
buffer_load_dwordx4 v241, s[60:63], s31 offen offset:1056 lds
v_mfma_f32_16x16x32_bf16 v[172:175], a[208:211], a[176:179], 0
v_exp_f32 v185, v185
v_mfma_f32_16x16x32_bf16 v[172:175], a[212:215], a[180:183], v[172:175]
ds_read_b64_tr_b16 a[242:243], v3 offset:35456
v_cvt_pk_bf16_f32 v228, v184, v185
v_mfma_f32_16x16x32_bf16 v[164:167], a[212:215], a[164:167], v[164:167]
v_exp_f32 v186, v186
v_mfma_f32_16x16x32_bf16 v[156:159], a[212:215], a[148:151], v[156:159]
ds_read_b64_tr_b16 a[244:245], v3 offset:34976
buffer_load_dwordx4 v242, s[60:63], s31 offen offset:2112 lds
v_mfma_f32_16x16x32_bf16 v[148:151], a[212:215], a[132:135], v[148:151]
v_exp_f32 v187, v187
v_mfma_f32_16x16x32_bf16 v[148:151], a[216:219], a[136:139], v[148:151]
ds_read_b64_tr_b16 a[246:247], v3 offset:35488
v_cvt_pk_bf16_f32 v229, v186, v187
v_mfma_f32_16x16x32_bf16 v[156:159], a[216:219], a[152:155], v[156:159]
v_exp_f32 v188, v188
v_mfma_f32_16x16x32_bf16 v[164:167], a[216:219], a[168:171], v[164:167]
ds_read_b64_tr_b16 a[248:249], v3 offset:35008
buffer_load_dwordx4 v243, s[60:63], s31 offen offset:3168 lds
v_mfma_f32_16x16x32_bf16 v[172:175], a[216:219], a[184:187], v[172:175]
v_exp_f32 v189, v189
v_mfma_f32_16x16x32_bf16 v[172:175], a[220:223], a[188:191], v[172:175]
ds_read_b64_tr_b16 a[250:251], v3 offset:35520
v_cvt_pk_bf16_f32 v230, v188, v189
v_mfma_f32_16x16x32_bf16 v[164:167], a[220:223], a[172:175], v[164:167]
v_exp_f32 v190, v190
v_mfma_f32_16x16x32_bf16 v[156:159], a[220:223], a[156:159], v[156:159]
ds_read_b64_tr_b16 a[252:253], v3 offset:35040
s_add_u32 s31, s12, 196608
v_mfma_f32_16x16x32_bf16 v[148:151], a[220:223], a[140:143], v[148:151]
s_add_u32 m0, s96, 50688
v_exp_f32 v191, v191
s_waitcnt lgkmcnt(7)
v_mfma_f32_16x16x32_bf16 v[16:19], a[224:227], v[208:211], 0
ds_read_b64_tr_b16 a[254:255], v3 offset:35552
buffer_load_dwordx4 v240, s[60:63], s31 offen offset:0 lds
v_cvt_pk_bf16_f32 v231, v190, v191
v_mfma_f32_16x16x32_bf16 v[24:27], a[224:227], v[212:215], 0
v_mfma_f32_16x16x32_bf16 v[32:35], a[224:227], v[216:219], 0
v_exp_f32 v192, v192
v_mfma_f32_16x16x32_bf16 v[40:43], a[224:227], v[220:223], 0
v_mfma_f32_16x16x32_bf16 v[44:47], a[228:231], v[220:223], 0
v_exp_f32 v193, v193
v_mfma_f32_16x16x32_bf16 v[36:39], a[228:231], v[216:219], 0
buffer_load_dwordx4 v241, s[60:63], s31 offen offset:1056 lds
v_cvt_pk_bf16_f32 v232, v192, v193
v_mfma_f32_16x16x32_bf16 v[28:31], a[228:231], v[212:215], 0
v_exp_f32 v194, v194
v_mfma_f32_16x16x32_bf16 v[20:23], a[228:231], v[208:211], 0
v_mfma_f32_16x16x32_bf16 v[48:51], a[232:235], v[208:211], 0
buffer_load_dwordx4 v242, s[60:63], s31 offen offset:2112 lds
v_exp_f32 v195, v195
v_mfma_f32_16x16x32_bf16 v[56:59], a[232:235], v[212:215], 0
s_waitcnt lgkmcnt(0)
v_cvt_pk_bf16_f32 v233, v194, v195
v_mfma_f32_16x16x32_bf16 v[64:67], a[232:235], v[216:219], 0
v_exp_f32 v196, v196
v_mfma_f32_16x16x32_bf16 v[72:75], a[232:235], v[220:223], 0
ds_read_b128 a[192:195], v1 offset:43520
v_mfma_f32_16x16x32_bf16 v[76:79], a[236:239], v[220:223], 0
buffer_load_dwordx4 v243, s[60:63], s31 offen offset:3168 lds
v_exp_f32 v197, v197
v_mfma_f32_16x16x32_bf16 v[68:71], a[236:239], v[216:219], 0
ds_read_b128 a[196:199], v1 offset:43584
v_cvt_pk_bf16_f32 v234, v196, v197
v_mfma_f32_16x16x32_bf16 v[60:63], a[236:239], v[212:215], 0
v_exp_f32 v198, v198
v_mfma_f32_16x16x32_bf16 v[52:55], a[236:239], v[208:211], 0
ds_read_b128 a[200:203], v1 offset:43648
v_mfma_f32_16x16x32_bf16 v[80:83], a[240:243], v[208:211], 0
s_sub_i32 s88, s11, 2
v_exp_f32 v199, v199
v_mfma_f32_16x16x32_bf16 v[88:91], a[240:243], v[212:215], 0
ds_read_b128 a[204:207], v1 offset:43712
v_cvt_pk_bf16_f32 v235, v198, v199
v_mfma_f32_16x16x32_bf16 v[96:99], a[240:243], v[216:219], 0
s_max_i32 s88, s88, 0
s_lshr_b32 s88, s88, 6
s_add_u32 s89, s11, 33
v_mfma_f32_16x16x32_bf16 v[104:107], a[240:243], v[220:223], 0
s_min_u32 s89, s89, 2047
v_exp_f32 v200, v200
v_mfma_f32_16x16x32_bf16 v[108:111], a[244:247], v[220:223], 0
ds_read_b128 a[208:211], v1 offset:47872
s_lshr_b32 s89, s89, 6
v_mov_b32 v15, s88
v_mfma_f32_16x16x32_bf16 v[100:103], a[244:247], v[216:219], 0
v_mov_b32 v252, s89
v_exp_f32 v201, v201
v_mfma_f32_16x16x32_bf16 v[92:95], a[244:247], v[212:215], 0
ds_read_b128 a[212:215], v1 offset:47936
v_cmp_gt_u32 vcc, 32, v0
v_cvt_pk_bf16_f32 v236, v200, v201
v_mfma_f32_16x16x32_bf16 v[84:87], a[244:247], v[208:211], 0
v_cndmask_b32 v15, v252, v15, vcc
v_exp_f32 v202, v202
v_mfma_f32_16x16x32_bf16 v[112:115], a[248:251], v[208:211], 0
ds_read_b128 a[216:219], v1 offset:48000
v_lshrrev_b32 v14, 2, v15
v_lshlrev_b32 v14, 5, v14
v_mfma_f32_16x16x32_bf16 v[120:123], a[248:251], v[212:215], 0
v_and_b32 v252, 3, v0
v_exp_f32 v203, v203
v_mfma_f32_16x16x32_bf16 v[128:131], a[248:251], v[216:219], 0
ds_read_b128 a[220:223], v1 offset:48064
v_lshl_add_u32 v14, v252, 3, v14
v_cvt_pk_bf16_f32 v237, v202, v203
v_mfma_f32_16x16x32_bf16 v[136:139], a[248:251], v[220:223], 0
v_bfe_u32 v252, v0, 2, 3
v_exp_f32 v204, v204
v_mfma_f32_16x16x32_bf16 v[140:143], a[252:255], v[220:223], 0
v_add_u32 v14, v14, v252
v_and_b32 v15, 3, v15
v_lshlrev_b32 v15, 2, v15
v_mfma_f32_16x16x32_bf16 v[132:135], a[252:255], v[216:219], 0
v_lshrrev_b32 v252, 4, v14
v_exp_f32 v205, v205
v_mfma_f32_16x16x32_bf16 v[124:127], a[252:255], v[212:215], 0
v_and_b32 v252, 12, v252
buffer_load_dword v252, v252, s[84:87], 0 offen sc1
v_cvt_pk_bf16_f32 v238, v204, v205
v_mfma_f32_16x16x32_bf16 v[116:119], a[252:255], v[208:211], 0
v_exp_f32 v206, v206
v_mfma_f32_16x16x32_bf16 a[108:111], a[124:127], v[208:211], 0
v_lshl_add_u32 v14, v14, 7, v15
buffer_load_dword v15, v14, s[76:79], s24 offen offset:0 sc1
v_mfma_f32_16x16x32_bf16 a[112:115], a[124:127], v[212:215], 0
v_exp_f32 v207, v207
v_mfma_f32_16x16x32_bf16 a[116:119], a[124:127], v[216:219], 0
v_cvt_pk_bf16_f32 v239, v206, v207
v_mfma_f32_16x16x32_bf16 a[120:123], a[124:127], v[220:223], 0
s_waitcnt lgkmcnt(0)
v_mfma_f32_16x16x32_bf16 v[176:179], a[192:195], a[128:131], 0
v_exp_f32 v144, v144
v_mfma_f32_16x16x32_bf16 v[184:187], a[192:195], a[144:147], 0
ds_read_b64_tr_b16 a[224:225], v3 offset:43264
s_add_u32 s31, s12, 262144
s_add_u32 m0, s96, 67584
v_mfma_f32_16x16x32_bf16 v[192:195], a[192:195], a[160:163], 0
buffer_load_dwordx4 v240, s[60:63], s31 offen offset:0 lds
v_exp_f32 v145, v145
v_mfma_f32_16x16x32_bf16 v[200:203], a[192:195], a[176:179], 0
ds_read_b64_tr_b16 a[226:227], v3 offset:43776
buffer_load_dwordx4 v241, s[60:63], s31 offen offset:1056 lds
v_cvt_pk_bf16_f32 v208, v144, v145
v_mfma_f32_16x16x32_bf16 v[200:203], a[196:199], a[180:183], v[200:203]
v_exp_f32 v146, v146
v_mfma_f32_16x16x32_bf16 v[192:195], a[196:199], a[164:167], v[192:195]
ds_read_b64_tr_b16 a[228:229], v3 offset:43296
v_mfma_f32_16x16x32_bf16 v[184:187], a[196:199], a[148:151], v[184:187]
buffer_load_dwordx4 v242, s[60:63], s31 offen offset:2112 lds
v_exp_f32 v147, v147
v_mfma_f32_16x16x32_bf16 v[176:179], a[196:199], a[132:135], v[176:179]
ds_read_b64_tr_b16 a[230:231], v3 offset:43808
v_cvt_pk_bf16_f32 v209, v146, v147
v_mfma_f32_16x16x32_bf16 v[176:179], a[200:203], a[136:139], v[176:179]
v_exp_f32 v148, v148
v_mfma_f32_16x16x32_bf16 v[184:187], a[200:203], a[152:155], v[184:187]
ds_read_b64_tr_b16 a[232:233], v3 offset:43328
buffer_load_dwordx4 v243, s[60:63], s31 offen offset:3168 lds
v_mfma_f32_16x16x32_bf16 v[192:195], a[200:203], a[168:171], v[192:195]
v_exp_f32 v149, v149
v_mfma_f32_16x16x32_bf16 v[200:203], a[200:203], a[184:187], v[200:203]
ds_read_b64_tr_b16 a[234:235], v3 offset:43840
v_cvt_pk_bf16_f32 v210, v148, v149
v_mfma_f32_16x16x32_bf16 v[200:203], a[204:207], a[188:191], v[200:203]
v_exp_f32 v150, v150
v_mfma_f32_16x16x32_bf16 v[192:195], a[204:207], a[172:175], v[192:195]
ds_read_b64_tr_b16 a[236:237], v3 offset:43360
s_waitcnt vmcnt(4)
v_cmp_ne_u32 vcc, v252, v15
s_cbranch_vccnz reslow_30
reback_31:
v_and_b32 v252, 15, v0
v_mfma_f32_16x16x32_bf16 v[184:187], a[204:207], a[156:159], v[184:187]
s_add_i32 s88, s11, -1
v_exp_f32 v151, v151
v_mfma_f32_16x16x32_bf16 v[176:179], a[204:207], a[140:143], v[176:179]
ds_read_b64_tr_b16 a[238:239], v3 offset:43872
v_add_u32 v252, s88, v252
v_cvt_pk_bf16_f32 v211, v150, v151
v_mfma_f32_16x16x32_bf16 v[180:183], a[208:211], a[128:131], 0
v_ashrrev_i32 v14, 4, v252
v_lshlrev_b32 v14, 10, v14
v_and_b32 v252, 15, v252
v_mfma_f32_16x16x32_bf16 v[188:191], a[208:211], a[144:147], 0
v_and_b32 v15, 48, v0
v_exp_f32 v152, v152
v_mfma_f32_16x16x32_bf16 v[196:199], a[208:211], a[160:163], 0
ds_read_b64_tr_b16 a[240:241], v3 offset:43392
v_add3_u32 v14, v14, v252, v15
v_lshlrev_b32 v14, 4, v14
v_mfma_f32_16x16x32_bf16 v[204:207], a[208:211], a[176:179], 0
v_add_u32 v15, 16384, v14
v_exp_f32 v153, v153
v_mfma_f32_16x16x32_bf16 v[204:207], a[212:215], a[180:183], v[204:207]
ds_read_b64_tr_b16 a[242:243], v3 offset:43904
buffer_load_dwordx4 a[0:3], v14, s[80:83], 0 offen offset:0 sc1
v_cvt_pk_bf16_f32 v212, v152, v153
v_mfma_f32_16x16x32_bf16 v[196:199], a[212:215], a[164:167], v[196:199]
buffer_load_dwordx4 a[4:7], v15, s[80:83], 0 offen offset:0 sc1
v_exp_f32 v154, v154
v_mfma_f32_16x16x32_bf16 v[188:191], a[212:215], a[148:151], v[188:191]
ds_read_b64_tr_b16 a[244:245], v3 offset:43424
buffer_load_dwordx4 a[8:11], v14, s[80:83], 0 offen offset:1024 sc1
v_mfma_f32_16x16x32_bf16 v[180:183], a[212:215], a[132:135], v[180:183]
v_exp_f32 v155, v155
v_mfma_f32_16x16x32_bf16 v[180:183], a[216:219], a[136:139], v[180:183]
ds_read_b64_tr_b16 a[246:247], v3 offset:43936
buffer_load_dwordx4 a[12:15], v15, s[80:83], 0 offen offset:1024 sc1
v_cvt_pk_bf16_f32 v213, v154, v155
v_mfma_f32_16x16x32_bf16 v[188:191], a[216:219], a[152:155], v[188:191]
v_exp_f32 v156, v156
v_mfma_f32_16x16x32_bf16 v[196:199], a[216:219], a[168:171], v[196:199]
ds_read_b64_tr_b16 a[248:249], v3 offset:43456
v_mfma_f32_16x16x32_bf16 v[204:207], a[216:219], a[184:187], v[204:207]
buffer_load_dwordx4 a[16:19], v14, s[80:83], 0 offen offset:2048 sc1
v_exp_f32 v157, v157
v_mfma_f32_16x16x32_bf16 v[204:207], a[220:223], a[188:191], v[204:207]
ds_read_b64_tr_b16 a[250:251], v3 offset:43968
v_cvt_pk_bf16_f32 v214, v156, v157
v_mfma_f32_16x16x32_bf16 v[196:199], a[220:223], a[172:175], v[196:199]
v_exp_f32 v158, v158
v_mfma_f32_16x16x32_bf16 v[188:191], a[220:223], a[156:159], v[188:191]
ds_read_b64_tr_b16 a[252:253], v3 offset:43488
buffer_load_dwordx4 a[20:23], v15, s[80:83], 0 offen offset:2048 sc1
v_mfma_f32_16x16x32_bf16 v[180:183], a[220:223], a[140:143], v[180:183]
v_exp_f32 v159, v159
s_waitcnt lgkmcnt(7)
v_mfma_f32_16x16x32_bf16 v[16:19], a[224:227], v[224:227], v[16:19]
ds_read_b64_tr_b16 a[254:255], v3 offset:44000
v_cvt_pk_bf16_f32 v215, v158, v159
v_mfma_f32_16x16x32_bf16 v[24:27], a[224:227], v[228:231], v[24:27]
buffer_load_dwordx4 a[24:27], v14, s[80:83], 0 offen offset:3072 sc1
v_mfma_f32_16x16x32_bf16 v[32:35], a[224:227], v[232:235], v[32:35]
v_exp_f32 v160, v160
v_mfma_f32_16x16x32_bf16 v[40:43], a[224:227], v[236:239], v[40:43]
v_mfma_f32_16x16x32_bf16 v[44:47], a[228:231], v[236:239], v[44:47]
v_exp_f32 v161, v161
v_mfma_f32_16x16x32_bf16 v[36:39], a[228:231], v[232:235], v[36:39]
buffer_load_dwordx4 a[28:31], v15, s[80:83], 0 offen offset:3072 sc1
v_cvt_pk_bf16_f32 v216, v160, v161
v_mfma_f32_16x16x32_bf16 v[28:31], a[228:231], v[228:231], v[28:31]
v_exp_f32 v162, v162
v_mfma_f32_16x16x32_bf16 v[20:23], a[228:231], v[224:227], v[20:23]
v_and_b32 v252, 15, v0
s_add_i32 s88, s11, 1
v_add_u32 v252, s88, v252
v_mfma_f32_16x16x32_bf16 v[48:51], a[232:235], v[224:227], v[48:51]
v_ashrrev_i32 v14, 4, v252
v_lshlrev_b32 v14, 10, v14
v_exp_f32 v163, v163
v_mfma_f32_16x16x32_bf16 v[56:59], a[232:235], v[228:231], v[56:59]
s_waitcnt lgkmcnt(0)
s_barrier
v_cvt_pk_bf16_f32 v217, v162, v163
v_mfma_f32_16x16x32_bf16 v[64:67], a[232:235], v[232:235], v[64:67]
ds_read_b64_tr_b16 a[224:225], v3 offset:0
v_exp_f32 v164, v164
v_mfma_f32_16x16x32_bf16 v[72:75], a[232:235], v[236:239], v[72:75]
ds_read_b64_tr_b16 a[228:229], v3 offset:32
ds_read_b64_tr_b16 a[232:233], v3 offset:64
v_mfma_f32_16x16x32_bf16 v[76:79], a[236:239], v[236:239], v[76:79]
ds_read_b64_tr_b16 a[226:227], v3 offset:512
v_exp_f32 v165, v165
v_mfma_f32_16x16x32_bf16 v[68:71], a[236:239], v[232:235], v[68:71]
ds_read_b64_tr_b16 a[230:231], v3 offset:544
ds_read_b64_tr_b16 a[234:235], v3 offset:576
v_cvt_pk_bf16_f32 v218, v164, v165
v_mfma_f32_16x16x32_bf16 v[60:63], a[236:239], v[228:231], v[60:63]
v_exp_f32 v166, v166
v_mfma_f32_16x16x32_bf16 v[52:55], a[236:239], v[224:227], v[52:55]
ds_read_b64_tr_b16 a[236:237], v3 offset:96
v_mfma_f32_16x16x32_bf16 v[80:83], a[240:243], v[224:227], v[80:83]
v_exp_f32 v167, v167
v_mfma_f32_16x16x32_bf16 v[88:91], a[240:243], v[228:231], v[88:91]
ds_read_b64_tr_b16 a[238:239], v3 offset:608
v_cvt_pk_bf16_f32 v219, v166, v167
v_mfma_f32_16x16x32_bf16 v[96:99], a[240:243], v[232:235], v[96:99]
v_mfma_f32_16x16x32_bf16 v[104:107], a[240:243], v[236:239], v[104:107]
ds_read_b64_tr_b16 a[240:241], v3 offset:128
v_exp_f32 v168, v168
v_mfma_f32_16x16x32_bf16 v[108:111], a[244:247], v[236:239], v[108:111]
s_add_u32 m0, s99, 138240
s_add_u32 s95, s94, 49152
buffer_load_dwordx4 v4, s[40:43], s95 offen offset:0 lds
v_mfma_f32_16x16x32_bf16 v[100:103], a[244:247], v[232:235], v[100:103]
ds_read_b64_tr_b16 a[242:243], v3 offset:640
v_exp_f32 v169, v169
v_mfma_f32_16x16x32_bf16 v[92:95], a[244:247], v[228:231], v[92:95]
v_cvt_pk_bf16_f32 v220, v168, v169
v_mfma_f32_16x16x32_bf16 v[84:87], a[244:247], v[224:227], v[84:87]
ds_read_b64_tr_b16 a[244:245], v3 offset:160
v_exp_f32 v170, v170
v_mfma_f32_16x16x32_bf16 v[112:115], a[248:251], v[224:227], v[112:115]
buffer_load_dwordx4 v5, s[40:43], s95 offen offset:1088 lds
v_mfma_f32_16x16x32_bf16 v[120:123], a[248:251], v[228:231], v[120:123]
ds_read_b64_tr_b16 a[246:247], v3 offset:672
v_exp_f32 v171, v171
v_mfma_f32_16x16x32_bf16 v[128:131], a[248:251], v[232:235], v[128:131]
v_cvt_pk_bf16_f32 v221, v170, v171
v_mfma_f32_16x16x32_bf16 v[136:139], a[248:251], v[236:239], v[136:139]
ds_read_b64_tr_b16 a[248:249], v3 offset:192
v_exp_f32 v172, v172
v_mfma_f32_16x16x32_bf16 v[140:143], a[252:255], v[236:239], v[140:143]
buffer_load_dwordx4 v6, s[40:43], s95 offen offset:2176 lds
v_mfma_f32_16x16x32_bf16 v[132:135], a[252:255], v[232:235], v[132:135]
ds_read_b64_tr_b16 a[250:251], v3 offset:704
v_exp_f32 v173, v173
v_mfma_f32_16x16x32_bf16 v[124:127], a[252:255], v[228:231], v[124:127]
v_cvt_pk_bf16_f32 v222, v172, v173
v_mfma_f32_16x16x32_bf16 v[116:119], a[252:255], v[224:227], v[116:119]
ds_read_b64_tr_b16 a[252:253], v3 offset:224
v_exp_f32 v174, v174
v_mfma_f32_16x16x32_bf16 a[108:111], a[124:127], v[224:227], a[108:111]
buffer_load_dwordx4 v7, s[40:43], s95 offen offset:3264 lds
v_mfma_f32_16x16x32_bf16 a[112:115], a[124:127], v[228:231], a[112:115]
ds_read_b64_tr_b16 a[254:255], v3 offset:736
v_exp_f32 v175, v175
v_mfma_f32_16x16x32_bf16 a[116:119], a[124:127], v[232:235], a[116:119]
v_cvt_pk_bf16_f32 v223, v174, v175
v_mfma_f32_16x16x32_bf16 a[120:123], a[124:127], v[236:239], a[120:123]
s_waitcnt lgkmcnt(12)
v_mfma_f32_16x16x32_bf16 v[16:19], a[224:227], v[208:211], v[16:19]
s_add_u32 m0, s96, 120832
v_exp_f32 v176, v176
v_mfma_f32_16x16x32_bf16 v[24:27], a[224:227], v[212:215], v[24:27]
s_add_u32 s95, s94, 32768
buffer_load_dwordx4 v8, s[44:47], s95 offen offset:0 lds
v_exp_f32 v177, v177
v_mfma_f32_16x16x32_bf16 v[32:35], a[224:227], v[216:219], v[32:35]
v_cvt_pk_bf16_f32 v224, v176, v177
v_exp_f32 v178, v178
v_mfma_f32_16x16x32_bf16 v[40:43], a[224:227], v[220:223], v[40:43]
ds_read_b64_tr_b16 a[224:225], v3 offset:8448
buffer_load_dwordx4 v9, s[44:47], s95 offen offset:1056 lds
v_exp_f32 v179, v179
s_waitcnt lgkmcnt(12)
v_mfma_f32_16x16x32_bf16 v[44:47], a[228:231], v[220:223], v[44:47]
v_cvt_pk_bf16_f32 v225, v178, v179
v_exp_f32 v180, v180
v_mfma_f32_16x16x32_bf16 v[36:39], a[228:231], v[216:219], v[36:39]
ds_read_b64_tr_b16 a[226:227], v3 offset:8960
buffer_load_dwordx4 v10, s[44:47], s95 offen offset:2112 lds
v_exp_f32 v181, v181
v_mfma_f32_16x16x32_bf16 v[28:31], a[228:231], v[212:215], v[28:31]
v_cvt_pk_bf16_f32 v226, v180, v181
v_exp_f32 v182, v182
v_mfma_f32_16x16x32_bf16 v[20:23], a[228:231], v[208:211], v[20:23]
ds_read_b64_tr_b16 a[228:229], v3 offset:8480
v_exp_f32 v183, v183
s_waitcnt lgkmcnt(13)
v_mfma_f32_16x16x32_bf16 v[48:51], a[232:235], v[208:211], v[48:51]
buffer_load_dwordx4 v11, s[44:47], s95 offen offset:3168 lds
v_cvt_pk_bf16_f32 v227, v182, v183
v_mfma_f32_16x16x32_bf16 v[56:59], a[232:235], v[212:215], v[56:59]
ds_read_b64_tr_b16 a[230:231], v3 offset:8992
v_exp_f32 v184, v184
v_mfma_f32_16x16x32_bf16 v[64:67], a[232:235], v[216:219], v[64:67]
v_and_b32 v252, 15, v252
v_exp_f32 v185, v185
v_mfma_f32_16x16x32_bf16 v[72:75], a[232:235], v[220:223], v[72:75]
ds_read_b64_tr_b16 a[232:233], v3 offset:8512
v_cvt_pk_bf16_f32 v228, v184, v185
v_exp_f32 v186, v186
s_waitcnt lgkmcnt(13)
v_mfma_f32_16x16x32_bf16 v[76:79], a[236:239], v[220:223], v[76:79]
v_and_b32 v15, 48, v0
v_add3_u32 v14, v14, v252, v15
v_lshlrev_b32 v14, 4, v14
v_exp_f32 v187, v187
v_mfma_f32_16x16x32_bf16 v[68:71], a[236:239], v[216:219], v[68:71]
ds_read_b64_tr_b16 a[234:235], v3 offset:9024
v_add_u32 v14, 4096, v14
v_cvt_pk_bf16_f32 v229, v186, v187
v_exp_f32 v188, v188
v_mfma_f32_16x16x32_bf16 v[60:63], a[236:239], v[212:215], v[60:63]
v_add_u32 v15, 16384, v14
buffer_load_dwordx4 a[32:35], v14, s[80:83], 0 offen offset:0 sc1
v_exp_f32 v189, v189
v_mfma_f32_16x16x32_bf16 v[52:55], a[236:239], v[208:211], v[52:55]
ds_read_b64_tr_b16 a[236:237], v3 offset:8544
v_cvt_pk_bf16_f32 v230, v188, v189
v_exp_f32 v190, v190
s_waitcnt lgkmcnt(13)
v_mfma_f32_16x16x32_bf16 v[80:83], a[240:243], v[208:211], v[80:83]
buffer_load_dwordx4 a[36:39], v15, s[80:83], 0 offen offset:0 sc1
v_exp_f32 v191, v191
v_mfma_f32_16x16x32_bf16 v[88:91], a[240:243], v[212:215], v[88:91]
ds_read_b64_tr_b16 a[238:239], v3 offset:9056
buffer_load_dwordx4 a[40:43], v14, s[80:83], 0 offen offset:1024 sc1
v_cvt_pk_bf16_f32 v231, v190, v191
v_mfma_f32_16x16x32_bf16 v[96:99], a[240:243], v[216:219], v[96:99]
v_exp_f32 v192, v192
v_mfma_f32_16x16x32_bf16 v[104:107], a[240:243], v[220:223], v[104:107]
ds_read_b64_tr_b16 a[240:241], v3 offset:8576
v_exp_f32 v193, v193
s_waitcnt lgkmcnt(13)
v_mfma_f32_16x16x32_bf16 v[108:111], a[244:247], v[220:223], v[108:111]
buffer_load_dwordx4 a[44:47], v15, s[80:83], 0 offen offset:1024 sc1
v_cvt_pk_bf16_f32 v232, v192, v193
v_exp_f32 v194, v194
v_mfma_f32_16x16x32_bf16 v[100:103], a[244:247], v[216:219], v[100:103]
ds_read_b64_tr_b16 a[242:243], v3 offset:9088
v_exp_f32 v195, v195
v_mfma_f32_16x16x32_bf16 v[92:95], a[244:247], v[212:215], v[92:95]
buffer_load_dwordx4 a[48:51], v14, s[80:83], 0 offen offset:2048 sc1
v_cvt_pk_bf16_f32 v233, v194, v195
v_exp_f32 v196, v196
v_mfma_f32_16x16x32_bf16 v[84:87], a[244:247], v[208:211], v[84:87]
ds_read_b64_tr_b16 a[244:245], v3 offset:8608
v_exp_f32 v197, v197
s_waitcnt lgkmcnt(13)
v_mfma_f32_16x16x32_bf16 v[112:115], a[248:251], v[208:211], v[112:115]
v_cvt_pk_bf16_f32 v234, v196, v197
v_exp_f32 v198, v198
v_mfma_f32_16x16x32_bf16 v[120:123], a[248:251], v[212:215], v[120:123]
ds_read_b64_tr_b16 a[246:247], v3 offset:9120
v_exp_f32 v199, v199
v_mfma_f32_16x16x32_bf16 v[128:131], a[248:251], v[216:219], v[128:131]
buffer_load_dwordx4 a[52:55], v15, s[80:83], 0 offen offset:2048 sc1
v_cvt_pk_bf16_f32 v235, v198, v199
v_mfma_f32_16x16x32_bf16 v[136:139], a[248:251], v[220:223], v[136:139]
ds_read_b64_tr_b16 a[248:249], v3 offset:8640
v_exp_f32 v200, v200
s_waitcnt lgkmcnt(13)
v_mfma_f32_16x16x32_bf16 v[140:143], a[252:255], v[220:223], v[140:143]
buffer_load_dwordx4 a[56:59], v14, s[80:83], 0 offen offset:3072 sc1
v_exp_f32 v201, v201
v_mfma_f32_16x16x32_bf16 v[132:135], a[252:255], v[216:219], v[132:135]
ds_read_b64_tr_b16 a[250:251], v3 offset:9152
v_cvt_pk_bf16_f32 v236, v200, v201
v_exp_f32 v202, v202
v_mfma_f32_16x16x32_bf16 v[124:127], a[252:255], v[212:215], v[124:127]
buffer_load_dwordx4 a[60:63], v15, s[80:83], 0 offen offset:3072 sc1
v_exp_f32 v203, v203
v_mfma_f32_16x16x32_bf16 v[116:119], a[252:255], v[208:211], v[116:119]
ds_read_b64_tr_b16 a[252:253], v3 offset:8672
v_cvt_pk_bf16_f32 v237, v202, v203
v_exp_f32 v204, v204
v_mfma_f32_16x16x32_bf16 a[108:111], a[124:127], v[208:211], a[108:111]
v_exp_f32 v205, v205
v_mfma_f32_16x16x32_bf16 a[112:115], a[124:127], v[212:215], a[112:115]
ds_read_b64_tr_b16 a[254:255], v3 offset:9184
v_cvt_pk_bf16_f32 v238, v204, v205
v_exp_f32 v206, v206
v_mfma_f32_16x16x32_bf16 a[116:119], a[124:127], v[216:219], a[116:119]
v_and_b32 v252, 15, v0
v_exp_f32 v207, v207
v_mfma_f32_16x16x32_bf16 a[120:123], a[124:127], v[220:223], a[120:123]
s_add_i32 s88, s11, -2
v_add_u32 v252, s88, v252
v_ashrrev_i32 v14, 4, v252
v_lshlrev_b32 v14, 10, v14
v_and_b32 v252, 15, v252
v_and_b32 v15, 48, v0
v_add3_u32 v14, v14, v252, v15
v_lshlrev_b32 v14, 4, v14
v_cvt_pk_bf16_f32 v239, v206, v207
s_waitcnt lgkmcnt(14)
v_mfma_f32_16x16x32_bf16 v[16:19], a[224:227], v[224:227], v[16:19]
v_add_u32 v14, 8192, v14
v_mfma_f32_16x16x32_bf16 v[24:27], a[224:227], v[228:231], v[24:27]
v_add_u32 v15, 16384, v14
v_mfma_f32_16x16x32_bf16 v[32:35], a[224:227], v[232:235], v[32:35]
buffer_load_dwordx4 a[64:67], v14, s[80:83], 0 offen offset:0 sc1
v_mfma_f32_16x16x32_bf16 v[40:43], a[224:227], v[236:239], v[40:43]
buffer_load_dwordx4 a[68:71], v15, s[80:83], 0 offen offset:0 sc1
s_waitcnt lgkmcnt(12)
v_mfma_f32_16x16x32_bf16 v[44:47], a[228:231], v[236:239], v[44:47]
v_mfma_f32_16x16x32_bf16 v[36:39], a[228:231], v[232:235], v[36:39]
v_mfma_f32_16x16x32_bf16 v[28:31], a[228:231], v[228:231], v[28:31]
buffer_load_dwordx4 a[72:75], v14, s[80:83], 0 offen offset:1024 sc1
v_mfma_f32_16x16x32_bf16 v[20:23], a[228:231], v[224:227], v[20:23]
s_waitcnt lgkmcnt(10)
v_mfma_f32_16x16x32_bf16 v[48:51], a[232:235], v[224:227], v[48:51]
v_mfma_f32_16x16x32_bf16 v[56:59], a[232:235], v[228:231], v[56:59]
buffer_load_dwordx4 a[76:79], v15, s[80:83], 0 offen offset:1024 sc1
v_mfma_f32_16x16x32_bf16 v[64:67], a[232:235], v[232:235], v[64:67]
v_mfma_f32_16x16x32_bf16 v[72:75], a[232:235], v[236:239], v[72:75]
s_waitcnt lgkmcnt(8)
v_mfma_f32_16x16x32_bf16 v[76:79], a[236:239], v[236:239], v[76:79]
buffer_load_dwordx4 a[80:83], v14, s[80:83], 0 offen offset:2048 sc1
v_mfma_f32_16x16x32_bf16 v[68:71], a[236:239], v[232:235], v[68:71]
v_mfma_f32_16x16x32_bf16 v[60:63], a[236:239], v[228:231], v[60:63]
v_mfma_f32_16x16x32_bf16 v[52:55], a[236:239], v[224:227], v[52:55]
buffer_load_dwordx4 a[84:87], v15, s[80:83], 0 offen offset:2048 sc1
s_waitcnt lgkmcnt(6)
v_mfma_f32_16x16x32_bf16 v[80:83], a[240:243], v[224:227], v[80:83]
v_mfma_f32_16x16x32_bf16 v[88:91], a[240:243], v[228:231], v[88:91]
buffer_load_dwordx4 a[88:91], v14, s[80:83], 0 offen offset:3072 sc1
v_mfma_f32_16x16x32_bf16 v[96:99], a[240:243], v[232:235], v[96:99]
v_mfma_f32_16x16x32_bf16 v[104:107], a[240:243], v[236:239], v[104:107]
s_waitcnt lgkmcnt(4)
v_mfma_f32_16x16x32_bf16 v[108:111], a[244:247], v[236:239], v[108:111]
buffer_load_dwordx4 a[92:95], v15, s[80:83], 0 offen offset:3072 sc1
v_mfma_f32_16x16x32_bf16 v[100:103], a[244:247], v[232:235], v[100:103]
v_mfma_f32_16x16x32_bf16 v[92:95], a[244:247], v[228:231], v[92:95]
v_mfma_f32_16x16x32_bf16 v[84:87], a[244:247], v[224:227], v[84:87]
v_and_b32 v252, 15, v0
s_waitcnt lgkmcnt(2)
v_mfma_f32_16x16x32_bf16 v[112:115], a[248:251], v[224:227], v[112:115]
s_add_i32 s88, s11, 2
v_mfma_f32_16x16x32_bf16 v[120:123], a[248:251], v[228:231], v[120:123]
v_add_u32 v252, s88, v252
v_mfma_f32_16x16x32_bf16 v[128:131], a[248:251], v[232:235], v[128:131]
v_ashrrev_i32 v14, 4, v252
v_mfma_f32_16x16x32_bf16 v[136:139], a[248:251], v[236:239], v[136:139]
v_lshlrev_b32 v14, 10, v14
s_waitcnt lgkmcnt(0)
v_mfma_f32_16x16x32_bf16 v[140:143], a[252:255], v[236:239], v[140:143]
v_and_b32 v252, 15, v252
v_mfma_f32_16x16x32_bf16 v[132:135], a[252:255], v[232:235], v[132:135]
v_and_b32 v15, 48, v0
v_mfma_f32_16x16x32_bf16 v[124:127], a[252:255], v[228:231], v[124:127]
v_add3_u32 v14, v14, v252, v15
v_mfma_f32_16x16x32_bf16 v[116:119], a[252:255], v[224:227], v[116:119]
v_lshlrev_b32 v14, 4, v14
v_mfma_f32_16x16x32_bf16 a[108:111], a[124:127], v[224:227], a[108:111]
v_add_u32 v14, 12288, v14
v_mfma_f32_16x16x32_bf16 a[112:115], a[124:127], v[228:231], a[112:115]
v_add_u32 v15, 16384, v14
v_mfma_f32_16x16x32_bf16 a[116:119], a[124:127], v[232:235], a[116:119]
buffer_load_dwordx4 a[96:99], v14, s[80:83], 0 offen offset:0 sc1
v_mfma_f32_16x16x32_bf16 a[120:123], a[124:127], v[236:239], a[120:123]
buffer_load_dwordx4 a[100:103], v15, s[80:83], 0 offen offset:0 sc1
buffer_load_dwordx4 a[104:107], v14, s[80:83], 0 offen offset:1024 sc1
recurrent_scan__sliding_block_cached__mixer_s_mlp__prompt_kernel_bm2:
v_accvgpr_read_b32 v2, a108
s_nop 0
v_accvgpr_read_b32 v12, a112
s_nop 0
v_accvgpr_read_b32 v13, a116
s_nop 0
v_accvgpr_read_b32 v250, a120
s_barrier
ds_read_b64_tr_b16 a[224:225], v248 offset:0
ds_read_b64_tr_b16 a[226:227], v248 offset:256
ds_read_b64_tr_b16 a[228:229], v248 offset:32
ds_read_b64_tr_b16 a[230:231], v248 offset:288
ds_read_b64_tr_b16 a[232:233], v248 offset:64
ds_read_b64_tr_b16 a[234:235], v248 offset:320
ds_read_b64_tr_b16 a[236:237], v248 offset:96
ds_read_b64_tr_b16 a[238:239], v248 offset:352
ds_read_b64_tr_b16 a[240:241], v248 offset:128
ds_read_b64_tr_b16 a[242:243], v248 offset:384
ds_read_b64_tr_b16 a[244:245], v248 offset:160
ds_read_b64_tr_b16 a[246:247], v248 offset:416
ds_read_b64_tr_b16 a[248:249], v248 offset:192
ds_read_b64_tr_b16 a[250:251], v248 offset:448
ds_read_b64_tr_b16 a[252:253], v248 offset:224
ds_read_b64_tr_b16 a[254:255], v248 offset:480
s_waitcnt vmcnt(34) lgkmcnt(14)
v_mfma_f32_16x16x32_bf16 v[144:147], a[224:227], a[0:3], 0
s_waitcnt vmcnt(33)
v_mfma_f32_16x16x32_bf16 v[148:151], a[224:227], a[4:7], 0
ds_read_b64_tr_b16 a[224:225], v248 offset:8448
buffer_load_dwordx4 a[108:111], v15, s[80:83], 0 offen offset:1024 sc1
s_waitcnt lgkmcnt(13)
v_mfma_f32_16x16x32_bf16 v[156:159], a[228:231], a[4:7], 0
ds_read_b64_tr_b16 a[226:227], v248 offset:8704
v_mfma_f32_16x16x32_bf16 v[152:155], a[228:231], a[0:3], 0
ds_read_b64_tr_b16 a[228:229], v248 offset:8480
s_waitcnt lgkmcnt(13)
v_mfma_f32_16x16x32_bf16 v[160:163], a[232:235], a[0:3], 0
ds_read_b64_tr_b16 a[230:231], v248 offset:8736
buffer_load_dwordx4 a[112:115], v14, s[80:83], 0 offen offset:2048 sc1
v_mfma_f32_16x16x32_bf16 v[164:167], a[232:235], a[4:7], 0
ds_read_b64_tr_b16 a[232:233], v248 offset:8512
s_waitcnt lgkmcnt(13)
v_mfma_f32_16x16x32_bf16 v[172:175], a[236:239], a[4:7], 0
ds_read_b64_tr_b16 a[234:235], v248 offset:8768
v_mfma_f32_16x16x32_bf16 v[168:171], a[236:239], a[0:3], 0
ds_read_b64_tr_b16 a[236:237], v248 offset:8544
buffer_load_dwordx4 a[116:119], v15, s[80:83], 0 offen offset:2048 sc1
s_waitcnt lgkmcnt(8)
v_mfma_f32_16x16x32_bf16 v[176:179], a[240:243], a[0:3], 0
ds_read_b64_tr_b16 a[238:239], v248 offset:8800
v_mfma_f32_16x16x32_bf16 v[180:183], a[240:243], a[4:7], 0
ds_read_b64_tr_b16 a[240:241], v248 offset:8576
v_mfma_f32_16x16x32_bf16 v[188:191], a[244:247], a[4:7], 0
ds_read_b64_tr_b16 a[242:243], v248 offset:8832
v_mfma_f32_16x16x32_bf16 v[184:187], a[244:247], a[0:3], 0
ds_read_b64_tr_b16 a[244:245], v248 offset:8608
buffer_load_dwordx4 a[120:123], v14, s[80:83], 0 offen offset:3072 sc1
v_mfma_f32_16x16x32_bf16 v[192:195], a[248:251], a[0:3], 0
ds_read_b64_tr_b16 a[246:247], v248 offset:8864
v_mfma_f32_16x16x32_bf16 v[196:199], a[248:251], a[4:7], 0
ds_read_b64_tr_b16 a[248:249], v248 offset:8640
s_waitcnt lgkmcnt(13)
v_mfma_f32_16x16x32_bf16 v[204:207], a[252:255], a[4:7], 0
ds_read_b64_tr_b16 a[250:251], v248 offset:8896
buffer_load_dwordx4 a[124:127], v15, s[80:83], 0 offen offset:3072 sc1
v_mfma_f32_16x16x32_bf16 v[200:203], a[252:255], a[0:3], 0
ds_read_b64_tr_b16 a[252:253], v248 offset:8672
s_waitcnt lgkmcnt(8)
s_waitcnt vmcnt(37)
v_mfma_f32_16x16x32_bf16 v[144:147], a[224:227], a[8:11], v[144:147]
ds_read_b64_tr_b16 a[254:255], v248 offset:8928
s_waitcnt vmcnt(36)
v_mfma_f32_16x16x32_bf16 v[148:151], a[224:227], a[12:15], v[148:151]
s_barrier
ds_read_b64_tr_b16 a[224:225], v248 offset:16896
v_mfma_f32_16x16x32_bf16 v[156:159], a[228:231], a[12:15], v[156:159]
ds_read_b64_tr_b16 a[226:227], v248 offset:17152
s_lshl_b32 s27, s11, 10
s_lshl_b32 s88, s10, 12
s_add_u32 s27, s27, s88
v_mfma_f32_16x16x32_bf16 v[152:155], a[228:231], a[8:11], v[152:155]
ds_read_b64_tr_b16 a[228:229], v248 offset:16928
s_add_u32 s88, s27, 12582912
buffer_load_dwordx4 v[208:211], v251, s[76:79], s88 offen offset:0 sc1
v_mfma_f32_16x16x32_bf16 v[160:163], a[232:235], a[8:11], v[160:163]
ds_read_b64_tr_b16 a[230:231], v248 offset:17184
v_mfma_f32_16x16x32_bf16 v[164:167], a[232:235], a[12:15], v[164:167]
ds_read_b64_tr_b16 a[232:233], v248 offset:16960
s_waitcnt lgkmcnt(13)
v_mfma_f32_16x16x32_bf16 v[172:175], a[236:239], a[12:15], v[172:175]
ds_read_b64_tr_b16 a[234:235], v248 offset:17216
v_mfma_f32_16x16x32_bf16 v[168:171], a[236:239], a[8:11], v[168:171]
ds_read_b64_tr_b16 a[236:237], v248 offset:16992
buffer_load_dwordx4 v[216:219], v251, s[76:79], s88 offen offset:1024 sc1
s_waitcnt lgkmcnt(8)
v_mfma_f32_16x16x32_bf16 v[176:179], a[240:243], a[8:11], v[176:179]
ds_read_b64_tr_b16 a[238:239], v248 offset:17248
v_mfma_f32_16x16x32_bf16 v[180:183], a[240:243], a[12:15], v[180:183]
ds_read_b64_tr_b16 a[240:241], v248 offset:17024
v_mfma_f32_16x16x32_bf16 v[188:191], a[244:247], a[12:15], v[188:191]
ds_read_b64_tr_b16 a[242:243], v248 offset:17280
buffer_load_dwordx4 v[224:227], v251, s[76:79], s88 offen offset:2048 sc1
v_mfma_f32_16x16x32_bf16 v[184:187], a[244:247], a[8:11], v[184:187]
ds_read_b64_tr_b16 a[244:245], v248 offset:17056
v_mfma_f32_16x16x32_bf16 v[192:195], a[248:251], a[8:11], v[192:195]
ds_read_b64_tr_b16 a[246:247], v248 offset:17312
v_mfma_f32_16x16x32_bf16 v[196:199], a[248:251], a[12:15], v[196:199]
ds_read_b64_tr_b16 a[248:249], v248 offset:17088
s_waitcnt lgkmcnt(13)
v_mfma_f32_16x16x32_bf16 v[204:207], a[252:255], a[12:15], v[204:207]
ds_read_b64_tr_b16 a[250:251], v248 offset:17344
buffer_load_dwordx4 v[232:235], v251, s[76:79], s88 offen offset:3072 sc1
v_mfma_f32_16x16x32_bf16 v[200:203], a[252:255], a[8:11], v[200:203]
ds_read_b64_tr_b16 a[252:253], v248 offset:17120
s_waitcnt lgkmcnt(8)
s_waitcnt vmcnt(39)
v_mfma_f32_16x16x32_bf16 v[144:147], a[224:227], a[16:19], v[144:147]
ds_read_b64_tr_b16 a[254:255], v248 offset:17376
s_waitcnt vmcnt(38)
v_mfma_f32_16x16x32_bf16 v[148:151], a[224:227], a[20:23], v[148:151]
ds_read_b64_tr_b16 a[224:225], v248 offset:25344
s_add_u32 s88, s88, 16384
buffer_load_dwordx4 v[212:215], v251, s[76:79], s88 offen offset:0 sc1
v_mfma_f32_16x16x32_bf16 v[156:159], a[228:231], a[20:23], v[156:159]
ds_read_b64_tr_b16 a[226:227], v248 offset:25600
v_mfma_f32_16x16x32_bf16 v[152:155], a[228:231], a[16:19], v[152:155]
ds_read_b64_tr_b16 a[228:229], v248 offset:25376
v_mfma_f32_16x16x32_bf16 v[160:163], a[232:235], a[16:19], v[160:163]
ds_read_b64_tr_b16 a[230:231], v248 offset:25632
v_mfma_f32_16x16x32_bf16 v[164:167], a[232:235], a[20:23], v[164:167]
ds_read_b64_tr_b16 a[232:233], v248 offset:25408
buffer_load_dwordx4 v[220:223], v251, s[76:79], s88 offen offset:1024 sc1
s_waitcnt lgkmcnt(13)
v_mfma_f32_16x16x32_bf16 v[172:175], a[236:239], a[20:23], v[172:175]
ds_read_b64_tr_b16 a[234:235], v248 offset:25664
v_mfma_f32_16x16x32_bf16 v[168:171], a[236:239], a[16:19], v[168:171]
ds_read_b64_tr_b16 a[236:237], v248 offset:25440
s_waitcnt lgkmcnt(8)
v_mfma_f32_16x16x32_bf16 v[176:179], a[240:243], a[16:19], v[176:179]
ds_read_b64_tr_b16 a[238:239], v248 offset:25696
buffer_load_dwordx4 v[228:231], v251, s[76:79], s88 offen offset:2048 sc1
v_mfma_f32_16x16x32_bf16 v[180:183], a[240:243], a[20:23], v[180:183]
ds_read_b64_tr_b16 a[240:241], v248 offset:25472
v_mfma_f32_16x16x32_bf16 v[188:191], a[244:247], a[20:23], v[188:191]
ds_read_b64_tr_b16 a[242:243], v248 offset:25728
v_mfma_f32_16x16x32_bf16 v[184:187], a[244:247], a[16:19], v[184:187]
ds_read_b64_tr_b16 a[244:245], v248 offset:25504
v_mfma_f32_16x16x32_bf16 v[192:195], a[248:251], a[16:19], v[192:195]
ds_read_b64_tr_b16 a[246:247], v248 offset:25760
buffer_load_dwordx4 v[236:239], v251, s[76:79], s88 offen offset:3072 sc1
v_mfma_f32_16x16x32_bf16 v[196:199], a[248:251], a[20:23], v[196:199]
ds_read_b64_tr_b16 a[248:249], v248 offset:25536
s_waitcnt lgkmcnt(13)
v_mfma_f32_16x16x32_bf16 v[204:207], a[252:255], a[20:23], v[204:207]
ds_read_b64_tr_b16 a[250:251], v248 offset:25792
v_mfma_f32_16x16x32_bf16 v[200:203], a[252:255], a[16:19], v[200:203]
ds_read_b64_tr_b16 a[252:253], v248 offset:25568
s_add_u32 s27, s27, 4194304
s_waitcnt lgkmcnt(8)
s_waitcnt vmcnt(41)
v_mfma_f32_16x16x32_bf16 v[144:147], a[224:227], a[24:27], v[144:147]
ds_read_b64_tr_b16 a[254:255], v248 offset:25824
s_waitcnt vmcnt(40)
v_mfma_f32_16x16x32_bf16 v[148:151], a[224:227], a[28:31], v[148:151]
s_barrier
ds_read_b64_tr_b16 a[224:225], v248 offset:33792
v_and_b32 v14, 1, v0
v_mfma_f32_16x16x32_bf16 v[156:159], a[228:231], a[28:31], v[156:159]
ds_read_b64_tr_b16 a[226:227], v248 offset:34048
s_add_u32 s31, s12, 327680
s_add_u32 m0, s96, 0
v_mfma_f32_16x16x32_bf16 v[152:155], a[228:231], a[24:27], v[152:155]
ds_read_b64_tr_b16 a[228:229], v248 offset:33824
buffer_load_dwordx4 v240, s[60:63], s31 offen offset:0 lds
v_mfma_f32_16x16x32_bf16 v[160:163], a[232:235], a[24:27], v[160:163]
ds_read_b64_tr_b16 a[230:231], v248 offset:34080
v_lshlrev_b32 v14, 4, v14
v_mfma_f32_16x16x32_bf16 v[164:167], a[232:235], a[28:31], v[164:167]
ds_read_b64_tr_b16 a[232:233], v248 offset:33856
s_waitcnt lgkmcnt(13)
v_mfma_f32_16x16x32_bf16 v[172:175], a[236:239], a[28:31], v[172:175]
ds_read_b64_tr_b16 a[234:235], v248 offset:34112
v_mfma_f32_16x16x32_bf16 v[168:171], a[236:239], a[24:27], v[168:171]
ds_read_b64_tr_b16 a[236:237], v248 offset:33888
v_mov_b32 v15, 0x3f80
s_waitcnt lgkmcnt(8)
v_mfma_f32_16x16x32_bf16 v[176:179], a[240:243], a[24:27], v[176:179]
ds_read_b64_tr_b16 a[238:239], v248 offset:34144
v_mfma_f32_16x16x32_bf16 v[180:183], a[240:243], a[28:31], v[180:183]
ds_read_b64_tr_b16 a[240:241], v248 offset:33920
v_mfma_f32_16x16x32_bf16 v[188:191], a[244:247], a[28:31], v[188:191]
ds_read_b64_tr_b16 a[242:243], v248 offset:34176
v_mfma_f32_16x16x32_bf16 v[184:187], a[244:247], a[24:27], v[184:187]
ds_read_b64_tr_b16 a[244:245], v248 offset:33952
buffer_load_dwordx4 v241, s[60:63], s31 offen offset:1056 lds
v_lshlrev_b32 v14, v14, v15
v_mfma_f32_16x16x32_bf16 v[192:195], a[248:251], a[24:27], v[192:195]
ds_read_b64_tr_b16 a[246:247], v248 offset:34208
v_mfma_f32_16x16x32_bf16 v[196:199], a[248:251], a[28:31], v[196:199]
ds_read_b64_tr_b16 a[248:249], v248 offset:33984
s_waitcnt lgkmcnt(13)
v_mfma_f32_16x16x32_bf16 v[204:207], a[252:255], a[28:31], v[204:207]
ds_read_b64_tr_b16 a[250:251], v248 offset:34240
v_bfe_u32 v15, v0, 1, 3
v_mfma_f32_16x16x32_bf16 v[200:203], a[252:255], a[24:27], v[200:203]
ds_read_b64_tr_b16 a[252:253], v248 offset:34016
s_waitcnt lgkmcnt(8)
s_waitcnt vmcnt(33)
v_mfma_f32_16x16x32_bf16 v[144:147], a[224:227], a[32:35], v[144:147]
ds_read_b64_tr_b16 a[254:255], v248 offset:34272
s_waitcnt vmcnt(32)
v_mfma_f32_16x16x32_bf16 v[148:151], a[224:227], a[36:39], v[148:151]
ds_read_b64_tr_b16 a[224:225], v248 offset:42240
v_mfma_f32_16x16x32_bf16 v[156:159], a[228:231], a[36:39], v[156:159]
ds_read_b64_tr_b16 a[226:227], v248 offset:42496
buffer_load_dwordx4 v242, s[60:63], s31 offen offset:2112 lds
v_lshrrev_b32 v252, 4, v0
v_mfma_f32_16x16x32_bf16 v[152:155], a[228:231], a[32:35], v[152:155]
ds_read_b64_tr_b16 a[228:229], v248 offset:42272
v_mfma_f32_16x16x32_bf16 v[160:163], a[232:235], a[32:35], v[160:163]
ds_read_b64_tr_b16 a[230:231], v248 offset:42528
v_mfma_f32_16x16x32_bf16 v[164:167], a[232:235], a[36:39], v[164:167]
ds_read_b64_tr_b16 a[232:233], v248 offset:42304
v_lshlrev_b32 v252, 2, v252
s_waitcnt lgkmcnt(13)
v_mfma_f32_16x16x32_bf16 v[172:175], a[236:239], a[36:39], v[172:175]
ds_read_b64_tr_b16 a[234:235], v248 offset:42560
v_mfma_f32_16x16x32_bf16 v[168:171], a[236:239], a[32:35], v[168:171]
ds_read_b64_tr_b16 a[236:237], v248 offset:42336
s_waitcnt lgkmcnt(8)
v_mfma_f32_16x16x32_bf16 v[176:179], a[240:243], a[32:35], v[176:179]
ds_read_b64_tr_b16 a[238:239], v248 offset:42592
v_mfma_f32_16x16x32_bf16 v[180:183], a[240:243], a[36:39], v[180:183]
ds_read_b64_tr_b16 a[240:241], v248 offset:42368
buffer_load_dwordx4 v243, s[60:63], s31 offen offset:3168 lds
v_sub_u32 v15, v15, v252
v_mfma_f32_16x16x32_bf16 v[188:191], a[244:247], a[36:39], v[188:191]
ds_read_b64_tr_b16 a[242:243], v248 offset:42624
v_mfma_f32_16x16x32_bf16 v[184:187], a[244:247], a[32:35], v[184:187]
ds_read_b64_tr_b16 a[244:245], v248 offset:42400
v_mfma_f32_16x16x32_bf16 v[192:195], a[248:251], a[32:35], v[192:195]
ds_read_b64_tr_b16 a[246:247], v248 offset:42656
v_cmp_eq_u32 vcc, 0, v15
v_mfma_f32_16x16x32_bf16 v[196:199], a[248:251], a[36:39], v[196:199]
ds_read_b64_tr_b16 a[248:249], v248 offset:42432
s_waitcnt lgkmcnt(13)
v_mfma_f32_16x16x32_bf16 v[204:207], a[252:255], a[36:39], v[204:207]
ds_read_b64_tr_b16 a[250:251], v248 offset:42688
v_mfma_f32_16x16x32_bf16 v[200:203], a[252:255], a[32:35], v[200:203]
ds_read_b64_tr_b16 a[252:253], v248 offset:42464
s_waitcnt lgkmcnt(8)
s_waitcnt vmcnt(33)
v_mfma_f32_16x16x32_bf16 v[144:147], a[224:227], a[40:43], v[144:147]
ds_read_b64_tr_b16 a[254:255], v248 offset:42720
v_cndmask_b32 v252, 0, v14, vcc
s_waitcnt vmcnt(32)
v_mfma_f32_16x16x32_bf16 v[148:151], a[224:227], a[44:47], v[148:151]
s_barrier
ds_read_b64_tr_b16 a[224:225], v249 offset:0
v_mfma_f32_16x16x32_bf16 v[156:159], a[228:231], a[44:47], v[156:159]
ds_read_b64_tr_b16 a[226:227], v249 offset:256
s_add_u32 s31, s12, 393216
s_add_u32 m0, s96, 16896
v_mfma_f32_16x16x32_bf16 v[152:155], a[228:231], a[40:43], v[152:155]
ds_read_b64_tr_b16 a[228:229], v249 offset:32
buffer_load_dwordx4 v240, s[60:63], s31 offen offset:0 lds
v_accvgpr_write_b32 a192, v252
v_mfma_f32_16x16x32_bf16 v[160:163], a[232:235], a[40:43], v[160:163]
ds_read_b64_tr_b16 a[230:231], v249 offset:288
v_mfma_f32_16x16x32_bf16 v[164:167], a[232:235], a[44:47], v[164:167]
ds_read_b64_tr_b16 a[232:233], v249 offset:64
s_waitcnt lgkmcnt(13)
v_mfma_f32_16x16x32_bf16 v[172:175], a[236:239], a[44:47], v[172:175]
ds_read_b64_tr_b16 a[234:235], v249 offset:320
v_mfma_f32_16x16x32_bf16 v[168:171], a[236:239], a[40:43], v[168:171]
ds_read_b64_tr_b16 a[236:237], v249 offset:96
v_cmp_eq_u32 vcc, 1, v15
s_waitcnt lgkmcnt(8)
v_mfma_f32_16x16x32_bf16 v[176:179], a[240:243], a[40:43], v[176:179]
ds_read_b64_tr_b16 a[238:239], v249 offset:352
v_mfma_f32_16x16x32_bf16 v[180:183], a[240:243], a[44:47], v[180:183]
ds_read_b64_tr_b16 a[240:241], v249 offset:128
v_mfma_f32_16x16x32_bf16 v[188:191], a[244:247], a[44:47], v[188:191]
ds_read_b64_tr_b16 a[242:243], v249 offset:384
v_cndmask_b32 v252, 0, v14, vcc
v_mfma_f32_16x16x32_bf16 v[184:187], a[244:247], a[40:43], v[184:187]
ds_read_b64_tr_b16 a[244:245], v249 offset:160
buffer_load_dwordx4 v241, s[60:63], s31 offen offset:1056 lds
v_mfma_f32_16x16x32_bf16 v[192:195], a[248:251], a[40:43], v[192:195]
ds_read_b64_tr_b16 a[246:247], v249 offset:416
v_mfma_f32_16x16x32_bf16 v[196:199], a[248:251], a[44:47], v[196:199]
ds_read_b64_tr_b16 a[248:249], v249 offset:192
s_waitcnt lgkmcnt(13)
v_mfma_f32_16x16x32_bf16 v[204:207], a[252:255], a[44:47], v[204:207]
ds_read_b64_tr_b16 a[250:251], v249 offset:448
v_accvgpr_write_b32 a193, v252
v_mfma_f32_16x16x32_bf16 v[200:203], a[252:255], a[40:43], v[200:203]
ds_read_b64_tr_b16 a[252:253], v249 offset:224
s_waitcnt lgkmcnt(8)
s_waitcnt vmcnt(33)
v_mfma_f32_16x16x32_bf16 v[144:147], a[224:227], a[48:51], v[144:147]
ds_read_b64_tr_b16 a[254:255], v249 offset:480
s_waitcnt vmcnt(32)
v_mfma_f32_16x16x32_bf16 v[148:151], a[224:227], a[52:55], v[148:151]
ds_read_b64_tr_b16 a[224:225], v249 offset:8448
v_cmp_eq_u32 vcc, 2, v15
v_mfma_f32_16x16x32_bf16 v[156:159], a[228:231], a[52:55], v[156:159]
ds_read_b64_tr_b16 a[226:227], v249 offset:8704
buffer_load_dwordx4 v242, s[60:63], s31 offen offset:2112 lds
v_mfma_f32_16x16x32_bf16 v[152:155], a[228:231], a[48:51], v[152:155]
ds_read_b64_tr_b16 a[228:229], v249 offset:8480
v_mfma_f32_16x16x32_bf16 v[160:163], a[232:235], a[48:51], v[160:163]
ds_read_b64_tr_b16 a[230:231], v249 offset:8736
v_mfma_f32_16x16x32_bf16 v[164:167], a[232:235], a[52:55], v[164:167]
ds_read_b64_tr_b16 a[232:233], v249 offset:8512
v_cndmask_b32 v252, 0, v14, vcc
s_waitcnt lgkmcnt(13)
v_mfma_f32_16x16x32_bf16 v[172:175], a[236:239], a[52:55], v[172:175]
ds_read_b64_tr_b16 a[234:235], v249 offset:8768
v_mfma_f32_16x16x32_bf16 v[168:171], a[236:239], a[48:51], v[168:171]
ds_read_b64_tr_b16 a[236:237], v249 offset:8544
s_waitcnt lgkmcnt(8)
v_mfma_f32_16x16x32_bf16 v[176:179], a[240:243], a[48:51], v[176:179]
ds_read_b64_tr_b16 a[238:239], v249 offset:8800
v_accvgpr_write_b32 a194, v252
v_mfma_f32_16x16x32_bf16 v[180:183], a[240:243], a[52:55], v[180:183]
ds_read_b64_tr_b16 a[240:241], v249 offset:8576
buffer_load_dwordx4 v243, s[60:63], s31 offen offset:3168 lds
v_mfma_f32_16x16x32_bf16 v[188:191], a[244:247], a[52:55], v[188:191]
ds_read_b64_tr_b16 a[242:243], v249 offset:8832
v_mfma_f32_16x16x32_bf16 v[184:187], a[244:247], a[48:51], v[184:187]
ds_read_b64_tr_b16 a[244:245], v249 offset:8608
v_cmp_eq_u32 vcc, 3, v15
v_mfma_f32_16x16x32_bf16 v[192:195], a[248:251], a[48:51], v[192:195]
ds_read_b64_tr_b16 a[246:247], v249 offset:8864
v_mfma_f32_16x16x32_bf16 v[196:199], a[248:251], a[52:55], v[196:199]
ds_read_b64_tr_b16 a[248:249], v249 offset:8640
s_waitcnt lgkmcnt(13)
v_mfma_f32_16x16x32_bf16 v[204:207], a[252:255], a[52:55], v[204:207]
ds_read_b64_tr_b16 a[250:251], v249 offset:8896
v_mfma_f32_16x16x32_bf16 v[200:203], a[252:255], a[48:51], v[200:203]
ds_read_b64_tr_b16 a[252:253], v249 offset:8672
v_cndmask_b32 v252, 0, v14, vcc
s_waitcnt lgkmcnt(8)
s_waitcnt vmcnt(33)
v_mfma_f32_16x16x32_bf16 v[144:147], a[224:227], a[56:59], v[144:147]
ds_read_b64_tr_b16 a[254:255], v249 offset:8928
s_waitcnt vmcnt(32)
v_mfma_f32_16x16x32_bf16 v[148:151], a[224:227], a[60:63], v[148:151]
s_barrier
ds_read_b64_tr_b16 a[224:225], v249 offset:16896
v_mfma_f32_16x16x32_bf16 v[156:159], a[228:231], a[60:63], v[156:159]
ds_read_b64_tr_b16 a[226:227], v249 offset:17152
s_add_u32 s31, s12, 458752
s_add_u32 m0, s96, 33792
v_accvgpr_write_b32 a195, v252
v_mfma_f32_16x16x32_bf16 v[152:155], a[228:231], a[56:59], v[152:155]
ds_read_b64_tr_b16 a[228:229], v249 offset:16928
buffer_load_dwordx4 v240, s[60:63], s31 offen offset:0 lds
v_mfma_f32_16x16x32_bf16 v[160:163], a[232:235], a[56:59], v[160:163]
ds_read_b64_tr_b16 a[230:231], v249 offset:17184
v_mfma_f32_16x16x32_bf16 v[164:167], a[232:235], a[60:63], v[164:167]
ds_read_b64_tr_b16 a[232:233], v249 offset:16960
s_waitcnt lgkmcnt(13)
v_mfma_f32_16x16x32_bf16 v[172:175], a[236:239], a[60:63], v[172:175]
ds_read_b64_tr_b16 a[234:235], v249 offset:17216
v_cmp_eq_u32 vcc, -8, v15
v_mfma_f32_16x16x32_bf16 v[168:171], a[236:239], a[56:59], v[168:171]
ds_read_b64_tr_b16 a[236:237], v249 offset:16992
s_waitcnt lgkmcnt(8)
v_mfma_f32_16x16x32_bf16 v[176:179], a[240:243], a[56:59], v[176:179]
ds_read_b64_tr_b16 a[238:239], v249 offset:17248
v_mfma_f32_16x16x32_bf16 v[180:183], a[240:243], a[60:63], v[180:183]
ds_read_b64_tr_b16 a[240:241], v249 offset:17024
v_cndmask_b32 v252, 0, v14, vcc
v_mfma_f32_16x16x32_bf16 v[188:191], a[244:247], a[60:63], v[188:191]
ds_read_b64_tr_b16 a[242:243], v249 offset:17280
v_mfma_f32_16x16x32_bf16 v[184:187], a[244:247], a[56:59], v[184:187]
ds_read_b64_tr_b16 a[244:245], v249 offset:17056
buffer_load_dwordx4 v241, s[60:63], s31 offen offset:1056 lds
v_mfma_f32_16x16x32_bf16 v[192:195], a[248:251], a[56:59], v[192:195]
ds_read_b64_tr_b16 a[246:247], v249 offset:17312
v_mfma_f32_16x16x32_bf16 v[196:199], a[248:251], a[60:63], v[196:199]
ds_read_b64_tr_b16 a[248:249], v249 offset:17088
v_accvgpr_write_b32 a196, v252
s_waitcnt lgkmcnt(13)
v_mfma_f32_16x16x32_bf16 v[204:207], a[252:255], a[60:63], v[204:207]
ds_read_b64_tr_b16 a[250:251], v249 offset:17344
v_mfma_f32_16x16x32_bf16 v[200:203], a[252:255], a[56:59], v[200:203]
ds_read_b64_tr_b16 a[252:253], v249 offset:17120
s_waitcnt lgkmcnt(8)
s_waitcnt vmcnt(33)
v_mfma_f32_16x16x32_bf16 v[144:147], a[224:227], a[64:67], v[144:147]
ds_read_b64_tr_b16 a[254:255], v249 offset:17376
v_cmp_eq_u32 vcc, -7, v15
s_waitcnt vmcnt(32)
v_mfma_f32_16x16x32_bf16 v[148:151], a[224:227], a[68:71], v[148:151]
ds_read_b64_tr_b16 a[224:225], v249 offset:25344
v_mfma_f32_16x16x32_bf16 v[156:159], a[228:231], a[68:71], v[156:159]
ds_read_b64_tr_b16 a[226:227], v249 offset:25600
buffer_load_dwordx4 v242, s[60:63], s31 offen offset:2112 lds
v_mfma_f32_16x16x32_bf16 v[152:155], a[228:231], a[64:67], v[152:155]
ds_read_b64_tr_b16 a[228:229], v249 offset:25376
v_mfma_f32_16x16x32_bf16 v[160:163], a[232:235], a[64:67], v[160:163]
ds_read_b64_tr_b16 a[230:231], v249 offset:25632
v_cndmask_b32 v252, 0, v14, vcc
v_mfma_f32_16x16x32_bf16 v[164:167], a[232:235], a[68:71], v[164:167]
ds_read_b64_tr_b16 a[232:233], v249 offset:25408
s_waitcnt lgkmcnt(13)
v_mfma_f32_16x16x32_bf16 v[172:175], a[236:239], a[68:71], v[172:175]
ds_read_b64_tr_b16 a[234:235], v249 offset:25664
v_mfma_f32_16x16x32_bf16 v[168:171], a[236:239], a[64:67], v[168:171]
ds_read_b64_tr_b16 a[236:237], v249 offset:25440
v_accvgpr_write_b32 a197, v252
s_waitcnt lgkmcnt(8)
v_mfma_f32_16x16x32_bf16 v[176:179], a[240:243], a[64:67], v[176:179]
ds_read_b64_tr_b16 a[238:239], v249 offset:25696
v_mfma_f32_16x16x32_bf16 v[180:183], a[240:243], a[68:71], v[180:183]
ds_read_b64_tr_b16 a[240:241], v249 offset:25472
buffer_load_dwordx4 v243, s[60:63], s31 offen offset:3168 lds
v_mfma_f32_16x16x32_bf16 v[188:191], a[244:247], a[68:71], v[188:191]
ds_read_b64_tr_b16 a[242:243], v249 offset:25728
v_mfma_f32_16x16x32_bf16 v[184:187], a[244:247], a[64:67], v[184:187]
ds_read_b64_tr_b16 a[244:245], v249 offset:25504
v_cmp_eq_u32 vcc, -6, v15
v_mfma_f32_16x16x32_bf16 v[192:195], a[248:251], a[64:67], v[192:195]
ds_read_b64_tr_b16 a[246:247], v249 offset:25760
v_mfma_f32_16x16x32_bf16 v[196:199], a[248:251], a[68:71], v[196:199]
ds_read_b64_tr_b16 a[248:249], v249 offset:25536
s_waitcnt lgkmcnt(13)
v_mfma_f32_16x16x32_bf16 v[204:207], a[252:255], a[68:71], v[204:207]
ds_read_b64_tr_b16 a[250:251], v249 offset:25792
v_cndmask_b32 v252, 0, v14, vcc
v_mfma_f32_16x16x32_bf16 v[200:203], a[252:255], a[64:67], v[200:203]
ds_read_b64_tr_b16 a[252:253], v249 offset:25568
s_waitcnt lgkmcnt(8)
s_waitcnt vmcnt(33)
v_mfma_f32_16x16x32_bf16 v[144:147], a[224:227], a[72:75], v[144:147]
ds_read_b64_tr_b16 a[254:255], v249 offset:25824
s_waitcnt vmcnt(32)
v_mfma_f32_16x16x32_bf16 v[148:151], a[224:227], a[76:79], v[148:151]
s_waitcnt vmcnt(8)
s_barrier
ds_read_b64_tr_b16 a[224:225], v248 offset:0
v_mfma_f32_16x16x32_bf16 v[156:159], a[228:231], a[76:79], v[156:159]
ds_read_b64_tr_b16 a[226:227], v248 offset:256
v_accvgpr_write_b32 a198, v252
v_mfma_f32_16x16x32_bf16 v[152:155], a[228:231], a[72:75], v[152:155]
ds_read_b64_tr_b16 a[228:229], v248 offset:32
v_mfma_f32_16x16x32_bf16 v[160:163], a[232:235], a[72:75], v[160:163]
ds_read_b64_tr_b16 a[230:231], v248 offset:288
v_mfma_f32_16x16x32_bf16 v[164:167], a[232:235], a[76:79], v[164:167]
ds_read_b64_tr_b16 a[232:233], v248 offset:64
v_cmp_eq_u32 vcc, -5, v15
s_waitcnt lgkmcnt(13)
v_mfma_f32_16x16x32_bf16 v[172:175], a[236:239], a[76:79], v[172:175]
ds_read_b64_tr_b16 a[234:235], v248 offset:320
v_mfma_f32_16x16x32_bf16 v[168:171], a[236:239], a[72:75], v[168:171]
ds_read_b64_tr_b16 a[236:237], v248 offset:96
s_waitcnt lgkmcnt(8)
v_mfma_f32_16x16x32_bf16 v[176:179], a[240:243], a[72:75], v[176:179]
ds_read_b64_tr_b16 a[238:239], v248 offset:352
v_mfma_f32_16x16x32_bf16 v[180:183], a[240:243], a[76:79], v[180:183]
ds_read_b64_tr_b16 a[240:241], v248 offset:128
v_cndmask_b32 v252, 0, v14, vcc
v_mfma_f32_16x16x32_bf16 v[188:191], a[244:247], a[76:79], v[188:191]
ds_read_b64_tr_b16 a[242:243], v248 offset:384
v_mfma_f32_16x16x32_bf16 v[184:187], a[244:247], a[72:75], v[184:187]
ds_read_b64_tr_b16 a[244:245], v248 offset:160
v_mfma_f32_16x16x32_bf16 v[192:195], a[248:251], a[72:75], v[192:195]
ds_read_b64_tr_b16 a[246:247], v248 offset:416
v_accvgpr_write_b32 a199, v252
v_mfma_f32_16x16x32_bf16 v[196:199], a[248:251], a[76:79], v[196:199]
ds_read_b64_tr_b16 a[248:249], v248 offset:192
s_waitcnt lgkmcnt(13)
v_mfma_f32_16x16x32_bf16 v[204:207], a[252:255], a[76:79], v[204:207]
ds_read_b64_tr_b16 a[250:251], v248 offset:448
v_mfma_f32_16x16x32_bf16 v[200:203], a[252:255], a[72:75], v[200:203]
ds_read_b64_tr_b16 a[252:253], v248 offset:224
s_waitcnt lgkmcnt(8)
v_mfma_f32_16x16x32_bf16 v[144:147], a[224:227], a[80:83], v[144:147]
ds_read_b64_tr_b16 a[254:255], v248 offset:480
v_mfma_f32_16x16x32_bf16 v[148:151], a[224:227], a[84:87], v[148:151]
ds_read_b64_tr_b16 a[224:225], v248 offset:8448
v_mfma_f32_16x16x32_bf16 v[156:159], a[228:231], a[84:87], v[156:159]
ds_read_b64_tr_b16 a[226:227], v248 offset:8704
v_mfma_f32_16x16x32_bf16 v[152:155], a[228:231], a[80:83], v[152:155]
ds_read_b64_tr_b16 a[228:229], v248 offset:8480
v_mfma_f32_16x16x32_bf16 v[160:163], a[232:235], a[80:83], v[160:163]
ds_read_b64_tr_b16 a[230:231], v248 offset:8736
v_mfma_f32_16x16x32_bf16 v[164:167], a[232:235], a[84:87], v[164:167]
ds_read_b64_tr_b16 a[232:233], v248 offset:8512
s_waitcnt lgkmcnt(13)
v_mfma_f32_16x16x32_bf16 v[172:175], a[236:239], a[84:87], v[172:175]
ds_read_b64_tr_b16 a[234:235], v248 offset:8768
v_mfma_f32_16x16x32_bf16 v[168:171], a[236:239], a[80:83], v[168:171]
ds_read_b64_tr_b16 a[236:237], v248 offset:8544
s_waitcnt lgkmcnt(8)
v_mfma_f32_16x16x32_bf16 v[176:179], a[240:243], a[80:83], v[176:179]
ds_read_b64_tr_b16 a[238:239], v248 offset:8800
v_mfma_f32_16x16x32_bf16 v[180:183], a[240:243], a[84:87], v[180:183]
ds_read_b64_tr_b16 a[240:241], v248 offset:8576
v_mfma_f32_16x16x32_bf16 v[188:191], a[244:247], a[84:87], v[188:191]
ds_read_b64_tr_b16 a[242:243], v248 offset:8832
v_mfma_f32_16x16x32_bf16 v[184:187], a[244:247], a[80:83], v[184:187]
ds_read_b64_tr_b16 a[244:245], v248 offset:8608
v_mfma_f32_16x16x32_bf16 v[192:195], a[248:251], a[80:83], v[192:195]
ds_read_b64_tr_b16 a[246:247], v248 offset:8864
v_mfma_f32_16x16x32_bf16 v[196:199], a[248:251], a[84:87], v[196:199]
ds_read_b64_tr_b16 a[248:249], v248 offset:8640
s_waitcnt lgkmcnt(13)
v_mfma_f32_16x16x32_bf16 v[204:207], a[252:255], a[84:87], v[204:207]
ds_read_b64_tr_b16 a[250:251], v248 offset:8896
v_mfma_f32_16x16x32_bf16 v[200:203], a[252:255], a[80:83], v[200:203]
ds_read_b64_tr_b16 a[252:253], v248 offset:8672
s_waitcnt lgkmcnt(8)
v_mfma_f32_16x16x32_bf16 v[144:147], a[224:227], a[88:91], v[144:147]
ds_read_b64_tr_b16 a[254:255], v248 offset:8928
v_mfma_f32_16x16x32_bf16 v[148:151], a[224:227], a[92:95], v[148:151]
s_waitcnt vmcnt(4)
s_barrier
ds_read_b64_tr_b16 a[224:225], v248 offset:16896
v_mfma_f32_16x16x32_bf16 v[156:159], a[228:231], a[92:95], v[156:159]
ds_read_b64_tr_b16 a[226:227], v248 offset:17152
v_mfma_f32_16x16x32_bf16 v[152:155], a[228:231], a[88:91], v[152:155]
ds_read_b64_tr_b16 a[228:229], v248 offset:16928
v_mfma_f32_16x16x32_bf16 v[160:163], a[232:235], a[88:91], v[160:163]
ds_read_b64_tr_b16 a[230:231], v248 offset:17184
v_mfma_f32_16x16x32_bf16 v[164:167], a[232:235], a[92:95], v[164:167]
ds_read_b64_tr_b16 a[232:233], v248 offset:16960
s_waitcnt lgkmcnt(13)
v_mfma_f32_16x16x32_bf16 v[172:175], a[236:239], a[92:95], v[172:175]
ds_read_b64_tr_b16 a[234:235], v248 offset:17216
v_mfma_f32_16x16x32_bf16 v[168:171], a[236:239], a[88:91], v[168:171]
ds_read_b64_tr_b16 a[236:237], v248 offset:16992
s_waitcnt lgkmcnt(8)
v_mfma_f32_16x16x32_bf16 v[176:179], a[240:243], a[88:91], v[176:179]
ds_read_b64_tr_b16 a[238:239], v248 offset:17248
v_mfma_f32_16x16x32_bf16 v[180:183], a[240:243], a[92:95], v[180:183]
ds_read_b64_tr_b16 a[240:241], v248 offset:17024
v_mfma_f32_16x16x32_bf16 v[144:147], a[192:195], v[208:211], v[144:147]
v_mfma_f32_16x16x32_bf16 v[148:151], a[192:195], v[212:215], v[148:151]
v_mfma_f32_16x16x32_bf16 v[188:191], a[244:247], a[92:95], v[188:191]
ds_read_b64_tr_b16 a[242:243], v248 offset:17280
v_mfma_f32_16x16x32_bf16 v[152:155], a[196:199], v[208:211], v[152:155]
v_mfma_f32_16x16x32_bf16 v[184:187], a[244:247], a[88:91], v[184:187]
ds_read_b64_tr_b16 a[244:245], v248 offset:17056
v_mfma_f32_16x16x32_bf16 v[156:159], a[196:199], v[212:215], v[156:159]
v_mfma_f32_16x16x32_bf16 v[192:195], a[248:251], a[88:91], v[192:195]
ds_read_b64_tr_b16 a[246:247], v248 offset:17312
v_mfma_f32_16x16x32_bf16 v[160:163], a[192:195], v[216:219], v[160:163]
v_mfma_f32_16x16x32_bf16 v[196:199], a[248:251], a[92:95], v[196:199]
ds_read_b64_tr_b16 a[248:249], v248 offset:17088
v_mfma_f32_16x16x32_bf16 v[164:167], a[192:195], v[220:223], v[164:167]
s_waitcnt lgkmcnt(13)
v_mfma_f32_16x16x32_bf16 v[204:207], a[252:255], a[92:95], v[204:207]
ds_read_b64_tr_b16 a[250:251], v248 offset:17344
v_mfma_f32_16x16x32_bf16 v[168:171], a[196:199], v[216:219], v[168:171]
v_mfma_f32_16x16x32_bf16 v[200:203], a[252:255], a[88:91], v[200:203]
ds_read_b64_tr_b16 a[252:253], v248 offset:17120
v_mfma_f32_16x16x32_bf16 v[172:175], a[196:199], v[220:223], v[172:175]
s_waitcnt lgkmcnt(8)
v_mfma_f32_16x16x32_bf16 v[144:147], a[224:227], a[96:99], v[144:147]
ds_read_b64_tr_b16 a[254:255], v248 offset:17376
v_mfma_f32_16x16x32_bf16 v[176:179], a[192:195], v[224:227], v[176:179]
v_mfma_f32_16x16x32_bf16 v[148:151], a[224:227], a[100:103], v[148:151]
ds_read_b64_tr_b16 a[224:225], v248 offset:25344
v_mfma_f32_16x16x32_bf16 v[180:183], a[192:195], v[228:231], v[180:183]
v_mfma_f32_16x16x32_bf16 v[156:159], a[228:231], a[100:103], v[156:159]
ds_read_b64_tr_b16 a[226:227], v248 offset:25600
v_mfma_f32_16x16x32_bf16 v[184:187], a[196:199], v[224:227], v[184:187]
v_mfma_f32_16x16x32_bf16 v[152:155], a[228:231], a[96:99], v[152:155]
ds_read_b64_tr_b16 a[228:229], v248 offset:25376
v_mfma_f32_16x16x32_bf16 v[188:191], a[196:199], v[228:231], v[188:191]
v_mfma_f32_16x16x32_bf16 v[160:163], a[232:235], a[96:99], v[160:163]
ds_read_b64_tr_b16 a[230:231], v248 offset:25632
v_mfma_f32_16x16x32_bf16 v[192:195], a[192:195], v[232:235], v[192:195]
v_mfma_f32_16x16x32_bf16 v[164:167], a[232:235], a[100:103], v[164:167]
ds_read_b64_tr_b16 a[232:233], v248 offset:25408
v_mfma_f32_16x16x32_bf16 v[196:199], a[192:195], v[236:239], v[196:199]
s_waitcnt lgkmcnt(13)
v_mfma_f32_16x16x32_bf16 v[172:175], a[236:239], a[100:103], v[172:175]
ds_read_b64_tr_b16 a[234:235], v248 offset:25664
v_mfma_f32_16x16x32_bf16 v[200:203], a[196:199], v[232:235], v[200:203]
v_mfma_f32_16x16x32_bf16 v[168:171], a[236:239], a[96:99], v[168:171]
ds_read_b64_tr_b16 a[236:237], v248 offset:25440
v_mfma_f32_16x16x32_bf16 v[204:207], a[196:199], v[236:239], v[204:207]
s_waitcnt lgkmcnt(8)
v_mfma_f32_16x16x32_bf16 v[176:179], a[240:243], a[96:99], v[176:179]
ds_read_b64_tr_b16 a[238:239], v248 offset:25696
v_mfma_f32_16x16x32_bf16 v[180:183], a[240:243], a[100:103], v[180:183]
ds_read_b64_tr_b16 a[240:241], v248 offset:25472
v_mfma_f32_16x16x32_bf16 v[188:191], a[244:247], a[100:103], v[188:191]
ds_read_b64_tr_b16 a[242:243], v248 offset:25728
v_mfma_f32_16x16x32_bf16 v[184:187], a[244:247], a[96:99], v[184:187]
ds_read_b64_tr_b16 a[244:245], v248 offset:25504
v_mfma_f32_16x16x32_bf16 v[192:195], a[248:251], a[96:99], v[192:195]
ds_read_b64_tr_b16 a[246:247], v248 offset:25760
v_mfma_f32_16x16x32_bf16 v[196:199], a[248:251], a[100:103], v[196:199]
ds_read_b64_tr_b16 a[248:249], v248 offset:25536
s_waitcnt lgkmcnt(13)
v_mfma_f32_16x16x32_bf16 v[204:207], a[252:255], a[100:103], v[204:207]
ds_read_b64_tr_b16 a[250:251], v248 offset:25792
v_mfma_f32_16x16x32_bf16 v[200:203], a[252:255], a[96:99], v[200:203]
ds_read_b64_tr_b16 a[252:253], v248 offset:25568
s_waitcnt lgkmcnt(8)
v_mfma_f32_16x16x32_bf16 v[144:147], a[224:227], a[104:107], v[144:147]
ds_read_b64_tr_b16 a[254:255], v248 offset:25824
v_mfma_f32_16x16x32_bf16 v[148:151], a[224:227], a[108:111], v[148:151]
s_waitcnt vmcnt(0)
s_barrier
ds_read_b64_tr_b16 a[224:225], v248 offset:33792
v_mfma_f32_16x16x32_bf16 v[156:159], a[228:231], a[108:111], v[156:159]
ds_read_b64_tr_b16 a[226:227], v248 offset:34048
v_mfma_f32_16x16x32_bf16 v[152:155], a[228:231], a[104:107], v[152:155]
ds_read_b64_tr_b16 a[228:229], v248 offset:33824
v_mfma_f32_16x16x32_bf16 v[160:163], a[232:235], a[104:107], v[160:163]
ds_read_b64_tr_b16 a[230:231], v248 offset:34080
v_mfma_f32_16x16x32_bf16 v[164:167], a[232:235], a[108:111], v[164:167]
ds_read_b64_tr_b16 a[232:233], v248 offset:33856
s_waitcnt lgkmcnt(13)
v_mfma_f32_16x16x32_bf16 v[172:175], a[236:239], a[108:111], v[172:175]
ds_read_b64_tr_b16 a[234:235], v248 offset:34112
v_mfma_f32_16x16x32_bf16 v[168:171], a[236:239], a[104:107], v[168:171]
ds_read_b64_tr_b16 a[236:237], v248 offset:33888
s_waitcnt lgkmcnt(8)
v_mfma_f32_16x16x32_bf16 v[176:179], a[240:243], a[104:107], v[176:179]
ds_read_b64_tr_b16 a[238:239], v248 offset:34144
v_mfma_f32_16x16x32_bf16 v[180:183], a[240:243], a[108:111], v[180:183]
ds_read_b64_tr_b16 a[240:241], v248 offset:33920
v_mfma_f32_16x16x32_bf16 v[188:191], a[244:247], a[108:111], v[188:191]
ds_read_b64_tr_b16 a[242:243], v248 offset:34176
v_mfma_f32_16x16x32_bf16 v[184:187], a[244:247], a[104:107], v[184:187]
ds_read_b64_tr_b16 a[244:245], v248 offset:33952
v_mfma_f32_16x16x32_bf16 v[192:195], a[248:251], a[104:107], v[192:195]
ds_read_b64_tr_b16 a[246:247], v248 offset:34208
v_mfma_f32_16x16x32_bf16 v[196:199], a[248:251], a[108:111], v[196:199]
ds_read_b64_tr_b16 a[248:249], v248 offset:33984
s_waitcnt lgkmcnt(13)
v_mfma_f32_16x16x32_bf16 v[204:207], a[252:255], a[108:111], v[204:207]
ds_read_b64_tr_b16 a[250:251], v248 offset:34240
v_mfma_f32_16x16x32_bf16 v[200:203], a[252:255], a[104:107], v[200:203]
ds_read_b64_tr_b16 a[252:253], v248 offset:34016
s_waitcnt lgkmcnt(8)
v_mfma_f32_16x16x32_bf16 v[144:147], a[224:227], a[112:115], v[144:147]
ds_read_b64_tr_b16 a[254:255], v248 offset:34272
v_mfma_f32_16x16x32_bf16 v[148:151], a[224:227], a[116:119], v[148:151]
ds_read_b64_tr_b16 a[224:225], v248 offset:42240
v_mfma_f32_16x16x32_bf16 v[156:159], a[228:231], a[116:119], v[156:159]
ds_read_b64_tr_b16 a[226:227], v248 offset:42496
v_mfma_f32_16x16x32_bf16 v[152:155], a[228:231], a[112:115], v[152:155]
ds_read_b64_tr_b16 a[228:229], v248 offset:42272
v_mfma_f32_16x16x32_bf16 v[160:163], a[232:235], a[112:115], v[160:163]
ds_read_b64_tr_b16 a[230:231], v248 offset:42528
v_mfma_f32_16x16x32_bf16 v[164:167], a[232:235], a[116:119], v[164:167]
ds_read_b64_tr_b16 a[232:233], v248 offset:42304
s_waitcnt lgkmcnt(13)
v_mfma_f32_16x16x32_bf16 v[172:175], a[236:239], a[116:119], v[172:175]
ds_read_b64_tr_b16 a[234:235], v248 offset:42560
v_mfma_f32_16x16x32_bf16 v[168:171], a[236:239], a[112:115], v[168:171]
ds_read_b64_tr_b16 a[236:237], v248 offset:42336
s_waitcnt lgkmcnt(8)
v_mfma_f32_16x16x32_bf16 v[176:179], a[240:243], a[112:115], v[176:179]
ds_read_b64_tr_b16 a[238:239], v248 offset:42592
v_mfma_f32_16x16x32_bf16 v[180:183], a[240:243], a[116:119], v[180:183]
ds_read_b64_tr_b16 a[240:241], v248 offset:42368
v_mfma_f32_16x16x32_bf16 v[188:191], a[244:247], a[116:119], v[188:191]
ds_read_b64_tr_b16 a[242:243], v248 offset:42624
v_mfma_f32_16x16x32_bf16 v[184:187], a[244:247], a[112:115], v[184:187]
ds_read_b64_tr_b16 a[244:245], v248 offset:42400
v_mfma_f32_16x16x32_bf16 v[192:195], a[248:251], a[112:115], v[192:195]
ds_read_b64_tr_b16 a[246:247], v248 offset:42656
v_mfma_f32_16x16x32_bf16 v[196:199], a[248:251], a[116:119], v[196:199]
ds_read_b64_tr_b16 a[248:249], v248 offset:42432
s_waitcnt lgkmcnt(13)
v_mfma_f32_16x16x32_bf16 v[204:207], a[252:255], a[116:119], v[204:207]
ds_read_b64_tr_b16 a[250:251], v248 offset:42688
v_mfma_f32_16x16x32_bf16 v[200:203], a[252:255], a[112:115], v[200:203]
ds_read_b64_tr_b16 a[252:253], v248 offset:42464
s_waitcnt lgkmcnt(8)
v_mfma_f32_16x16x32_bf16 v[144:147], a[224:227], a[120:123], v[144:147]
ds_read_b64_tr_b16 a[254:255], v248 offset:42720
v_mfma_f32_16x16x32_bf16 v[148:151], a[224:227], a[124:127], v[148:151]
v_mfma_f32_16x16x32_bf16 v[156:159], a[228:231], a[124:127], v[156:159]
v_mfma_f32_16x16x32_bf16 v[152:155], a[228:231], a[120:123], v[152:155]
v_mfma_f32_16x16x32_bf16 v[160:163], a[232:235], a[120:123], v[160:163]
v_mfma_f32_16x16x32_bf16 v[164:167], a[232:235], a[124:127], v[164:167]
s_waitcnt lgkmcnt(8)
v_mfma_f32_16x16x32_bf16 v[172:175], a[236:239], a[124:127], v[172:175]
v_mfma_f32_16x16x32_bf16 v[168:171], a[236:239], a[120:123], v[168:171]
s_waitcnt lgkmcnt(0)
s_barrier
v_mfma_f32_16x16x32_bf16 v[176:179], a[240:243], a[120:123], v[176:179]
ds_read_b128 a[192:195], v1 offset:0
v_mfma_f32_16x16x32_bf16 v[180:183], a[240:243], a[124:127], v[180:183]
ds_read_b128 a[196:199], v1 offset:64
v_mfma_f32_16x16x32_bf16 v[188:191], a[244:247], a[124:127], v[188:191]
ds_read_b128 a[200:203], v1 offset:128
v_mfma_f32_16x16x32_bf16 v[184:187], a[244:247], a[120:123], v[184:187]
ds_read_b128 a[204:207], v1 offset:192
v_mfma_f32_16x16x32_bf16 v[192:195], a[248:251], a[120:123], v[192:195]
ds_read_b128 a[208:211], v1 offset:4352
v_mfma_f32_16x16x32_bf16 v[196:199], a[248:251], a[124:127], v[196:199]
ds_read_b128 a[212:215], v1 offset:4416
v_mfma_f32_16x16x32_bf16 v[204:207], a[252:255], a[124:127], v[204:207]
ds_read_b128 a[216:219], v1 offset:4480
v_mfma_f32_16x16x32_bf16 v[200:203], a[252:255], a[120:123], v[200:203]
ds_read_b128 a[220:223], v1 offset:4544
v_pk_add_f32 v[240:241], v[144:145], v[146:147]
v_pk_mul_f32 v[208:209], v[144:145], v[144:145]
v_pk_fma_f32 v[208:209], v[146:147], v[146:147], v[208:209]
v_pk_add_f32 v[240:241], v[240:241], v[152:153]
v_pk_fma_f32 v[208:209], v[152:153], v[152:153], v[208:209]
v_pk_add_f32 v[240:241], v[240:241], v[154:155]
v_pk_fma_f32 v[208:209], v[154:155], v[154:155], v[208:209]
v_cvt_pk_bf16_f32 v144, v144, v145
v_cvt_pk_bf16_f32 v145, v146, v147
v_cvt_pk_bf16_f32 v146, v152, v153
v_cvt_pk_bf16_f32 v147, v154, v155
buffer_store_dwordx4 v[144:147], v251, s[76:79], s27 offen offset:0 sc1
v_pk_add_f32 v[240:241], v[240:241], v[160:161]
v_pk_fma_f32 v[208:209], v[160:161], v[160:161], v[208:209]
v_pk_add_f32 v[240:241], v[240:241], v[162:163]
v_pk_fma_f32 v[208:209], v[162:163], v[162:163], v[208:209]
v_pk_add_f32 v[240:241], v[240:241], v[168:169]
v_pk_fma_f32 v[208:209], v[168:169], v[168:169], v[208:209]
v_pk_add_f32 v[240:241], v[240:241], v[170:171]
v_pk_fma_f32 v[208:209], v[170:171], v[170:171], v[208:209]
v_cvt_pk_bf16_f32 v160, v160, v161
v_cvt_pk_bf16_f32 v161, v162, v163
v_cvt_pk_bf16_f32 v162, v168, v169
v_cvt_pk_bf16_f32 v163, v170, v171
buffer_store_dwordx4 v[160:163], v251, s[76:79], s27 offen offset:1024 sc1
v_pk_add_f32 v[240:241], v[240:241], v[176:177]
v_pk_fma_f32 v[208:209], v[176:177], v[176:177], v[208:209]
v_pk_add_f32 v[240:241], v[240:241], v[178:179]
v_pk_fma_f32 v[208:209], v[178:179], v[178:179], v[208:209]
v_pk_add_f32 v[240:241], v[240:241], v[184:185]
v_pk_fma_f32 v[208:209], v[184:185], v[184:185], v[208:209]
v_pk_add_f32 v[240:241], v[240:241], v[186:187]
v_pk_fma_f32 v[208:209], v[186:187], v[186:187], v[208:209]
v_cvt_pk_bf16_f32 v176, v176, v177
v_cvt_pk_bf16_f32 v177, v178, v179
v_cvt_pk_bf16_f32 v178, v184, v185
v_cvt_pk_bf16_f32 v179, v186, v187
buffer_store_dwordx4 v[176:179], v251, s[76:79], s27 offen offset:2048 sc1
v_pk_add_f32 v[240:241], v[240:241], v[192:193]
v_pk_fma_f32 v[208:209], v[192:193], v[192:193], v[208:209]
v_pk_add_f32 v[240:241], v[240:241], v[194:195]
v_pk_fma_f32 v[208:209], v[194:195], v[194:195], v[208:209]
v_pk_add_f32 v[240:241], v[240:241], v[200:201]
v_pk_fma_f32 v[208:209], v[200:201], v[200:201], v[208:209]
v_pk_add_f32 v[240:241], v[240:241], v[202:203]
v_pk_fma_f32 v[208:209], v[202:203], v[202:203], v[208:209]
v_cvt_pk_bf16_f32 v192, v192, v193
v_cvt_pk_bf16_f32 v193, v194, v195
v_cvt_pk_bf16_f32 v194, v200, v201
v_cvt_pk_bf16_f32 v195, v202, v203
buffer_store_dwordx4 v[192:195], v251, s[76:79], s27 offen offset:3072 sc1
v_add_f32 v240, v240, v241
v_add_f32 v241, v208, v209
v_pk_add_f32 v[242:243], v[148:149], v[150:151]
v_pk_mul_f32 v[210:211], v[148:149], v[148:149]
v_pk_fma_f32 v[210:211], v[150:151], v[150:151], v[210:211]
v_pk_add_f32 v[242:243], v[242:243], v[156:157]
v_pk_fma_f32 v[210:211], v[156:157], v[156:157], v[210:211]
v_pk_add_f32 v[242:243], v[242:243], v[158:159]
v_pk_fma_f32 v[210:211], v[158:159], v[158:159], v[210:211]
v_cvt_pk_bf16_f32 v148, v148, v149
v_cvt_pk_bf16_f32 v149, v150, v151
v_cvt_pk_bf16_f32 v150, v156, v157
v_cvt_pk_bf16_f32 v151, v158, v159
s_add_u32 s27, s27, 16384
buffer_store_dwordx4 v[148:151], v251, s[76:79], s27 offen offset:0 sc1
v_pk_add_f32 v[242:243], v[242:243], v[164:165]
v_pk_fma_f32 v[210:211], v[164:165], v[164:165], v[210:211]
v_pk_add_f32 v[242:243], v[242:243], v[166:167]
v_pk_fma_f32 v[210:211], v[166:167], v[166:167], v[210:211]
v_pk_add_f32 v[242:243], v[242:243], v[172:173]
v_pk_fma_f32 v[210:211], v[172:173], v[172:173], v[210:211]
v_pk_add_f32 v[242:243], v[242:243], v[174:175]
v_pk_fma_f32 v[210:211], v[174:175], v[174:175], v[210:211]
v_cvt_pk_bf16_f32 v164, v164, v165
v_cvt_pk_bf16_f32 v165, v166, v167
v_cvt_pk_bf16_f32 v166, v172, v173
v_cvt_pk_bf16_f32 v167, v174, v175
buffer_store_dwordx4 v[164:167], v251, s[76:79], s27 offen offset:1024 sc1
v_pk_add_f32 v[242:243], v[242:243], v[180:181]
v_pk_fma_f32 v[210:211], v[180:181], v[180:181], v[210:211]
v_pk_add_f32 v[242:243], v[242:243], v[182:183]
v_pk_fma_f32 v[210:211], v[182:183], v[182:183], v[210:211]
v_pk_add_f32 v[242:243], v[242:243], v[188:189]
v_pk_fma_f32 v[210:211], v[188:189], v[188:189], v[210:211]
v_pk_add_f32 v[242:243], v[242:243], v[190:191]
v_pk_fma_f32 v[210:211], v[190:191], v[190:191], v[210:211]
v_cvt_pk_bf16_f32 v180, v180, v181
v_cvt_pk_bf16_f32 v181, v182, v183
v_cvt_pk_bf16_f32 v182, v188, v189
v_cvt_pk_bf16_f32 v183, v190, v191
buffer_store_dwordx4 v[180:183], v251, s[76:79], s27 offen offset:2048 sc1
v_pk_add_f32 v[242:243], v[242:243], v[196:197]
v_pk_fma_f32 v[210:211], v[196:197], v[196:197], v[210:211]
v_pk_add_f32 v[242:243], v[242:243], v[198:199]
v_pk_fma_f32 v[210:211], v[198:199], v[198:199], v[210:211]
v_pk_add_f32 v[242:243], v[242:243], v[204:205]
v_pk_fma_f32 v[210:211], v[204:205], v[204:205], v[210:211]
v_pk_add_f32 v[242:243], v[242:243], v[206:207]
v_pk_fma_f32 v[210:211], v[206:207], v[206:207], v[210:211]
v_cvt_pk_bf16_f32 v196, v196, v197
v_cvt_pk_bf16_f32 v197, v198, v199
v_cvt_pk_bf16_f32 v198, v204, v205
v_cvt_pk_bf16_f32 v199, v206, v207
buffer_store_dwordx4 v[196:199], v251, s[76:79], s27 offen offset:3072 sc1
v_add_f32 v242, v242, v243
v_add_f32 v243, v210, v211
v_mov_b32 v212, v240
v_mov_b32 v213, v241
v_mov_b32 v214, v242
v_mov_b32 v215, v243
v_permlane16_swap_b32 v212, v240
v_permlane16_swap_b32 v213, v241
v_permlane16_swap_b32 v214, v242
v_permlane16_swap_b32 v215, v243
v_add_f32 v240, v240, v212
v_add_f32 v241, v241, v213
v_add_f32 v242, v242, v214
v_add_f32 v243, v243, v215
v_mov_b32 v212, v240
v_mov_b32 v213, v241
v_mov_b32 v214, v242
v_mov_b32 v215, v243
v_permlane32_swap_b32 v212, v240
v_permlane32_swap_b32 v213, v241
v_permlane32_swap_b32 v214, v242
v_permlane32_swap_b32 v215, v243
v_add_f32 v240, v240, v212
v_add_f32 v241, v241, v213
v_add_f32 v242, v242, v214
v_add_f32 v243, v243, v215
v_lshlrev_b32 v212, 5, v0
s_lshl_b32 s88, s11, 5
s_lshl_b32 s89, s10, 3
s_add_u32 s88, s88, s89
s_add_u32 s88, s88, 65536
s_mov_b64 exec, 0xffff
buffer_store_dwordx2 v[240:241], v212, s[76:79], s88 offen offset:0 sc1
buffer_store_dwordx2 v[242:243], v212, s[76:79], s88 offen offset:512 sc1
s_mov_b64 exec, -1
v_mov_b32 v14, 0x3f803f80
v_accvgpr_write_b32 a124, v14
v_accvgpr_write_b32 a125, v14
v_accvgpr_write_b32 a126, v14
v_accvgpr_write_b32 a127, v14
s_waitcnt lgkmcnt(7)
v_mfma_f32_16x16x32_bf16 v[144:147], a[192:195], a[128:131], 0
s_lshl_b32 s88, s3, 6
v_mfma_f32_16x16x32_bf16 v[152:155], a[192:195], a[144:147], 0
v_add_u32 v252, s88, v0
v_mfma_f32_16x16x32_bf16 v[160:163], a[192:195], a[160:163], 0
v_lshlrev_b32 v252, 5, v252
v_mfma_f32_16x16x32_bf16 v[168:171], a[192:195], a[176:179], 0
ds_read_b128 a[192:195], v1 offset:8704
s_waitcnt lgkmcnt(7)
v_mfma_f32_16x16x32_bf16 v[168:171], a[196:199], a[180:183], v[168:171]
s_lshl_b32 s88, s5, 6
v_mfma_f32_16x16x32_bf16 v[160:163], a[196:199], a[164:167], v[160:163]
s_add_u32 s88, s88, s4
v_mfma_f32_16x16x32_bf16 v[152:155], a[196:199], a[148:151], v[152:155]
s_lshl_b32 s88, s88, 13
s_add_u32 s88, s88, 458752
v_mfma_f32_16x16x32_bf16 v[144:147], a[196:199], a[132:135], v[144:147]
ds_read_b128 a[196:199], v1 offset:8768
s_waitcnt lgkmcnt(7)
v_mfma_f32_16x16x32_bf16 v[144:147], a[200:203], a[136:139], v[144:147]
buffer_load_dword v253, v252, s[40:43], s88 offen
v_mfma_f32_16x16x32_bf16 v[152:155], a[200:203], a[152:155], v[152:155]
v_mfma_f32_16x16x32_bf16 v[160:163], a[200:203], a[168:171], v[160:163]
v_mfma_f32_16x16x32_bf16 v[168:171], a[200:203], a[184:187], v[168:171]
ds_read_b128 a[200:203], v1 offset:8832
s_waitcnt lgkmcnt(7)
v_mfma_f32_16x16x32_bf16 v[168:171], a[204:207], a[188:191], v[168:171]
v_mfma_f32_16x16x32_bf16 v[160:163], a[204:207], a[172:175], v[160:163]
v_mfma_f32_16x16x32_bf16 v[152:155], a[204:207], a[156:159], v[152:155]
v_mfma_f32_16x16x32_bf16 v[144:147], a[204:207], a[140:143], v[144:147]
ds_read_b128 a[204:207], v1 offset:8896
s_waitcnt lgkmcnt(7)
v_mfma_f32_16x16x32_bf16 v[148:151], a[208:211], a[128:131], 0
s_lshl_b32 s88, s3, 6
v_mfma_f32_16x16x32_bf16 v[156:159], a[208:211], a[144:147], 0
v_add_u32 v252, s88, v0
v_mfma_f32_16x16x32_bf16 v[164:167], a[208:211], a[160:163], 0
v_lshlrev_b32 v252, 5, v252
v_mfma_f32_16x16x32_bf16 v[172:175], a[208:211], a[176:179], 0
ds_read_b128 a[208:211], v1 offset:13056
s_waitcnt lgkmcnt(7)
v_mfma_f32_16x16x32_bf16 v[172:175], a[212:215], a[180:183], v[172:175]
s_lshl_b32 s88, s5, 6
v_mfma_f32_16x16x32_bf16 v[164:167], a[212:215], a[164:167], v[164:167]
s_add_u32 s88, s88, s4
v_mfma_f32_16x16x32_bf16 v[156:159], a[212:215], a[148:151], v[156:159]
s_lshl_b32 s88, s88, 13
s_add_u32 s88, s88, 458752
v_mfma_f32_16x16x32_bf16 v[148:151], a[212:215], a[132:135], v[148:151]
ds_read_b128 a[212:215], v1 offset:13120
s_waitcnt lgkmcnt(7)
v_mfma_f32_16x16x32_bf16 v[148:151], a[216:219], a[136:139], v[148:151]
buffer_load_dword v253, v252, s[44:47], s88 offen
v_mfma_f32_16x16x32_bf16 v[156:159], a[216:219], a[152:155], v[156:159]
v_mfma_f32_16x16x32_bf16 v[164:167], a[216:219], a[168:171], v[164:167]
v_mfma_f32_16x16x32_bf16 v[172:175], a[216:219], a[184:187], v[172:175]
ds_read_b128 a[216:219], v1 offset:13184
s_waitcnt lgkmcnt(7)
v_mfma_f32_16x16x32_bf16 v[172:175], a[220:223], a[188:191], v[172:175]
v_mfma_f32_16x16x32_bf16 v[164:167], a[220:223], a[172:175], v[164:167]
v_mfma_f32_16x16x32_bf16 v[156:159], a[220:223], a[156:159], v[156:159]
v_mfma_f32_16x16x32_bf16 v[148:151], a[220:223], a[140:143], v[148:151]
ds_read_b128 a[220:223], v1 offset:13248
s_waitcnt lgkmcnt(7)
v_mfma_f32_16x16x32_bf16 v[176:179], a[192:195], a[128:131], 0
v_exp_f32 v144, v144
v_mfma_f32_16x16x32_bf16 v[184:187], a[192:195], a[144:147], 0
v_exp_f32 v145, v145
v_mfma_f32_16x16x32_bf16 v[192:195], a[192:195], a[160:163], 0
v_cvt_pk_bf16_f32 v208, v144, v145
v_exp_f32 v146, v146
v_mfma_f32_16x16x32_bf16 v[200:203], a[192:195], a[176:179], 0
s_waitcnt lgkmcnt(0)
s_barrier
ds_read_b128 a[192:195], v1 offset:34816
v_exp_f32 v147, v147
v_mfma_f32_16x16x32_bf16 v[200:203], a[196:199], a[180:183], v[200:203]
v_cvt_pk_bf16_f32 v209, v146, v147
v_exp_f32 v148, v148
v_mfma_f32_16x16x32_bf16 v[192:195], a[196:199], a[164:167], v[192:195]
s_add_u32 m0, s99, 103424
s_add_u32 s95, s94, 65536
v_exp_f32 v149, v149
v_mfma_f32_16x16x32_bf16 v[184:187], a[196:199], a[148:151], v[184:187]
buffer_load_dwordx4 v4, s[40:43], s95 offen offset:0 lds
v_cvt_pk_bf16_f32 v210, v148, v149
v_exp_f32 v150, v150
v_mfma_f32_16x16x32_bf16 v[176:179], a[196:199], a[132:135], v[176:179]
ds_read_b128 a[196:199], v1 offset:34880
buffer_load_dwordx4 v5, s[40:43], s95 offen offset:1088 lds
v_exp_f32 v151, v151
v_mfma_f32_16x16x32_bf16 v[176:179], a[200:203], a[136:139], v[176:179]
v_cvt_pk_bf16_f32 v211, v150, v151
v_exp_f32 v152, v152
v_mfma_f32_16x16x32_bf16 v[184:187], a[200:203], a[152:155], v[184:187]
v_exp_f32 v153, v153
v_mfma_f32_16x16x32_bf16 v[192:195], a[200:203], a[168:171], v[192:195]
v_cvt_pk_bf16_f32 v212, v152, v153
v_exp_f32 v154, v154
v_mfma_f32_16x16x32_bf16 v[200:203], a[200:203], a[184:187], v[200:203]
ds_read_b128 a[200:203], v1 offset:34944
buffer_load_dwordx4 v6, s[40:43], s95 offen offset:2176 lds
v_exp_f32 v155, v155
v_mfma_f32_16x16x32_bf16 v[200:203], a[204:207], a[188:191], v[200:203]
v_cvt_pk_bf16_f32 v213, v154, v155
v_exp_f32 v156, v156
v_mfma_f32_16x16x32_bf16 v[192:195], a[204:207], a[172:175], v[192:195]
v_exp_f32 v157, v157
v_mfma_f32_16x16x32_bf16 v[184:187], a[204:207], a[156:159], v[184:187]
buffer_load_dwordx4 v7, s[40:43], s95 offen offset:3264 lds
v_cvt_pk_bf16_f32 v214, v156, v157
v_exp_f32 v158, v158
v_mfma_f32_16x16x32_bf16 v[176:179], a[204:207], a[140:143], v[176:179]
ds_read_b128 a[204:207], v1 offset:35008
v_exp_f32 v159, v159
v_mfma_f32_16x16x32_bf16 v[180:183], a[208:211], a[128:131], 0
v_cvt_pk_bf16_f32 v215, v158, v159
v_exp_f32 v160, v160
v_mfma_f32_16x16x32_bf16 v[188:191], a[208:211], a[144:147], 0
s_add_u32 m0, s96, 86016
s_add_u32 s95, s94, 49152
v_exp_f32 v161, v161
v_mfma_f32_16x16x32_bf16 v[196:199], a[208:211], a[160:163], 0
buffer_load_dwordx4 v8, s[44:47], s95 offen offset:0 lds
v_cvt_pk_bf16_f32 v216, v160, v161
v_exp_f32 v162, v162
v_mfma_f32_16x16x32_bf16 v[204:207], a[208:211], a[176:179], 0
ds_read_b128 a[208:211], v1 offset:39168
v_exp_f32 v163, v163
v_mfma_f32_16x16x32_bf16 v[204:207], a[212:215], a[180:183], v[204:207]
v_cvt_pk_bf16_f32 v217, v162, v163
v_exp_f32 v164, v164
v_mfma_f32_16x16x32_bf16 v[196:199], a[212:215], a[164:167], v[196:199]
buffer_load_dwordx4 v9, s[44:47], s95 offen offset:1056 lds
v_exp_f32 v165, v165
v_mfma_f32_16x16x32_bf16 v[188:191], a[212:215], a[148:151], v[188:191]
v_cvt_pk_bf16_f32 v218, v164, v165
v_exp_f32 v166, v166
v_mfma_f32_16x16x32_bf16 v[180:183], a[212:215], a[132:135], v[180:183]
ds_read_b128 a[212:215], v1 offset:39232
v_exp_f32 v167, v167
v_mfma_f32_16x16x32_bf16 v[180:183], a[216:219], a[136:139], v[180:183]
v_cvt_pk_bf16_f32 v219, v166, v167
v_exp_f32 v168, v168
v_mfma_f32_16x16x32_bf16 v[188:191], a[216:219], a[152:155], v[188:191]
buffer_load_dwordx4 v10, s[44:47], s95 offen offset:2112 lds
v_exp_f32 v169, v169
v_mfma_f32_16x16x32_bf16 v[196:199], a[216:219], a[168:171], v[196:199]
v_cvt_pk_bf16_f32 v220, v168, v169
v_exp_f32 v170, v170
v_mfma_f32_16x16x32_bf16 v[204:207], a[216:219], a[184:187], v[204:207]
ds_read_b128 a[216:219], v1 offset:39296
buffer_load_dwordx4 v11, s[44:47], s95 offen offset:3168 lds
v_exp_f32 v171, v171
v_mfma_f32_16x16x32_bf16 v[204:207], a[220:223], a[188:191], v[204:207]
v_cvt_pk_bf16_f32 v221, v170, v171
v_exp_f32 v172, v172
v_mfma_f32_16x16x32_bf16 v[196:199], a[220:223], a[172:175], v[196:199]
v_exp_f32 v173, v173
v_mfma_f32_16x16x32_bf16 v[188:191], a[220:223], a[156:159], v[188:191]
v_cvt_pk_bf16_f32 v222, v172, v173
v_exp_f32 v174, v174
v_mfma_f32_16x16x32_bf16 v[180:183], a[220:223], a[140:143], v[180:183]
ds_read_b128 a[220:223], v1 offset:39360
v_mov_b32 v14, s8
s_lshl_b32 s100, s2, 5
s_add_u32 s100, s100, s3
s_lshl_b32 s100, s100, 2
s_add_u32 s100, s100, 131088
s_waitcnt vmcnt(10)
s_mov_b64 exec, 1
buffer_store_dword v14, off, s[76:79], s100 sc1
s_mov_b64 exec, -1
v_exp_f32 v175, v175
s_nop 0
v_cvt_pk_bf16_f32 v223, v174, v175
s_waitcnt lgkmcnt(0)
v_mfma_f32_16x16x32_bf16 v[144:147], a[192:195], a[128:131], 0
v_exp_f32 v176, v176
v_mfma_f32_16x16x32_bf16 v[152:155], a[192:195], a[144:147], 0
ds_read_b64_tr_b16 a[224:225], v3 offset:34816
s_lshl_b32 s88, s3, 6
v_add_u32 v252, s88, v0
v_mfma_f32_16x16x32_bf16 v[160:163], a[192:195], a[160:163], 0
v_exp_f32 v177, v177
v_mfma_f32_16x16x32_bf16 v[168:171], a[192:195], a[176:179], 0
ds_read_b64_tr_b16 a[226:227], v3 offset:35328
v_lshlrev_b32 v252, 6, v252
v_cvt_pk_bf16_f32 v224, v176, v177
v_mfma_f32_16x16x32_bf16 v[168:171], a[196:199], a[180:183], v[168:171]
v_exp_f32 v178, v178
v_mfma_f32_16x16x32_bf16 v[160:163], a[196:199], a[164:167], v[160:163]
ds_read_b64_tr_b16 a[228:229], v3 offset:34848
s_lshr_b32 s89, s2, 3
v_mfma_f32_16x16x32_bf16 v[152:155], a[196:199], a[148:151], v[152:155]
v_exp_f32 v179, v179
v_mfma_f32_16x16x32_bf16 v[144:147], a[196:199], a[132:135], v[144:147]
ds_read_b64_tr_b16 a[230:231], v3 offset:35360
s_lshl_b32 s88, s6, 5
v_cvt_pk_bf16_f32 v225, v178, v179
v_mfma_f32_16x16x32_bf16 v[144:147], a[200:203], a[136:139], v[144:147]
v_exp_f32 v180, v180
v_mfma_f32_16x16x32_bf16 v[152:155], a[200:203], a[152:155], v[152:155]
ds_read_b64_tr_b16 a[232:233], v3 offset:34880
s_add_u32 s88, s88, s89
v_mfma_f32_16x16x32_bf16 v[160:163], a[200:203], a[168:171], v[160:163]
v_exp_f32 v181, v181
v_mfma_f32_16x16x32_bf16 v[168:171], a[200:203], a[184:187], v[168:171]
ds_read_b64_tr_b16 a[234:235], v3 offset:35392
s_lshl_b32 s88, s88, 14
v_cvt_pk_bf16_f32 v226, v180, v181
v_mfma_f32_16x16x32_bf16 v[168:171], a[204:207], a[188:191], v[168:171]
v_exp_f32 v182, v182
v_mfma_f32_16x16x32_bf16 v[160:163], a[204:207], a[172:175], v[160:163]
ds_read_b64_tr_b16 a[236:237], v3 offset:34912
buffer_load_dword v253, v252, s[52:55], s88 offen offset:128
v_mfma_f32_16x16x32_bf16 v[152:155], a[204:207], a[156:159], v[152:155]
v_exp_f32 v183, v183
v_mfma_f32_16x16x32_bf16 v[144:147], a[204:207], a[140:143], v[144:147]
ds_read_b64_tr_b16 a[238:239], v3 offset:35424
v_cvt_pk_bf16_f32 v227, v182, v183
v_mfma_f32_16x16x32_bf16 v[148:151], a[208:211], a[128:131], 0
v_mfma_f32_16x16x32_bf16 v[156:159], a[208:211], a[144:147], 0
v_exp_f32 v184, v184
v_mfma_f32_16x16x32_bf16 v[164:167], a[208:211], a[160:163], 0
ds_read_b64_tr_b16 a[240:241], v3 offset:34944
v_mfma_f32_16x16x32_bf16 v[172:175], a[208:211], a[176:179], 0
v_exp_f32 v185, v185
v_mfma_f32_16x16x32_bf16 v[172:175], a[212:215], a[180:183], v[172:175]
ds_read_b64_tr_b16 a[242:243], v3 offset:35456
v_cvt_pk_bf16_f32 v228, v184, v185
v_mfma_f32_16x16x32_bf16 v[164:167], a[212:215], a[164:167], v[164:167]
v_exp_f32 v186, v186
v_mfma_f32_16x16x32_bf16 v[156:159], a[212:215], a[148:151], v[156:159]
ds_read_b64_tr_b16 a[244:245], v3 offset:34976
v_mfma_f32_16x16x32_bf16 v[148:151], a[212:215], a[132:135], v[148:151]
v_exp_f32 v187, v187
v_mfma_f32_16x16x32_bf16 v[148:151], a[216:219], a[136:139], v[148:151]
ds_read_b64_tr_b16 a[246:247], v3 offset:35488
v_cvt_pk_bf16_f32 v229, v186, v187
v_mfma_f32_16x16x32_bf16 v[156:159], a[216:219], a[152:155], v[156:159]
v_exp_f32 v188, v188
v_mfma_f32_16x16x32_bf16 v[164:167], a[216:219], a[168:171], v[164:167]
ds_read_b64_tr_b16 a[248:249], v3 offset:35008
v_mfma_f32_16x16x32_bf16 v[172:175], a[216:219], a[184:187], v[172:175]
v_exp_f32 v189, v189
v_mfma_f32_16x16x32_bf16 v[172:175], a[220:223], a[188:191], v[172:175]
ds_read_b64_tr_b16 a[250:251], v3 offset:35520
s_lshl_b32 s88, s3, 6
v_cvt_pk_bf16_f32 v230, v188, v189
v_mfma_f32_16x16x32_bf16 v[164:167], a[220:223], a[172:175], v[164:167]
v_exp_f32 v190, v190
v_mfma_f32_16x16x32_bf16 v[156:159], a[220:223], a[156:159], v[156:159]
ds_read_b64_tr_b16 a[252:253], v3 offset:35040
v_add_u32 v252, s88, v0
v_mfma_f32_16x16x32_bf16 v[148:151], a[220:223], a[140:143], v[148:151]
v_exp_f32 v191, v191
s_waitcnt lgkmcnt(7)
v_mfma_f32_16x16x32_bf16 v[16:19], a[224:227], v[208:211], v[16:19]
ds_read_b64_tr_b16 a[254:255], v3 offset:35552
v_cvt_pk_bf16_f32 v231, v190, v191
v_mfma_f32_16x16x32_bf16 v[24:27], a[224:227], v[212:215], v[24:27]
v_lshlrev_b32 v252, 5, v252
v_mfma_f32_16x16x32_bf16 v[32:35], a[224:227], v[216:219], v[32:35]
v_exp_f32 v192, v192
v_mfma_f32_16x16x32_bf16 v[40:43], a[224:227], v[220:223], v[40:43]
s_mul_i32 s88, s2, 5504
v_mfma_f32_16x16x32_bf16 v[44:47], a[228:231], v[220:223], v[44:47]
v_exp_f32 v193, v193
v_mfma_f32_16x16x32_bf16 v[36:39], a[228:231], v[216:219], v[36:39]
buffer_load_dword v253, v252, s[64:67], s88 offen
v_cvt_pk_bf16_f32 v232, v192, v193
v_mfma_f32_16x16x32_bf16 v[28:31], a[228:231], v[212:215], v[28:31]
v_exp_f32 v194, v194
v_mfma_f32_16x16x32_bf16 v[20:23], a[228:231], v[208:211], v[20:23]
v_mfma_f32_16x16x32_bf16 v[48:51], a[232:235], v[208:211], v[48:51]
v_exp_f32 v195, v195
v_mfma_f32_16x16x32_bf16 v[56:59], a[232:235], v[212:215], v[56:59]
s_waitcnt lgkmcnt(0)
v_cvt_pk_bf16_f32 v233, v194, v195
v_mfma_f32_16x16x32_bf16 v[64:67], a[232:235], v[216:219], v[64:67]
v_exp_f32 v196, v196
v_mfma_f32_16x16x32_bf16 v[72:75], a[232:235], v[220:223], v[72:75]
ds_read_b128 a[192:195], v1 offset:43520
v_mfma_f32_16x16x32_bf16 v[76:79], a[236:239], v[220:223], v[76:79]
v_exp_f32 v197, v197
v_mfma_f32_16x16x32_bf16 v[68:71], a[236:239], v[216:219], v[68:71]
ds_read_b128 a[196:199], v1 offset:43584
v_cvt_pk_bf16_f32 v234, v196, v197
v_mfma_f32_16x16x32_bf16 v[60:63], a[236:239], v[212:215], v[60:63]
v_exp_f32 v198, v198
v_mfma_f32_16x16x32_bf16 v[52:55], a[236:239], v[208:211], v[52:55]
ds_read_b128 a[200:203], v1 offset:43648
v_mfma_f32_16x16x32_bf16 v[80:83], a[240:243], v[208:211], v[80:83]
v_exp_f32 v199, v199
v_mfma_f32_16x16x32_bf16 v[88:91], a[240:243], v[212:215], v[88:91]
ds_read_b128 a[204:207], v1 offset:43712
v_cvt_pk_bf16_f32 v235, v198, v199
v_mfma_f32_16x16x32_bf16 v[96:99], a[240:243], v[216:219], v[96:99]
v_mfma_f32_16x16x32_bf16 v[104:107], a[240:243], v[220:223], v[104:107]
v_exp_f32 v200, v200
v_mfma_f32_16x16x32_bf16 v[108:111], a[244:247], v[220:223], v[108:111]
ds_read_b128 a[208:211], v1 offset:47872
buffer_load_dword v253, v252, s[68:71], s88 offen offset:128
v_mfma_f32_16x16x32_bf16 v[100:103], a[244:247], v[216:219], v[100:103]
v_exp_f32 v201, v201
v_mfma_f32_16x16x32_bf16 v[92:95], a[244:247], v[212:215], v[92:95]
ds_read_b128 a[212:215], v1 offset:47936
v_cvt_pk_bf16_f32 v236, v200, v201
v_mfma_f32_16x16x32_bf16 v[84:87], a[244:247], v[208:211], v[84:87]
v_exp_f32 v202, v202
v_mfma_f32_16x16x32_bf16 v[112:115], a[248:251], v[208:211], v[112:115]
ds_read_b128 a[216:219], v1 offset:48000
v_mfma_f32_16x16x32_bf16 v[120:123], a[248:251], v[212:215], v[120:123]
v_exp_f32 v203, v203
v_mfma_f32_16x16x32_bf16 v[128:131], a[248:251], v[216:219], v[128:131]
ds_read_b128 a[220:223], v1 offset:48064
v_cvt_pk_bf16_f32 v237, v202, v203
v_mfma_f32_16x16x32_bf16 v[136:139], a[248:251], v[220:223], v[136:139]
v_exp_f32 v204, v204
v_mfma_f32_16x16x32_bf16 v[140:143], a[252:255], v[220:223], v[140:143]
v_mfma_f32_16x16x32_bf16 v[132:135], a[252:255], v[216:219], v[132:135]
v_exp_f32 v205, v205
v_mfma_f32_16x16x32_bf16 v[124:127], a[252:255], v[212:215], v[124:127]
v_cvt_pk_bf16_f32 v238, v204, v205
v_mfma_f32_16x16x32_bf16 v[116:119], a[252:255], v[208:211], v[116:119]
v_exp_f32 v206, v206
v_mfma_f32_16x16x32_bf16 a[108:111], a[124:127], v[208:211], 0
v_mfma_f32_16x16x32_bf16 a[112:115], a[124:127], v[212:215], 0
v_exp_f32 v207, v207
v_mfma_f32_16x16x32_bf16 a[116:119], a[124:127], v[216:219], 0
v_cvt_pk_bf16_f32 v239, v206, v207
v_mfma_f32_16x16x32_bf16 a[120:123], a[124:127], v[220:223], 0
s_waitcnt lgkmcnt(0)
v_mfma_f32_16x16x32_bf16 v[176:179], a[192:195], a[128:131], 0
v_exp_f32 v144, v144
v_mfma_f32_16x16x32_bf16 v[184:187], a[192:195], a[144:147], 0
ds_read_b64_tr_b16 a[224:225], v3 offset:43264
s_lshl_b32 s25, s6, 19
s_xor_b32 s88, s7, 0
v_mfma_f32_16x16x32_bf16 v[192:195], a[192:195], a[160:163], 0
s_lshl_b32 s88, s88, 8
v_exp_f32 v145, v145
v_mfma_f32_16x16x32_bf16 v[200:203], a[192:195], a[176:179], 0
ds_read_b64_tr_b16 a[226:227], v3 offset:43776
s_add_u32 s25, s25, s88
v_cvt_pk_bf16_f32 v208, v144, v145
v_mfma_f32_16x16x32_bf16 v[200:203], a[196:199], a[180:183], v[200:203]
v_exp_f32 v146, v146
v_mfma_f32_16x16x32_bf16 v[192:195], a[196:199], a[164:167], v[192:195]
ds_read_b64_tr_b16 a[228:229], v3 offset:43296
s_cmp_eq_u32 s7, 1
s_cselect_b32 s13, 2, 1
v_mfma_f32_16x16x32_bf16 v[184:187], a[196:199], a[148:151], v[184:187]
v_exp_f32 v147, v147
v_mfma_f32_16x16x32_bf16 v[176:179], a[196:199], a[132:135], v[176:179]
ds_read_b64_tr_b16 a[230:231], v3 offset:43808
v_cvt_pk_bf16_f32 v209, v146, v147
v_mfma_f32_16x16x32_bf16 v[176:179], a[200:203], a[136:139], v[176:179]
v_exp_f32 v148, v148
v_mfma_f32_16x16x32_bf16 v[184:187], a[200:203], a[152:155], v[184:187]
ds_read_b64_tr_b16 a[232:233], v3 offset:43328
s_sub_u32 s88, s7, 1
s_cmp_lt_u32 s88, 2
s_cselect_b32 s14, 3, 2
v_mfma_f32_16x16x32_bf16 v[192:195], a[200:203], a[168:171], v[192:195]
v_exp_f32 v149, v149
v_mfma_f32_16x16x32_bf16 v[200:203], a[200:203], a[184:187], v[200:203]
ds_read_b64_tr_b16 a[234:235], v3 offset:43840
v_cvt_pk_bf16_f32 v210, v148, v149
v_mfma_f32_16x16x32_bf16 v[200:203], a[204:207], a[188:191], v[200:203]
v_exp_f32 v150, v150
v_mfma_f32_16x16x32_bf16 v[192:195], a[204:207], a[172:175], v[192:195]
ds_read_b64_tr_b16 a[236:237], v3 offset:43360
s_cmp_eq_u32 s7, 0
s_cselect_b32 s15, 3, 0
v_mfma_f32_16x16x32_bf16 v[184:187], a[204:207], a[156:159], v[184:187]
v_exp_f32 v151, v151
v_mfma_f32_16x16x32_bf16 v[176:179], a[204:207], a[140:143], v[176:179]
ds_read_b64_tr_b16 a[238:239], v3 offset:43872
v_cvt_pk_bf16_f32 v211, v150, v151
v_mfma_f32_16x16x32_bf16 v[180:183], a[208:211], a[128:131], 0
v_bfe_u32 v14, v0, 4, 1
v_mfma_f32_16x16x32_bf16 v[188:191], a[208:211], a[144:147], 0
v_exp_f32 v152, v152
v_mfma_f32_16x16x32_bf16 v[196:199], a[208:211], a[160:163], 0
ds_read_b64_tr_b16 a[240:241], v3 offset:43392
v_mul_u32_u24 v14, 16, v14
v_lshrrev_b32 v15, 5, v0
v_mfma_f32_16x16x32_bf16 v[204:207], a[208:211], a[176:179], 0
v_exp_f32 v153, v153
v_mfma_f32_16x16x32_bf16 v[204:207], a[212:215], a[180:183], v[204:207]
ds_read_b64_tr_b16 a[242:243], v3 offset:43904
v_mul_u32_u24 v15, 8, v15
v_cvt_pk_bf16_f32 v212, v152, v153
v_mfma_f32_16x16x32_bf16 v[196:199], a[212:215], a[164:167], v[196:199]
v_exp_f32 v154, v154
v_mfma_f32_16x16x32_bf16 v[188:191], a[212:215], a[148:151], v[188:191]
ds_read_b64_tr_b16 a[244:245], v3 offset:43424
v_add_u32 v14, v14, v15
s_and_b32 s88, s3, 1
v_mfma_f32_16x16x32_bf16 v[180:183], a[212:215], a[132:135], v[180:183]
v_exp_f32 v155, v155
v_mfma_f32_16x16x32_bf16 v[180:183], a[216:219], a[136:139], v[180:183]
ds_read_b64_tr_b16 a[246:247], v3 offset:43936
s_mul_i32 s88, s88, 4
v_cvt_pk_bf16_f32 v213, v154, v155
v_mfma_f32_16x16x32_bf16 v[188:191], a[216:219], a[152:155], v[188:191]
v_exp_f32 v156, v156
v_mfma_f32_16x16x32_bf16 v[196:199], a[216:219], a[168:171], v[196:199]
ds_read_b64_tr_b16 a[248:249], v3 offset:43456
s_lshr_b32 s89, s3, 1
s_lshl_b32 s89, s89, 5
v_mfma_f32_16x16x32_bf16 v[204:207], a[216:219], a[184:187], v[204:207]
s_add_u32 s88, s88, s89
v_exp_f32 v157, v157
v_mfma_f32_16x16x32_bf16 v[204:207], a[220:223], a[188:191], v[204:207]
ds_read_b64_tr_b16 a[250:251], v3 offset:43968
v_cvt_pk_bf16_f32 v214, v156, v157
v_mfma_f32_16x16x32_bf16 v[196:199], a[220:223], a[172:175], v[196:199]
v_exp_f32 v158, v158
v_mfma_f32_16x16x32_bf16 v[188:191], a[220:223], a[156:159], v[188:191]
ds_read_b64_tr_b16 a[252:253], v3 offset:43488
v_add_u32 v14, s88, v14
s_mov_b32 s89, 1024
v_mfma_f32_16x16x32_bf16 v[180:183], a[220:223], a[140:143], v[180:183]
v_mul_lo_u32 v14, v14, s89
v_exp_f32 v159, v159
s_waitcnt lgkmcnt(7)
v_mfma_f32_16x16x32_bf16 v[16:19], a[224:227], v[224:227], v[16:19]
ds_read_b64_tr_b16 a[254:255], v3 offset:44000
v_cvt_pk_bf16_f32 v215, v158, v159
v_mfma_f32_16x16x32_bf16 v[24:27], a[224:227], v[228:231], v[24:27]
v_and_b32 v15, 15, v0
v_mfma_f32_16x16x32_bf16 v[32:35], a[224:227], v[232:235], v[32:35]
v_exp_f32 v160, v160
v_mfma_f32_16x16x32_bf16 v[40:43], a[224:227], v[236:239], v[40:43]
v_lshl_add_u32 v244, v15, 4, v14
v_add_u32 v244, 128, v244
v_mfma_f32_16x16x32_bf16 v[44:47], a[228:231], v[236:239], v[44:47]
v_exp_f32 v161, v161
v_mfma_f32_16x16x32_bf16 v[36:39], a[228:231], v[232:235], v[36:39]
v_subrev_u32 v245, 32, v244
v_cvt_pk_bf16_f32 v216, v160, v161
v_mfma_f32_16x16x32_bf16 v[28:31], a[228:231], v[228:231], v[28:31]
v_exp_f32 v162, v162
v_mfma_f32_16x16x32_bf16 v[20:23], a[228:231], v[224:227], v[20:23]
v_subrev_u32 v246, 64, v244
v_subrev_u32 v247, 96, v244
v_mfma_f32_16x16x32_bf16 v[48:51], a[232:235], v[224:227], v[48:51]
v_exp_f32 v163, v163
v_mfma_f32_16x16x32_bf16 v[56:59], a[232:235], v[228:231], v[56:59]
s_waitcnt vmcnt(4) lgkmcnt(0)
s_barrier
v_cvt_pk_bf16_f32 v217, v162, v163
v_mfma_f32_16x16x32_bf16 v[64:67], a[232:235], v[232:235], v[64:67]
v_exp_f32 v164, v164
v_mfma_f32_16x16x32_bf16 v[72:75], a[232:235], v[236:239], v[72:75]
ds_read_b128 a[192:195], v1 offset:0
v_mfma_f32_16x16x32_bf16 v[76:79], a[236:239], v[236:239], v[76:79]
v_exp_f32 v165, v165
v_mfma_f32_16x16x32_bf16 v[68:71], a[236:239], v[232:235], v[68:71]
ds_read_b128 a[196:199], v1 offset:64
v_cvt_pk_bf16_f32 v218, v164, v165
v_mfma_f32_16x16x32_bf16 v[60:63], a[236:239], v[228:231], v[60:63]
v_exp_f32 v166, v166
v_mfma_f32_16x16x32_bf16 v[52:55], a[236:239], v[224:227], v[52:55]
ds_read_b128 a[200:203], v1 offset:128
v_mfma_f32_16x16x32_bf16 v[80:83], a[240:243], v[224:227], v[80:83]
v_exp_f32 v167, v167
v_mfma_f32_16x16x32_bf16 v[88:91], a[240:243], v[228:231], v[88:91]
ds_read_b128 a[204:207], v1 offset:192
v_cvt_pk_bf16_f32 v219, v166, v167
v_mfma_f32_16x16x32_bf16 v[96:99], a[240:243], v[232:235], v[96:99]
v_mfma_f32_16x16x32_bf16 v[104:107], a[240:243], v[236:239], v[104:107]
v_exp_f32 v168, v168
v_mfma_f32_16x16x32_bf16 v[108:111], a[244:247], v[236:239], v[108:111]
ds_read_b128 a[208:211], v1 offset:4352
s_add_u32 m0, s99, 138240
s_add_u32 s95, s94, 81920
v_mfma_f32_16x16x32_bf16 v[100:103], a[244:247], v[232:235], v[100:103]
buffer_load_dwordx4 v4, s[40:43], s95 offen offset:0 lds
v_exp_f32 v169, v169
v_mfma_f32_16x16x32_bf16 v[92:95], a[244:247], v[228:231], v[92:95]
ds_read_b128 a[212:215], v1 offset:4416
v_cvt_pk_bf16_f32 v220, v168, v169
v_mfma_f32_16x16x32_bf16 v[84:87], a[244:247], v[224:227], v[84:87]
v_exp_f32 v170, v170
v_mfma_f32_16x16x32_bf16 v[112:115], a[248:251], v[224:227], v[112:115]
ds_read_b128 a[216:219], v1 offset:4480
buffer_load_dwordx4 v5, s[40:43], s95 offen offset:1088 lds
v_mfma_f32_16x16x32_bf16 v[120:123], a[248:251], v[228:231], v[120:123]
v_exp_f32 v171, v171
v_mfma_f32_16x16x32_bf16 v[128:131], a[248:251], v[232:235], v[128:131]
ds_read_b128 a[220:223], v1 offset:4544
v_cvt_pk_bf16_f32 v221, v170, v171
v_mfma_f32_16x16x32_bf16 v[136:139], a[248:251], v[236:239], v[136:139]
v_exp_f32 v172, v172
v_mfma_f32_16x16x32_bf16 v[140:143], a[252:255], v[236:239], v[140:143]
buffer_load_dwordx4 v6, s[40:43], s95 offen offset:2176 lds
v_mfma_f32_16x16x32_bf16 v[132:135], a[252:255], v[232:235], v[132:135]
v_exp_f32 v173, v173
v_mfma_f32_16x16x32_bf16 v[124:127], a[252:255], v[228:231], v[124:127]
v_cvt_pk_bf16_f32 v222, v172, v173
v_mfma_f32_16x16x32_bf16 v[116:119], a[252:255], v[224:227], v[116:119]
v_exp_f32 v174, v174
v_mfma_f32_16x16x32_bf16 a[108:111], a[124:127], v[224:227], a[108:111]
buffer_load_dwordx4 v7, s[40:43], s95 offen offset:3264 lds
v_mfma_f32_16x16x32_bf16 a[112:115], a[124:127], v[228:231], a[112:115]
v_exp_f32 v175, v175
v_mfma_f32_16x16x32_bf16 a[116:119], a[124:127], v[232:235], a[116:119]
v_cvt_pk_bf16_f32 v223, v174, v175
v_mfma_f32_16x16x32_bf16 a[120:123], a[124:127], v[236:239], a[120:123]
s_waitcnt lgkmcnt(0)
v_mfma_f32_16x16x32_bf16 v[144:147], a[192:195], a[128:131], 0
v_exp_f32 v176, v176
v_mfma_f32_16x16x32_bf16 v[152:155], a[192:195], a[144:147], 0
ds_read_b64_tr_b16 a[224:225], v3 offset:0
s_add_u32 m0, s96, 120832
s_add_u32 s95, s94, 65536
v_mfma_f32_16x16x32_bf16 v[160:163], a[192:195], a[160:163], 0
v_exp_f32 v177, v177
v_mfma_f32_16x16x32_bf16 v[168:171], a[192:195], a[176:179], 0
ds_read_b64_tr_b16 a[226:227], v3 offset:512
buffer_load_dwordx4 v8, s[44:47], s95 offen offset:0 lds
v_cvt_pk_bf16_f32 v224, v176, v177
v_mfma_f32_16x16x32_bf16 v[168:171], a[196:199], a[180:183], v[168:171]
v_exp_f32 v178, v178
v_mfma_f32_16x16x32_bf16 v[160:163], a[196:199], a[164:167], v[160:163]
ds_read_b64_tr_b16 a[228:229], v3 offset:32
v_mfma_f32_16x16x32_bf16 v[152:155], a[196:199], a[148:151], v[152:155]
v_exp_f32 v179, v179
v_mfma_f32_16x16x32_bf16 v[144:147], a[196:199], a[132:135], v[144:147]
ds_read_b64_tr_b16 a[230:231], v3 offset:544
v_cvt_pk_bf16_f32 v225, v178, v179
v_mfma_f32_16x16x32_bf16 v[144:147], a[200:203], a[136:139], v[144:147]
v_exp_f32 v180, v180
v_mfma_f32_16x16x32_bf16 v[152:155], a[200:203], a[152:155], v[152:155]
ds_read_b64_tr_b16 a[232:233], v3 offset:64
v_mfma_f32_16x16x32_bf16 v[160:163], a[200:203], a[168:171], v[160:163]
v_exp_f32 v181, v181
v_mfma_f32_16x16x32_bf16 v[168:171], a[200:203], a[184:187], v[168:171]
ds_read_b64_tr_b16 a[234:235], v3 offset:576
v_cvt_pk_bf16_f32 v226, v180, v181
v_mfma_f32_16x16x32_bf16 v[168:171], a[204:207], a[188:191], v[168:171]
v_exp_f32 v182, v182
v_mfma_f32_16x16x32_bf16 v[160:163], a[204:207], a[172:175], v[160:163]
ds_read_b64_tr_b16 a[236:237], v3 offset:96
v_mfma_f32_16x16x32_bf16 v[152:155], a[204:207], a[156:159], v[152:155]
v_exp_f32 v183, v183
v_mfma_f32_16x16x32_bf16 v[144:147], a[204:207], a[140:143], v[144:147]
ds_read_b64_tr_b16 a[238:239], v3 offset:608
v_cvt_pk_bf16_f32 v227, v182, v183
v_mfma_f32_16x16x32_bf16 v[148:151], a[208:211], a[128:131], 0
v_mfma_f32_16x16x32_bf16 v[156:159], a[208:211], a[144:147], 0
v_exp_f32 v184, v184
v_mfma_f32_16x16x32_bf16 v[164:167], a[208:211], a[160:163], 0
ds_read_b64_tr_b16 a[240:241], v3 offset:128
v_mfma_f32_16x16x32_bf16 v[172:175], a[208:211], a[176:179], 0
buffer_load_dwordx4 v9, s[44:47], s95 offen offset:1056 lds
v_exp_f32 v185, v185
v_mfma_f32_16x16x32_bf16 v[172:175], a[212:215], a[180:183], v[172:175]
ds_read_b64_tr_b16 a[242:243], v3 offset:640
v_cvt_pk_bf16_f32 v228, v184, v185
v_mfma_f32_16x16x32_bf16 v[164:167], a[212:215], a[164:167], v[164:167]
v_exp_f32 v186, v186
v_mfma_f32_16x16x32_bf16 v[156:159], a[212:215], a[148:151], v[156:159]
ds_read_b64_tr_b16 a[244:245], v3 offset:160
v_mfma_f32_16x16x32_bf16 v[148:151], a[212:215], a[132:135], v[148:151]
v_exp_f32 v187, v187
v_mfma_f32_16x16x32_bf16 v[148:151], a[216:219], a[136:139], v[148:151]
ds_read_b64_tr_b16 a[246:247], v3 offset:672
v_cvt_pk_bf16_f32 v229, v186, v187
v_mfma_f32_16x16x32_bf16 v[156:159], a[216:219], a[152:155], v[156:159]
v_exp_f32 v188, v188
v_mfma_f32_16x16x32_bf16 v[164:167], a[216:219], a[168:171], v[164:167]
ds_read_b64_tr_b16 a[248:249], v3 offset:192
v_mfma_f32_16x16x32_bf16 v[172:175], a[216:219], a[184:187], v[172:175]
v_exp_f32 v189, v189
v_mfma_f32_16x16x32_bf16 v[172:175], a[220:223], a[188:191], v[172:175]
ds_read_b64_tr_b16 a[250:251], v3 offset:704
v_cvt_pk_bf16_f32 v230, v188, v189
v_mfma_f32_16x16x32_bf16 v[164:167], a[220:223], a[172:175], v[164:167]
v_exp_f32 v190, v190
v_mfma_f32_16x16x32_bf16 v[156:159], a[220:223], a[156:159], v[156:159]
ds_read_b64_tr_b16 a[252:253], v3 offset:224
v_mfma_f32_16x16x32_bf16 v[148:151], a[220:223], a[140:143], v[148:151]
v_exp_f32 v191, v191
s_waitcnt lgkmcnt(7)
v_mfma_f32_16x16x32_bf16 v[16:19], a[224:227], v[208:211], v[16:19]
ds_read_b64_tr_b16 a[254:255], v3 offset:736
v_cvt_pk_bf16_f32 v231, v190, v191
v_mfma_f32_16x16x32_bf16 v[24:27], a[224:227], v[212:215], v[24:27]
v_mfma_f32_16x16x32_bf16 v[32:35], a[224:227], v[216:219], v[32:35]
v_exp_f32 v192, v192
v_mfma_f32_16x16x32_bf16 v[40:43], a[224:227], v[220:223], v[40:43]
buffer_load_dwordx4 v10, s[44:47], s95 offen offset:2112 lds
v_mfma_f32_16x16x32_bf16 v[44:47], a[228:231], v[220:223], v[44:47]
v_exp_f32 v193, v193
v_mfma_f32_16x16x32_bf16 v[36:39], a[228:231], v[216:219], v[36:39]
v_cvt_pk_bf16_f32 v232, v192, v193
v_mfma_f32_16x16x32_bf16 v[28:31], a[228:231], v[212:215], v[28:31]
v_exp_f32 v194, v194
v_mfma_f32_16x16x32_bf16 v[20:23], a[228:231], v[208:211], v[20:23]
v_mfma_f32_16x16x32_bf16 v[48:51], a[232:235], v[208:211], v[48:51]
v_exp_f32 v195, v195
v_mfma_f32_16x16x32_bf16 v[56:59], a[232:235], v[212:215], v[56:59]
s_waitcnt lgkmcnt(0)
v_cvt_pk_bf16_f32 v233, v194, v195
v_mfma_f32_16x16x32_bf16 v[64:67], a[232:235], v[216:219], v[64:67]
v_exp_f32 v196, v196
v_mfma_f32_16x16x32_bf16 v[72:75], a[232:235], v[220:223], v[72:75]
ds_read_b128 a[192:195], v1 offset:8704
v_mfma_f32_16x16x32_bf16 v[76:79], a[236:239], v[220:223], v[76:79]
v_exp_f32 v197, v197
v_mfma_f32_16x16x32_bf16 v[68:71], a[236:239], v[216:219], v[68:71]
ds_read_b128 a[196:199], v1 offset:8768
v_cvt_pk_bf16_f32 v234, v196, v197
v_mfma_f32_16x16x32_bf16 v[60:63], a[236:239], v[212:215], v[60:63]
v_exp_f32 v198, v198
v_mfma_f32_16x16x32_bf16 v[52:55], a[236:239], v[208:211], v[52:55]
ds_read_b128 a[200:203], v1 offset:8832
v_mfma_f32_16x16x32_bf16 v[80:83], a[240:243], v[208:211], v[80:83]
v_exp_f32 v199, v199
v_mfma_f32_16x16x32_bf16 v[88:91], a[240:243], v[212:215], v[88:91]
ds_read_b128 a[204:207], v1 offset:8896
v_cvt_pk_bf16_f32 v235, v198, v199
v_mfma_f32_16x16x32_bf16 v[96:99], a[240:243], v[216:219], v[96:99]
v_mfma_f32_16x16x32_bf16 v[104:107], a[240:243], v[220:223], v[104:107]
v_exp_f32 v200, v200
v_mfma_f32_16x16x32_bf16 v[108:111], a[244:247], v[220:223], v[108:111]
ds_read_b128 a[208:211], v1 offset:13056
buffer_load_dwordx4 v11, s[44:47], s95 offen offset:3168 lds
v_mfma_f32_16x16x32_bf16 v[100:103], a[244:247], v[216:219], v[100:103]
v_exp_f32 v201, v201
v_mfma_f32_16x16x32_bf16 v[92:95], a[244:247], v[212:215], v[92:95]
ds_read_b128 a[212:215], v1 offset:13120
v_cvt_pk_bf16_f32 v236, v200, v201
v_mfma_f32_16x16x32_bf16 v[84:87], a[244:247], v[208:211], v[84:87]
v_exp_f32 v202, v202
v_mfma_f32_16x16x32_bf16 v[112:115], a[248:251], v[208:211], v[112:115]
ds_read_b128 a[216:219], v1 offset:13184
v_mfma_f32_16x16x32_bf16 v[120:123], a[248:251], v[212:215], v[120:123]
v_exp_f32 v203, v203
v_mfma_f32_16x16x32_bf16 v[128:131], a[248:251], v[216:219], v[128:131]
ds_read_b128 a[220:223], v1 offset:13248
v_cvt_pk_bf16_f32 v237, v202, v203
v_mfma_f32_16x16x32_bf16 v[136:139], a[248:251], v[220:223], v[136:139]
v_exp_f32 v204, v204
v_mfma_f32_16x16x32_bf16 v[140:143], a[252:255], v[220:223], v[140:143]
v_mfma_f32_16x16x32_bf16 v[132:135], a[252:255], v[216:219], v[132:135]
v_exp_f32 v205, v205
v_mfma_f32_16x16x32_bf16 v[124:127], a[252:255], v[212:215], v[124:127]
v_cvt_pk_bf16_f32 v238, v204, v205
v_mfma_f32_16x16x32_bf16 v[116:119], a[252:255], v[208:211], v[116:119]
v_exp_f32 v206, v206
v_mfma_f32_16x16x32_bf16 a[108:111], a[124:127], v[208:211], a[108:111]
v_mfma_f32_16x16x32_bf16 a[112:115], a[124:127], v[212:215], a[112:115]
v_exp_f32 v207, v207
v_mfma_f32_16x16x32_bf16 a[116:119], a[124:127], v[216:219], a[116:119]
v_cvt_pk_bf16_f32 v239, v206, v207
v_mfma_f32_16x16x32_bf16 a[120:123], a[124:127], v[220:223], a[120:123]
s_waitcnt lgkmcnt(0)
v_mfma_f32_16x16x32_bf16 v[176:179], a[192:195], a[128:131], 0
v_exp_f32 v144, v144
v_mfma_f32_16x16x32_bf16 v[184:187], a[192:195], a[144:147], 0
ds_read_b64_tr_b16 a[224:225], v3 offset:8448
s_lshr_b32 s88, s6, 1
s_lshl_b32 s17, s4, 2
v_mfma_f32_16x16x32_bf16 v[192:195], a[192:195], a[160:163], 0
s_add_u32 s17, s17, s88
v_exp_f32 v145, v145
v_mfma_f32_16x16x32_bf16 v[200:203], a[192:195], a[176:179], 0
ds_read_b64_tr_b16 a[226:227], v3 offset:8960
s_and_b32 s88, s6, 1
v_cvt_pk_bf16_f32 v208, v144, v145
v_mfma_f32_16x16x32_bf16 v[200:203], a[196:199], a[180:183], v[200:203]
v_exp_f32 v146, v146
v_mfma_f32_16x16x32_bf16 v[192:195], a[196:199], a[164:167], v[192:195]
ds_read_b64_tr_b16 a[228:229], v3 offset:8480
s_xor_b32 s88, s88, 1
s_xor_b32 s18, s7, 0
v_mfma_f32_16x16x32_bf16 v[184:187], a[196:199], a[148:151], v[184:187]
s_lshl_b32 s18, s18, 1
v_exp_f32 v147, v147
v_mfma_f32_16x16x32_bf16 v[176:179], a[196:199], a[132:135], v[176:179]
ds_read_b64_tr_b16 a[230:231], v3 offset:8992
s_add_u32 s18, s18, s88
v_cvt_pk_bf16_f32 v209, v146, v147
v_mfma_f32_16x16x32_bf16 v[176:179], a[200:203], a[136:139], v[176:179]
v_exp_f32 v148, v148
v_mfma_f32_16x16x32_bf16 v[184:187], a[200:203], a[152:155], v[184:187]
ds_read_b64_tr_b16 a[232:233], v3 offset:8512
s_lshr_b32 s89, s3, 1
s_mul_i32 s26, s89, 21
v_mfma_f32_16x16x32_bf16 v[192:195], a[200:203], a[168:171], v[192:195]
s_and_b32 s88, s3, 1
v_exp_f32 v149, v149
v_mfma_f32_16x16x32_bf16 v[200:203], a[200:203], a[184:187], v[200:203]
ds_read_b64_tr_b16 a[234:235], v3 offset:9024
s_lshl_b32 s19, s88, 1
v_cvt_pk_bf16_f32 v210, v148, v149
v_mfma_f32_16x16x32_bf16 v[200:203], a[204:207], a[188:191], v[200:203]
v_exp_f32 v150, v150
v_mfma_f32_16x16x32_bf16 v[192:195], a[204:207], a[172:175], v[192:195]
ds_read_b64_tr_b16 a[236:237], v3 offset:8544
s_add_u32 s19, s19, s89
s_add_u32 s12, s26, s88
v_mfma_f32_16x16x32_bf16 v[184:187], a[204:207], a[156:159], v[184:187]
s_lshl_b32 s88, s18, 7
v_exp_f32 v151, v151
v_mfma_f32_16x16x32_bf16 v[176:179], a[204:207], a[140:143], v[176:179]
ds_read_b64_tr_b16 a[238:239], v3 offset:9056
v_cvt_pk_bf16_f32 v211, v150, v151
v_mfma_f32_16x16x32_bf16 v[180:183], a[208:211], a[128:131], 0
s_movk_i32 s92, 0x400
s_add_u32 s32, s76, 1044480
s_addc_u32 s33, s77, 0
s_cmp_eq_u32 s18, 3
s_cselect_b32 s68, s32, s68
s_cselect_b32 s69, s33, s69
s_cselect_b32 s70, 180224, s70
s_cselect_b32 s89, 0x80, s92
s_cselect_b32 s88, 0, s88
v_mfma_f32_16x16x32_bf16 v[188:191], a[208:211], a[144:147], 0
v_exp_f32 v152, v152
v_mfma_f32_16x16x32_bf16 v[196:199], a[208:211], a[160:163], 0
ds_read_b64_tr_b16 a[240:241], v3 offset:8576
v_mfma_f32_16x16x32_bf16 v[204:207], a[208:211], a[176:179], 0
s_mul_i32 s12, s12, s89
v_exp_f32 v153, v153
v_mfma_f32_16x16x32_bf16 v[204:207], a[212:215], a[180:183], v[204:207]
ds_read_b64_tr_b16 a[242:243], v3 offset:9088
s_lshl_b32 s12, s12, 5
v_cvt_pk_bf16_f32 v212, v152, v153
v_mfma_f32_16x16x32_bf16 v[196:199], a[212:215], a[164:167], v[196:199]
v_exp_f32 v154, v154
v_mfma_f32_16x16x32_bf16 v[188:191], a[212:215], a[148:151], v[188:191]
ds_read_b64_tr_b16 a[244:245], v3 offset:8608
s_add_u32 s12, s12, s88
s_lshl_b32 s92, s89, 6
v_mfma_f32_16x16x32_bf16 v[180:183], a[212:215], a[132:135], v[180:183]
s_cmp_eq_u32 s89, 0x80
s_movk_i32 s88, 128
s_cselect_b32 s88, 4096, s88
v_exp_f32 v155, v155
v_mfma_f32_16x16x32_bf16 v[180:183], a[216:219], a[136:139], v[180:183]
ds_read_b64_tr_b16 a[246:247], v3 offset:9120
v_cvt_pk_bf16_f32 v213, v154, v155
v_mfma_f32_16x16x32_bf16 v[188:191], a[216:219], a[152:155], v[188:191]
v_exp_f32 v156, v156
v_mfma_f32_16x16x32_bf16 v[196:199], a[216:219], a[168:171], v[196:199]
ds_read_b64_tr_b16 a[248:249], v3 offset:8640
v_bfe_u32 v14, v0, 3, 1
v_mfma_f32_16x16x32_bf16 v[204:207], a[216:219], a[184:187], v[204:207]
v_lshlrev_b32 v14, 2, v14
v_exp_f32 v157, v157
v_mfma_f32_16x16x32_bf16 v[204:207], a[220:223], a[188:191], v[204:207]
ds_read_b64_tr_b16 a[250:251], v3 offset:9152
v_bfe_u32 v15, v0, 4, 1
v_cvt_pk_bf16_f32 v214, v156, v157
v_mfma_f32_16x16x32_bf16 v[196:199], a[220:223], a[172:175], v[196:199]
v_exp_f32 v158, v158
v_mfma_f32_16x16x32_bf16 v[188:191], a[220:223], a[156:159], v[188:191]
ds_read_b64_tr_b16 a[252:253], v3 offset:8672
v_lshl_add_u32 v14, v15, 4, v14
v_lshrrev_b32 v15, 5, v0
v_mfma_f32_16x16x32_bf16 v[180:183], a[220:223], a[140:143], v[180:183]
v_lshl_add_u32 v14, v15, 3, v14
v_exp_f32 v159, v159
s_waitcnt lgkmcnt(7)
v_mfma_f32_16x16x32_bf16 v[16:19], a[224:227], v[224:227], v[16:19]
ds_read_b64_tr_b16 a[254:255], v3 offset:9184
v_cvt_pk_bf16_f32 v215, v158, v159
v_mfma_f32_16x16x32_bf16 v[24:27], a[224:227], v[228:231], v[24:27]
v_mul_u32_u24 v14, s89, v14
v_and_b32 v15, 7, v0
v_mfma_f32_16x16x32_bf16 v[32:35], a[224:227], v[232:235], v[32:35]
v_exp_f32 v160, v160
v_mfma_f32_16x16x32_bf16 v[40:43], a[224:227], v[236:239], v[40:43]
v_lshl_add_u32 v14, v15, 4, v14
v_add_u32 v240, s88, v14
v_mfma_f32_16x16x32_bf16 v[44:47], a[228:231], v[236:239], v[44:47]
v_exp_f32 v161, v161
v_mfma_f32_16x16x32_bf16 v[36:39], a[228:231], v[232:235], v[36:39]
s_sub_u32 s89, 1056, s89
v_subrev_u32 v241, s89, v240
v_cvt_pk_bf16_f32 v216, v160, v161
v_mfma_f32_16x16x32_bf16 v[28:31], a[228:231], v[228:231], v[28:31]
v_exp_f32 v162, v162
v_mfma_f32_16x16x32_bf16 v[20:23], a[228:231], v[224:227], v[20:23]
v_subrev_u32 v242, s89, v241
v_subrev_u32 v243, s89, v242
v_mfma_f32_16x16x32_bf16 v[48:51], a[232:235], v[224:227], v[48:51]
v_exp_f32 v163, v163
v_mfma_f32_16x16x32_bf16 v[56:59], a[232:235], v[228:231], v[56:59]
s_waitcnt vmcnt(0) lgkmcnt(0)
s_barrier
v_cvt_pk_bf16_f32 v217, v162, v163
v_mfma_f32_16x16x32_bf16 v[64:67], a[232:235], v[232:235], v[64:67]
v_exp_f32 v164, v164
v_mfma_f32_16x16x32_bf16 v[72:75], a[232:235], v[236:239], v[72:75]
ds_read_b128 a[192:195], v1 offset:34816
v_mfma_f32_16x16x32_bf16 v[76:79], a[236:239], v[236:239], v[76:79]
v_exp_f32 v165, v165
v_mfma_f32_16x16x32_bf16 v[68:71], a[236:239], v[232:235], v[68:71]
ds_read_b128 a[196:199], v1 offset:34880
v_cvt_pk_bf16_f32 v218, v164, v165
v_mfma_f32_16x16x32_bf16 v[60:63], a[236:239], v[228:231], v[60:63]
v_exp_f32 v166, v166
v_mfma_f32_16x16x32_bf16 v[52:55], a[236:239], v[224:227], v[52:55]
ds_read_b128 a[200:203], v1 offset:34944
v_mfma_f32_16x16x32_bf16 v[80:83], a[240:243], v[224:227], v[80:83]
v_exp_f32 v167, v167
v_mfma_f32_16x16x32_bf16 v[88:91], a[240:243], v[228:231], v[88:91]
ds_read_b128 a[204:207], v1 offset:35008
v_cvt_pk_bf16_f32 v219, v166, v167
v_mfma_f32_16x16x32_bf16 v[96:99], a[240:243], v[232:235], v[96:99]
v_mfma_f32_16x16x32_bf16 v[104:107], a[240:243], v[236:239], v[104:107]
v_exp_f32 v168, v168
v_mfma_f32_16x16x32_bf16 v[108:111], a[244:247], v[236:239], v[108:111]
ds_read_b128 a[208:211], v1 offset:39168
s_add_u32 m0, s99, 103424
s_add_u32 s95, s94, 98304
v_mfma_f32_16x16x32_bf16 v[100:103], a[244:247], v[232:235], v[100:103]
buffer_load_dwordx4 v4, s[40:43], s95 offen offset:0 lds
v_exp_f32 v169, v169
v_mfma_f32_16x16x32_bf16 v[92:95], a[244:247], v[228:231], v[92:95]
ds_read_b128 a[212:215], v1 offset:39232
v_cvt_pk_bf16_f32 v220, v168, v169
v_mfma_f32_16x16x32_bf16 v[84:87], a[244:247], v[224:227], v[84:87]
v_exp_f32 v170, v170
v_mfma_f32_16x16x32_bf16 v[112:115], a[248:251], v[224:227], v[112:115]
ds_read_b128 a[216:219], v1 offset:39296
buffer_load_dwordx4 v5, s[40:43], s95 offen offset:1088 lds
v_mfma_f32_16x16x32_bf16 v[120:123], a[248:251], v[228:231], v[120:123]
v_exp_f32 v171, v171
v_mfma_f32_16x16x32_bf16 v[128:131], a[248:251], v[232:235], v[128:131]
ds_read_b128 a[220:223], v1 offset:39360
v_cvt_pk_bf16_f32 v221, v170, v171
v_mfma_f32_16x16x32_bf16 v[136:139], a[248:251], v[236:239], v[136:139]
v_exp_f32 v172, v172
v_mfma_f32_16x16x32_bf16 v[140:143], a[252:255], v[236:239], v[140:143]
buffer_load_dwordx4 v6, s[40:43], s95 offen offset:2176 lds
v_mfma_f32_16x16x32_bf16 v[132:135], a[252:255], v[232:235], v[132:135]
v_exp_f32 v173, v173
v_mfma_f32_16x16x32_bf16 v[124:127], a[252:255], v[228:231], v[124:127]
v_cvt_pk_bf16_f32 v222, v172, v173
v_mfma_f32_16x16x32_bf16 v[116:119], a[252:255], v[224:227], v[116:119]
v_exp_f32 v174, v174
v_mfma_f32_16x16x32_bf16 a[108:111], a[124:127], v[224:227], a[108:111]
buffer_load_dwordx4 v7, s[40:43], s95 offen offset:3264 lds
v_mfma_f32_16x16x32_bf16 a[112:115], a[124:127], v[228:231], a[112:115]
v_exp_f32 v175, v175
v_mfma_f32_16x16x32_bf16 a[116:119], a[124:127], v[232:235], a[116:119]
v_cvt_pk_bf16_f32 v223, v174, v175
v_mfma_f32_16x16x32_bf16 a[120:123], a[124:127], v[236:239], a[120:123]
s_waitcnt lgkmcnt(0)
v_mfma_f32_16x16x32_bf16 v[144:147], a[192:195], a[128:131], 0
v_exp_f32 v176, v176
v_mfma_f32_16x16x32_bf16 v[152:155], a[192:195], a[144:147], 0
ds_read_b64_tr_b16 a[224:225], v3 offset:34816
s_add_u32 m0, s96, 86016
s_add_u32 s95, s94, 81920
v_mfma_f32_16x16x32_bf16 v[160:163], a[192:195], a[160:163], 0
buffer_load_dwordx4 v8, s[44:47], s95 offen offset:0 lds
v_exp_f32 v177, v177
v_mfma_f32_16x16x32_bf16 v[168:171], a[192:195], a[176:179], 0
ds_read_b64_tr_b16 a[226:227], v3 offset:35328
v_cvt_pk_bf16_f32 v224, v176, v177
v_mfma_f32_16x16x32_bf16 v[168:171], a[196:199], a[180:183], v[168:171]
v_exp_f32 v178, v178
v_mfma_f32_16x16x32_bf16 v[160:163], a[196:199], a[164:167], v[160:163]
ds_read_b64_tr_b16 a[228:229], v3 offset:34848
v_mfma_f32_16x16x32_bf16 v[152:155], a[196:199], a[148:151], v[152:155]
v_exp_f32 v179, v179
v_mfma_f32_16x16x32_bf16 v[144:147], a[196:199], a[132:135], v[144:147]
ds_read_b64_tr_b16 a[230:231], v3 offset:35360
buffer_load_dwordx4 v9, s[44:47], s95 offen offset:1056 lds
v_cvt_pk_bf16_f32 v225, v178, v179
v_mfma_f32_16x16x32_bf16 v[144:147], a[200:203], a[136:139], v[144:147]
v_exp_f32 v180, v180
v_mfma_f32_16x16x32_bf16 v[152:155], a[200:203], a[152:155], v[152:155]
ds_read_b64_tr_b16 a[232:233], v3 offset:34880
v_mfma_f32_16x16x32_bf16 v[160:163], a[200:203], a[168:171], v[160:163]
v_exp_f32 v181, v181
v_mfma_f32_16x16x32_bf16 v[168:171], a[200:203], a[184:187], v[168:171]
ds_read_b64_tr_b16 a[234:235], v3 offset:35392
v_cvt_pk_bf16_f32 v226, v180, v181
v_mfma_f32_16x16x32_bf16 v[168:171], a[204:207], a[188:191], v[168:171]
v_exp_f32 v182, v182
v_mfma_f32_16x16x32_bf16 v[160:163], a[204:207], a[172:175], v[160:163]
ds_read_b64_tr_b16 a[236:237], v3 offset:34912
buffer_load_dwordx4 v10, s[44:47], s95 offen offset:2112 lds
v_mfma_f32_16x16x32_bf16 v[152:155], a[204:207], a[156:159], v[152:155]
v_exp_f32 v183, v183
v_mfma_f32_16x16x32_bf16 v[144:147], a[204:207], a[140:143], v[144:147]
ds_read_b64_tr_b16 a[238:239], v3 offset:35424
v_cvt_pk_bf16_f32 v227, v182, v183
v_mfma_f32_16x16x32_bf16 v[148:151], a[208:211], a[128:131], 0
v_mfma_f32_16x16x32_bf16 v[156:159], a[208:211], a[144:147], 0
v_exp_f32 v184, v184
v_mfma_f32_16x16x32_bf16 v[164:167], a[208:211], a[160:163], 0
ds_read_b64_tr_b16 a[240:241], v3 offset:34944
buffer_load_dwordx4 v11, s[44:47], s95 offen offset:3168 lds
v_mfma_f32_16x16x32_bf16 v[172:175], a[208:211], a[176:179], 0
v_exp_f32 v185, v185
v_mfma_f32_16x16x32_bf16 v[172:175], a[212:215], a[180:183], v[172:175]
ds_read_b64_tr_b16 a[242:243], v3 offset:35456
v_cvt_pk_bf16_f32 v228, v184, v185
v_mfma_f32_16x16x32_bf16 v[164:167], a[212:215], a[164:167], v[164:167]
v_exp_f32 v186, v186
v_mfma_f32_16x16x32_bf16 v[156:159], a[212:215], a[148:151], v[156:159]
ds_read_b64_tr_b16 a[244:245], v3 offset:34976
v_mfma_f32_16x16x32_bf16 v[148:151], a[212:215], a[132:135], v[148:151]
v_exp_f32 v187, v187
v_mfma_f32_16x16x32_bf16 v[148:151], a[216:219], a[136:139], v[148:151]
ds_read_b64_tr_b16 a[246:247], v3 offset:35488
v_min_u32 v14, 42, v0
v_cvt_pk_bf16_f32 v229, v186, v187
v_mfma_f32_16x16x32_bf16 v[156:159], a[216:219], a[152:155], v[156:159]
v_exp_f32 v188, v188
v_mfma_f32_16x16x32_bf16 v[164:167], a[216:219], a[168:171], v[164:167]
ds_read_b64_tr_b16 a[248:249], v3 offset:35008
v_lshlrev_b32 v14, 8, v14
v_add_u32 v14, 42, v14
v_mfma_f32_16x16x32_bf16 v[172:175], a[216:219], a[184:187], v[172:175]
v_mul_u32_u24 v14, 6097, v14
v_exp_f32 v189, v189
v_mfma_f32_16x16x32_bf16 v[172:175], a[220:223], a[188:191], v[172:175]
ds_read_b64_tr_b16 a[250:251], v3 offset:35520
v_lshrrev_b32 v14, 18, v14
v_cvt_pk_bf16_f32 v230, v188, v189
v_mfma_f32_16x16x32_bf16 v[164:167], a[220:223], a[172:175], v[164:167]
v_mov_b32 v15, 0
v_exp_f32 v190, v190
v_mfma_f32_16x16x32_bf16 v[156:159], a[220:223], a[156:159], v[156:159]
ds_read_b64_tr_b16 a[252:253], v3 offset:35040
v_lshrrev_b32 v252, 4, v14
v_and_b32 v252, 12, v252
v_mfma_f32_16x16x32_bf16 v[148:151], a[220:223], a[140:143], v[148:151]
buffer_load_dword v252, v252, s[84:87], 0 offen sc1
v_exp_f32 v191, v191
s_waitcnt lgkmcnt(7)
v_mfma_f32_16x16x32_bf16 v[16:19], a[224:227], v[208:211], v[16:19]
ds_read_b64_tr_b16 a[254:255], v3 offset:35552
v_cvt_pk_bf16_f32 v231, v190, v191
v_mfma_f32_16x16x32_bf16 v[24:27], a[224:227], v[212:215], v[24:27]
v_mfma_f32_16x16x32_bf16 v[32:35], a[224:227], v[216:219], v[32:35]
v_exp_f32 v192, v192
v_mfma_f32_16x16x32_bf16 v[40:43], a[224:227], v[220:223], v[40:43]
v_lshl_add_u32 v14, v14, 7, v15
v_mfma_f32_16x16x32_bf16 v[44:47], a[228:231], v[220:223], v[44:47]
v_exp_f32 v193, v193
v_mfma_f32_16x16x32_bf16 v[36:39], a[228:231], v[216:219], v[36:39]
buffer_load_dword v15, v14, s[76:79], s24 offen offset:0 sc1
v_cvt_pk_bf16_f32 v232, v192, v193
v_mfma_f32_16x16x32_bf16 v[28:31], a[228:231], v[212:215], v[28:31]
v_exp_f32 v194, v194
v_mfma_f32_16x16x32_bf16 v[20:23], a[228:231], v[208:211], v[20:23]
v_mfma_f32_16x16x32_bf16 v[48:51], a[232:235], v[208:211], v[48:51]
v_exp_f32 v195, v195
v_mfma_f32_16x16x32_bf16 v[56:59], a[232:235], v[212:215], v[56:59]
s_waitcnt lgkmcnt(0)
v_cvt_pk_bf16_f32 v233, v194, v195
v_mfma_f32_16x16x32_bf16 v[64:67], a[232:235], v[216:219], v[64:67]
v_exp_f32 v196, v196
v_mfma_f32_16x16x32_bf16 v[72:75], a[232:235], v[220:223], v[72:75]
ds_read_b128 a[192:195], v1 offset:43520
s_lshl_b32 s22, s7, 17
s_add_u32 s22, s22, s25
v_mfma_f32_16x16x32_bf16 v[76:79], a[236:239], v[220:223], v[76:79]
s_add_u32 s22, s22, 65536
v_exp_f32 v197, v197
v_mfma_f32_16x16x32_bf16 v[68:71], a[236:239], v[216:219], v[68:71]
ds_read_b128 a[196:199], v1 offset:43584
s_add_u32 m0, s96, 0
v_cvt_pk_bf16_f32 v234, v196, v197
v_mfma_f32_16x16x32_bf16 v[60:63], a[236:239], v[212:215], v[60:63]
buffer_load_dwordx4 v244, s[52:55], s22 offen offset:0 lds
v_exp_f32 v198, v198
v_mfma_f32_16x16x32_bf16 v[52:55], a[236:239], v[208:211], v[52:55]
ds_read_b128 a[200:203], v1 offset:43648
v_mfma_f32_16x16x32_bf16 v[80:83], a[240:243], v[208:211], v[80:83]
v_exp_f32 v199, v199
v_mfma_f32_16x16x32_bf16 v[88:91], a[240:243], v[212:215], v[88:91]
ds_read_b128 a[204:207], v1 offset:43712
v_cvt_pk_bf16_f32 v235, v198, v199
v_mfma_f32_16x16x32_bf16 v[96:99], a[240:243], v[216:219], v[96:99]
buffer_load_dwordx4 v245, s[52:55], s22 offen offset:1056 lds
v_mfma_f32_16x16x32_bf16 v[104:107], a[240:243], v[220:223], v[104:107]
v_exp_f32 v200, v200
v_mfma_f32_16x16x32_bf16 v[108:111], a[244:247], v[220:223], v[108:111]
ds_read_b128 a[208:211], v1 offset:47872
v_mfma_f32_16x16x32_bf16 v[100:103], a[244:247], v[216:219], v[100:103]
v_exp_f32 v201, v201
v_mfma_f32_16x16x32_bf16 v[92:95], a[244:247], v[212:215], v[92:95]
ds_read_b128 a[212:215], v1 offset:47936
v_cvt_pk_bf16_f32 v236, v200, v201
v_mfma_f32_16x16x32_bf16 v[84:87], a[244:247], v[208:211], v[84:87]
v_exp_f32 v202, v202
v_mfma_f32_16x16x32_bf16 v[112:115], a[248:251], v[208:211], v[112:115]
ds_read_b128 a[216:219], v1 offset:48000
buffer_load_dwordx4 v246, s[52:55], s22 offen offset:2112 lds
v_mfma_f32_16x16x32_bf16 v[120:123], a[248:251], v[212:215], v[120:123]
v_exp_f32 v203, v203
v_mfma_f32_16x16x32_bf16 v[128:131], a[248:251], v[216:219], v[128:131]
ds_read_b128 a[220:223], v1 offset:48064
v_cvt_pk_bf16_f32 v237, v202, v203
v_mfma_f32_16x16x32_bf16 v[136:139], a[248:251], v[220:223], v[136:139]
v_exp_f32 v204, v204
v_mfma_f32_16x16x32_bf16 v[140:143], a[252:255], v[220:223], v[140:143]
v_mfma_f32_16x16x32_bf16 v[132:135], a[252:255], v[216:219], v[132:135]
v_exp_f32 v205, v205
v_mfma_f32_16x16x32_bf16 v[124:127], a[252:255], v[212:215], v[124:127]
buffer_load_dwordx4 v247, s[52:55], s22 offen offset:3168 lds
v_cvt_pk_bf16_f32 v238, v204, v205
v_mfma_f32_16x16x32_bf16 v[116:119], a[252:255], v[208:211], v[116:119]
v_exp_f32 v206, v206
v_mfma_f32_16x16x32_bf16 a[108:111], a[124:127], v[208:211], a[108:111]
v_mfma_f32_16x16x32_bf16 a[112:115], a[124:127], v[212:215], a[112:115]
v_exp_f32 v207, v207
v_mfma_f32_16x16x32_bf16 a[116:119], a[124:127], v[216:219], a[116:119]
v_cvt_pk_bf16_f32 v239, v206, v207
v_mfma_f32_16x16x32_bf16 a[120:123], a[124:127], v[220:223], a[120:123]
s_waitcnt lgkmcnt(0)
v_mfma_f32_16x16x32_bf16 v[176:179], a[192:195], a[128:131], 0
v_exp_f32 v144, v144
v_mfma_f32_16x16x32_bf16 v[184:187], a[192:195], a[144:147], 0
ds_read_b64_tr_b16 a[224:225], v3 offset:43264
s_waitcnt vmcnt(4)
v_cmp_ne_u32 vcc, v252, v15
s_cbranch_vccnz reslow_33
reback_34:
v_mfma_f32_16x16x32_bf16 v[192:195], a[192:195], a[160:163], 0
s_lshl_b32 s22, s13, 17
v_exp_f32 v145, v145
v_mfma_f32_16x16x32_bf16 v[200:203], a[192:195], a[176:179], 0
ds_read_b64_tr_b16 a[226:227], v3 offset:43776
s_add_u32 s22, s22, s25
v_cvt_pk_bf16_f32 v208, v144, v145
v_mfma_f32_16x16x32_bf16 v[200:203], a[196:199], a[180:183], v[200:203]
v_exp_f32 v146, v146
v_mfma_f32_16x16x32_bf16 v[192:195], a[196:199], a[164:167], v[192:195]
ds_read_b64_tr_b16 a[228:229], v3 offset:43296
s_add_u32 m0, s96, 16896
s_nop 0
buffer_load_dwordx4 v244, s[52:55], s22 offen offset:0 lds
v_mfma_f32_16x16x32_bf16 v[184:187], a[196:199], a[148:151], v[184:187]
v_exp_f32 v147, v147
v_mfma_f32_16x16x32_bf16 v[176:179], a[196:199], a[132:135], v[176:179]
ds_read_b64_tr_b16 a[230:231], v3 offset:43808
v_cvt_pk_bf16_f32 v209, v146, v147
v_mfma_f32_16x16x32_bf16 v[176:179], a[200:203], a[136:139], v[176:179]
v_exp_f32 v148, v148
v_mfma_f32_16x16x32_bf16 v[184:187], a[200:203], a[152:155], v[184:187]
ds_read_b64_tr_b16 a[232:233], v3 offset:43328
v_mfma_f32_16x16x32_bf16 v[192:195], a[200:203], a[168:171], v[192:195]
v_exp_f32 v149, v149
v_mfma_f32_16x16x32_bf16 v[200:203], a[200:203], a[184:187], v[200:203]
ds_read_b64_tr_b16 a[234:235], v3 offset:43840
v_cvt_pk_bf16_f32 v210, v148, v149
v_mfma_f32_16x16x32_bf16 v[200:203], a[204:207], a[188:191], v[200:203]
v_exp_f32 v150, v150
v_mfma_f32_16x16x32_bf16 v[192:195], a[204:207], a[172:175], v[192:195]
ds_read_b64_tr_b16 a[236:237], v3 offset:43360
v_mfma_f32_16x16x32_bf16 v[184:187], a[204:207], a[156:159], v[184:187]
buffer_load_dwordx4 v245, s[52:55], s22 offen offset:1056 lds
v_exp_f32 v151, v151
v_mfma_f32_16x16x32_bf16 v[176:179], a[204:207], a[140:143], v[176:179]
ds_read_b64_tr_b16 a[238:239], v3 offset:43872
v_cvt_pk_bf16_f32 v211, v150, v151
v_mfma_f32_16x16x32_bf16 v[180:183], a[208:211], a[128:131], 0
v_mfma_f32_16x16x32_bf16 v[188:191], a[208:211], a[144:147], 0
v_exp_f32 v152, v152
v_mfma_f32_16x16x32_bf16 v[196:199], a[208:211], a[160:163], 0
ds_read_b64_tr_b16 a[240:241], v3 offset:43392
v_mfma_f32_16x16x32_bf16 v[204:207], a[208:211], a[176:179], 0
v_exp_f32 v153, v153
v_mfma_f32_16x16x32_bf16 v[204:207], a[212:215], a[180:183], v[204:207]
ds_read_b64_tr_b16 a[242:243], v3 offset:43904
v_cvt_pk_bf16_f32 v212, v152, v153
v_mfma_f32_16x16x32_bf16 v[196:199], a[212:215], a[164:167], v[196:199]
v_exp_f32 v154, v154
v_mfma_f32_16x16x32_bf16 v[188:191], a[212:215], a[148:151], v[188:191]
ds_read_b64_tr_b16 a[244:245], v3 offset:43424
v_mfma_f32_16x16x32_bf16 v[180:183], a[212:215], a[132:135], v[180:183]
buffer_load_dwordx4 v246, s[52:55], s22 offen offset:2112 lds
v_exp_f32 v155, v155
v_mfma_f32_16x16x32_bf16 v[180:183], a[216:219], a[136:139], v[180:183]
ds_read_b64_tr_b16 a[246:247], v3 offset:43936
v_cvt_pk_bf16_f32 v213, v154, v155
v_mfma_f32_16x16x32_bf16 v[188:191], a[216:219], a[152:155], v[188:191]
v_exp_f32 v156, v156
v_mfma_f32_16x16x32_bf16 v[196:199], a[216:219], a[168:171], v[196:199]
ds_read_b64_tr_b16 a[248:249], v3 offset:43456
v_mfma_f32_16x16x32_bf16 v[204:207], a[216:219], a[184:187], v[204:207]
v_exp_f32 v157, v157
v_mfma_f32_16x16x32_bf16 v[204:207], a[220:223], a[188:191], v[204:207]
ds_read_b64_tr_b16 a[250:251], v3 offset:43968
v_cvt_pk_bf16_f32 v214, v156, v157
v_mfma_f32_16x16x32_bf16 v[196:199], a[220:223], a[172:175], v[196:199]
v_exp_f32 v158, v158
v_mfma_f32_16x16x32_bf16 v[188:191], a[220:223], a[156:159], v[188:191]
ds_read_b64_tr_b16 a[252:253], v3 offset:43488
v_mfma_f32_16x16x32_bf16 v[180:183], a[220:223], a[140:143], v[180:183]
v_exp_f32 v159, v159
s_waitcnt lgkmcnt(7)
v_mfma_f32_16x16x32_bf16 v[16:19], a[224:227], v[224:227], v[16:19]
ds_read_b64_tr_b16 a[254:255], v3 offset:44000
v_cvt_pk_bf16_f32 v215, v158, v159
v_mfma_f32_16x16x32_bf16 v[24:27], a[224:227], v[228:231], v[24:27]
buffer_load_dwordx4 v247, s[52:55], s22 offen offset:3168 lds
v_mfma_f32_16x16x32_bf16 v[32:35], a[224:227], v[232:235], v[32:35]
v_exp_f32 v160, v160
v_mfma_f32_16x16x32_bf16 v[40:43], a[224:227], v[236:239], v[40:43]
v_mfma_f32_16x16x32_bf16 v[44:47], a[228:231], v[236:239], v[44:47]
v_exp_f32 v161, v161
v_mfma_f32_16x16x32_bf16 v[36:39], a[228:231], v[232:235], v[36:39]
v_cvt_pk_bf16_f32 v216, v160, v161
v_mfma_f32_16x16x32_bf16 v[28:31], a[228:231], v[228:231], v[28:31]
v_exp_f32 v162, v162
v_mfma_f32_16x16x32_bf16 v[20:23], a[228:231], v[224:227], v[20:23]
v_mfma_f32_16x16x32_bf16 v[48:51], a[232:235], v[224:227], v[48:51]
v_exp_f32 v163, v163
v_mfma_f32_16x16x32_bf16 v[56:59], a[232:235], v[228:231], v[56:59]
s_waitcnt lgkmcnt(0)
s_barrier
v_cvt_pk_bf16_f32 v217, v162, v163
v_mfma_f32_16x16x32_bf16 v[64:67], a[232:235], v[232:235], v[64:67]
v_exp_f32 v164, v164
v_mfma_f32_16x16x32_bf16 v[72:75], a[232:235], v[236:239], v[72:75]
ds_read_b128 a[192:195], v1 offset:0
v_mfma_f32_16x16x32_bf16 v[76:79], a[236:239], v[236:239], v[76:79]
v_exp_f32 v165, v165
v_mfma_f32_16x16x32_bf16 v[68:71], a[236:239], v[232:235], v[68:71]
ds_read_b128 a[196:199], v1 offset:64
v_cvt_pk_bf16_f32 v218, v164, v165
v_mfma_f32_16x16x32_bf16 v[60:63], a[236:239], v[228:231], v[60:63]
v_exp_f32 v166, v166
v_mfma_f32_16x16x32_bf16 v[52:55], a[236:239], v[224:227], v[52:55]
ds_read_b128 a[200:203], v1 offset:128
v_mfma_f32_16x16x32_bf16 v[80:83], a[240:243], v[224:227], v[80:83]
v_exp_f32 v167, v167
v_mfma_f32_16x16x32_bf16 v[88:91], a[240:243], v[228:231], v[88:91]
ds_read_b128 a[204:207], v1 offset:192
v_cvt_pk_bf16_f32 v219, v166, v167
v_mfma_f32_16x16x32_bf16 v[96:99], a[240:243], v[232:235], v[96:99]
v_mfma_f32_16x16x32_bf16 v[104:107], a[240:243], v[236:239], v[104:107]
v_exp_f32 v168, v168
v_mfma_f32_16x16x32_bf16 v[108:111], a[244:247], v[236:239], v[108:111]
ds_read_b128 a[208:211], v1 offset:4352
s_add_u32 m0, s99, 138240
s_add_u32 s95, s94, 114688
v_mfma_f32_16x16x32_bf16 v[100:103], a[244:247], v[232:235], v[100:103]
buffer_load_dwordx4 v4, s[40:43], s95 offen offset:0 lds
v_exp_f32 v169, v169
v_mfma_f32_16x16x32_bf16 v[92:95], a[244:247], v[228:231], v[92:95]
ds_read_b128 a[212:215], v1 offset:4416
v_cvt_pk_bf16_f32 v220, v168, v169
v_mfma_f32_16x16x32_bf16 v[84:87], a[244:247], v[224:227], v[84:87]
v_exp_f32 v170, v170
v_mfma_f32_16x16x32_bf16 v[112:115], a[248:251], v[224:227], v[112:115]
ds_read_b128 a[216:219], v1 offset:4480
buffer_load_dwordx4 v5, s[40:43], s95 offen offset:1088 lds
v_mfma_f32_16x16x32_bf16 v[120:123], a[248:251], v[228:231], v[120:123]
v_exp_f32 v171, v171
v_mfma_f32_16x16x32_bf16 v[128:131], a[248:251], v[232:235], v[128:131]
ds_read_b128 a[220:223], v1 offset:4544
v_cvt_pk_bf16_f32 v221, v170, v171
v_mfma_f32_16x16x32_bf16 v[136:139], a[248:251], v[236:239], v[136:139]
v_exp_f32 v172, v172
v_mfma_f32_16x16x32_bf16 v[140:143], a[252:255], v[236:239], v[140:143]
buffer_load_dwordx4 v6, s[40:43], s95 offen offset:2176 lds
v_mfma_f32_16x16x32_bf16 v[132:135], a[252:255], v[232:235], v[132:135]
v_exp_f32 v173, v173
v_mfma_f32_16x16x32_bf16 v[124:127], a[252:255], v[228:231], v[124:127]
v_cvt_pk_bf16_f32 v222, v172, v173
v_mfma_f32_16x16x32_bf16 v[116:119], a[252:255], v[224:227], v[116:119]
v_exp_f32 v174, v174
v_mfma_f32_16x16x32_bf16 a[108:111], a[124:127], v[224:227], a[108:111]
buffer_load_dwordx4 v7, s[40:43], s95 offen offset:3264 lds
v_mfma_f32_16x16x32_bf16 a[112:115], a[124:127], v[228:231], a[112:115]
v_exp_f32 v175, v175
v_mfma_f32_16x16x32_bf16 a[116:119], a[124:127], v[232:235], a[116:119]
v_cvt_pk_bf16_f32 v223, v174, v175
v_mfma_f32_16x16x32_bf16 a[120:123], a[124:127], v[236:239], a[120:123]
s_waitcnt lgkmcnt(0)
v_mfma_f32_16x16x32_bf16 v[144:147], a[192:195], a[128:131], 0
v_exp_f32 v176, v176
v_mfma_f32_16x16x32_bf16 v[152:155], a[192:195], a[144:147], 0
ds_read_b64_tr_b16 a[224:225], v3 offset:0
s_add_u32 m0, s96, 120832
s_add_u32 s95, s94, 98304
v_mfma_f32_16x16x32_bf16 v[160:163], a[192:195], a[160:163], 0
buffer_load_dwordx4 v8, s[44:47], s95 offen offset:0 lds
v_exp_f32 v177, v177
v_mfma_f32_16x16x32_bf16 v[168:171], a[192:195], a[176:179], 0
ds_read_b64_tr_b16 a[226:227], v3 offset:512
v_cvt_pk_bf16_f32 v224, v176, v177
v_mfma_f32_16x16x32_bf16 v[168:171], a[196:199], a[180:183], v[168:171]
v_exp_f32 v178, v178
v_mfma_f32_16x16x32_bf16 v[160:163], a[196:199], a[164:167], v[160:163]
ds_read_b64_tr_b16 a[228:229], v3 offset:32
v_mfma_f32_16x16x32_bf16 v[152:155], a[196:199], a[148:151], v[152:155]
v_exp_f32 v179, v179
v_mfma_f32_16x16x32_bf16 v[144:147], a[196:199], a[132:135], v[144:147]
ds_read_b64_tr_b16 a[230:231], v3 offset:544
v_cvt_pk_bf16_f32 v225, v178, v179
v_mfma_f32_16x16x32_bf16 v[144:147], a[200:203], a[136:139], v[144:147]
v_exp_f32 v180, v180
v_mfma_f32_16x16x32_bf16 v[152:155], a[200:203], a[152:155], v[152:155]
ds_read_b64_tr_b16 a[232:233], v3 offset:64
buffer_load_dwordx4 v9, s[44:47], s95 offen offset:1056 lds
v_mfma_f32_16x16x32_bf16 v[160:163], a[200:203], a[168:171], v[160:163]
v_exp_f32 v181, v181
v_mfma_f32_16x16x32_bf16 v[168:171], a[200:203], a[184:187], v[168:171]
ds_read_b64_tr_b16 a[234:235], v3 offset:576
v_cvt_pk_bf16_f32 v226, v180, v181
v_mfma_f32_16x16x32_bf16 v[168:171], a[204:207], a[188:191], v[168:171]
v_exp_f32 v182, v182
v_mfma_f32_16x16x32_bf16 v[160:163], a[204:207], a[172:175], v[160:163]
ds_read_b64_tr_b16 a[236:237], v3 offset:96
v_mfma_f32_16x16x32_bf16 v[152:155], a[204:207], a[156:159], v[152:155]
v_exp_f32 v183, v183
v_mfma_f32_16x16x32_bf16 v[144:147], a[204:207], a[140:143], v[144:147]
ds_read_b64_tr_b16 a[238:239], v3 offset:608
v_cvt_pk_bf16_f32 v227, v182, v183
v_mfma_f32_16x16x32_bf16 v[148:151], a[208:211], a[128:131], 0
v_mfma_f32_16x16x32_bf16 v[156:159], a[208:211], a[144:147], 0
v_exp_f32 v184, v184
v_mfma_f32_16x16x32_bf16 v[164:167], a[208:211], a[160:163], 0
ds_read_b64_tr_b16 a[240:241], v3 offset:128
buffer_load_dwordx4 v10, s[44:47], s95 offen offset:2112 lds
v_mfma_f32_16x16x32_bf16 v[172:175], a[208:211], a[176:179], 0
v_exp_f32 v185, v185
v_mfma_f32_16x16x32_bf16 v[172:175], a[212:215], a[180:183], v[172:175]
ds_read_b64_tr_b16 a[242:243], v3 offset:640
v_cvt_pk_bf16_f32 v228, v184, v185
v_mfma_f32_16x16x32_bf16 v[164:167], a[212:215], a[164:167], v[164:167]
v_exp_f32 v186, v186
v_mfma_f32_16x16x32_bf16 v[156:159], a[212:215], a[148:151], v[156:159]
ds_read_b64_tr_b16 a[244:245], v3 offset:160
v_mfma_f32_16x16x32_bf16 v[148:151], a[212:215], a[132:135], v[148:151]
v_exp_f32 v187, v187
v_mfma_f32_16x16x32_bf16 v[148:151], a[216:219], a[136:139], v[148:151]
ds_read_b64_tr_b16 a[246:247], v3 offset:672
v_cvt_pk_bf16_f32 v229, v186, v187
v_mfma_f32_16x16x32_bf16 v[156:159], a[216:219], a[152:155], v[156:159]
v_exp_f32 v188, v188
v_mfma_f32_16x16x32_bf16 v[164:167], a[216:219], a[168:171], v[164:167]
ds_read_b64_tr_b16 a[248:249], v3 offset:192
buffer_load_dwordx4 v11, s[44:47], s95 offen offset:3168 lds
v_mfma_f32_16x16x32_bf16 v[172:175], a[216:219], a[184:187], v[172:175]
v_exp_f32 v189, v189
v_mfma_f32_16x16x32_bf16 v[172:175], a[220:223], a[188:191], v[172:175]
ds_read_b64_tr_b16 a[250:251], v3 offset:704
v_cvt_pk_bf16_f32 v230, v188, v189
v_mfma_f32_16x16x32_bf16 v[164:167], a[220:223], a[172:175], v[164:167]
v_exp_f32 v190, v190
v_mfma_f32_16x16x32_bf16 v[156:159], a[220:223], a[156:159], v[156:159]
ds_read_b64_tr_b16 a[252:253], v3 offset:224
v_mfma_f32_16x16x32_bf16 v[148:151], a[220:223], a[140:143], v[148:151]
v_exp_f32 v191, v191
s_waitcnt lgkmcnt(7)
v_mfma_f32_16x16x32_bf16 v[16:19], a[224:227], v[208:211], v[16:19]
ds_read_b64_tr_b16 a[254:255], v3 offset:736
v_cvt_pk_bf16_f32 v231, v190, v191
v_mfma_f32_16x16x32_bf16 v[24:27], a[224:227], v[212:215], v[24:27]
s_lshl_b32 s22, s13, 17
v_mfma_f32_16x16x32_bf16 v[32:35], a[224:227], v[216:219], v[32:35]
v_exp_f32 v192, v192
v_mfma_f32_16x16x32_bf16 v[40:43], a[224:227], v[220:223], v[40:43]
s_add_u32 s22, s22, s25
s_add_u32 s22, s22, 65536
s_add_u32 m0, s96, 33792
v_mfma_f32_16x16x32_bf16 v[44:47], a[228:231], v[220:223], v[44:47]
v_exp_f32 v193, v193
v_mfma_f32_16x16x32_bf16 v[36:39], a[228:231], v[216:219], v[36:39]
buffer_load_dwordx4 v244, s[52:55], s22 offen offset:0 lds
v_cvt_pk_bf16_f32 v232, v192, v193
v_mfma_f32_16x16x32_bf16 v[28:31], a[228:231], v[212:215], v[28:31]
v_exp_f32 v194, v194
v_mfma_f32_16x16x32_bf16 v[20:23], a[228:231], v[208:211], v[20:23]
v_mfma_f32_16x16x32_bf16 v[48:51], a[232:235], v[208:211], v[48:51]
v_exp_f32 v195, v195
v_mfma_f32_16x16x32_bf16 v[56:59], a[232:235], v[212:215], v[56:59]
s_waitcnt lgkmcnt(0)
v_cvt_pk_bf16_f32 v233, v194, v195
v_mfma_f32_16x16x32_bf16 v[64:67], a[232:235], v[216:219], v[64:67]
v_exp_f32 v196, v196
v_mfma_f32_16x16x32_bf16 v[72:75], a[232:235], v[220:223], v[72:75]
ds_read_b128 a[192:195], v1 offset:8704
v_mfma_f32_16x16x32_bf16 v[76:79], a[236:239], v[220:223], v[76:79]
buffer_load_dwordx4 v245, s[52:55], s22 offen offset:1056 lds
v_exp_f32 v197, v197
v_mfma_f32_16x16x32_bf16 v[68:71], a[236:239], v[216:219], v[68:71]
ds_read_b128 a[196:199], v1 offset:8768
v_cvt_pk_bf16_f32 v234, v196, v197
v_mfma_f32_16x16x32_bf16 v[60:63], a[236:239], v[212:215], v[60:63]
v_exp_f32 v198, v198
v_mfma_f32_16x16x32_bf16 v[52:55], a[236:239], v[208:211], v[52:55]
ds_read_b128 a[200:203], v1 offset:8832
v_mfma_f32_16x16x32_bf16 v[80:83], a[240:243], v[208:211], v[80:83]
v_exp_f32 v199, v199
v_mfma_f32_16x16x32_bf16 v[88:91], a[240:243], v[212:215], v[88:91]
ds_read_b128 a[204:207], v1 offset:8896
v_cvt_pk_bf16_f32 v235, v198, v199
v_mfma_f32_16x16x32_bf16 v[96:99], a[240:243], v[216:219], v[96:99]
v_mfma_f32_16x16x32_bf16 v[104:107], a[240:243], v[220:223], v[104:107]
v_exp_f32 v200, v200
v_mfma_f32_16x16x32_bf16 v[108:111], a[244:247], v[220:223], v[108:111]
ds_read_b128 a[208:211], v1 offset:13056
buffer_load_dwordx4 v246, s[52:55], s22 offen offset:2112 lds
v_mfma_f32_16x16x32_bf16 v[100:103], a[244:247], v[216:219], v[100:103]
v_exp_f32 v201, v201
v_mfma_f32_16x16x32_bf16 v[92:95], a[244:247], v[212:215], v[92:95]
ds_read_b128 a[212:215], v1 offset:13120
v_cvt_pk_bf16_f32 v236, v200, v201
v_mfma_f32_16x16x32_bf16 v[84:87], a[244:247], v[208:211], v[84:87]
v_exp_f32 v202, v202
v_mfma_f32_16x16x32_bf16 v[112:115], a[248:251], v[208:211], v[112:115]
ds_read_b128 a[216:219], v1 offset:13184
v_mfma_f32_16x16x32_bf16 v[120:123], a[248:251], v[212:215], v[120:123]
v_exp_f32 v203, v203
v_mfma_f32_16x16x32_bf16 v[128:131], a[248:251], v[216:219], v[128:131]
ds_read_b128 a[220:223], v1 offset:13248
v_cvt_pk_bf16_f32 v237, v202, v203
v_mfma_f32_16x16x32_bf16 v[136:139], a[248:251], v[220:223], v[136:139]
v_exp_f32 v204, v204
v_mfma_f32_16x16x32_bf16 v[140:143], a[252:255], v[220:223], v[140:143]
buffer_load_dwordx4 v247, s[52:55], s22 offen offset:3168 lds
v_mfma_f32_16x16x32_bf16 v[132:135], a[252:255], v[216:219], v[132:135]
v_exp_f32 v205, v205
v_mfma_f32_16x16x32_bf16 v[124:127], a[252:255], v[212:215], v[124:127]
v_cvt_pk_bf16_f32 v238, v204, v205
v_mfma_f32_16x16x32_bf16 v[116:119], a[252:255], v[208:211], v[116:119]
v_exp_f32 v206, v206
v_mfma_f32_16x16x32_bf16 a[108:111], a[124:127], v[208:211], a[108:111]
v_mfma_f32_16x16x32_bf16 a[112:115], a[124:127], v[212:215], a[112:115]
v_exp_f32 v207, v207
v_mfma_f32_16x16x32_bf16 a[116:119], a[124:127], v[216:219], a[116:119]
v_cvt_pk_bf16_f32 v239, v206, v207
v_mfma_f32_16x16x32_bf16 a[120:123], a[124:127], v[220:223], a[120:123]
s_waitcnt lgkmcnt(0)
v_mfma_f32_16x16x32_bf16 v[176:179], a[192:195], a[128:131], 0
v_exp_f32 v144, v144
v_mfma_f32_16x16x32_bf16 v[184:187], a[192:195], a[144:147], 0
ds_read_b64_tr_b16 a[224:225], v3 offset:8448
s_lshl_b32 s22, s14, 17
s_add_u32 s22, s22, s25
v_mfma_f32_16x16x32_bf16 v[192:195], a[192:195], a[160:163], 0
s_add_u32 m0, s96, 50688
v_exp_f32 v145, v145
v_mfma_f32_16x16x32_bf16 v[200:203], a[192:195], a[176:179], 0
ds_read_b64_tr_b16 a[226:227], v3 offset:8960
buffer_load_dwordx4 v244, s[52:55], s22 offen offset:0 lds
v_cvt_pk_bf16_f32 v208, v144, v145
v_mfma_f32_16x16x32_bf16 v[200:203], a[196:199], a[180:183], v[200:203]
v_exp_f32 v146, v146
v_mfma_f32_16x16x32_bf16 v[192:195], a[196:199], a[164:167], v[192:195]
ds_read_b64_tr_b16 a[228:229], v3 offset:8480
v_mfma_f32_16x16x32_bf16 v[184:187], a[196:199], a[148:151], v[184:187]
v_exp_f32 v147, v147
v_mfma_f32_16x16x32_bf16 v[176:179], a[196:199], a[132:135], v[176:179]
ds_read_b64_tr_b16 a[230:231], v3 offset:8992
v_cvt_pk_bf16_f32 v209, v146, v147
v_mfma_f32_16x16x32_bf16 v[176:179], a[200:203], a[136:139], v[176:179]
v_exp_f32 v148, v148
v_mfma_f32_16x16x32_bf16 v[184:187], a[200:203], a[152:155], v[184:187]
ds_read_b64_tr_b16 a[232:233], v3 offset:8512
v_mfma_f32_16x16x32_bf16 v[192:195], a[200:203], a[168:171], v[192:195]
v_exp_f32 v149, v149
v_mfma_f32_16x16x32_bf16 v[200:203], a[200:203], a[184:187], v[200:203]
ds_read_b64_tr_b16 a[234:235], v3 offset:9024
v_cvt_pk_bf16_f32 v210, v148, v149
v_mfma_f32_16x16x32_bf16 v[200:203], a[204:207], a[188:191], v[200:203]
v_exp_f32 v150, v150
v_mfma_f32_16x16x32_bf16 v[192:195], a[204:207], a[172:175], v[192:195]
ds_read_b64_tr_b16 a[236:237], v3 offset:8544
buffer_load_dwordx4 v245, s[52:55], s22 offen offset:1056 lds
v_mfma_f32_16x16x32_bf16 v[184:187], a[204:207], a[156:159], v[184:187]
v_exp_f32 v151, v151
v_mfma_f32_16x16x32_bf16 v[176:179], a[204:207], a[140:143], v[176:179]
ds_read_b64_tr_b16 a[238:239], v3 offset:9056
v_cvt_pk_bf16_f32 v211, v150, v151
v_mfma_f32_16x16x32_bf16 v[180:183], a[208:211], a[128:131], 0
v_mfma_f32_16x16x32_bf16 v[188:191], a[208:211], a[144:147], 0
v_exp_f32 v152, v152
v_mfma_f32_16x16x32_bf16 v[196:199], a[208:211], a[160:163], 0
ds_read_b64_tr_b16 a[240:241], v3 offset:8576
v_mfma_f32_16x16x32_bf16 v[204:207], a[208:211], a[176:179], 0
v_exp_f32 v153, v153
v_mfma_f32_16x16x32_bf16 v[204:207], a[212:215], a[180:183], v[204:207]
ds_read_b64_tr_b16 a[242:243], v3 offset:9088
v_cvt_pk_bf16_f32 v212, v152, v153
v_mfma_f32_16x16x32_bf16 v[196:199], a[212:215], a[164:167], v[196:199]
v_exp_f32 v154, v154
v_mfma_f32_16x16x32_bf16 v[188:191], a[212:215], a[148:151], v[188:191]
ds_read_b64_tr_b16 a[244:245], v3 offset:8608
buffer_load_dwordx4 v246, s[52:55], s22 offen offset:2112 lds
v_mfma_f32_16x16x32_bf16 v[180:183], a[212:215], a[132:135], v[180:183]
v_exp_f32 v155, v155
v_mfma_f32_16x16x32_bf16 v[180:183], a[216:219], a[136:139], v[180:183]
ds_read_b64_tr_b16 a[246:247], v3 offset:9120
v_cvt_pk_bf16_f32 v213, v154, v155
v_mfma_f32_16x16x32_bf16 v[188:191], a[216:219], a[152:155], v[188:191]
v_exp_f32 v156, v156
v_mfma_f32_16x16x32_bf16 v[196:199], a[216:219], a[168:171], v[196:199]
ds_read_b64_tr_b16 a[248:249], v3 offset:8640
v_mfma_f32_16x16x32_bf16 v[204:207], a[216:219], a[184:187], v[204:207]
v_exp_f32 v157, v157
v_mfma_f32_16x16x32_bf16 v[204:207], a[220:223], a[188:191], v[204:207]
ds_read_b64_tr_b16 a[250:251], v3 offset:9152
v_cvt_pk_bf16_f32 v214, v156, v157
v_mfma_f32_16x16x32_bf16 v[196:199], a[220:223], a[172:175], v[196:199]
v_exp_f32 v158, v158
v_mfma_f32_16x16x32_bf16 v[188:191], a[220:223], a[156:159], v[188:191]
ds_read_b64_tr_b16 a[252:253], v3 offset:8672
v_mfma_f32_16x16x32_bf16 v[180:183], a[220:223], a[140:143], v[180:183]
buffer_load_dwordx4 v247, s[52:55], s22 offen offset:3168 lds
v_exp_f32 v159, v159
s_waitcnt lgkmcnt(7)
v_mfma_f32_16x16x32_bf16 v[16:19], a[224:227], v[224:227], v[16:19]
ds_read_b64_tr_b16 a[254:255], v3 offset:9184
v_cvt_pk_bf16_f32 v215, v158, v159
v_mfma_f32_16x16x32_bf16 v[24:27], a[224:227], v[228:231], v[24:27]
v_mfma_f32_16x16x32_bf16 v[32:35], a[224:227], v[232:235], v[32:35]
v_exp_f32 v160, v160
v_mfma_f32_16x16x32_bf16 v[40:43], a[224:227], v[236:239], v[40:43]
v_mfma_f32_16x16x32_bf16 v[44:47], a[228:231], v[236:239], v[44:47]
v_exp_f32 v161, v161
v_mfma_f32_16x16x32_bf16 v[36:39], a[228:231], v[232:235], v[36:39]
v_cvt_pk_bf16_f32 v216, v160, v161
v_mfma_f32_16x16x32_bf16 v[28:31], a[228:231], v[228:231], v[28:31]
v_exp_f32 v162, v162
v_mfma_f32_16x16x32_bf16 v[20:23], a[228:231], v[224:227], v[20:23]
v_mfma_f32_16x16x32_bf16 v[48:51], a[232:235], v[224:227], v[48:51]
v_exp_f32 v163, v163
v_mfma_f32_16x16x32_bf16 v[56:59], a[232:235], v[228:231], v[56:59]
s_waitcnt vmcnt(8) lgkmcnt(0)
s_barrier
v_cvt_pk_bf16_f32 v217, v162, v163
v_mfma_f32_16x16x32_bf16 v[64:67], a[232:235], v[232:235], v[64:67]
v_exp_f32 v164, v164
v_mfma_f32_16x16x32_bf16 v[72:75], a[232:235], v[236:239], v[72:75]
ds_read_b128 a[192:195], v1 offset:34816
v_mfma_f32_16x16x32_bf16 v[76:79], a[236:239], v[236:239], v[76:79]
v_exp_f32 v165, v165
v_mfma_f32_16x16x32_bf16 v[68:71], a[236:239], v[232:235], v[68:71]
ds_read_b128 a[196:199], v1 offset:34880
v_cvt_pk_bf16_f32 v218, v164, v165
v_mfma_f32_16x16x32_bf16 v[60:63], a[236:239], v[228:231], v[60:63]
v_exp_f32 v166, v166
v_mfma_f32_16x16x32_bf16 v[52:55], a[236:239], v[224:227], v[52:55]
ds_read_b128 a[200:203], v1 offset:34944
v_mfma_f32_16x16x32_bf16 v[80:83], a[240:243], v[224:227], v[80:83]
v_exp_f32 v167, v167
v_mfma_f32_16x16x32_bf16 v[88:91], a[240:243], v[228:231], v[88:91]
ds_read_b128 a[204:207], v1 offset:35008
v_cvt_pk_bf16_f32 v219, v166, v167
v_mfma_f32_16x16x32_bf16 v[96:99], a[240:243], v[232:235], v[96:99]
v_mfma_f32_16x16x32_bf16 v[104:107], a[240:243], v[236:239], v[104:107]
v_exp_f32 v168, v168
v_mfma_f32_16x16x32_bf16 v[108:111], a[244:247], v[236:239], v[108:111]
ds_read_b128 a[208:211], v1 offset:39168
s_add_u32 m0, s96, 86016
s_add_u32 s95, s94, 114688
v_mfma_f32_16x16x32_bf16 v[100:103], a[244:247], v[232:235], v[100:103]
buffer_load_dwordx4 v8, s[44:47], s95 offen offset:0 lds
v_exp_f32 v169, v169
v_mfma_f32_16x16x32_bf16 v[92:95], a[244:247], v[228:231], v[92:95]
ds_read_b128 a[212:215], v1 offset:39232
v_cvt_pk_bf16_f32 v220, v168, v169
v_mfma_f32_16x16x32_bf16 v[84:87], a[244:247], v[224:227], v[84:87]
v_exp_f32 v170, v170
v_mfma_f32_16x16x32_bf16 v[112:115], a[248:251], v[224:227], v[112:115]
ds_read_b128 a[216:219], v1 offset:39296
buffer_load_dwordx4 v9, s[44:47], s95 offen offset:1056 lds
v_mfma_f32_16x16x32_bf16 v[120:123], a[248:251], v[228:231], v[120:123]
v_exp_f32 v171, v171
v_mfma_f32_16x16x32_bf16 v[128:131], a[248:251], v[232:235], v[128:131]
ds_read_b128 a[220:223], v1 offset:39360
v_cvt_pk_bf16_f32 v221, v170, v171
v_mfma_f32_16x16x32_bf16 v[136:139], a[248:251], v[236:239], v[136:139]
v_exp_f32 v172, v172
v_mfma_f32_16x16x32_bf16 v[140:143], a[252:255], v[236:239], v[140:143]
buffer_load_dwordx4 v10, s[44:47], s95 offen offset:2112 lds
v_mfma_f32_16x16x32_bf16 v[132:135], a[252:255], v[232:235], v[132:135]
v_exp_f32 v173, v173
v_mfma_f32_16x16x32_bf16 v[124:127], a[252:255], v[228:231], v[124:127]
v_cvt_pk_bf16_f32 v222, v172, v173
v_mfma_f32_16x16x32_bf16 v[116:119], a[252:255], v[224:227], v[116:119]
v_exp_f32 v174, v174
v_mfma_f32_16x16x32_bf16 a[108:111], a[124:127], v[224:227], a[108:111]
buffer_load_dwordx4 v11, s[44:47], s95 offen offset:3168 lds
v_mfma_f32_16x16x32_bf16 a[112:115], a[124:127], v[228:231], a[112:115]
v_exp_f32 v175, v175
v_mfma_f32_16x16x32_bf16 a[116:119], a[124:127], v[232:235], a[116:119]
v_cvt_pk_bf16_f32 v223, v174, v175
v_mfma_f32_16x16x32_bf16 a[120:123], a[124:127], v[236:239], a[120:123]
s_waitcnt lgkmcnt(0)
v_mfma_f32_16x16x32_bf16 v[144:147], a[192:195], a[128:131], 0
v_exp_f32 v176, v176
v_mfma_f32_16x16x32_bf16 v[152:155], a[192:195], a[144:147], 0
ds_read_b64_tr_b16 a[224:225], v3 offset:34816
s_lshl_b32 s88, s4, 2
s_add_u32 s88, s88, s3
v_mfma_f32_16x16x32_bf16 v[160:163], a[192:195], a[160:163], 0
s_and_b32 s88, s88, 15
v_exp_f32 v177, v177
v_mfma_f32_16x16x32_bf16 v[168:171], a[192:195], a[176:179], 0
ds_read_b64_tr_b16 a[226:227], v3 offset:35328
s_lshl_b32 s88, s88, 10
v_cvt_pk_bf16_f32 v224, v176, v177
v_mfma_f32_16x16x32_bf16 v[168:171], a[196:199], a[180:183], v[168:171]
v_exp_f32 v178, v178
v_mfma_f32_16x16x32_bf16 v[160:163], a[196:199], a[164:167], v[160:163]
ds_read_b64_tr_b16 a[228:229], v3 offset:34848
v_lshlrev_b32 v252, 4, v0
v_mfma_f32_16x16x32_bf16 v[152:155], a[196:199], a[148:151], v[152:155]
s_add_u32 s88, s88, recurrent_scan__sliding_block_cached__mixer_s_mlp__prompt_kernel_bo-recurrent_scan__sliding_block_cached__mixer_s_mlp__prompt_kernel_pc
v_exp_f32 v179, v179
v_mfma_f32_16x16x32_bf16 v[144:147], a[196:199], a[132:135], v[144:147]
ds_read_b64_tr_b16 a[230:231], v3 offset:35360
v_cvt_pk_bf16_f32 v225, v178, v179
v_mfma_f32_16x16x32_bf16 v[144:147], a[200:203], a[136:139], v[144:147]
v_exp_f32 v180, v180
v_mfma_f32_16x16x32_bf16 v[152:155], a[200:203], a[152:155], v[152:155]
ds_read_b64_tr_b16 a[232:233], v3 offset:34880
buffer_load_dword v253, v252, s[72:75], s88 offen
v_mfma_f32_16x16x32_bf16 v[160:163], a[200:203], a[168:171], v[160:163]
v_exp_f32 v181, v181
v_mfma_f32_16x16x32_bf16 v[168:171], a[200:203], a[184:187], v[168:171]
ds_read_b64_tr_b16 a[234:235], v3 offset:35392
v_cvt_pk_bf16_f32 v226, v180, v181
v_mfma_f32_16x16x32_bf16 v[168:171], a[204:207], a[188:191], v[168:171]
v_exp_f32 v182, v182
v_mfma_f32_16x16x32_bf16 v[160:163], a[204:207], a[172:175], v[160:163]
ds_read_b64_tr_b16 a[236:237], v3 offset:34912
v_mfma_f32_16x16x32_bf16 v[152:155], a[204:207], a[156:159], v[152:155]
v_exp_f32 v183, v183
v_mfma_f32_16x16x32_bf16 v[144:147], a[204:207], a[140:143], v[144:147]
ds_read_b64_tr_b16 a[238:239], v3 offset:35424
v_cvt_pk_bf16_f32 v227, v182, v183
v_mfma_f32_16x16x32_bf16 v[148:151], a[208:211], a[128:131], 0
v_mfma_f32_16x16x32_bf16 v[156:159], a[208:211], a[144:147], 0
v_exp_f32 v184, v184
v_mfma_f32_16x16x32_bf16 v[164:167], a[208:211], a[160:163], 0
ds_read_b64_tr_b16 a[240:241], v3 offset:34944
v_mfma_f32_16x16x32_bf16 v[172:175], a[208:211], a[176:179], 0
v_exp_f32 v185, v185
v_mfma_f32_16x16x32_bf16 v[172:175], a[212:215], a[180:183], v[172:175]
ds_read_b64_tr_b16 a[242:243], v3 offset:35456
s_lshl_b32 s22, s14, 17
v_cvt_pk_bf16_f32 v228, v184, v185
v_mfma_f32_16x16x32_bf16 v[164:167], a[212:215], a[164:167], v[164:167]
v_exp_f32 v186, v186
v_mfma_f32_16x16x32_bf16 v[156:159], a[212:215], a[148:151], v[156:159]
ds_read_b64_tr_b16 a[244:245], v3 offset:34976
s_add_u32 s22, s22, s25
s_add_u32 s22, s22, 65536
v_mfma_f32_16x16x32_bf16 v[148:151], a[212:215], a[132:135], v[148:151]
v_exp_f32 v187, v187
v_mfma_f32_16x16x32_bf16 v[148:151], a[216:219], a[136:139], v[148:151]
ds_read_b64_tr_b16 a[246:247], v3 offset:35488
s_add_u32 m0, s96, 67584
v_cvt_pk_bf16_f32 v229, v186, v187
v_mfma_f32_16x16x32_bf16 v[156:159], a[216:219], a[152:155], v[156:159]
v_exp_f32 v188, v188
v_mfma_f32_16x16x32_bf16 v[164:167], a[216:219], a[168:171], v[164:167]
ds_read_b64_tr_b16 a[248:249], v3 offset:35008
buffer_load_dwordx4 v244, s[52:55], s22 offen offset:0 lds
v_mfma_f32_16x16x32_bf16 v[172:175], a[216:219], a[184:187], v[172:175]
v_exp_f32 v189, v189
v_mfma_f32_16x16x32_bf16 v[172:175], a[220:223], a[188:191], v[172:175]
ds_read_b64_tr_b16 a[250:251], v3 offset:35520
v_cvt_pk_bf16_f32 v230, v188, v189
v_mfma_f32_16x16x32_bf16 v[164:167], a[220:223], a[172:175], v[164:167]
v_exp_f32 v190, v190
v_mfma_f32_16x16x32_bf16 v[156:159], a[220:223], a[156:159], v[156:159]
ds_read_b64_tr_b16 a[252:253], v3 offset:35040
v_mfma_f32_16x16x32_bf16 v[148:151], a[220:223], a[140:143], v[148:151]
v_exp_f32 v191, v191
s_waitcnt lgkmcnt(7)
v_mfma_f32_16x16x32_bf16 v[16:19], a[224:227], v[208:211], v[16:19]
ds_read_b64_tr_b16 a[254:255], v3 offset:35552
v_cvt_pk_bf16_f32 v231, v190, v191
v_mfma_f32_16x16x32_bf16 v[24:27], a[224:227], v[212:215], v[24:27]
v_mfma_f32_16x16x32_bf16 v[32:35], a[224:227], v[216:219], v[32:35]
v_exp_f32 v192, v192
v_mfma_f32_16x16x32_bf16 v[40:43], a[224:227], v[220:223], v[40:43]
v_mfma_f32_16x16x32_bf16 v[44:47], a[228:231], v[220:223], v[44:47]
v_exp_f32 v193, v193
v_mfma_f32_16x16x32_bf16 v[36:39], a[228:231], v[216:219], v[36:39]
buffer_load_dwordx4 v245, s[52:55], s22 offen offset:1056 lds
v_cvt_pk_bf16_f32 v232, v192, v193
v_mfma_f32_16x16x32_bf16 v[28:31], a[228:231], v[212:215], v[28:31]
v_exp_f32 v194, v194
v_mfma_f32_16x16x32_bf16 v[20:23], a[228:231], v[208:211], v[20:23]
v_mfma_f32_16x16x32_bf16 v[48:51], a[232:235], v[208:211], v[48:51]
v_exp_f32 v195, v195
v_mfma_f32_16x16x32_bf16 v[56:59], a[232:235], v[212:215], v[56:59]
s_waitcnt lgkmcnt(0)
v_cvt_pk_bf16_f32 v233, v194, v195
v_mfma_f32_16x16x32_bf16 v[64:67], a[232:235], v[216:219], v[64:67]
v_exp_f32 v196, v196
v_mfma_f32_16x16x32_bf16 v[72:75], a[232:235], v[220:223], v[72:75]
ds_read_b128 a[192:195], v1 offset:43520
v_mfma_f32_16x16x32_bf16 v[76:79], a[236:239], v[220:223], v[76:79]
v_exp_f32 v197, v197
v_mfma_f32_16x16x32_bf16 v[68:71], a[236:239], v[216:219], v[68:71]
ds_read_b128 a[196:199], v1 offset:43584
v_cvt_pk_bf16_f32 v234, v196, v197
v_mfma_f32_16x16x32_bf16 v[60:63], a[236:239], v[212:215], v[60:63]
v_exp_f32 v198, v198
v_mfma_f32_16x16x32_bf16 v[52:55], a[236:239], v[208:211], v[52:55]
ds_read_b128 a[200:203], v1 offset:43648
buffer_load_dwordx4 v246, s[52:55], s22 offen offset:2112 lds
v_mfma_f32_16x16x32_bf16 v[80:83], a[240:243], v[208:211], v[80:83]
v_exp_f32 v199, v199
v_mfma_f32_16x16x32_bf16 v[88:91], a[240:243], v[212:215], v[88:91]
ds_read_b128 a[204:207], v1 offset:43712
v_cvt_pk_bf16_f32 v235, v198, v199
v_mfma_f32_16x16x32_bf16 v[96:99], a[240:243], v[216:219], v[96:99]
v_mfma_f32_16x16x32_bf16 v[104:107], a[240:243], v[220:223], v[104:107]
v_exp_f32 v200, v200
v_mfma_f32_16x16x32_bf16 v[108:111], a[244:247], v[220:223], v[108:111]
ds_read_b128 a[208:211], v1 offset:47872
v_mfma_f32_16x16x32_bf16 v[100:103], a[244:247], v[216:219], v[100:103]
v_exp_f32 v201, v201
v_mfma_f32_16x16x32_bf16 v[92:95], a[244:247], v[212:215], v[92:95]
ds_read_b128 a[212:215], v1 offset:47936
v_cvt_pk_bf16_f32 v236, v200, v201
v_mfma_f32_16x16x32_bf16 v[84:87], a[244:247], v[208:211], v[84:87]
v_exp_f32 v202, v202
v_mfma_f32_16x16x32_bf16 v[112:115], a[248:251], v[208:211], v[112:115]
ds_read_b128 a[216:219], v1 offset:48000
v_mfma_f32_16x16x32_bf16 v[120:123], a[248:251], v[212:215], v[120:123]
buffer_load_dwordx4 v247, s[52:55], s22 offen offset:3168 lds
v_exp_f32 v203, v203
v_mfma_f32_16x16x32_bf16 v[128:131], a[248:251], v[216:219], v[128:131]
ds_read_b128 a[220:223], v1 offset:48064
v_cvt_pk_bf16_f32 v237, v202, v203
v_mfma_f32_16x16x32_bf16 v[136:139], a[248:251], v[220:223], v[136:139]
v_exp_f32 v204, v204
v_mfma_f32_16x16x32_bf16 v[140:143], a[252:255], v[220:223], v[140:143]
v_mfma_f32_16x16x32_bf16 v[132:135], a[252:255], v[216:219], v[132:135]
v_exp_f32 v205, v205
v_mfma_f32_16x16x32_bf16 v[124:127], a[252:255], v[212:215], v[124:127]
v_cvt_pk_bf16_f32 v238, v204, v205
v_mfma_f32_16x16x32_bf16 v[116:119], a[252:255], v[208:211], v[116:119]
v_exp_f32 v206, v206
v_mfma_f32_16x16x32_bf16 a[108:111], a[124:127], v[208:211], a[108:111]
v_mfma_f32_16x16x32_bf16 a[112:115], a[124:127], v[212:215], a[112:115]
v_exp_f32 v207, v207
v_mfma_f32_16x16x32_bf16 a[116:119], a[124:127], v[216:219], a[116:119]
v_cvt_pk_bf16_f32 v239, v206, v207
v_mfma_f32_16x16x32_bf16 a[120:123], a[124:127], v[220:223], a[120:123]
s_waitcnt lgkmcnt(0)
v_mfma_f32_16x16x32_bf16 v[176:179], a[192:195], a[128:131], 0
v_exp_f32 v144, v144
v_mfma_f32_16x16x32_bf16 v[184:187], a[192:195], a[144:147], 0
ds_read_b64_tr_b16 a[224:225], v3 offset:43264
v_mfma_f32_16x16x32_bf16 v[192:195], a[192:195], a[160:163], 0
v_exp_f32 v145, v145
v_mfma_f32_16x16x32_bf16 v[200:203], a[192:195], a[176:179], 0
ds_read_b64_tr_b16 a[226:227], v3 offset:43776
v_cvt_pk_bf16_f32 v208, v144, v145
v_mfma_f32_16x16x32_bf16 v[200:203], a[196:199], a[180:183], v[200:203]
v_exp_f32 v146, v146
v_mfma_f32_16x16x32_bf16 v[192:195], a[196:199], a[164:167], v[192:195]
ds_read_b64_tr_b16 a[228:229], v3 offset:43296
v_mfma_f32_16x16x32_bf16 v[184:187], a[196:199], a[148:151], v[184:187]
v_exp_f32 v147, v147
v_mfma_f32_16x16x32_bf16 v[176:179], a[196:199], a[132:135], v[176:179]
ds_read_b64_tr_b16 a[230:231], v3 offset:43808
v_cvt_pk_bf16_f32 v209, v146, v147
v_mfma_f32_16x16x32_bf16 v[176:179], a[200:203], a[136:139], v[176:179]
v_exp_f32 v148, v148
v_mfma_f32_16x16x32_bf16 v[184:187], a[200:203], a[152:155], v[184:187]
ds_read_b64_tr_b16 a[232:233], v3 offset:43328
v_mfma_f32_16x16x32_bf16 v[192:195], a[200:203], a[168:171], v[192:195]
v_exp_f32 v149, v149
v_mfma_f32_16x16x32_bf16 v[200:203], a[200:203], a[184:187], v[200:203]
ds_read_b64_tr_b16 a[234:235], v3 offset:43840
v_cvt_pk_bf16_f32 v210, v148, v149
v_mfma_f32_16x16x32_bf16 v[200:203], a[204:207], a[188:191], v[200:203]
v_exp_f32 v150, v150
v_mfma_f32_16x16x32_bf16 v[192:195], a[204:207], a[172:175], v[192:195]
ds_read_b64_tr_b16 a[236:237], v3 offset:43360
v_mfma_f32_16x16x32_bf16 v[184:187], a[204:207], a[156:159], v[184:187]
v_exp_f32 v151, v151
v_mfma_f32_16x16x32_bf16 v[176:179], a[204:207], a[140:143], v[176:179]
ds_read_b64_tr_b16 a[238:239], v3 offset:43872
v_cvt_pk_bf16_f32 v211, v150, v151
v_mfma_f32_16x16x32_bf16 v[180:183], a[208:211], a[128:131], 0
v_mfma_f32_16x16x32_bf16 v[188:191], a[208:211], a[144:147], 0
v_exp_f32 v152, v152
v_mfma_f32_16x16x32_bf16 v[196:199], a[208:211], a[160:163], 0
ds_read_b64_tr_b16 a[240:241], v3 offset:43392
v_mfma_f32_16x16x32_bf16 v[204:207], a[208:211], a[176:179], 0
v_exp_f32 v153, v153
v_mfma_f32_16x16x32_bf16 v[204:207], a[212:215], a[180:183], v[204:207]
ds_read_b64_tr_b16 a[242:243], v3 offset:43904
v_cvt_pk_bf16_f32 v212, v152, v153
v_mfma_f32_16x16x32_bf16 v[196:199], a[212:215], a[164:167], v[196:199]
v_exp_f32 v154, v154
v_mfma_f32_16x16x32_bf16 v[188:191], a[212:215], a[148:151], v[188:191]
ds_read_b64_tr_b16 a[244:245], v3 offset:43424
v_mfma_f32_16x16x32_bf16 v[180:183], a[212:215], a[132:135], v[180:183]
v_exp_f32 v155, v155
v_mfma_f32_16x16x32_bf16 v[180:183], a[216:219], a[136:139], v[180:183]
ds_read_b64_tr_b16 a[246:247], v3 offset:43936
v_cvt_pk_bf16_f32 v213, v154, v155
v_mfma_f32_16x16x32_bf16 v[188:191], a[216:219], a[152:155], v[188:191]
v_exp_f32 v156, v156
v_mfma_f32_16x16x32_bf16 v[196:199], a[216:219], a[168:171], v[196:199]
ds_read_b64_tr_b16 a[248:249], v3 offset:43456
v_mfma_f32_16x16x32_bf16 v[204:207], a[216:219], a[184:187], v[204:207]
v_exp_f32 v157, v157
v_mfma_f32_16x16x32_bf16 v[204:207], a[220:223], a[188:191], v[204:207]
ds_read_b64_tr_b16 a[250:251], v3 offset:43968
v_cvt_pk_bf16_f32 v214, v156, v157
v_mfma_f32_16x16x32_bf16 v[196:199], a[220:223], a[172:175], v[196:199]
v_exp_f32 v158, v158
v_mfma_f32_16x16x32_bf16 v[188:191], a[220:223], a[156:159], v[188:191]
ds_read_b64_tr_b16 a[252:253], v3 offset:43488
v_mfma_f32_16x16x32_bf16 v[180:183], a[220:223], a[140:143], v[180:183]
v_exp_f32 v159, v159
s_waitcnt lgkmcnt(7)
v_mfma_f32_16x16x32_bf16 v[16:19], a[224:227], v[224:227], v[16:19]
ds_read_b64_tr_b16 a[254:255], v3 offset:44000
v_cvt_pk_bf16_f32 v215, v158, v159
v_mfma_f32_16x16x32_bf16 v[24:27], a[224:227], v[228:231], v[24:27]
v_mfma_f32_16x16x32_bf16 v[32:35], a[224:227], v[232:235], v[32:35]
v_exp_f32 v160, v160
v_mfma_f32_16x16x32_bf16 v[40:43], a[224:227], v[236:239], v[40:43]
v_mfma_f32_16x16x32_bf16 v[44:47], a[228:231], v[236:239], v[44:47]
v_exp_f32 v161, v161
v_mfma_f32_16x16x32_bf16 v[36:39], a[228:231], v[232:235], v[36:39]
v_cvt_pk_bf16_f32 v216, v160, v161
v_mfma_f32_16x16x32_bf16 v[28:31], a[228:231], v[228:231], v[28:31]
v_exp_f32 v162, v162
v_mfma_f32_16x16x32_bf16 v[20:23], a[228:231], v[224:227], v[20:23]
v_mfma_f32_16x16x32_bf16 v[48:51], a[232:235], v[224:227], v[48:51]
v_exp_f32 v163, v163
v_mfma_f32_16x16x32_bf16 v[56:59], a[232:235], v[228:231], v[56:59]
s_waitcnt vmcnt(5) lgkmcnt(0)
s_barrier
v_cvt_pk_bf16_f32 v217, v162, v163
v_mfma_f32_16x16x32_bf16 v[64:67], a[232:235], v[232:235], v[64:67]
ds_read_b64_tr_b16 a[224:225], v3 offset:0
v_exp_f32 v164, v164
v_mfma_f32_16x16x32_bf16 v[72:75], a[232:235], v[236:239], v[72:75]
ds_read_b64_tr_b16 a[228:229], v3 offset:32
ds_read_b64_tr_b16 a[232:233], v3 offset:64
v_mfma_f32_16x16x32_bf16 v[76:79], a[236:239], v[236:239], v[76:79]
ds_read_b64_tr_b16 a[226:227], v3 offset:512
v_exp_f32 v165, v165
v_mfma_f32_16x16x32_bf16 v[68:71], a[236:239], v[232:235], v[68:71]
ds_read_b64_tr_b16 a[230:231], v3 offset:544
ds_read_b64_tr_b16 a[234:235], v3 offset:576
v_cvt_pk_bf16_f32 v218, v164, v165
v_mfma_f32_16x16x32_bf16 v[60:63], a[236:239], v[228:231], v[60:63]
v_exp_f32 v166, v166
v_mfma_f32_16x16x32_bf16 v[52:55], a[236:239], v[224:227], v[52:55]
ds_read_b64_tr_b16 a[236:237], v3 offset:96
v_mfma_f32_16x16x32_bf16 v[80:83], a[240:243], v[224:227], v[80:83]
v_exp_f32 v167, v167
v_mfma_f32_16x16x32_bf16 v[88:91], a[240:243], v[228:231], v[88:91]
ds_read_b64_tr_b16 a[238:239], v3 offset:608
v_cvt_pk_bf16_f32 v219, v166, v167
v_mfma_f32_16x16x32_bf16 v[96:99], a[240:243], v[232:235], v[96:99]
v_mfma_f32_16x16x32_bf16 v[104:107], a[240:243], v[236:239], v[104:107]
ds_read_b64_tr_b16 a[240:241], v3 offset:128
v_exp_f32 v168, v168
v_mfma_f32_16x16x32_bf16 v[108:111], a[244:247], v[236:239], v[108:111]
v_mfma_f32_16x16x32_bf16 v[100:103], a[244:247], v[232:235], v[100:103]
ds_read_b64_tr_b16 a[242:243], v3 offset:640
v_exp_f32 v169, v169
v_mfma_f32_16x16x32_bf16 v[92:95], a[244:247], v[228:231], v[92:95]
v_cvt_pk_bf16_f32 v220, v168, v169
v_mfma_f32_16x16x32_bf16 v[84:87], a[244:247], v[224:227], v[84:87]
ds_read_b64_tr_b16 a[244:245], v3 offset:160
v_exp_f32 v170, v170
v_mfma_f32_16x16x32_bf16 v[112:115], a[248:251], v[224:227], v[112:115]
v_mfma_f32_16x16x32_bf16 v[120:123], a[248:251], v[228:231], v[120:123]
ds_read_b64_tr_b16 a[246:247], v3 offset:672
v_exp_f32 v171, v171
v_mfma_f32_16x16x32_bf16 v[128:131], a[248:251], v[232:235], v[128:131]
v_cvt_pk_bf16_f32 v221, v170, v171
v_mfma_f32_16x16x32_bf16 v[136:139], a[248:251], v[236:239], v[136:139]
ds_read_b64_tr_b16 a[248:249], v3 offset:192
v_exp_f32 v172, v172
v_mfma_f32_16x16x32_bf16 v[140:143], a[252:255], v[236:239], v[140:143]
v_mfma_f32_16x16x32_bf16 v[132:135], a[252:255], v[232:235], v[132:135]
ds_read_b64_tr_b16 a[250:251], v3 offset:704
v_exp_f32 v173, v173
v_mfma_f32_16x16x32_bf16 v[124:127], a[252:255], v[228:231], v[124:127]
v_cvt_pk_bf16_f32 v222, v172, v173
v_mfma_f32_16x16x32_bf16 v[116:119], a[252:255], v[224:227], v[116:119]
ds_read_b64_tr_b16 a[252:253], v3 offset:224
v_exp_f32 v174, v174
v_mfma_f32_16x16x32_bf16 a[108:111], a[124:127], v[224:227], a[108:111]
v_mfma_f32_16x16x32_bf16 a[112:115], a[124:127], v[228:231], a[112:115]
ds_read_b64_tr_b16 a[254:255], v3 offset:736
v_exp_f32 v175, v175
v_mfma_f32_16x16x32_bf16 a[116:119], a[124:127], v[232:235], a[116:119]
v_cvt_pk_bf16_f32 v223, v174, v175
v_mfma_f32_16x16x32_bf16 a[120:123], a[124:127], v[236:239], a[120:123]
s_waitcnt lgkmcnt(12)
v_mfma_f32_16x16x32_bf16 v[16:19], a[224:227], v[208:211], v[16:19]
s_lshl_b32 s22, s7, 17
v_exp_f32 v176, v176
v_mfma_f32_16x16x32_bf16 v[24:27], a[224:227], v[212:215], v[24:27]
s_add_u32 s22, s22, s25
s_add_u32 m0, s96, 135168
v_exp_f32 v177, v177
v_mfma_f32_16x16x32_bf16 v[32:35], a[224:227], v[216:219], v[32:35]
buffer_load_dwordx4 v244, s[52:55], s22 offen offset:0 lds
v_cvt_pk_bf16_f32 v224, v176, v177
v_exp_f32 v178, v178
v_mfma_f32_16x16x32_bf16 v[40:43], a[224:227], v[220:223], v[40:43]
ds_read_b64_tr_b16 a[224:225], v3 offset:8448
v_exp_f32 v179, v179
s_waitcnt lgkmcnt(12)
v_mfma_f32_16x16x32_bf16 v[44:47], a[228:231], v[220:223], v[44:47]
v_cvt_pk_bf16_f32 v225, v178, v179
v_exp_f32 v180, v180
v_mfma_f32_16x16x32_bf16 v[36:39], a[228:231], v[216:219], v[36:39]
ds_read_b64_tr_b16 a[226:227], v3 offset:8960
buffer_load_dwordx4 v245, s[52:55], s22 offen offset:1056 lds
v_exp_f32 v181, v181
v_mfma_f32_16x16x32_bf16 v[28:31], a[228:231], v[212:215], v[28:31]
v_cvt_pk_bf16_f32 v226, v180, v181
v_exp_f32 v182, v182
v_mfma_f32_16x16x32_bf16 v[20:23], a[228:231], v[208:211], v[20:23]
ds_read_b64_tr_b16 a[228:229], v3 offset:8480
v_exp_f32 v183, v183
s_waitcnt lgkmcnt(13)
v_mfma_f32_16x16x32_bf16 v[48:51], a[232:235], v[208:211], v[48:51]
v_cvt_pk_bf16_f32 v227, v182, v183
v_mfma_f32_16x16x32_bf16 v[56:59], a[232:235], v[212:215], v[56:59]
ds_read_b64_tr_b16 a[230:231], v3 offset:8992
v_exp_f32 v184, v184
v_mfma_f32_16x16x32_bf16 v[64:67], a[232:235], v[216:219], v[64:67]
buffer_load_dwordx4 v246, s[52:55], s22 offen offset:2112 lds
v_exp_f32 v185, v185
v_mfma_f32_16x16x32_bf16 v[72:75], a[232:235], v[220:223], v[72:75]
ds_read_b64_tr_b16 a[232:233], v3 offset:8512
v_cvt_pk_bf16_f32 v228, v184, v185
v_exp_f32 v186, v186
s_waitcnt lgkmcnt(13)
v_mfma_f32_16x16x32_bf16 v[76:79], a[236:239], v[220:223], v[76:79]
v_exp_f32 v187, v187
v_mfma_f32_16x16x32_bf16 v[68:71], a[236:239], v[216:219], v[68:71]
ds_read_b64_tr_b16 a[234:235], v3 offset:9024
v_cvt_pk_bf16_f32 v229, v186, v187
v_exp_f32 v188, v188
v_mfma_f32_16x16x32_bf16 v[60:63], a[236:239], v[212:215], v[60:63]
buffer_load_dwordx4 v247, s[52:55], s22 offen offset:3168 lds
v_exp_f32 v189, v189
v_mfma_f32_16x16x32_bf16 v[52:55], a[236:239], v[208:211], v[52:55]
ds_read_b64_tr_b16 a[236:237], v3 offset:8544
v_cvt_pk_bf16_f32 v230, v188, v189
v_exp_f32 v190, v190
s_waitcnt lgkmcnt(13)
v_mfma_f32_16x16x32_bf16 v[80:83], a[240:243], v[208:211], v[80:83]
v_exp_f32 v191, v191
v_mfma_f32_16x16x32_bf16 v[88:91], a[240:243], v[212:215], v[88:91]
ds_read_b64_tr_b16 a[238:239], v3 offset:9056
v_cvt_pk_bf16_f32 v231, v190, v191
v_mfma_f32_16x16x32_bf16 v[96:99], a[240:243], v[216:219], v[96:99]
s_mul_i32 s31, s92, 0
s_add_u32 s31, s31, s12
v_exp_f32 v192, v192
v_mfma_f32_16x16x32_bf16 v[104:107], a[240:243], v[220:223], v[104:107]
ds_read_b64_tr_b16 a[240:241], v3 offset:8576
s_add_u32 m0, s96, 118272
v_exp_f32 v193, v193
s_waitcnt lgkmcnt(13)
v_mfma_f32_16x16x32_bf16 v[108:111], a[244:247], v[220:223], v[108:111]
buffer_load_dwordx4 v240, s[68:71], s31 offen offset:0 lds
v_cvt_pk_bf16_f32 v232, v192, v193
v_exp_f32 v194, v194
v_mfma_f32_16x16x32_bf16 v[100:103], a[244:247], v[216:219], v[100:103]
ds_read_b64_tr_b16 a[242:243], v3 offset:9088
v_exp_f32 v195, v195
v_mfma_f32_16x16x32_bf16 v[92:95], a[244:247], v[212:215], v[92:95]
v_cvt_pk_bf16_f32 v233, v194, v195
v_exp_f32 v196, v196
v_mfma_f32_16x16x32_bf16 v[84:87], a[244:247], v[208:211], v[84:87]
ds_read_b64_tr_b16 a[244:245], v3 offset:8608
buffer_load_dwordx4 v241, s[68:71], s31 offen offset:1056 lds
v_exp_f32 v197, v197
s_waitcnt lgkmcnt(13)
v_mfma_f32_16x16x32_bf16 v[112:115], a[248:251], v[208:211], v[112:115]
v_cvt_pk_bf16_f32 v234, v196, v197
v_exp_f32 v198, v198
v_mfma_f32_16x16x32_bf16 v[120:123], a[248:251], v[212:215], v[120:123]
ds_read_b64_tr_b16 a[246:247], v3 offset:9120
v_exp_f32 v199, v199
v_mfma_f32_16x16x32_bf16 v[128:131], a[248:251], v[216:219], v[128:131]
v_cvt_pk_bf16_f32 v235, v198, v199
v_mfma_f32_16x16x32_bf16 v[136:139], a[248:251], v[220:223], v[136:139]
ds_read_b64_tr_b16 a[248:249], v3 offset:8640
v_exp_f32 v200, v200
s_waitcnt lgkmcnt(13)
v_mfma_f32_16x16x32_bf16 v[140:143], a[252:255], v[220:223], v[140:143]
buffer_load_dwordx4 v242, s[68:71], s31 offen offset:2112 lds
v_exp_f32 v201, v201
v_mfma_f32_16x16x32_bf16 v[132:135], a[252:255], v[216:219], v[132:135]
ds_read_b64_tr_b16 a[250:251], v3 offset:9152
v_cvt_pk_bf16_f32 v236, v200, v201
v_exp_f32 v202, v202
v_mfma_f32_16x16x32_bf16 v[124:127], a[252:255], v[212:215], v[124:127]
v_exp_f32 v203, v203
v_mfma_f32_16x16x32_bf16 v[116:119], a[252:255], v[208:211], v[116:119]
ds_read_b64_tr_b16 a[252:253], v3 offset:8672
v_cvt_pk_bf16_f32 v237, v202, v203
v_exp_f32 v204, v204
v_mfma_f32_16x16x32_bf16 a[108:111], a[124:127], v[208:211], a[108:111]
buffer_load_dwordx4 v243, s[68:71], s31 offen offset:3168 lds
v_exp_f32 v205, v205
v_mfma_f32_16x16x32_bf16 a[112:115], a[124:127], v[212:215], a[112:115]
ds_read_b64_tr_b16 a[254:255], v3 offset:9184
v_cvt_pk_bf16_f32 v238, v204, v205
v_exp_f32 v206, v206
v_mfma_f32_16x16x32_bf16 a[116:119], a[124:127], v[216:219], a[116:119]
v_exp_f32 v207, v207
v_mfma_f32_16x16x32_bf16 a[120:123], a[124:127], v[220:223], a[120:123]
v_cvt_pk_bf16_f32 v239, v206, v207
s_waitcnt lgkmcnt(14)
v_mfma_f32_16x16x32_bf16 v[16:19], a[224:227], v[224:227], v[16:19]
v_mfma_f32_16x16x32_bf16 v[24:27], a[224:227], v[228:231], v[24:27]
v_mfma_f32_16x16x32_bf16 v[32:35], a[224:227], v[232:235], v[32:35]
v_mfma_f32_16x16x32_bf16 v[40:43], a[224:227], v[236:239], v[40:43]
s_waitcnt lgkmcnt(12)
v_mfma_f32_16x16x32_bf16 v[44:47], a[228:231], v[236:239], v[44:47]
v_mfma_f32_16x16x32_bf16 v[36:39], a[228:231], v[232:235], v[36:39]
v_mfma_f32_16x16x32_bf16 v[28:31], a[228:231], v[228:231], v[28:31]
v_mfma_f32_16x16x32_bf16 v[20:23], a[228:231], v[224:227], v[20:23]
s_waitcnt lgkmcnt(10)
v_mfma_f32_16x16x32_bf16 v[48:51], a[232:235], v[224:227], v[48:51]
v_mfma_f32_16x16x32_bf16 v[56:59], a[232:235], v[228:231], v[56:59]
v_mfma_f32_16x16x32_bf16 v[64:67], a[232:235], v[232:235], v[64:67]
v_mfma_f32_16x16x32_bf16 v[72:75], a[232:235], v[236:239], v[72:75]
s_waitcnt lgkmcnt(8)
v_mfma_f32_16x16x32_bf16 v[76:79], a[236:239], v[236:239], v[76:79]
v_mfma_f32_16x16x32_bf16 v[68:71], a[236:239], v[232:235], v[68:71]
v_mfma_f32_16x16x32_bf16 v[60:63], a[236:239], v[228:231], v[60:63]
v_mfma_f32_16x16x32_bf16 v[52:55], a[236:239], v[224:227], v[52:55]
s_waitcnt lgkmcnt(6)
v_mfma_f32_16x16x32_bf16 v[80:83], a[240:243], v[224:227], v[80:83]
v_mfma_f32_16x16x32_bf16 v[88:91], a[240:243], v[228:231], v[88:91]
v_mfma_f32_16x16x32_bf16 v[96:99], a[240:243], v[232:235], v[96:99]
v_mfma_f32_16x16x32_bf16 v[104:107], a[240:243], v[236:239], v[104:107]
s_waitcnt lgkmcnt(4)
v_mfma_f32_16x16x32_bf16 v[108:111], a[244:247], v[236:239], v[108:111]
v_mfma_f32_16x16x32_bf16 v[100:103], a[244:247], v[232:235], v[100:103]
v_mfma_f32_16x16x32_bf16 v[92:95], a[244:247], v[228:231], v[92:95]
v_mfma_f32_16x16x32_bf16 v[84:87], a[244:247], v[224:227], v[84:87]
s_waitcnt lgkmcnt(2)
v_mfma_f32_16x16x32_bf16 v[112:115], a[248:251], v[224:227], v[112:115]
v_mfma_f32_16x16x32_bf16 v[120:123], a[248:251], v[228:231], v[120:123]
v_mfma_f32_16x16x32_bf16 v[128:131], a[248:251], v[232:235], v[128:131]
v_mfma_f32_16x16x32_bf16 v[136:139], a[248:251], v[236:239], v[136:139]
s_waitcnt lgkmcnt(0)
v_mfma_f32_16x16x32_bf16 v[140:143], a[252:255], v[236:239], v[140:143]
v_mfma_f32_16x16x32_bf16 v[132:135], a[252:255], v[232:235], v[132:135]
v_mfma_f32_16x16x32_bf16 v[124:127], a[252:255], v[228:231], v[124:127]
v_mfma_f32_16x16x32_bf16 v[116:119], a[252:255], v[224:227], v[116:119]
v_mfma_f32_16x16x32_bf16 a[108:111], a[124:127], v[224:227], a[108:111]
v_mfma_f32_16x16x32_bf16 a[112:115], a[124:127], v[228:231], a[112:115]
v_mfma_f32_16x16x32_bf16 a[116:119], a[124:127], v[232:235], a[116:119]
v_mfma_f32_16x16x32_bf16 a[120:123], a[124:127], v[236:239], a[120:123]
recurrent_scan__sliding_block_cached__mixer_s_mlp__prompt_kernel_bo:
recurrent_scan__sliding_block_cached__mixer_s_mlp__prompt_kernel_redob:
s_nop 4
v_accvgpr_read_b32 v148, a108
v_accvgpr_read_b32 v149, a112
v_accvgpr_read_b32 v150, a116
v_accvgpr_read_b32 v151, a120
v_add_f32 v148, v148, v2
v_add_f32 v149, v149, v12
v_add_f32 v150, v150, v13
v_add_f32 v151, v151, v250
v_rcp_f32 v144, v148
v_rcp_f32 v145, v149
v_rcp_f32 v146, v150
v_rcp_f32 v147, v151
v_min3_f32 v152, v148, v149, v150
v_add_f32 v153, v148, v149
v_min_f32 v152, v152, v151
v_add_f32 v153, v153, v150
s_mov_b32 s88, 0x4e800000
v_add_f32 v153, v153, v151
s_mov_b32 s89, 0x30800000
v_cmp_nge_f32 s[32:33], s88, v153
v_cmp_nle_f32 vcc, s89, v152
v_mov_b32 v154, 159744
s_or_b64 vcc, vcc, s[32:33]
s_cbranch_vccz revote_36
ds_write_b32 v154, v154
revote_36:
s_waitcnt lgkmcnt(0)
s_barrier
ds_read_b32 v155, v154
v_pk_mul_f32 v[16:17], v[16:17], v[144:145] op_sel:[0,0] op_sel_hi:[1,0]
v_pk_mul_f32 v[18:19], v[18:19], v[144:145] op_sel:[0,0] op_sel_hi:[1,0]
v_pk_mul_f32 v[20:21], v[20:21], v[144:145] op_sel:[0,0] op_sel_hi:[1,0]
v_pk_mul_f32 v[22:23], v[22:23], v[144:145] op_sel:[0,0] op_sel_hi:[1,0]
v_cvt_pk_bf16_f32 v16, v16, v17
v_cvt_pk_bf16_f32 v17, v18, v19
v_cvt_pk_bf16_f32 v18, v20, v21
v_cvt_pk_bf16_f32 v19, v22, v23
v_pk_mul_f32 v[24:25], v[24:25], v[144:145] op_sel:[0,1] op_sel_hi:[1,1]
v_pk_mul_f32 v[26:27], v[26:27], v[144:145] op_sel:[0,1] op_sel_hi:[1,1]
v_pk_mul_f32 v[28:29], v[28:29], v[144:145] op_sel:[0,1] op_sel_hi:[1,1]
v_pk_mul_f32 v[30:31], v[30:31], v[144:145] op_sel:[0,1] op_sel_hi:[1,1]
s_waitcnt lgkmcnt(0)
v_readfirstlane_b32 s88, v155
s_nop 0
s_andn2_b32 s88, s88, s16
s_cmp_lg_u32 s88, 0
s_cbranch_scc1 recurrent_scan__sliding_block_cached__mixer_s_mlp__prompt_kernel_fb
v_cvt_pk_bf16_f32 v24, v24, v25
v_add_u32 v250, 101376, v248
s_lshl_b32 s29, s6, 2
s_add_u32 s29, s29, s7
v_cvt_pk_bf16_f32 v25, v26, v27
s_lshl_b32 s29, s29, 3
s_add_u32 s29, s29, s4
v_cvt_pk_bf16_f32 v26, v28, v29
s_lshl_b32 s29, s29, 2
s_add_u32 s29, s29, s3
v_cvt_pk_bf16_f32 v27, v30, v31
s_lshl_b32 s29, s29, 14
s_add_u32 s29, s29, 16777216
v_pk_mul_f32 v[32:33], v[32:33], v[146:147] op_sel:[0,0] op_sel_hi:[1,0]
buffer_store_dwordx4 v[16:19], v251, s[76:79], s29 offen offset:0 sc1
v_pk_mul_f32 v[34:35], v[34:35], v[146:147] op_sel:[0,0] op_sel_hi:[1,0]
v_pk_mul_f32 v[36:37], v[36:37], v[146:147] op_sel:[0,0] op_sel_hi:[1,0]
v_pk_mul_f32 v[38:39], v[38:39], v[146:147] op_sel:[0,0] op_sel_hi:[1,0]
v_cvt_pk_bf16_f32 v32, v32, v33
buffer_store_dwordx4 v[24:27], v251, s[76:79], s29 offen offset:1024 sc1
v_cvt_pk_bf16_f32 v33, v34, v35
v_cvt_pk_bf16_f32 v34, v36, v37
v_cvt_pk_bf16_f32 v35, v38, v39
v_pk_mul_f32 v[40:41], v[40:41], v[146:147] op_sel:[0,1] op_sel_hi:[1,1]
buffer_store_dwordx4 v[32:35], v251, s[76:79], s29 offen offset:2048 sc1
v_pk_mul_f32 v[42:43], v[42:43], v[146:147] op_sel:[0,1] op_sel_hi:[1,1]
v_pk_mul_f32 v[44:45], v[44:45], v[146:147] op_sel:[0,1] op_sel_hi:[1,1]
v_pk_mul_f32 v[46:47], v[46:47], v[146:147] op_sel:[0,1] op_sel_hi:[1,1]
v_cvt_pk_bf16_f32 v40, v40, v41
v_cvt_pk_bf16_f32 v41, v42, v43
v_cvt_pk_bf16_f32 v42, v44, v45
v_cvt_pk_bf16_f32 v43, v46, v47
buffer_store_dwordx4 v[40:43], v251, s[76:79], s29 offen offset:3072 sc1
v_pk_mul_f32 v[48:49], v[48:49], v[144:145] op_sel:[0,0] op_sel_hi:[1,0]
v_pk_mul_f32 v[50:51], v[50:51], v[144:145] op_sel:[0,0] op_sel_hi:[1,0]
v_pk_mul_f32 v[52:53], v[52:53], v[144:145] op_sel:[0,0] op_sel_hi:[1,0]
v_pk_mul_f32 v[54:55], v[54:55], v[144:145] op_sel:[0,0] op_sel_hi:[1,0]
v_cvt_pk_bf16_f32 v48, v48, v49
v_cvt_pk_bf16_f32 v49, v50, v51
v_cvt_pk_bf16_f32 v50, v52, v53
v_cvt_pk_bf16_f32 v51, v54, v55
s_add_u32 s29, s29, 4096
buffer_store_dwordx4 v[48:51], v251, s[76:79], s29 offen offset:0 sc1
v_pk_mul_f32 v[56:57], v[56:57], v[144:145] op_sel:[0,1] op_sel_hi:[1,1]
v_pk_mul_f32 v[58:59], v[58:59], v[144:145] op_sel:[0,1] op_sel_hi:[1,1]
v_pk_mul_f32 v[60:61], v[60:61], v[144:145] op_sel:[0,1] op_sel_hi:[1,1]
v_pk_mul_f32 v[62:63], v[62:63], v[144:145] op_sel:[0,1] op_sel_hi:[1,1]
v_cvt_pk_bf16_f32 v56, v56, v57
v_cvt_pk_bf16_f32 v57, v58, v59
v_cvt_pk_bf16_f32 v58, v60, v61
v_cvt_pk_bf16_f32 v59, v62, v63
buffer_store_dwordx4 v[56:59], v251, s[76:79], s29 offen offset:1024 sc1
v_pk_mul_f32 v[64:65], v[64:65], v[146:147] op_sel:[0,0] op_sel_hi:[1,0]
v_pk_mul_f32 v[66:67], v[66:67], v[146:147] op_sel:[0,0] op_sel_hi:[1,0]
v_pk_mul_f32 v[68:69], v[68:69], v[146:147] op_sel:[0,0] op_sel_hi:[1,0]
v_pk_mul_f32 v[70:71], v[70:71], v[146:147] op_sel:[0,0] op_sel_hi:[1,0]
v_cvt_pk_bf16_f32 v64, v64, v65
v_cvt_pk_bf16_f32 v65, v66, v67
v_cvt_pk_bf16_f32 v66, v68, v69
v_cvt_pk_bf16_f32 v67, v70, v71
buffer_store_dwordx4 v[64:67], v251, s[76:79], s29 offen offset:2048 sc1
v_pk_mul_f32 v[72:73], v[72:73], v[146:147] op_sel:[0,1] op_sel_hi:[1,1]
v_pk_mul_f32 v[74:75], v[74:75], v[146:147] op_sel:[0,1] op_sel_hi:[1,1]
v_pk_mul_f32 v[76:77], v[76:77], v[146:147] op_sel:[0,1] op_sel_hi:[1,1]
v_pk_mul_f32 v[78:79], v[78:79], v[146:147] op_sel:[0,1] op_sel_hi:[1,1]
v_cvt_pk_bf16_f32 v72, v72, v73
v_cvt_pk_bf16_f32 v73, v74, v75
v_cvt_pk_bf16_f32 v74, v76, v77
v_cvt_pk_bf16_f32 v75, v78, v79
buffer_store_dwordx4 v[72:75], v251, s[76:79], s29 offen offset:3072 sc1
v_pk_mul_f32 v[80:81], v[80:81], v[144:145] op_sel:[0,0] op_sel_hi:[1,0]
v_pk_mul_f32 v[82:83], v[82:83], v[144:145] op_sel:[0,0] op_sel_hi:[1,0]
v_pk_mul_f32 v[84:85], v[84:85], v[144:145] op_sel:[0,0] op_sel_hi:[1,0]
v_pk_mul_f32 v[86:87], v[86:87], v[144:145] op_sel:[0,0] op_sel_hi:[1,0]
v_cvt_pk_bf16_f32 v80, v80, v81
v_cvt_pk_bf16_f32 v81, v82, v83
v_cvt_pk_bf16_f32 v82, v84, v85
v_cvt_pk_bf16_f32 v83, v86, v87
s_add_u32 s29, s29, 4096
buffer_store_dwordx4 v[80:83], v251, s[76:79], s29 offen offset:0 sc1
v_pk_mul_f32 v[88:89], v[88:89], v[144:145] op_sel:[0,1] op_sel_hi:[1,1]
v_pk_mul_f32 v[90:91], v[90:91], v[144:145] op_sel:[0,1] op_sel_hi:[1,1]
v_pk_mul_f32 v[92:93], v[92:93], v[144:145] op_sel:[0,1] op_sel_hi:[1,1]
v_pk_mul_f32 v[94:95], v[94:95], v[144:145] op_sel:[0,1] op_sel_hi:[1,1]
v_cvt_pk_bf16_f32 v88, v88, v89
v_cvt_pk_bf16_f32 v89, v90, v91
v_cvt_pk_bf16_f32 v90, v92, v93
v_cvt_pk_bf16_f32 v91, v94, v95
buffer_store_dwordx4 v[88:91], v251, s[76:79], s29 offen offset:1024 sc1
v_pk_mul_f32 v[96:97], v[96:97], v[146:147] op_sel:[0,0] op_sel_hi:[1,0]
v_pk_mul_f32 v[98:99], v[98:99], v[146:147] op_sel:[0,0] op_sel_hi:[1,0]
v_pk_mul_f32 v[100:101], v[100:101], v[146:147] op_sel:[0,0] op_sel_hi:[1,0]
v_pk_mul_f32 v[102:103], v[102:103], v[146:147] op_sel:[0,0] op_sel_hi:[1,0]
v_cvt_pk_bf16_f32 v96, v96, v97
v_cvt_pk_bf16_f32 v97, v98, v99
v_cvt_pk_bf16_f32 v98, v100, v101
v_cvt_pk_bf16_f32 v99, v102, v103
buffer_store_dwordx4 v[96:99], v251, s[76:79], s29 offen offset:2048 sc1
v_pk_mul_f32 v[104:105], v[104:105], v[146:147] op_sel:[0,1] op_sel_hi:[1,1]
v_pk_mul_f32 v[106:107], v[106:107], v[146:147] op_sel:[0,1] op_sel_hi:[1,1]
v_pk_mul_f32 v[108:109], v[108:109], v[146:147] op_sel:[0,1] op_sel_hi:[1,1]
v_pk_mul_f32 v[110:111], v[110:111], v[146:147] op_sel:[0,1] op_sel_hi:[1,1]
v_cvt_pk_bf16_f32 v104, v104, v105
v_cvt_pk_bf16_f32 v105, v106, v107
v_cvt_pk_bf16_f32 v106, v108, v109
v_cvt_pk_bf16_f32 v107, v110, v111
buffer_store_dwordx4 v[104:107], v251, s[76:79], s29 offen offset:3072 sc1
v_pk_mul_f32 v[112:113], v[112:113], v[144:145] op_sel:[0,0] op_sel_hi:[1,0]
v_pk_mul_f32 v[114:115], v[114:115], v[144:145] op_sel:[0,0] op_sel_hi:[1,0]
v_pk_mul_f32 v[116:117], v[116:117], v[144:145] op_sel:[0,0] op_sel_hi:[1,0]
v_pk_mul_f32 v[118:119], v[118:119], v[144:145] op_sel:[0,0] op_sel_hi:[1,0]
v_cvt_pk_bf16_f32 v112, v112, v113
v_cvt_pk_bf16_f32 v113, v114, v115
v_cvt_pk_bf16_f32 v114, v116, v117
v_cvt_pk_bf16_f32 v115, v118, v119
s_add_u32 s29, s29, 4096
buffer_store_dwordx4 v[112:115], v251, s[76:79], s29 offen offset:0 sc1
v_pk_mul_f32 v[120:121], v[120:121], v[144:145] op_sel:[0,1] op_sel_hi:[1,1]
v_pk_mul_f32 v[122:123], v[122:123], v[144:145] op_sel:[0,1] op_sel_hi:[1,1]
v_pk_mul_f32 v[124:125], v[124:125], v[144:145] op_sel:[0,1] op_sel_hi:[1,1]
v_pk_mul_f32 v[126:127], v[126:127], v[144:145] op_sel:[0,1] op_sel_hi:[1,1]
v_cvt_pk_bf16_f32 v120, v120, v121
v_cvt_pk_bf16_f32 v121, v122, v123
v_cvt_pk_bf16_f32 v122, v124, v125
v_cvt_pk_bf16_f32 v123, v126, v127
buffer_store_dwordx4 v[120:123], v251, s[76:79], s29 offen offset:1024 sc1
v_pk_mul_f32 v[128:129], v[128:129], v[146:147] op_sel:[0,0] op_sel_hi:[1,0]
v_pk_mul_f32 v[130:131], v[130:131], v[146:147] op_sel:[0,0] op_sel_hi:[1,0]
v_pk_mul_f32 v[132:133], v[132:133], v[146:147] op_sel:[0,0] op_sel_hi:[1,0]
v_pk_mul_f32 v[134:135], v[134:135], v[146:147] op_sel:[0,0] op_sel_hi:[1,0]
v_cvt_pk_bf16_f32 v128, v128, v129
v_cvt_pk_bf16_f32 v129, v130, v131
v_cvt_pk_bf16_f32 v130, v132, v133
v_cvt_pk_bf16_f32 v131, v134, v135
buffer_store_dwordx4 v[128:131], v251, s[76:79], s29 offen offset:2048 sc1
v_pk_mul_f32 v[136:137], v[136:137], v[146:147] op_sel:[0,1] op_sel_hi:[1,1]
v_pk_mul_f32 v[138:139], v[138:139], v[146:147] op_sel:[0,1] op_sel_hi:[1,1]
v_pk_mul_f32 v[140:141], v[140:141], v[146:147] op_sel:[0,1] op_sel_hi:[1,1]
v_pk_mul_f32 v[142:143], v[142:143], v[146:147] op_sel:[0,1] op_sel_hi:[1,1]
v_cvt_pk_bf16_f32 v136, v136, v137
v_cvt_pk_bf16_f32 v137, v138, v139
v_cvt_pk_bf16_f32 v138, v140, v141
v_cvt_pk_bf16_f32 v139, v142, v143
buffer_store_dwordx4 v[136:139], v251, s[76:79], s29 offen offset:3072 sc1
s_and_b32 s88, s2, 0xe7
v_mov_b32 v14, s13
v_mov_b32 v15, s14
v_cmp_lt_u32 vcc, 15, v0
s_nop 1
v_cndmask_b32 v14, v14, v15, vcc
v_mov_b32 v15, s15
v_cmp_lt_u32 vcc, 31, v0
s_nop 1
v_cndmask_b32 v14, v14, v15, vcc
v_lshl_add_u32 v14, v14, 3, s88
s_lshl_b32 s89, s3, 2
v_mov_b32 v15, s89
v_lshrrev_b32 v252, 4, v14
v_and_b32 v252, 12, v252
buffer_load_dword v252, v252, s[84:87], 0 offen sc1
v_lshl_add_u32 v14, v14, 7, v15
buffer_load_dword v15, v14, s[76:79], s24 offen offset:32 sc1
s_waitcnt vmcnt(22)
s_barrier
ds_read_b64_tr_b16 a[192:193], v250 offset:33792
ds_read_b64_tr_b16 a[194:195], v250 offset:34048
ds_read_b64_tr_b16 a[196:197], v250 offset:33824
ds_read_b64_tr_b16 a[198:199], v250 offset:34080
ds_read_b64_tr_b16 a[200:201], v250 offset:33856
ds_read_b64_tr_b16 a[202:203], v250 offset:34112
ds_read_b64_tr_b16 a[204:205], v250 offset:33888
ds_read_b64_tr_b16 a[206:207], v250 offset:34144
ds_read_b64_tr_b16 a[208:209], v250 offset:33920
ds_read_b64_tr_b16 a[210:211], v250 offset:34176
ds_read_b64_tr_b16 a[212:213], v250 offset:33952
ds_read_b64_tr_b16 a[214:215], v250 offset:34208
ds_read_b64_tr_b16 a[216:217], v250 offset:33984
ds_read_b64_tr_b16 a[218:219], v250 offset:34240
ds_read_b64_tr_b16 a[220:221], v250 offset:34016
ds_read_b64_tr_b16 a[222:223], v250 offset:34272
s_waitcnt lgkmcnt(14)
v_mfma_f32_16x16x32_bf16 v[20:23], a[192:195], v[16:19], 0
v_mfma_f32_16x16x32_bf16 v[28:31], a[192:195], v[24:27], 0
s_waitcnt vmcnt(0)
v_cmp_ne_u32 vcc, v252, v15
s_cbranch_vccnz reslow_37
reback_38:
v_mfma_f32_16x16x32_bf16 v[36:39], a[192:195], v[32:35], 0
s_lshl_b32 s27, s6, 2
s_add_u32 s27, s27, s13
v_mfma_f32_16x16x32_bf16 v[44:47], a[192:195], v[40:43], 0
ds_read_b64_tr_b16 a[192:193], v250 offset:42240
s_lshl_b32 s27, s27, 3
s_waitcnt lgkmcnt(13)
v_mfma_f32_16x16x32_bf16 v[76:79], a[196:199], v[40:43], 0
ds_read_b64_tr_b16 a[194:195], v250 offset:42496
v_mfma_f32_16x16x32_bf16 v[68:71], a[196:199], v[32:35], 0
s_add_u32 s27, s27, s4
v_mfma_f32_16x16x32_bf16 v[60:63], a[196:199], v[24:27], 0
s_lshl_b32 s27, s27, 2
s_add_u32 s27, s27, s3
v_mfma_f32_16x16x32_bf16 v[52:55], a[196:199], v[16:19], 0
ds_read_b64_tr_b16 a[196:197], v250 offset:42272
s_lshl_b32 s27, s27, 14
s_waitcnt lgkmcnt(13)
v_mfma_f32_16x16x32_bf16 v[84:87], a[200:203], v[16:19], 0
ds_read_b64_tr_b16 a[198:199], v250 offset:42528
v_mfma_f32_16x16x32_bf16 v[92:95], a[200:203], v[24:27], 0
s_add_u32 s27, s27, 16777216
buffer_load_dwordx4 a[128:131], v251, s[76:79], s27 offen offset:0 sc1
v_mfma_f32_16x16x32_bf16 v[100:103], a[200:203], v[32:35], 0
buffer_load_dwordx4 a[132:135], v251, s[76:79], s27 offen offset:1024 sc1
v_mfma_f32_16x16x32_bf16 v[108:111], a[200:203], v[40:43], 0
ds_read_b64_tr_b16 a[200:201], v250 offset:42304
s_waitcnt lgkmcnt(13)
v_mfma_f32_16x16x32_bf16 v[140:143], a[204:207], v[40:43], 0
ds_read_b64_tr_b16 a[202:203], v250 offset:42560
v_mov_b32 v4, s8
s_lshl_b32 s100, s2, 5
s_add_u32 s100, s100, s3
s_lshl_b32 s100, s100, 2
s_add_u32 s100, s100, 131104
s_mov_b64 exec, 1
buffer_store_dword v4, off, s[76:79], s100 sc1
s_mov_b64 exec, -1
v_mfma_f32_16x16x32_bf16 v[132:135], a[204:207], v[32:35], 0
buffer_load_dwordx4 a[136:139], v251, s[76:79], s27 offen offset:2048 sc1
v_mfma_f32_16x16x32_bf16 v[124:127], a[204:207], v[24:27], 0
v_mfma_f32_16x16x32_bf16 v[116:119], a[204:207], v[16:19], 0
ds_read_b64_tr_b16 a[204:205], v250 offset:42336
s_waitcnt lgkmcnt(8)
v_mfma_f32_16x16x32_bf16 v[144:147], a[208:211], v[16:19], 0
ds_read_b64_tr_b16 a[206:207], v250 offset:42592
v_mfma_f32_16x16x32_bf16 v[148:151], a[208:211], v[24:27], 0
buffer_load_dwordx4 a[140:143], v251, s[76:79], s27 offen offset:3072 sc1
v_mfma_f32_16x16x32_bf16 v[152:155], a[208:211], v[32:35], 0
v_mfma_f32_16x16x32_bf16 v[156:159], a[208:211], v[40:43], 0
ds_read_b64_tr_b16 a[208:209], v250 offset:42368
v_mfma_f32_16x16x32_bf16 v[172:175], a[212:215], v[40:43], 0
ds_read_b64_tr_b16 a[210:211], v250 offset:42624
v_mfma_f32_16x16x32_bf16 v[168:171], a[212:215], v[32:35], 0
s_add_u32 s27, s27, 4096
v_mfma_f32_16x16x32_bf16 v[164:167], a[212:215], v[24:27], 0
buffer_load_dwordx4 a[144:147], v251, s[76:79], s27 offen offset:0 sc1
v_mfma_f32_16x16x32_bf16 v[160:163], a[212:215], v[16:19], 0
ds_read_b64_tr_b16 a[212:213], v250 offset:42400
v_mfma_f32_16x16x32_bf16 v[176:179], a[216:219], v[16:19], 0
ds_read_b64_tr_b16 a[214:215], v250 offset:42656
v_mfma_f32_16x16x32_bf16 v[180:183], a[216:219], v[24:27], 0
buffer_load_dwordx4 a[148:151], v251, s[76:79], s27 offen offset:1024 sc1
v_mfma_f32_16x16x32_bf16 v[184:187], a[216:219], v[32:35], 0
v_mfma_f32_16x16x32_bf16 v[188:191], a[216:219], v[40:43], 0
ds_read_b64_tr_b16 a[216:217], v250 offset:42432
s_waitcnt lgkmcnt(13)
v_mfma_f32_16x16x32_bf16 v[204:207], a[220:223], v[40:43], 0
ds_read_b64_tr_b16 a[218:219], v250 offset:42688
v_mfma_f32_16x16x32_bf16 v[200:203], a[220:223], v[32:35], 0
buffer_load_dwordx4 a[152:155], v251, s[76:79], s27 offen offset:2048 sc1
v_mfma_f32_16x16x32_bf16 v[196:199], a[220:223], v[24:27], 0
v_mfma_f32_16x16x32_bf16 v[192:195], a[220:223], v[16:19], 0
ds_read_b64_tr_b16 a[220:221], v250 offset:42464
s_waitcnt lgkmcnt(8)
v_mfma_f32_16x16x32_bf16 v[20:23], a[192:195], v[48:51], v[20:23]
ds_read_b64_tr_b16 a[222:223], v250 offset:42720
v_mfma_f32_16x16x32_bf16 v[28:31], a[192:195], v[56:59], v[28:31]
buffer_load_dwordx4 a[156:159], v251, s[76:79], s27 offen offset:3072 sc1
v_mfma_f32_16x16x32_bf16 v[36:39], a[192:195], v[64:67], v[36:39]
v_mfma_f32_16x16x32_bf16 v[44:47], a[192:195], v[72:75], v[44:47]
s_barrier
ds_read_b64_tr_b16 a[192:193], v248 offset:0
v_mfma_f32_16x16x32_bf16 v[76:79], a[196:199], v[72:75], v[76:79]
ds_read_b64_tr_b16 a[194:195], v248 offset:256
v_mfma_f32_16x16x32_bf16 v[68:71], a[196:199], v[64:67], v[68:71]
s_add_u32 s27, s27, 4096
v_mfma_f32_16x16x32_bf16 v[60:63], a[196:199], v[56:59], v[60:63]
buffer_load_dwordx4 a[160:163], v251, s[76:79], s27 offen offset:0 sc1
buffer_load_dwordx4 a[164:167], v251, s[76:79], s27 offen offset:1024 sc1
v_mfma_f32_16x16x32_bf16 v[52:55], a[196:199], v[48:51], v[52:55]
ds_read_b64_tr_b16 a[196:197], v248 offset:32
v_mfma_f32_16x16x32_bf16 v[84:87], a[200:203], v[48:51], v[84:87]
ds_read_b64_tr_b16 a[198:199], v248 offset:288
v_mfma_f32_16x16x32_bf16 v[92:95], a[200:203], v[56:59], v[92:95]
v_mfma_f32_16x16x32_bf16 v[100:103], a[200:203], v[64:67], v[100:103]
buffer_load_dwordx4 a[168:171], v251, s[76:79], s27 offen offset:2048 sc1
v_mfma_f32_16x16x32_bf16 v[108:111], a[200:203], v[72:75], v[108:111]
ds_read_b64_tr_b16 a[200:201], v248 offset:64
s_waitcnt lgkmcnt(13)
v_mfma_f32_16x16x32_bf16 v[140:143], a[204:207], v[72:75], v[140:143]
ds_read_b64_tr_b16 a[202:203], v248 offset:320
v_mfma_f32_16x16x32_bf16 v[132:135], a[204:207], v[64:67], v[132:135]
v_mfma_f32_16x16x32_bf16 v[124:127], a[204:207], v[56:59], v[124:127]
buffer_load_dwordx4 a[172:175], v251, s[76:79], s27 offen offset:3072 sc1
v_mfma_f32_16x16x32_bf16 v[116:119], a[204:207], v[48:51], v[116:119]
ds_read_b64_tr_b16 a[204:205], v248 offset:96
s_waitcnt lgkmcnt(8)
v_mfma_f32_16x16x32_bf16 v[144:147], a[208:211], v[48:51], v[144:147]
ds_read_b64_tr_b16 a[206:207], v248 offset:352
v_mfma_f32_16x16x32_bf16 v[148:151], a[208:211], v[56:59], v[148:151]
s_add_u32 s27, s27, 4096
v_mfma_f32_16x16x32_bf16 v[152:155], a[208:211], v[64:67], v[152:155]
buffer_load_dwordx4 a[176:179], v251, s[76:79], s27 offen offset:0 sc1
v_mfma_f32_16x16x32_bf16 v[156:159], a[208:211], v[72:75], v[156:159]
ds_read_b64_tr_b16 a[208:209], v248 offset:128
v_mfma_f32_16x16x32_bf16 v[172:175], a[212:215], v[72:75], v[172:175]
ds_read_b64_tr_b16 a[210:211], v248 offset:384
v_mfma_f32_16x16x32_bf16 v[168:171], a[212:215], v[64:67], v[168:171]
buffer_load_dwordx4 a[180:183], v251, s[76:79], s27 offen offset:1024 sc1
v_mfma_f32_16x16x32_bf16 v[164:167], a[212:215], v[56:59], v[164:167]
v_mfma_f32_16x16x32_bf16 v[160:163], a[212:215], v[48:51], v[160:163]
ds_read_b64_tr_b16 a[212:213], v248 offset:160
v_mfma_f32_16x16x32_bf16 v[176:179], a[216:219], v[48:51], v[176:179]
ds_read_b64_tr_b16 a[214:215], v248 offset:416
v_mfma_f32_16x16x32_bf16 v[180:183], a[216:219], v[56:59], v[180:183]
buffer_load_dwordx4 a[184:187], v251, s[76:79], s27 offen offset:2048 sc1
v_mfma_f32_16x16x32_bf16 v[184:187], a[216:219], v[64:67], v[184:187]
v_mfma_f32_16x16x32_bf16 v[188:191], a[216:219], v[72:75], v[188:191]
ds_read_b64_tr_b16 a[216:217], v248 offset:192
s_waitcnt lgkmcnt(13)
v_mfma_f32_16x16x32_bf16 v[204:207], a[220:223], v[72:75], v[204:207]
ds_read_b64_tr_b16 a[218:219], v248 offset:448
v_mfma_f32_16x16x32_bf16 v[200:203], a[220:223], v[64:67], v[200:203]
buffer_load_dwordx4 a[188:191], v251, s[76:79], s27 offen offset:3072 sc1
v_mfma_f32_16x16x32_bf16 v[196:199], a[220:223], v[56:59], v[196:199]
v_mfma_f32_16x16x32_bf16 v[192:195], a[220:223], v[48:51], v[192:195]
ds_read_b64_tr_b16 a[220:221], v248 offset:224
s_waitcnt lgkmcnt(8)
v_mfma_f32_16x16x32_bf16 v[20:23], a[192:195], v[80:83], v[20:23]
ds_read_b64_tr_b16 a[222:223], v248 offset:480
v_mfma_f32_16x16x32_bf16 v[28:31], a[192:195], v[88:91], v[28:31]
s_lshl_b32 s22, s15, 17
v_mfma_f32_16x16x32_bf16 v[36:39], a[192:195], v[96:99], v[36:39]
s_add_u32 s22, s22, s25
s_add_u32 m0, s96, 84480
v_mfma_f32_16x16x32_bf16 v[44:47], a[192:195], v[104:107], v[44:47]
ds_read_b64_tr_b16 a[192:193], v248 offset:8448
buffer_load_dwordx4 v244, s[52:55], s22 offen offset:0 lds
v_mfma_f32_16x16x32_bf16 v[76:79], a[196:199], v[104:107], v[76:79]
ds_read_b64_tr_b16 a[194:195], v248 offset:8704
v_mfma_f32_16x16x32_bf16 v[68:71], a[196:199], v[96:99], v[68:71]
buffer_load_dwordx4 v245, s[52:55], s22 offen offset:1056 lds
v_mfma_f32_16x16x32_bf16 v[60:63], a[196:199], v[88:91], v[60:63]
v_mfma_f32_16x16x32_bf16 v[52:55], a[196:199], v[80:83], v[52:55]
ds_read_b64_tr_b16 a[196:197], v248 offset:8480
v_mfma_f32_16x16x32_bf16 v[84:87], a[200:203], v[80:83], v[84:87]
ds_read_b64_tr_b16 a[198:199], v248 offset:8736
v_mfma_f32_16x16x32_bf16 v[92:95], a[200:203], v[88:91], v[92:95]
buffer_load_dwordx4 v246, s[52:55], s22 offen offset:2112 lds
v_mfma_f32_16x16x32_bf16 v[100:103], a[200:203], v[96:99], v[100:103]
v_mfma_f32_16x16x32_bf16 v[108:111], a[200:203], v[104:107], v[108:111]
ds_read_b64_tr_b16 a[200:201], v248 offset:8512
s_waitcnt lgkmcnt(13)
v_mfma_f32_16x16x32_bf16 v[140:143], a[204:207], v[104:107], v[140:143]
ds_read_b64_tr_b16 a[202:203], v248 offset:8768
v_mfma_f32_16x16x32_bf16 v[132:135], a[204:207], v[96:99], v[132:135]
buffer_load_dwordx4 v247, s[52:55], s22 offen offset:3168 lds
v_mfma_f32_16x16x32_bf16 v[124:127], a[204:207], v[88:91], v[124:127]
s_lshl_b32 s22, s15, 17
s_add_u32 s22, s22, s25
v_mfma_f32_16x16x32_bf16 v[116:119], a[204:207], v[80:83], v[116:119]
ds_read_b64_tr_b16 a[204:205], v248 offset:8544
s_add_u32 s22, s22, 65536
s_waitcnt lgkmcnt(8)
v_mfma_f32_16x16x32_bf16 v[144:147], a[208:211], v[80:83], v[144:147]
ds_read_b64_tr_b16 a[206:207], v248 offset:8800
v_mfma_f32_16x16x32_bf16 v[148:151], a[208:211], v[88:91], v[148:151]
s_add_u32 m0, s96, 101376
v_mfma_f32_16x16x32_bf16 v[152:155], a[208:211], v[96:99], v[152:155]
buffer_load_dwordx4 v244, s[52:55], s22 offen offset:0 lds
buffer_load_dwordx4 v245, s[52:55], s22 offen offset:1056 lds
v_mfma_f32_16x16x32_bf16 v[156:159], a[208:211], v[104:107], v[156:159]
ds_read_b64_tr_b16 a[208:209], v248 offset:8576
v_mfma_f32_16x16x32_bf16 v[172:175], a[212:215], v[104:107], v[172:175]
ds_read_b64_tr_b16 a[210:211], v248 offset:8832
v_mfma_f32_16x16x32_bf16 v[168:171], a[212:215], v[96:99], v[168:171]
buffer_load_dwordx4 v246, s[52:55], s22 offen offset:2112 lds
v_mfma_f32_16x16x32_bf16 v[164:167], a[212:215], v[88:91], v[164:167]
v_mfma_f32_16x16x32_bf16 v[160:163], a[212:215], v[80:83], v[160:163]
ds_read_b64_tr_b16 a[212:213], v248 offset:8608
v_mfma_f32_16x16x32_bf16 v[176:179], a[216:219], v[80:83], v[176:179]
ds_read_b64_tr_b16 a[214:215], v248 offset:8864
v_mfma_f32_16x16x32_bf16 v[180:183], a[216:219], v[88:91], v[180:183]
buffer_load_dwordx4 v247, s[52:55], s22 offen offset:3168 lds
v_mfma_f32_16x16x32_bf16 v[184:187], a[216:219], v[96:99], v[184:187]
v_mfma_f32_16x16x32_bf16 v[188:191], a[216:219], v[104:107], v[188:191]
ds_read_b64_tr_b16 a[216:217], v248 offset:8640
s_waitcnt lgkmcnt(13)
v_mfma_f32_16x16x32_bf16 v[204:207], a[220:223], v[104:107], v[204:207]
ds_read_b64_tr_b16 a[218:219], v248 offset:8896
v_mfma_f32_16x16x32_bf16 v[200:203], a[220:223], v[96:99], v[200:203]
s_lshl_b32 s27, s6, 2
v_mfma_f32_16x16x32_bf16 v[196:199], a[220:223], v[88:91], v[196:199]
s_add_u32 s27, s27, s14
s_lshl_b32 s27, s27, 3
v_mfma_f32_16x16x32_bf16 v[192:195], a[220:223], v[80:83], v[192:195]
ds_read_b64_tr_b16 a[220:221], v248 offset:8672
s_add_u32 s27, s27, s4
s_waitcnt lgkmcnt(8)
v_mfma_f32_16x16x32_bf16 v[20:23], a[192:195], v[112:115], v[20:23]
ds_read_b64_tr_b16 a[222:223], v248 offset:8928
v_mfma_f32_16x16x32_bf16 v[28:31], a[192:195], v[120:123], v[28:31]
s_lshl_b32 s27, s27, 2
s_add_u32 s27, s27, s3
s_lshl_b32 s27, s27, 14
v_mfma_f32_16x16x32_bf16 v[36:39], a[192:195], v[128:131], v[36:39]
s_add_u32 s27, s27, 16777216
buffer_load_dwordx4 a[0:3], v251, s[76:79], s27 offen offset:0 sc1
buffer_load_dwordx4 a[4:7], v251, s[76:79], s27 offen offset:1024 sc1
v_mfma_f32_16x16x32_bf16 v[44:47], a[192:195], v[136:139], v[44:47]
s_barrier
ds_read_b64_tr_b16 a[192:193], v248 offset:16896
v_mfma_f32_16x16x32_bf16 v[76:79], a[196:199], v[136:139], v[76:79]
ds_read_b64_tr_b16 a[194:195], v248 offset:17152
v_mfma_f32_16x16x32_bf16 v[68:71], a[196:199], v[128:131], v[68:71]
buffer_load_dwordx4 a[8:11], v251, s[76:79], s27 offen offset:2048 sc1
v_mfma_f32_16x16x32_bf16 v[60:63], a[196:199], v[120:123], v[60:63]
v_mfma_f32_16x16x32_bf16 v[52:55], a[196:199], v[112:115], v[52:55]
ds_read_b64_tr_b16 a[196:197], v248 offset:16928
v_mfma_f32_16x16x32_bf16 v[84:87], a[200:203], v[112:115], v[84:87]
ds_read_b64_tr_b16 a[198:199], v248 offset:17184
v_mfma_f32_16x16x32_bf16 v[92:95], a[200:203], v[120:123], v[92:95]
buffer_load_dwordx4 a[12:15], v251, s[76:79], s27 offen offset:3072 sc1
v_mfma_f32_16x16x32_bf16 v[100:103], a[200:203], v[128:131], v[100:103]
s_add_u32 s27, s27, 4096
v_mfma_f32_16x16x32_bf16 v[108:111], a[200:203], v[136:139], v[108:111]
ds_read_b64_tr_b16 a[200:201], v248 offset:16960
s_waitcnt lgkmcnt(13)
v_mfma_f32_16x16x32_bf16 v[140:143], a[204:207], v[136:139], v[140:143]
ds_read_b64_tr_b16 a[202:203], v248 offset:17216
v_mfma_f32_16x16x32_bf16 v[132:135], a[204:207], v[128:131], v[132:135]
buffer_load_dwordx4 a[16:19], v251, s[76:79], s27 offen offset:0 sc1
v_mfma_f32_16x16x32_bf16 v[124:127], a[204:207], v[120:123], v[124:127]
buffer_load_dwordx4 a[20:23], v251, s[76:79], s27 offen offset:1024 sc1
v_mfma_f32_16x16x32_bf16 v[116:119], a[204:207], v[112:115], v[116:119]
ds_read_b64_tr_b16 a[204:205], v248 offset:16992
s_waitcnt lgkmcnt(8)
v_mfma_f32_16x16x32_bf16 v[144:147], a[208:211], v[112:115], v[144:147]
ds_read_b64_tr_b16 a[206:207], v248 offset:17248
v_mfma_f32_16x16x32_bf16 v[148:151], a[208:211], v[120:123], v[148:151]
buffer_load_dwordx4 a[24:27], v251, s[76:79], s27 offen offset:2048 sc1
v_mfma_f32_16x16x32_bf16 v[152:155], a[208:211], v[128:131], v[152:155]
v_mfma_f32_16x16x32_bf16 v[156:159], a[208:211], v[136:139], v[156:159]
ds_read_b64_tr_b16 a[208:209], v248 offset:17024
v_mfma_f32_16x16x32_bf16 v[172:175], a[212:215], v[136:139], v[172:175]
ds_read_b64_tr_b16 a[210:211], v248 offset:17280
v_mfma_f32_16x16x32_bf16 v[168:171], a[212:215], v[128:131], v[168:171]
buffer_load_dwordx4 a[28:31], v251, s[76:79], s27 offen offset:3072 sc1
v_mfma_f32_16x16x32_bf16 v[164:167], a[212:215], v[120:123], v[164:167]
v_mfma_f32_16x16x32_bf16 v[160:163], a[212:215], v[112:115], v[160:163]
ds_read_b64_tr_b16 a[212:213], v248 offset:17056
v_mfma_f32_16x16x32_bf16 v[176:179], a[216:219], v[112:115], v[176:179]
ds_read_b64_tr_b16 a[214:215], v248 offset:17312
v_mfma_f32_16x16x32_bf16 v[180:183], a[216:219], v[120:123], v[180:183]
s_add_u32 s27, s27, 4096
v_mfma_f32_16x16x32_bf16 v[184:187], a[216:219], v[128:131], v[184:187]
buffer_load_dwordx4 a[32:35], v251, s[76:79], s27 offen offset:0 sc1
buffer_load_dwordx4 a[36:39], v251, s[76:79], s27 offen offset:1024 sc1
v_mfma_f32_16x16x32_bf16 v[188:191], a[216:219], v[136:139], v[188:191]
ds_read_b64_tr_b16 a[216:217], v248 offset:17088
s_waitcnt lgkmcnt(13)
v_mfma_f32_16x16x32_bf16 v[204:207], a[220:223], v[136:139], v[204:207]
ds_read_b64_tr_b16 a[218:219], v248 offset:17344
v_mfma_f32_16x16x32_bf16 v[200:203], a[220:223], v[128:131], v[200:203]
buffer_load_dwordx4 a[40:43], v251, s[76:79], s27 offen offset:2048 sc1
v_mfma_f32_16x16x32_bf16 v[196:199], a[220:223], v[120:123], v[196:199]
v_mfma_f32_16x16x32_bf16 v[192:195], a[220:223], v[112:115], v[192:195]
ds_read_b64_tr_b16 a[220:221], v248 offset:17120
s_waitcnt lgkmcnt(8)
s_waitcnt vmcnt(35)
v_mfma_f32_16x16x32_bf16 v[20:23], a[192:195], a[128:131], v[20:23]
ds_read_b64_tr_b16 a[222:223], v248 offset:17376
s_waitcnt vmcnt(34)
v_mfma_f32_16x16x32_bf16 v[28:31], a[192:195], a[132:135], v[28:31]
buffer_load_dwordx4 a[44:47], v251, s[76:79], s27 offen offset:3072 sc1
s_waitcnt vmcnt(33)
v_mfma_f32_16x16x32_bf16 v[36:39], a[192:195], a[136:139], v[36:39]
s_waitcnt vmcnt(32)
v_mfma_f32_16x16x32_bf16 v[44:47], a[192:195], a[140:143], v[44:47]
ds_read_b64_tr_b16 a[192:193], v248 offset:25344
v_mfma_f32_16x16x32_bf16 v[76:79], a[196:199], a[140:143], v[76:79]
ds_read_b64_tr_b16 a[194:195], v248 offset:25600
v_mfma_f32_16x16x32_bf16 v[68:71], a[196:199], a[136:139], v[68:71]
s_add_u32 s27, s27, 4096
v_mfma_f32_16x16x32_bf16 v[60:63], a[196:199], a[132:135], v[60:63]
buffer_load_dwordx4 a[48:51], v251, s[76:79], s27 offen offset:0 sc1
buffer_load_dwordx4 a[52:55], v251, s[76:79], s27 offen offset:1024 sc1
v_mfma_f32_16x16x32_bf16 v[52:55], a[196:199], a[128:131], v[52:55]
ds_read_b64_tr_b16 a[196:197], v248 offset:25376
v_mfma_f32_16x16x32_bf16 v[84:87], a[200:203], a[128:131], v[84:87]
ds_read_b64_tr_b16 a[198:199], v248 offset:25632
v_mfma_f32_16x16x32_bf16 v[92:95], a[200:203], a[132:135], v[92:95]
buffer_load_dwordx4 a[56:59], v251, s[76:79], s27 offen offset:2048 sc1
v_mfma_f32_16x16x32_bf16 v[100:103], a[200:203], a[136:139], v[100:103]
v_mfma_f32_16x16x32_bf16 v[108:111], a[200:203], a[140:143], v[108:111]
ds_read_b64_tr_b16 a[200:201], v248 offset:25408
s_waitcnt lgkmcnt(13)
v_mfma_f32_16x16x32_bf16 v[140:143], a[204:207], a[140:143], v[140:143]
ds_read_b64_tr_b16 a[202:203], v248 offset:25664
v_mfma_f32_16x16x32_bf16 v[132:135], a[204:207], a[136:139], v[132:135]
buffer_load_dwordx4 a[60:63], v251, s[76:79], s27 offen offset:3072 sc1
v_mfma_f32_16x16x32_bf16 v[124:127], a[204:207], a[132:135], v[124:127]
v_mfma_f32_16x16x32_bf16 v[116:119], a[204:207], a[128:131], v[116:119]
ds_read_b64_tr_b16 a[204:205], v248 offset:25440
s_waitcnt lgkmcnt(8)
v_mfma_f32_16x16x32_bf16 v[144:147], a[208:211], a[128:131], v[144:147]
ds_read_b64_tr_b16 a[206:207], v248 offset:25696
v_mfma_f32_16x16x32_bf16 v[148:151], a[208:211], a[132:135], v[148:151]
v_mfma_f32_16x16x32_bf16 v[152:155], a[208:211], a[136:139], v[152:155]
s_lshl_b32 s27, s6, 2
s_add_u32 s27, s27, s15
v_mfma_f32_16x16x32_bf16 v[156:159], a[208:211], a[140:143], v[156:159]
ds_read_b64_tr_b16 a[208:209], v248 offset:25472
s_lshl_b32 s27, s27, 3
v_mfma_f32_16x16x32_bf16 v[172:175], a[212:215], a[140:143], v[172:175]
ds_read_b64_tr_b16 a[210:211], v248 offset:25728
v_mfma_f32_16x16x32_bf16 v[168:171], a[212:215], a[136:139], v[168:171]
s_add_u32 s27, s27, s4
v_mfma_f32_16x16x32_bf16 v[164:167], a[212:215], a[132:135], v[164:167]
s_lshl_b32 s27, s27, 2
s_add_u32 s27, s27, s3
v_mfma_f32_16x16x32_bf16 v[160:163], a[212:215], a[128:131], v[160:163]
ds_read_b64_tr_b16 a[212:213], v248 offset:25504
s_lshl_b32 s27, s27, 14
v_mfma_f32_16x16x32_bf16 v[176:179], a[216:219], a[128:131], v[176:179]
ds_read_b64_tr_b16 a[214:215], v248 offset:25760
v_mfma_f32_16x16x32_bf16 v[180:183], a[216:219], a[132:135], v[180:183]
s_add_u32 s27, s27, 16777216
buffer_load_dwordx4 a[64:67], v251, s[76:79], s27 offen offset:0 sc1
v_mfma_f32_16x16x32_bf16 v[184:187], a[216:219], a[136:139], v[184:187]
buffer_load_dwordx4 a[68:71], v251, s[76:79], s27 offen offset:1024 sc1
v_mfma_f32_16x16x32_bf16 v[188:191], a[216:219], a[140:143], v[188:191]
ds_read_b64_tr_b16 a[216:217], v248 offset:25536
s_waitcnt lgkmcnt(13)
v_mfma_f32_16x16x32_bf16 v[204:207], a[220:223], a[140:143], v[204:207]
ds_read_b64_tr_b16 a[218:219], v248 offset:25792
v_mfma_f32_16x16x32_bf16 v[200:203], a[220:223], a[136:139], v[200:203]
buffer_load_dwordx4 a[72:75], v251, s[76:79], s27 offen offset:2048 sc1
v_mfma_f32_16x16x32_bf16 v[196:199], a[220:223], a[132:135], v[196:199]
v_mfma_f32_16x16x32_bf16 v[192:195], a[220:223], a[128:131], v[192:195]
ds_read_b64_tr_b16 a[220:221], v248 offset:25568
s_waitcnt lgkmcnt(8)
s_waitcnt vmcnt(38)
v_mfma_f32_16x16x32_bf16 v[20:23], a[192:195], a[144:147], v[20:23]
ds_read_b64_tr_b16 a[222:223], v248 offset:25824
s_waitcnt vmcnt(37)
v_mfma_f32_16x16x32_bf16 v[28:31], a[192:195], a[148:151], v[28:31]
buffer_load_dwordx4 a[76:79], v251, s[76:79], s27 offen offset:3072 sc1
s_waitcnt vmcnt(37)
v_mfma_f32_16x16x32_bf16 v[36:39], a[192:195], a[152:155], v[36:39]
s_waitcnt vmcnt(36)
v_mfma_f32_16x16x32_bf16 v[44:47], a[192:195], a[156:159], v[44:47]
s_barrier
ds_read_b64_tr_b16 a[192:193], v248 offset:33792
v_mfma_f32_16x16x32_bf16 v[76:79], a[196:199], a[156:159], v[76:79]
ds_read_b64_tr_b16 a[194:195], v248 offset:34048
v_mfma_f32_16x16x32_bf16 v[68:71], a[196:199], a[152:155], v[68:71]
s_add_u32 s27, s27, 4096
v_mfma_f32_16x16x32_bf16 v[60:63], a[196:199], a[148:151], v[60:63]
buffer_load_dwordx4 a[80:83], v251, s[76:79], s27 offen offset:0 sc1
v_mfma_f32_16x16x32_bf16 v[52:55], a[196:199], a[144:147], v[52:55]
ds_read_b64_tr_b16 a[196:197], v248 offset:33824
v_mfma_f32_16x16x32_bf16 v[84:87], a[200:203], a[144:147], v[84:87]
ds_read_b64_tr_b16 a[198:199], v248 offset:34080
v_mfma_f32_16x16x32_bf16 v[92:95], a[200:203], a[148:151], v[92:95]
buffer_load_dwordx4 a[84:87], v251, s[76:79], s27 offen offset:1024 sc1
v_mfma_f32_16x16x32_bf16 v[100:103], a[200:203], a[152:155], v[100:103]
v_mfma_f32_16x16x32_bf16 v[108:111], a[200:203], a[156:159], v[108:111]
ds_read_b64_tr_b16 a[200:201], v248 offset:33856
s_waitcnt lgkmcnt(13)
v_mfma_f32_16x16x32_bf16 v[140:143], a[204:207], a[156:159], v[140:143]
ds_read_b64_tr_b16 a[202:203], v248 offset:34112
v_mfma_f32_16x16x32_bf16 v[132:135], a[204:207], a[152:155], v[132:135]
buffer_load_dwordx4 a[88:91], v251, s[76:79], s27 offen offset:2048 sc1
v_mfma_f32_16x16x32_bf16 v[124:127], a[204:207], a[148:151], v[124:127]
buffer_load_dwordx4 a[92:95], v251, s[76:79], s27 offen offset:3072 sc1
v_mfma_f32_16x16x32_bf16 v[116:119], a[204:207], a[144:147], v[116:119]
ds_read_b64_tr_b16 a[204:205], v248 offset:33888
s_waitcnt lgkmcnt(8)
v_mfma_f32_16x16x32_bf16 v[144:147], a[208:211], a[144:147], v[144:147]
ds_read_b64_tr_b16 a[206:207], v248 offset:34144
v_mfma_f32_16x16x32_bf16 v[148:151], a[208:211], a[148:151], v[148:151]
v_mfma_f32_16x16x32_bf16 v[152:155], a[208:211], a[152:155], v[152:155]
s_add_u32 s27, s27, 4096
buffer_load_dwordx4 a[96:99], v251, s[76:79], s27 offen offset:0 sc1
v_mfma_f32_16x16x32_bf16 v[156:159], a[208:211], a[156:159], v[156:159]
ds_read_b64_tr_b16 a[208:209], v248 offset:33920
v_mfma_f32_16x16x32_bf16 v[172:175], a[212:215], a[156:159], v[172:175]
ds_read_b64_tr_b16 a[210:211], v248 offset:34176
v_mfma_f32_16x16x32_bf16 v[168:171], a[212:215], a[152:155], v[168:171]
v_mfma_f32_16x16x32_bf16 v[164:167], a[212:215], a[148:151], v[164:167]
buffer_load_dwordx4 a[100:103], v251, s[76:79], s27 offen offset:1024 sc1
v_mfma_f32_16x16x32_bf16 v[160:163], a[212:215], a[144:147], v[160:163]
ds_read_b64_tr_b16 a[212:213], v248 offset:33952
v_mfma_f32_16x16x32_bf16 v[176:179], a[216:219], a[144:147], v[176:179]
ds_read_b64_tr_b16 a[214:215], v248 offset:34208
v_mfma_f32_16x16x32_bf16 v[180:183], a[216:219], a[148:151], v[180:183]
buffer_load_dwordx4 a[104:107], v251, s[76:79], s27 offen offset:2048 sc1
v_mfma_f32_16x16x32_bf16 v[184:187], a[216:219], a[152:155], v[184:187]
v_mfma_f32_16x16x32_bf16 v[188:191], a[216:219], a[156:159], v[188:191]
ds_read_b64_tr_b16 a[216:217], v248 offset:33984
s_waitcnt lgkmcnt(13)
v_mfma_f32_16x16x32_bf16 v[204:207], a[220:223], a[156:159], v[204:207]
ds_read_b64_tr_b16 a[218:219], v248 offset:34240
v_mfma_f32_16x16x32_bf16 v[200:203], a[220:223], a[152:155], v[200:203]
buffer_load_dwordx4 a[108:111], v251, s[76:79], s27 offen offset:3072 sc1
v_mfma_f32_16x16x32_bf16 v[196:199], a[220:223], a[148:151], v[196:199]
v_mfma_f32_16x16x32_bf16 v[192:195], a[220:223], a[144:147], v[192:195]
ds_read_b64_tr_b16 a[220:221], v248 offset:34016
s_waitcnt lgkmcnt(8)
s_waitcnt vmcnt(43)
v_mfma_f32_16x16x32_bf16 v[20:23], a[192:195], a[160:163], v[20:23]
ds_read_b64_tr_b16 a[222:223], v248 offset:34272
s_waitcnt vmcnt(42)
v_mfma_f32_16x16x32_bf16 v[28:31], a[192:195], a[164:167], v[28:31]
s_add_u32 s27, s27, 4096
s_waitcnt vmcnt(41)
v_mfma_f32_16x16x32_bf16 v[36:39], a[192:195], a[168:171], v[36:39]
buffer_load_dwordx4 a[112:115], v251, s[76:79], s27 offen offset:0 sc1
s_waitcnt vmcnt(41)
v_mfma_f32_16x16x32_bf16 v[44:47], a[192:195], a[172:175], v[44:47]
ds_read_b64_tr_b16 a[192:193], v248 offset:42240
v_mfma_f32_16x16x32_bf16 v[76:79], a[196:199], a[172:175], v[76:79]
ds_read_b64_tr_b16 a[194:195], v248 offset:42496
v_mfma_f32_16x16x32_bf16 v[68:71], a[196:199], a[168:171], v[68:71]
buffer_load_dwordx4 a[116:119], v251, s[76:79], s27 offen offset:1024 sc1
v_mfma_f32_16x16x32_bf16 v[60:63], a[196:199], a[164:167], v[60:63]
v_mfma_f32_16x16x32_bf16 v[52:55], a[196:199], a[160:163], v[52:55]
ds_read_b64_tr_b16 a[196:197], v248 offset:42272
v_mfma_f32_16x16x32_bf16 v[84:87], a[200:203], a[160:163], v[84:87]
ds_read_b64_tr_b16 a[198:199], v248 offset:42528
v_mfma_f32_16x16x32_bf16 v[92:95], a[200:203], a[164:167], v[92:95]
buffer_load_dwordx4 a[120:123], v251, s[76:79], s27 offen offset:2048 sc1
v_mfma_f32_16x16x32_bf16 v[100:103], a[200:203], a[168:171], v[100:103]
v_mfma_f32_16x16x32_bf16 v[108:111], a[200:203], a[172:175], v[108:111]
ds_read_b64_tr_b16 a[200:201], v248 offset:42304
s_waitcnt lgkmcnt(13)
v_mfma_f32_16x16x32_bf16 v[140:143], a[204:207], a[172:175], v[140:143]
ds_read_b64_tr_b16 a[202:203], v248 offset:42560
v_mfma_f32_16x16x32_bf16 v[132:135], a[204:207], a[168:171], v[132:135]
buffer_load_dwordx4 a[124:127], v251, s[76:79], s27 offen offset:3072 sc1
v_mfma_f32_16x16x32_bf16 v[124:127], a[204:207], a[164:167], v[124:127]
v_mfma_f32_16x16x32_bf16 v[116:119], a[204:207], a[160:163], v[116:119]
ds_read_b64_tr_b16 a[204:205], v248 offset:42336
s_waitcnt lgkmcnt(8)
v_mfma_f32_16x16x32_bf16 v[144:147], a[208:211], a[160:163], v[144:147]
ds_read_b64_tr_b16 a[206:207], v248 offset:42592
v_mfma_f32_16x16x32_bf16 v[148:151], a[208:211], a[164:167], v[148:151]
s_bfe_u32 s88, s17, 0x10001
v_mfma_f32_16x16x32_bf16 v[152:155], a[208:211], a[168:171], v[152:155]
s_mul_i32 s89, s88, 11
v_lshrrev_b32 v14, 1, v0
v_mfma_f32_16x16x32_bf16 v[156:159], a[208:211], a[172:175], v[156:159]
ds_read_b64_tr_b16 a[208:209], v248 offset:42368
v_min_u32 v14, 10, v14
v_mfma_f32_16x16x32_bf16 v[172:175], a[212:215], a[172:175], v[172:175]
ds_read_b64_tr_b16 a[210:211], v248 offset:42624
v_add_u32 v14, s89, v14
v_mfma_f32_16x16x32_bf16 v[168:171], a[212:215], a[168:171], v[168:171]
v_mul_u32_u24 v15, 86, v14
v_lshrrev_b32 v15, 8, v15
v_mfma_f32_16x16x32_bf16 v[164:167], a[212:215], a[164:167], v[164:167]
v_add3_u32 v14, v14, v15, 1
s_lshl_b32 s88, s88, 2
v_mfma_f32_16x16x32_bf16 v[160:163], a[212:215], a[160:163], v[160:163]
ds_read_b64_tr_b16 a[212:213], v248 offset:42400
s_lshr_b32 s89, s18, 1
s_add_u32 s88, s88, s89
s_lshl_b32 s88, s88, 2
v_mfma_f32_16x16x32_bf16 v[176:179], a[216:219], a[160:163], v[176:179]
ds_read_b64_tr_b16 a[214:215], v248 offset:42656
v_mov_b32 v15, s88
v_cmp_gt_u32 vcc, 22, v0
v_mfma_f32_16x16x32_bf16 v[180:183], a[216:219], a[164:167], v[180:183]
s_nop 0
v_cndmask_b32 v14, v15, v14, vcc
v_lshl_add_u32 v14, v14, 3, s4
s_and_b32 s88, s17, 1
v_mfma_f32_16x16x32_bf16 v[184:187], a[216:219], a[168:171], v[184:187]
s_lshl_b32 s88, s88, 3
v_and_b32 v15, 1, v0
v_mfma_f32_16x16x32_bf16 v[188:191], a[216:219], a[172:175], v[188:191]
ds_read_b64_tr_b16 a[216:217], v248 offset:42432
v_lshl_add_u32 v15, v15, 2, s88
v_lshrrev_b32 v252, 4, v14
s_waitcnt lgkmcnt(13)
v_mfma_f32_16x16x32_bf16 v[204:207], a[220:223], a[172:175], v[204:207]
ds_read_b64_tr_b16 a[218:219], v248 offset:42688
v_and_b32 v252, 12, v252
buffer_load_dword v252, v252, s[84:87], 0 offen sc1
v_mfma_f32_16x16x32_bf16 v[200:203], a[220:223], a[168:171], v[200:203]
v_lshl_add_u32 v14, v14, 7, v15
v_mfma_f32_16x16x32_bf16 v[196:199], a[220:223], a[164:167], v[196:199]
buffer_load_dword v15, v14, s[76:79], s24 offen offset:16 sc1
v_mfma_f32_16x16x32_bf16 v[192:195], a[220:223], a[160:163], v[192:195]
ds_read_b64_tr_b16 a[220:221], v248 offset:42464
s_waitcnt lgkmcnt(8)
s_waitcnt vmcnt(45)
v_mfma_f32_16x16x32_bf16 v[20:23], a[192:195], a[176:179], v[20:23]
ds_read_b64_tr_b16 a[222:223], v248 offset:42720
s_waitcnt vmcnt(44)
v_mfma_f32_16x16x32_bf16 v[28:31], a[192:195], a[180:183], v[28:31]
s_lshl_b32 s88, s4, 2
s_waitcnt vmcnt(43)
v_mfma_f32_16x16x32_bf16 v[36:39], a[192:195], a[184:187], v[36:39]
s_add_u32 s88, s88, s3
s_and_b32 s88, s88, 15
s_lshl_b32 s88, s88, 10
v_lshlrev_b32 v8, 4, v0
s_add_u32 s88, s88, recurrent_scan__sliding_block_cached__mixer_s_mlp__prompt_kernel_fin-recurrent_scan__sliding_block_cached__mixer_s_mlp__prompt_kernel_pc
s_waitcnt vmcnt(42)
v_mfma_f32_16x16x32_bf16 v[44:47], a[192:195], a[188:191], v[44:47]
s_waitcnt vmcnt(34)
s_barrier
ds_read_b64_tr_b16 a[192:193], v249 offset:0
v_mfma_f32_16x16x32_bf16 v[76:79], a[196:199], a[188:191], v[76:79]
ds_read_b64_tr_b16 a[194:195], v249 offset:256
v_mfma_f32_16x16x32_bf16 v[68:71], a[196:199], a[184:187], v[68:71]
buffer_load_dword v253, v8, s[72:75], s88 offen
v_mfma_f32_16x16x32_bf16 v[60:63], a[196:199], a[180:183], v[60:63]
s_lshl_b32 s27, s4, 2
v_mfma_f32_16x16x32_bf16 v[52:55], a[196:199], a[176:179], v[52:55]
ds_read_b64_tr_b16 a[196:197], v249 offset:8448
v_mfma_f32_16x16x32_bf16 v[84:87], a[200:203], a[176:179], v[84:87]
ds_read_b64_tr_b16 a[198:199], v249 offset:8704
v_mfma_f32_16x16x32_bf16 v[92:95], a[200:203], a[180:183], v[92:95]
s_add_u32 s27, s27, s3
v_mfma_f32_16x16x32_bf16 v[100:103], a[200:203], a[184:187], v[100:103]
s_lshl_b32 s27, s27, 16
s_xor_b32 s88, s7, 0
v_mfma_f32_16x16x32_bf16 v[108:111], a[200:203], a[188:191], v[108:111]
ds_read_b64_tr_b16 a[200:201], v249 offset:16896
s_lshl_b32 s88, s88, 12
s_waitcnt lgkmcnt(13)
v_mfma_f32_16x16x32_bf16 v[140:143], a[204:207], a[188:191], v[140:143]
ds_read_b64_tr_b16 a[202:203], v249 offset:17152
s_add_u32 s27, s27, s88
s_lshl_b32 s88, s6, 21
v_mfma_f32_16x16x32_bf16 v[132:135], a[204:207], a[184:187], v[132:135]
s_add_u32 s27, s27, s88
s_add_u32 s27, s27, 33554432
s_lshr_b32 s88, s6, 1
v_mfma_f32_16x16x32_bf16 v[124:127], a[204:207], a[180:183], v[124:127]
s_and_b32 s89, s18, 1
s_cmp_eq_u32 s88, s3
s_cselect_b32 s97, s89, 2
s_cmp_eq_u32 s97, 1
s_cselect_b32 s98, 1073741824, s27
s_cmp_eq_u32 s97, 0
s_cselect_b32 s27, 1073741824, s27
v_mfma_f32_16x16x32_bf16 v[116:119], a[204:207], a[176:179], v[116:119]
ds_read_b64_tr_b16 a[204:205], v249 offset:25344
v_add_u32 v5, 155648, v251
s_waitcnt lgkmcnt(8)
v_mfma_f32_16x16x32_bf16 v[144:147], a[208:211], a[176:179], v[144:147]
ds_read_b64_tr_b16 a[206:207], v249 offset:25600
v_mfma_f32_16x16x32_bf16 v[148:151], a[208:211], a[180:183], v[148:151]
s_mul_i32 s31, s92, 1
v_mfma_f32_16x16x32_bf16 v[152:155], a[208:211], a[184:187], v[152:155]
s_add_u32 s31, s31, s12
s_add_u32 m0, s96, 135168
s_nop 0
buffer_load_dwordx4 v240, s[68:71], s31 offen offset:0 lds
v_mfma_f32_16x16x32_bf16 v[156:159], a[208:211], a[188:191], v[156:159]
ds_read_b64_tr_b16 a[208:209], v249 offset:33792
buffer_load_dwordx4 v241, s[68:71], s31 offen offset:1056 lds
v_mfma_f32_16x16x32_bf16 v[172:175], a[212:215], a[188:191], v[172:175]
ds_read_b64_tr_b16 a[210:211], v249 offset:34048
v_mfma_f32_16x16x32_bf16 v[168:171], a[212:215], a[184:187], v[168:171]
buffer_load_dwordx4 v242, s[68:71], s31 offen offset:2112 lds
v_mfma_f32_16x16x32_bf16 v[164:167], a[212:215], a[180:183], v[164:167]
v_mfma_f32_16x16x32_bf16 v[160:163], a[212:215], a[176:179], v[160:163]
ds_read_b64_tr_b16 a[212:213], v249 offset:42240
v_mfma_f32_16x16x32_bf16 v[176:179], a[216:219], a[176:179], v[176:179]
ds_read_b64_tr_b16 a[214:215], v249 offset:42496
v_mfma_f32_16x16x32_bf16 v[180:183], a[216:219], a[180:183], v[180:183]
buffer_load_dwordx4 v243, s[68:71], s31 offen offset:3168 lds
v_mfma_f32_16x16x32_bf16 v[184:187], a[216:219], a[184:187], v[184:187]
s_waitcnt vmcnt(5)
v_cmp_ne_u32 vcc, v252, v15
s_cbranch_vccnz reslow_40
reback_41:
v_mfma_f32_16x16x32_bf16 v[188:191], a[216:219], a[188:191], v[188:191]
ds_read_b64_tr_b16 a[216:217], v250 offset:0
s_waitcnt lgkmcnt(13)
v_mfma_f32_16x16x32_bf16 v[204:207], a[220:223], a[188:191], v[204:207]
ds_read_b64_tr_b16 a[218:219], v250 offset:256
v_mfma_f32_16x16x32_bf16 v[200:203], a[220:223], a[184:187], v[200:203]
s_mul_i32 s31, s92, 2
v_mfma_f32_16x16x32_bf16 v[196:199], a[220:223], a[180:183], v[196:199]
s_add_u32 s31, s31, s12
s_add_u32 m0, s96, 0
v_mfma_f32_16x16x32_bf16 v[192:195], a[220:223], a[176:179], v[192:195]
ds_read_b64_tr_b16 a[220:221], v250 offset:8448
buffer_load_dwordx4 v240, s[68:71], s31 offen offset:0 lds
s_waitcnt lgkmcnt(8)
v_mfma_f32_16x16x32_bf16 v[20:23], a[192:195], a[0:3], v[20:23]
ds_read_b64_tr_b16 a[222:223], v250 offset:8704
v_mfma_f32_16x16x32_bf16 v[28:31], a[192:195], a[4:7], v[28:31]
buffer_load_dwordx4 v241, s[68:71], s31 offen offset:1056 lds
v_mfma_f32_16x16x32_bf16 v[36:39], a[192:195], a[8:11], v[36:39]
buffer_load_dwordx4 v242, s[68:71], s31 offen offset:2112 lds
v_mfma_f32_16x16x32_bf16 v[44:47], a[192:195], a[12:15], v[44:47]
ds_read_b64_tr_b16 a[192:193], v249 offset:32
v_mfma_f32_16x16x32_bf16 v[44:47], a[196:199], a[28:31], v[44:47]
ds_read_b64_tr_b16 a[194:195], v249 offset:288
v_mfma_f32_16x16x32_bf16 v[36:39], a[196:199], a[24:27], v[36:39]
buffer_load_dwordx4 v243, s[68:71], s31 offen offset:3168 lds
v_mfma_f32_16x16x32_bf16 v[28:31], a[196:199], a[20:23], v[28:31]
v_mfma_f32_16x16x32_bf16 v[20:23], a[196:199], a[16:19], v[20:23]
ds_read_b64_tr_b16 a[196:197], v249 offset:8480
v_mfma_f32_16x16x32_bf16 v[20:23], a[200:203], a[32:35], v[20:23]
ds_read_b64_tr_b16 a[198:199], v249 offset:8736
v_mfma_f32_16x16x32_bf16 v[28:31], a[200:203], a[36:39], v[28:31]
s_lshl_b32 s88, s17, 2
v_mfma_f32_16x16x32_bf16 v[36:39], a[200:203], a[40:43], v[36:39]
s_add_u32 s88, s88, s19
s_xor_b32 s89, s88, 1
v_mfma_f32_16x16x32_bf16 v[44:47], a[200:203], a[44:47], v[44:47]
ds_read_b64_tr_b16 a[200:201], v249 offset:16928
s_mul_i32 s20, s88, 44032
s_waitcnt lgkmcnt(13)
v_mfma_f32_16x16x32_bf16 v[44:47], a[204:207], a[60:63], v[44:47]
ds_read_b64_tr_b16 a[202:203], v249 offset:17184
v_mfma_f32_16x16x32_bf16 v[36:39], a[204:207], a[56:59], v[36:39]
s_mul_i32 s93, s89, 44032
v_mfma_f32_16x16x32_bf16 v[28:31], a[204:207], a[52:55], v[28:31]
s_lshl_b32 s88, s26, 10
s_add_u32 s88, s88, 6291456
v_mfma_f32_16x16x32_bf16 v[20:23], a[204:207], a[48:51], v[20:23]
ds_read_b64_tr_b16 a[204:205], v249 offset:25376
s_add_u32 s20, s20, s88
s_add_u32 s93, s93, s88
s_cmp_ge_u32 s3, 2
s_cselect_b32 s89, 1073741824, 0
s_waitcnt lgkmcnt(8)
v_mfma_f32_16x16x32_bf16 v[20:23], a[208:211], a[64:67], v[20:23]
ds_read_b64_tr_b16 a[206:207], v249 offset:25632
v_mfma_f32_16x16x32_bf16 v[28:31], a[208:211], a[68:71], v[28:31]
s_or_b32 s88, s20, s89
buffer_load_dwordx4 a[224:227], v251, s[76:79], s88 offen sc1
v_mfma_f32_16x16x32_bf16 v[36:39], a[208:211], a[72:75], v[36:39]
s_or_b32 s88, s93, s89
buffer_load_dwordx4 a[228:231], v251, s[76:79], s88 offen sc1
v_mfma_f32_16x16x32_bf16 v[44:47], a[208:211], a[76:79], v[44:47]
ds_read_b64_tr_b16 a[208:209], v249 offset:33824
v_mfma_f32_16x16x32_bf16 v[44:47], a[212:215], a[92:95], v[44:47]
ds_read_b64_tr_b16 a[210:211], v249 offset:34080
v_mfma_f32_16x16x32_bf16 v[36:39], a[212:215], a[88:91], v[36:39]
buffer_load_dwordx4 a[232:235], v251, s[76:79], s20 offen offset:1024 sc1
v_mfma_f32_16x16x32_bf16 v[28:31], a[212:215], a[84:87], v[28:31]
buffer_load_dwordx4 a[236:239], v251, s[76:79], s93 offen offset:1024 sc1
v_mfma_f32_16x16x32_bf16 v[20:23], a[212:215], a[80:83], v[20:23]
ds_read_b64_tr_b16 a[212:213], v249 offset:42272
v_mfma_f32_16x16x32_bf16 v[20:23], a[216:219], a[96:99], v[20:23]
ds_read_b64_tr_b16 a[214:215], v249 offset:42528
v_mfma_f32_16x16x32_bf16 v[28:31], a[216:219], a[100:103], v[28:31]
buffer_load_dwordx4 a[240:243], v251, s[76:79], s20 offen offset:2048 sc1
v_mfma_f32_16x16x32_bf16 v[36:39], a[216:219], a[104:107], v[36:39]
v_mfma_f32_16x16x32_bf16 v[44:47], a[216:219], a[108:111], v[44:47]
ds_read_b64_tr_b16 a[216:217], v250 offset:32
s_waitcnt lgkmcnt(13)
v_mfma_f32_16x16x32_bf16 v[44:47], a[220:223], a[124:127], v[44:47]
ds_read_b64_tr_b16 a[218:219], v250 offset:288
v_mfma_f32_16x16x32_bf16 v[36:39], a[220:223], a[120:123], v[36:39]
buffer_load_dwordx4 a[244:247], v251, s[76:79], s93 offen offset:2048 sc1
v_mfma_f32_16x16x32_bf16 v[28:31], a[220:223], a[116:119], v[28:31]
v_mfma_f32_16x16x32_bf16 v[20:23], a[220:223], a[112:115], v[20:23]
ds_read_b64_tr_b16 a[220:221], v250 offset:8480
s_waitcnt lgkmcnt(8)
v_mfma_f32_16x16x32_bf16 v[52:55], a[192:195], a[0:3], v[52:55]
ds_read_b64_tr_b16 a[222:223], v250 offset:8736
v_mfma_f32_16x16x32_bf16 v[60:63], a[192:195], a[4:7], v[60:63]
buffer_load_dwordx4 a[248:251], v251, s[76:79], s20 offen offset:3072 sc1
v_mfma_f32_16x16x32_bf16 v[68:71], a[192:195], a[8:11], v[68:71]
buffer_load_dwordx4 a[252:255], v251, s[76:79], s93 offen offset:3072 sc1
v_mfma_f32_16x16x32_bf16 v[76:79], a[192:195], a[12:15], v[76:79]
s_barrier
ds_read_b64_tr_b16 a[192:193], v249 offset:64
v_mfma_f32_16x16x32_bf16 v[76:79], a[196:199], a[28:31], v[76:79]
ds_read_b64_tr_b16 a[194:195], v249 offset:320
v_mfma_f32_16x16x32_bf16 v[68:71], a[196:199], a[24:27], v[68:71]
v_mfma_f32_16x16x32_bf16 v[60:63], a[196:199], a[20:23], v[60:63]
v_mfma_f32_16x16x32_bf16 v[52:55], a[196:199], a[16:19], v[52:55]
ds_read_b64_tr_b16 a[196:197], v249 offset:8512
v_mfma_f32_16x16x32_bf16 v[52:55], a[200:203], a[32:35], v[52:55]
ds_read_b64_tr_b16 a[198:199], v249 offset:8768
v_mfma_f32_16x16x32_bf16 v[60:63], a[200:203], a[36:39], v[60:63]
s_mul_i32 s31, s92, 3
v_mfma_f32_16x16x32_bf16 v[68:71], a[200:203], a[40:43], v[68:71]
s_add_u32 s31, s31, s12
s_add_u32 m0, s96, 16896
v_mfma_f32_16x16x32_bf16 v[76:79], a[200:203], a[44:47], v[76:79]
ds_read_b64_tr_b16 a[200:201], v249 offset:16960
buffer_load_dwordx4 v240, s[68:71], s31 offen offset:0 lds
s_waitcnt lgkmcnt(13)
v_mfma_f32_16x16x32_bf16 v[76:79], a[204:207], a[60:63], v[76:79]
ds_read_b64_tr_b16 a[202:203], v249 offset:17216
v_mfma_f32_16x16x32_bf16 v[68:71], a[204:207], a[56:59], v[68:71]
buffer_load_dwordx4 v241, s[68:71], s31 offen offset:1056 lds
v_mfma_f32_16x16x32_bf16 v[60:63], a[204:207], a[52:55], v[60:63]
v_mfma_f32_16x16x32_bf16 v[52:55], a[204:207], a[48:51], v[52:55]
ds_read_b64_tr_b16 a[204:205], v249 offset:25408
s_waitcnt lgkmcnt(8)
v_mfma_f32_16x16x32_bf16 v[52:55], a[208:211], a[64:67], v[52:55]
ds_read_b64_tr_b16 a[206:207], v249 offset:25664
v_mfma_f32_16x16x32_bf16 v[60:63], a[208:211], a[68:71], v[60:63]
v_mfma_f32_16x16x32_bf16 v[68:71], a[208:211], a[72:75], v[68:71]
buffer_load_dwordx4 v242, s[68:71], s31 offen offset:2112 lds
v_mfma_f32_16x16x32_bf16 v[76:79], a[208:211], a[76:79], v[76:79]
ds_read_b64_tr_b16 a[208:209], v249 offset:33856
v_mfma_f32_16x16x32_bf16 v[76:79], a[212:215], a[92:95], v[76:79]
ds_read_b64_tr_b16 a[210:211], v249 offset:34112
v_mfma_f32_16x16x32_bf16 v[68:71], a[212:215], a[88:91], v[68:71]
v_mfma_f32_16x16x32_bf16 v[60:63], a[212:215], a[84:87], v[60:63]
v_mfma_f32_16x16x32_bf16 v[52:55], a[212:215], a[80:83], v[52:55]
ds_read_b64_tr_b16 a[212:213], v249 offset:42304
v_mfma_f32_16x16x32_bf16 v[52:55], a[216:219], a[96:99], v[52:55]
ds_read_b64_tr_b16 a[214:215], v249 offset:42560
v_mfma_f32_16x16x32_bf16 v[60:63], a[216:219], a[100:103], v[60:63]
buffer_load_dwordx4 v243, s[68:71], s31 offen offset:3168 lds
v_mfma_f32_16x16x32_bf16 v[68:71], a[216:219], a[104:107], v[68:71]
v_mfma_f32_16x16x32_bf16 v[76:79], a[216:219], a[108:111], v[76:79]
ds_read_b64_tr_b16 a[216:217], v250 offset:64
s_waitcnt lgkmcnt(13)
v_mfma_f32_16x16x32_bf16 v[76:79], a[220:223], a[124:127], v[76:79]
ds_read_b64_tr_b16 a[218:219], v250 offset:320
v_mfma_f32_16x16x32_bf16 v[68:71], a[220:223], a[120:123], v[68:71]
s_mul_i32 s31, s92, 4
v_mfma_f32_16x16x32_bf16 v[60:63], a[220:223], a[116:119], v[60:63]
s_add_u32 s31, s31, s12
s_add_u32 m0, s96, 33792
v_mfma_f32_16x16x32_bf16 v[52:55], a[220:223], a[112:115], v[52:55]
ds_read_b64_tr_b16 a[220:221], v250 offset:8512
buffer_load_dwordx4 v240, s[68:71], s31 offen offset:0 lds
s_waitcnt lgkmcnt(8)
v_mfma_f32_16x16x32_bf16 v[84:87], a[192:195], a[0:3], v[84:87]
ds_read_b64_tr_b16 a[222:223], v250 offset:8768
v_mfma_f32_16x16x32_bf16 v[92:95], a[192:195], a[4:7], v[92:95]
v_bfe_u32 v10, v0, 2, 2
v_mfma_f32_16x16x32_bf16 v[100:103], a[192:195], a[8:11], v[100:103]
buffer_load_dwordx4 v241, s[68:71], s31 offen offset:1056 lds
v_mfma_f32_16x16x32_bf16 v[108:111], a[192:195], a[12:15], v[108:111]
ds_read_b64_tr_b16 a[192:193], v249 offset:96
v_mfma_f32_16x16x32_bf16 v[108:111], a[196:199], a[28:31], v[108:111]
ds_read_b64_tr_b16 a[194:195], v249 offset:352
v_mfma_f32_16x16x32_bf16 v[100:103], a[196:199], a[24:27], v[100:103]
v_mul_u32_u24 v10, 1056, v10
v_mfma_f32_16x16x32_bf16 v[92:95], a[196:199], a[20:23], v[92:95]
v_cvt_pk_bf16_f32 v20, v20, v21
v_bfe_u32 v11, v0, 4, 1
v_mfma_f32_16x16x32_bf16 v[84:87], a[196:199], a[16:19], v[84:87]
ds_read_b64_tr_b16 a[196:197], v249 offset:8544
v_cvt_pk_bf16_f32 v21, v22, v23
v_mfma_f32_16x16x32_bf16 v[84:87], a[200:203], a[32:35], v[84:87]
ds_read_b64_tr_b16 a[198:199], v249 offset:8800
v_mfma_f32_16x16x32_bf16 v[92:95], a[200:203], a[36:39], v[92:95]
v_cvt_pk_bf16_f32 v22, v52, v53
v_mfma_f32_16x16x32_bf16 v[100:103], a[200:203], a[40:43], v[100:103]
buffer_load_dwordx4 v242, s[68:71], s31 offen offset:2112 lds
v_cvt_pk_bf16_f32 v23, v54, v55
v_mfma_f32_16x16x32_bf16 v[108:111], a[200:203], a[44:47], v[108:111]
ds_read_b64_tr_b16 a[200:201], v249 offset:16992
v_lshl_add_u32 v10, v11, 7, v10
s_waitcnt lgkmcnt(13)
v_mfma_f32_16x16x32_bf16 v[108:111], a[204:207], a[60:63], v[108:111]
ds_read_b64_tr_b16 a[202:203], v249 offset:17248
v_cvt_pk_bf16_f32 v28, v28, v29
s_add_u32 s30, s27, 0
buffer_store_dwordx4 v[20:23], v251, s[76:79], s30 offen offset:0 sc1
v_mfma_f32_16x16x32_bf16 v[100:103], a[204:207], a[56:59], v[100:103]
v_cvt_pk_bf16_f32 v29, v30, v31
v_mfma_f32_16x16x32_bf16 v[92:95], a[204:207], a[52:55], v[92:95]
v_lshrrev_b32 v11, 5, v0
v_cvt_pk_bf16_f32 v30, v60, v61
v_mfma_f32_16x16x32_bf16 v[84:87], a[204:207], a[48:51], v[84:87]
ds_read_b64_tr_b16 a[204:205], v249 offset:25440
v_cvt_pk_bf16_f32 v31, v62, v63
s_waitcnt lgkmcnt(8)
v_mfma_f32_16x16x32_bf16 v[84:87], a[208:211], a[64:67], v[84:87]
ds_read_b64_tr_b16 a[206:207], v249 offset:25696
buffer_load_dwordx4 v243, s[68:71], s31 offen offset:3168 lds
v_lshl_add_u32 v10, v11, 9, v10
v_cvt_pk_bf16_f32 v36, v36, v37
v_mfma_f32_16x16x32_bf16 v[92:95], a[208:211], a[68:71], v[92:95]
v_cvt_pk_bf16_f32 v37, v38, v39
v_mfma_f32_16x16x32_bf16 v[100:103], a[208:211], a[72:75], v[100:103]
v_cvt_pk_bf16_f32 v38, v68, v69
v_and_b32 v11, 3, v0
v_mfma_f32_16x16x32_bf16 v[108:111], a[208:211], a[76:79], v[108:111]
ds_read_b64_tr_b16 a[208:209], v249 offset:33888
v_cvt_pk_bf16_f32 v39, v70, v71
v_mfma_f32_16x16x32_bf16 v[108:111], a[212:215], a[92:95], v[108:111]
ds_read_b64_tr_b16 a[210:211], v249 offset:34144
v_cvt_pk_bf16_f32 v44, v44, v45
v_mfma_f32_16x16x32_bf16 v[100:103], a[212:215], a[88:91], v[100:103]
s_add_u32 s20, s20, 4096
s_add_u32 s93, s93, 4096
v_lshl_add_u32 v10, v11, 3, v10
v_cvt_pk_bf16_f32 v45, v46, v47
v_mfma_f32_16x16x32_bf16 v[92:95], a[212:215], a[84:87], v[92:95]
buffer_load_dwordx4 v[16:19], v251, s[76:79], s20 offen offset:0 sc1
v_cvt_pk_bf16_f32 v46, v76, v77
v_mfma_f32_16x16x32_bf16 v[84:87], a[212:215], a[80:83], v[84:87]
ds_read_b64_tr_b16 a[212:213], v249 offset:42336
v_cvt_pk_bf16_f32 v47, v78, v79
v_mfma_f32_16x16x32_bf16 v[84:87], a[216:219], a[96:99], v[84:87]
ds_read_b64_tr_b16 a[214:215], v249 offset:42592
s_lshr_b32 s88, s3, 1
s_cmp_eq_u32 s97, 0
s_cbranch_scc1 rekp_43
rekpb_44:
v_mfma_f32_16x16x32_bf16 v[92:95], a[216:219], a[100:103], v[92:95]
s_mul_i32 s88, s88, 8448
v_mfma_f32_16x16x32_bf16 v[100:103], a[216:219], a[104:107], v[100:103]
buffer_load_dwordx4 v[24:27], v251, s[76:79], s93 offen offset:0 sc1
v_add_u32 v244, s88, v10
v_mfma_f32_16x16x32_bf16 v[108:111], a[216:219], a[108:111], v[108:111]
ds_read_b64_tr_b16 a[216:217], v250 offset:96
s_add_u32 s30, s27, 16384
s_waitcnt lgkmcnt(13)
v_mfma_f32_16x16x32_bf16 v[108:111], a[220:223], a[124:127], v[108:111]
ds_read_b64_tr_b16 a[218:219], v250 offset:352
v_mfma_f32_16x16x32_bf16 v[100:103], a[220:223], a[120:123], v[100:103]
buffer_store_dwordx4 v[28:31], v251, s[76:79], s30 offen offset:0 sc1
v_mfma_f32_16x16x32_bf16 v[92:95], a[220:223], a[116:119], v[92:95]
buffer_load_dwordx4 v[32:35], v251, s[76:79], s20 offen offset:1024 sc1
v_add_u32 v245, 50688, v244
v_mfma_f32_16x16x32_bf16 v[84:87], a[220:223], a[112:115], v[84:87]
ds_read_b64_tr_b16 a[220:221], v250 offset:8544
v_add_u32 v246, 101376, v244
s_waitcnt lgkmcnt(8)
v_mfma_f32_16x16x32_bf16 v[116:119], a[192:195], a[0:3], v[116:119]
ds_read_b64_tr_b16 a[222:223], v250 offset:8800
v_mfma_f32_16x16x32_bf16 v[124:127], a[192:195], a[4:7], v[124:127]
buffer_load_dwordx4 v[40:43], v251, s[76:79], s93 offen offset:1024 sc1
v_mfma_f32_16x16x32_bf16 v[132:135], a[192:195], a[8:11], v[132:135]
v_mfma_f32_16x16x32_bf16 v[140:143], a[192:195], a[12:15], v[140:143]
ds_read_b64_tr_b16 a[192:193], v249 offset:128
v_mfma_f32_16x16x32_bf16 v[140:143], a[196:199], a[28:31], v[140:143]
ds_read_b64_tr_b16 a[194:195], v249 offset:384
v_mfma_f32_16x16x32_bf16 v[132:135], a[196:199], a[24:27], v[132:135]
buffer_load_dwordx4 v[48:51], v251, s[76:79], s20 offen offset:2048 sc1
v_mfma_f32_16x16x32_bf16 v[124:127], a[196:199], a[20:23], v[124:127]
v_mfma_f32_16x16x32_bf16 v[116:119], a[196:199], a[16:19], v[116:119]
ds_read_b64_tr_b16 a[196:197], v249 offset:8576
v_mfma_f32_16x16x32_bf16 v[116:119], a[200:203], a[32:35], v[116:119]
ds_read_b64_tr_b16 a[198:199], v249 offset:8832
v_mfma_f32_16x16x32_bf16 v[124:127], a[200:203], a[36:39], v[124:127]
v_mfma_f32_16x16x32_bf16 v[132:135], a[200:203], a[40:43], v[132:135]
buffer_load_dwordx4 v[56:59], v251, s[76:79], s93 offen offset:2048 sc1
v_mfma_f32_16x16x32_bf16 v[140:143], a[200:203], a[44:47], v[140:143]
ds_read_b64_tr_b16 a[200:201], v249 offset:17024
s_waitcnt lgkmcnt(13)
v_mfma_f32_16x16x32_bf16 v[140:143], a[204:207], a[60:63], v[140:143]
ds_read_b64_tr_b16 a[202:203], v249 offset:17280
v_mfma_f32_16x16x32_bf16 v[132:135], a[204:207], a[56:59], v[132:135]
s_add_u32 s30, s27, 32768
v_mfma_f32_16x16x32_bf16 v[124:127], a[204:207], a[52:55], v[124:127]
buffer_store_dwordx4 v[36:39], v251, s[76:79], s30 offen offset:0 sc1
v_mfma_f32_16x16x32_bf16 v[116:119], a[204:207], a[48:51], v[116:119]
ds_read_b64_tr_b16 a[204:205], v249 offset:25472
s_waitcnt lgkmcnt(8)
v_mfma_f32_16x16x32_bf16 v[116:119], a[208:211], a[64:67], v[116:119]
ds_read_b64_tr_b16 a[206:207], v249 offset:25728
v_mfma_f32_16x16x32_bf16 v[124:127], a[208:211], a[68:71], v[124:127]
buffer_load_dwordx4 v[64:67], v251, s[76:79], s20 offen offset:3072 sc1
v_mfma_f32_16x16x32_bf16 v[132:135], a[208:211], a[72:75], v[132:135]
v_mfma_f32_16x16x32_bf16 v[140:143], a[208:211], a[76:79], v[140:143]
ds_read_b64_tr_b16 a[208:209], v249 offset:33920
v_mfma_f32_16x16x32_bf16 v[140:143], a[212:215], a[92:95], v[140:143]
ds_read_b64_tr_b16 a[210:211], v249 offset:34176
v_mfma_f32_16x16x32_bf16 v[132:135], a[212:215], a[88:91], v[132:135]
buffer_load_dwordx4 v[72:75], v251, s[76:79], s93 offen offset:3072 sc1
v_mfma_f32_16x16x32_bf16 v[124:127], a[212:215], a[84:87], v[124:127]
v_mfma_f32_16x16x32_bf16 v[116:119], a[212:215], a[80:83], v[116:119]
ds_read_b64_tr_b16 a[212:213], v249 offset:42368
v_mfma_f32_16x16x32_bf16 v[116:119], a[216:219], a[96:99], v[116:119]
ds_read_b64_tr_b16 a[214:215], v249 offset:42624
v_mfma_f32_16x16x32_bf16 v[124:127], a[216:219], a[100:103], v[124:127]
s_add_u32 s20, s20, 4096
v_mfma_f32_16x16x32_bf16 v[132:135], a[216:219], a[104:107], v[132:135]
s_add_u32 s93, s93, 4096
buffer_load_dwordx4 v[80:83], v251, s[76:79], s20 offen offset:0 sc1
v_mfma_f32_16x16x32_bf16 v[140:143], a[216:219], a[108:111], v[140:143]
ds_read_b64_tr_b16 a[216:217], v250 offset:128
s_waitcnt lgkmcnt(13)
v_mfma_f32_16x16x32_bf16 v[140:143], a[220:223], a[124:127], v[140:143]
ds_read_b64_tr_b16 a[218:219], v250 offset:384
v_mfma_f32_16x16x32_bf16 v[132:135], a[220:223], a[120:123], v[132:135]
v_mfma_f32_16x16x32_bf16 v[124:127], a[220:223], a[116:119], v[124:127]
buffer_load_dwordx4 v[88:91], v251, s[76:79], s93 offen offset:0 sc1
s_add_u32 s30, s27, 49152
v_mfma_f32_16x16x32_bf16 v[116:119], a[220:223], a[112:115], v[116:119]
ds_read_b64_tr_b16 a[220:221], v250 offset:8576
buffer_store_dwordx4 v[44:47], v251, s[76:79], s30 offen offset:0 sc1
s_waitcnt lgkmcnt(8)
v_mfma_f32_16x16x32_bf16 v[144:147], a[192:195], a[0:3], v[144:147]
ds_read_b64_tr_b16 a[222:223], v250 offset:8832
v_mfma_f32_16x16x32_bf16 v[148:151], a[192:195], a[4:7], v[148:151]
v_mfma_f32_16x16x32_bf16 v[152:155], a[192:195], a[8:11], v[152:155]
v_mfma_f32_16x16x32_bf16 v[156:159], a[192:195], a[12:15], v[156:159]
ds_read_b64_tr_b16 a[192:193], v249 offset:160
v_mfma_f32_16x16x32_bf16 v[156:159], a[196:199], a[28:31], v[156:159]
ds_read_b64_tr_b16 a[194:195], v249 offset:416
v_mfma_f32_16x16x32_bf16 v[152:155], a[196:199], a[24:27], v[152:155]
buffer_load_dwordx4 v[96:99], v251, s[76:79], s20 offen offset:1024 sc1
v_mfma_f32_16x16x32_bf16 v[148:151], a[196:199], a[20:23], v[148:151]
v_cvt_pk_bf16_f32 v84, v84, v85
v_cvt_pk_bf16_f32 v85, v86, v87
v_mfma_f32_16x16x32_bf16 v[144:147], a[196:199], a[16:19], v[144:147]
ds_read_b64_tr_b16 a[196:197], v249 offset:8608
v_cvt_pk_bf16_f32 v86, v116, v117
v_mfma_f32_16x16x32_bf16 v[144:147], a[200:203], a[32:35], v[144:147]
ds_read_b64_tr_b16 a[198:199], v249 offset:8864
v_mfma_f32_16x16x32_bf16 v[148:151], a[200:203], a[36:39], v[148:151]
v_cvt_pk_bf16_f32 v87, v118, v119
v_mfma_f32_16x16x32_bf16 v[152:155], a[200:203], a[40:43], v[152:155]
buffer_load_dwordx4 v[104:107], v251, s[76:79], s93 offen offset:1024 sc1
v_cvt_pk_bf16_f32 v92, v92, v93
v_mfma_f32_16x16x32_bf16 v[156:159], a[200:203], a[44:47], v[156:159]
ds_read_b64_tr_b16 a[200:201], v249 offset:17056
v_cvt_pk_bf16_f32 v93, v94, v95
s_waitcnt lgkmcnt(13)
v_mfma_f32_16x16x32_bf16 v[156:159], a[204:207], a[60:63], v[156:159]
ds_read_b64_tr_b16 a[202:203], v249 offset:17312
v_mfma_f32_16x16x32_bf16 v[152:155], a[204:207], a[56:59], v[152:155]
v_cvt_pk_bf16_f32 v94, v124, v125
v_mfma_f32_16x16x32_bf16 v[148:151], a[204:207], a[52:55], v[148:151]
v_cvt_pk_bf16_f32 v95, v126, v127
v_cvt_pk_bf16_f32 v100, v100, v101
v_mfma_f32_16x16x32_bf16 v[144:147], a[204:207], a[48:51], v[144:147]
ds_read_b64_tr_b16 a[204:205], v249 offset:25504
buffer_load_dwordx4 v[112:115], v251, s[76:79], s20 offen offset:2048 sc1
s_waitcnt lgkmcnt(8)
v_mfma_f32_16x16x32_bf16 v[144:147], a[208:211], a[64:67], v[144:147]
ds_read_b64_tr_b16 a[206:207], v249 offset:25760
v_mfma_f32_16x16x32_bf16 v[148:151], a[208:211], a[68:71], v[148:151]
v_cvt_pk_bf16_f32 v101, v102, v103
v_mfma_f32_16x16x32_bf16 v[152:155], a[208:211], a[72:75], v[152:155]
v_cvt_pk_bf16_f32 v102, v132, v133
v_cvt_pk_bf16_f32 v103, v134, v135
v_mfma_f32_16x16x32_bf16 v[156:159], a[208:211], a[76:79], v[156:159]
ds_read_b64_tr_b16 a[208:209], v249 offset:33952
v_cvt_pk_bf16_f32 v108, v108, v109
v_mfma_f32_16x16x32_bf16 v[156:159], a[212:215], a[92:95], v[156:159]
ds_read_b64_tr_b16 a[210:211], v249 offset:34208
s_add_u32 s30, s27, 0
buffer_store_dwordx4 v[84:87], v251, s[76:79], s30 offen offset:1024 sc1
v_mfma_f32_16x16x32_bf16 v[152:155], a[212:215], a[88:91], v[152:155]
v_cvt_pk_bf16_f32 v109, v110, v111
v_mfma_f32_16x16x32_bf16 v[148:151], a[212:215], a[84:87], v[148:151]
buffer_load_dwordx4 v[120:123], v251, s[76:79], s93 offen offset:2048 sc1
v_cvt_pk_bf16_f32 v110, v140, v141
v_mfma_f32_16x16x32_bf16 v[144:147], a[212:215], a[80:83], v[144:147]
ds_read_b64_tr_b16 a[212:213], v249 offset:42400
v_cvt_pk_bf16_f32 v111, v142, v143
s_cmp_eq_u32 s97, 0
s_cbranch_scc1 rekp_45
rekpb_46:
v_mfma_f32_16x16x32_bf16 v[144:147], a[216:219], a[96:99], v[144:147]
ds_read_b64_tr_b16 a[214:215], v249 offset:42656
v_mfma_f32_16x16x32_bf16 v[148:151], a[216:219], a[100:103], v[148:151]
buffer_load_dwordx4 v[128:131], v251, s[76:79], s20 offen offset:3072 sc1
v_mfma_f32_16x16x32_bf16 v[152:155], a[216:219], a[104:107], v[152:155]
v_mfma_f32_16x16x32_bf16 v[156:159], a[216:219], a[108:111], v[156:159]
ds_read_b64_tr_b16 a[216:217], v250 offset:160
s_waitcnt lgkmcnt(13)
v_mfma_f32_16x16x32_bf16 v[156:159], a[220:223], a[124:127], v[156:159]
ds_read_b64_tr_b16 a[218:219], v250 offset:416
v_mfma_f32_16x16x32_bf16 v[152:155], a[220:223], a[120:123], v[152:155]
buffer_load_dwordx4 v[136:139], v251, s[76:79], s93 offen offset:3072 sc1
v_mfma_f32_16x16x32_bf16 v[148:151], a[220:223], a[116:119], v[148:151]
v_mfma_f32_16x16x32_bf16 v[144:147], a[220:223], a[112:115], v[144:147]
ds_read_b64_tr_b16 a[220:221], v250 offset:8608
s_waitcnt lgkmcnt(8)
v_mfma_f32_16x16x32_bf16 v[160:163], a[192:195], a[0:3], v[160:163]
ds_read_b64_tr_b16 a[222:223], v250 offset:8864
v_mfma_f32_16x16x32_bf16 v[164:167], a[192:195], a[4:7], v[164:167]
s_add_u32 s20, s20, 4096
v_mfma_f32_16x16x32_bf16 v[168:171], a[192:195], a[8:11], v[168:171]
s_add_u32 s93, s93, 4096
buffer_load_dwordx4 a[128:131], v251, s[76:79], s20 offen offset:0 sc1
v_mfma_f32_16x16x32_bf16 v[172:175], a[192:195], a[12:15], v[172:175]
ds_read_b64_tr_b16 a[192:193], v249 offset:192
s_add_u32 s30, s27, 16384
v_mfma_f32_16x16x32_bf16 v[172:175], a[196:199], a[28:31], v[172:175]
ds_read_b64_tr_b16 a[194:195], v249 offset:448
v_mfma_f32_16x16x32_bf16 v[168:171], a[196:199], a[24:27], v[168:171]
buffer_store_dwordx4 v[92:95], v251, s[76:79], s30 offen offset:1024 sc1
v_mfma_f32_16x16x32_bf16 v[164:167], a[196:199], a[20:23], v[164:167]
buffer_load_dwordx4 a[132:135], v251, s[76:79], s93 offen offset:0 sc1
v_mfma_f32_16x16x32_bf16 v[160:163], a[196:199], a[16:19], v[160:163]
ds_read_b64_tr_b16 a[196:197], v249 offset:8640
v_mfma_f32_16x16x32_bf16 v[160:163], a[200:203], a[32:35], v[160:163]
ds_read_b64_tr_b16 a[198:199], v249 offset:8896
v_mfma_f32_16x16x32_bf16 v[164:167], a[200:203], a[36:39], v[164:167]
v_mfma_f32_16x16x32_bf16 v[168:171], a[200:203], a[40:43], v[168:171]
v_mfma_f32_16x16x32_bf16 v[172:175], a[200:203], a[44:47], v[172:175]
ds_read_b64_tr_b16 a[200:201], v249 offset:17088
s_waitcnt lgkmcnt(13)
v_mfma_f32_16x16x32_bf16 v[172:175], a[204:207], a[60:63], v[172:175]
ds_read_b64_tr_b16 a[202:203], v249 offset:17344
v_mfma_f32_16x16x32_bf16 v[168:171], a[204:207], a[56:59], v[168:171]
buffer_load_dwordx4 a[136:139], v251, s[76:79], s20 offen offset:1024 sc1
v_mfma_f32_16x16x32_bf16 v[164:167], a[204:207], a[52:55], v[164:167]
v_mfma_f32_16x16x32_bf16 v[160:163], a[204:207], a[48:51], v[160:163]
ds_read_b64_tr_b16 a[204:205], v249 offset:25536
s_waitcnt lgkmcnt(8)
v_mfma_f32_16x16x32_bf16 v[160:163], a[208:211], a[64:67], v[160:163]
ds_read_b64_tr_b16 a[206:207], v249 offset:25792
v_mfma_f32_16x16x32_bf16 v[164:167], a[208:211], a[68:71], v[164:167]
buffer_load_dwordx4 a[140:143], v251, s[76:79], s93 offen offset:1024 sc1
v_mfma_f32_16x16x32_bf16 v[168:171], a[208:211], a[72:75], v[168:171]
v_mfma_f32_16x16x32_bf16 v[172:175], a[208:211], a[76:79], v[172:175]
ds_read_b64_tr_b16 a[208:209], v249 offset:33984
v_mfma_f32_16x16x32_bf16 v[172:175], a[212:215], a[92:95], v[172:175]
ds_read_b64_tr_b16 a[210:211], v249 offset:34240
v_mfma_f32_16x16x32_bf16 v[168:171], a[212:215], a[88:91], v[168:171]
buffer_load_dwordx4 a[144:147], v251, s[76:79], s20 offen offset:2048 sc1
v_mfma_f32_16x16x32_bf16 v[164:167], a[212:215], a[84:87], v[164:167]
s_add_u32 s30, s27, 32768
buffer_store_dwordx4 v[100:103], v251, s[76:79], s30 offen offset:1024 sc1
v_mfma_f32_16x16x32_bf16 v[160:163], a[212:215], a[80:83], v[160:163]
ds_read_b64_tr_b16 a[212:213], v249 offset:42432
v_mfma_f32_16x16x32_bf16 v[160:163], a[216:219], a[96:99], v[160:163]
ds_read_b64_tr_b16 a[214:215], v249 offset:42688
v_mfma_f32_16x16x32_bf16 v[164:167], a[216:219], a[100:103], v[164:167]
buffer_load_dwordx4 a[148:151], v251, s[76:79], s93 offen offset:2048 sc1
v_mfma_f32_16x16x32_bf16 v[168:171], a[216:219], a[104:107], v[168:171]
v_mfma_f32_16x16x32_bf16 v[172:175], a[216:219], a[108:111], v[172:175]
ds_read_b64_tr_b16 a[216:217], v250 offset:192
s_waitcnt lgkmcnt(13)
v_mfma_f32_16x16x32_bf16 v[172:175], a[220:223], a[124:127], v[172:175]
ds_read_b64_tr_b16 a[218:219], v250 offset:448
v_mfma_f32_16x16x32_bf16 v[168:171], a[220:223], a[120:123], v[168:171]
v_mfma_f32_16x16x32_bf16 v[164:167], a[220:223], a[116:119], v[164:167]
buffer_load_dwordx4 a[152:155], v251, s[76:79], s20 offen offset:3072 sc1
v_mfma_f32_16x16x32_bf16 v[160:163], a[220:223], a[112:115], v[160:163]
ds_read_b64_tr_b16 a[220:221], v250 offset:8640
s_waitcnt lgkmcnt(8)
v_mfma_f32_16x16x32_bf16 v[176:179], a[192:195], a[0:3], v[176:179]
ds_read_b64_tr_b16 a[222:223], v250 offset:8896
v_mfma_f32_16x16x32_bf16 v[180:183], a[192:195], a[4:7], v[180:183]
v_mfma_f32_16x16x32_bf16 v[184:187], a[192:195], a[8:11], v[184:187]
v_mfma_f32_16x16x32_bf16 v[188:191], a[192:195], a[12:15], v[188:191]
ds_read_b64_tr_b16 a[192:193], v249 offset:224
v_mfma_f32_16x16x32_bf16 v[188:191], a[196:199], a[28:31], v[188:191]
ds_read_b64_tr_b16 a[194:195], v249 offset:480
v_mfma_f32_16x16x32_bf16 v[184:187], a[196:199], a[24:27], v[184:187]
buffer_load_dwordx4 a[156:159], v251, s[76:79], s93 offen offset:3072 sc1
v_mfma_f32_16x16x32_bf16 v[180:183], a[196:199], a[20:23], v[180:183]
v_cvt_pk_bf16_f32 v144, v144, v145
v_cvt_pk_bf16_f32 v145, v146, v147
v_mfma_f32_16x16x32_bf16 v[176:179], a[196:199], a[16:19], v[176:179]
ds_read_b64_tr_b16 a[196:197], v249 offset:8672
v_cvt_pk_bf16_f32 v146, v160, v161
v_mfma_f32_16x16x32_bf16 v[176:179], a[200:203], a[32:35], v[176:179]
ds_read_b64_tr_b16 a[198:199], v249 offset:8928
v_mfma_f32_16x16x32_bf16 v[180:183], a[200:203], a[36:39], v[180:183]
s_add_u32 s30, s27, 49152
v_mfma_f32_16x16x32_bf16 v[184:187], a[200:203], a[40:43], v[184:187]
buffer_store_dwordx4 v[108:111], v251, s[76:79], s30 offen offset:1024 sc1
v_cvt_pk_bf16_f32 v147, v162, v163
v_mfma_f32_16x16x32_bf16 v[188:191], a[200:203], a[44:47], v[188:191]
ds_read_b64_tr_b16 a[200:201], v249 offset:17120
s_add_u32 s20, s20, 4096
s_waitcnt lgkmcnt(13)
v_mfma_f32_16x16x32_bf16 v[188:191], a[204:207], a[60:63], v[188:191]
ds_read_b64_tr_b16 a[202:203], v249 offset:17376
s_add_u32 s93, s93, 4096
v_cvt_pk_bf16_f32 v148, v148, v149
v_mfma_f32_16x16x32_bf16 v[184:187], a[204:207], a[56:59], v[184:187]
buffer_load_dwordx4 a[160:163], v251, s[76:79], s20 offen offset:0 sc1
v_cvt_pk_bf16_f32 v149, v150, v151
v_mfma_f32_16x16x32_bf16 v[180:183], a[204:207], a[52:55], v[180:183]
v_cvt_pk_bf16_f32 v150, v164, v165
v_cvt_pk_bf16_f32 v151, v166, v167
v_mfma_f32_16x16x32_bf16 v[176:179], a[204:207], a[48:51], v[176:179]
ds_read_b64_tr_b16 a[204:205], v249 offset:25568
v_cvt_pk_bf16_f32 v152, v152, v153
s_waitcnt lgkmcnt(8)
v_mfma_f32_16x16x32_bf16 v[176:179], a[208:211], a[64:67], v[176:179]
ds_read_b64_tr_b16 a[206:207], v249 offset:25824
v_mfma_f32_16x16x32_bf16 v[180:183], a[208:211], a[68:71], v[180:183]
v_cvt_pk_bf16_f32 v153, v154, v155
v_mfma_f32_16x16x32_bf16 v[184:187], a[208:211], a[72:75], v[184:187]
buffer_load_dwordx4 a[164:167], v251, s[76:79], s93 offen offset:0 sc1
v_cvt_pk_bf16_f32 v154, v168, v169
v_mfma_f32_16x16x32_bf16 v[188:191], a[208:211], a[76:79], v[188:191]
ds_read_b64_tr_b16 a[208:209], v249 offset:34016
v_cvt_pk_bf16_f32 v155, v170, v171
v_mfma_f32_16x16x32_bf16 v[188:191], a[212:215], a[92:95], v[188:191]
ds_read_b64_tr_b16 a[210:211], v249 offset:34272
v_cvt_pk_bf16_f32 v156, v156, v157
v_mfma_f32_16x16x32_bf16 v[184:187], a[212:215], a[88:91], v[184:187]
v_cvt_pk_bf16_f32 v157, v158, v159
v_mfma_f32_16x16x32_bf16 v[180:183], a[212:215], a[84:87], v[180:183]
v_cvt_pk_bf16_f32 v158, v172, v173
buffer_load_dwordx4 a[168:171], v251, s[76:79], s20 offen offset:1024 sc1
v_mfma_f32_16x16x32_bf16 v[176:179], a[212:215], a[80:83], v[176:179]
ds_read_b64_tr_b16 a[212:213], v249 offset:42464
v_cvt_pk_bf16_f32 v159, v174, v175
s_cmp_eq_u32 s97, 1
s_cbranch_scc1 rekp_47
rekpb_48:
v_mfma_f32_16x16x32_bf16 v[176:179], a[216:219], a[96:99], v[176:179]
ds_read_b64_tr_b16 a[214:215], v249 offset:42720
v_mfma_f32_16x16x32_bf16 v[180:183], a[216:219], a[100:103], v[180:183]
buffer_load_dwordx4 a[172:175], v251, s[76:79], s93 offen offset:1024 sc1
v_mfma_f32_16x16x32_bf16 v[184:187], a[216:219], a[104:107], v[184:187]
s_add_u32 s30, s98, 0
buffer_store_dwordx4 v[144:147], v251, s[76:79], s30 offen offset:2048 sc1
v_mfma_f32_16x16x32_bf16 v[188:191], a[216:219], a[108:111], v[188:191]
ds_read_b64_tr_b16 a[216:217], v250 offset:224
s_waitcnt lgkmcnt(13)
v_mfma_f32_16x16x32_bf16 v[188:191], a[220:223], a[124:127], v[188:191]
ds_read_b64_tr_b16 a[218:219], v250 offset:480
v_mfma_f32_16x16x32_bf16 v[184:187], a[220:223], a[120:123], v[184:187]
buffer_load_dwordx4 a[176:179], v251, s[76:79], s20 offen offset:2048 sc1
v_mfma_f32_16x16x32_bf16 v[180:183], a[220:223], a[116:119], v[180:183]
v_mfma_f32_16x16x32_bf16 v[176:179], a[220:223], a[112:115], v[176:179]
ds_read_b64_tr_b16 a[220:221], v250 offset:8672
s_waitcnt lgkmcnt(8)
v_mfma_f32_16x16x32_bf16 v[192:195], a[192:195], a[0:3], v[192:195]
ds_read_b64_tr_b16 a[222:223], v250 offset:8928
v_mfma_f32_16x16x32_bf16 v[196:199], a[192:195], a[4:7], v[196:199]
buffer_load_dwordx4 a[180:183], v251, s[76:79], s93 offen offset:2048 sc1
v_mfma_f32_16x16x32_bf16 v[200:203], a[192:195], a[8:11], v[200:203]
v_mfma_f32_16x16x32_bf16 v[204:207], a[192:195], a[12:15], v[204:207]
v_mfma_f32_16x16x32_bf16 v[204:207], a[196:199], a[28:31], v[204:207]
v_mfma_f32_16x16x32_bf16 v[200:203], a[196:199], a[24:27], v[200:203]
v_mfma_f32_16x16x32_bf16 v[196:199], a[196:199], a[20:23], v[196:199]
buffer_load_dwordx4 a[184:187], v251, s[76:79], s20 offen offset:3072 sc1
v_mfma_f32_16x16x32_bf16 v[192:195], a[196:199], a[16:19], v[192:195]
v_mfma_f32_16x16x32_bf16 v[192:195], a[200:203], a[32:35], v[192:195]
v_mfma_f32_16x16x32_bf16 v[196:199], a[200:203], a[36:39], v[196:199]
v_mfma_f32_16x16x32_bf16 v[200:203], a[200:203], a[40:43], v[200:203]
s_add_u32 s30, s98, 16384
v_mfma_f32_16x16x32_bf16 v[204:207], a[200:203], a[44:47], v[204:207]
buffer_store_dwordx4 v[148:151], v251, s[76:79], s30 offen offset:2048 sc1
s_waitcnt lgkmcnt(8)
v_mfma_f32_16x16x32_bf16 v[204:207], a[204:207], a[60:63], v[204:207]
buffer_load_dwordx4 a[188:191], v251, s[76:79], s93 offen offset:3072 sc1
v_mfma_f32_16x16x32_bf16 v[200:203], a[204:207], a[56:59], v[200:203]
v_mfma_f32_16x16x32_bf16 v[196:199], a[204:207], a[52:55], v[196:199]
v_mfma_f32_16x16x32_bf16 v[192:195], a[204:207], a[48:51], v[192:195]
s_waitcnt lgkmcnt(0)
s_barrier
v_mfma_f32_16x16x32_bf16 v[192:195], a[208:211], a[64:67], v[192:195]
v_mfma_f32_16x16x32_bf16 v[196:199], a[208:211], a[68:71], v[196:199]
v_mfma_f32_16x16x32_bf16 v[200:203], a[208:211], a[72:75], v[200:203]
v_mfma_f32_16x16x32_bf16 v[204:207], a[208:211], a[76:79], v[204:207]
v_mfma_f32_16x16x32_bf16 v[204:207], a[212:215], a[92:95], v[204:207]
v_mfma_f32_16x16x32_bf16 v[200:203], a[212:215], a[88:91], v[200:203]
v_mfma_f32_16x16x32_bf16 v[196:199], a[212:215], a[84:87], v[196:199]
v_mfma_f32_16x16x32_bf16 v[192:195], a[212:215], a[80:83], v[192:195]
v_mfma_f32_16x16x32_bf16 v[192:195], a[216:219], a[96:99], v[192:195]
v_mfma_f32_16x16x32_bf16 v[196:199], a[216:219], a[100:103], v[196:199]
v_mfma_f32_16x16x32_bf16 v[200:203], a[216:219], a[104:107], v[200:203]
v_mfma_f32_16x16x32_bf16 v[204:207], a[216:219], a[108:111], v[204:207]
v_mfma_f32_16x16x32_bf16 v[204:207], a[220:223], a[124:127], v[204:207]
s_add_u32 s30, s98, 32768
v_mfma_f32_16x16x32_bf16 v[200:203], a[220:223], a[120:123], v[200:203]
buffer_store_dwordx4 v[152:155], v251, s[76:79], s30 offen offset:2048 sc1
v_mfma_f32_16x16x32_bf16 v[196:199], a[220:223], a[116:119], v[196:199]
v_mfma_f32_16x16x32_bf16 v[192:195], a[220:223], a[112:115], v[192:195]
s_load_dwordx2 s[72:73], s[0:1], 80
v_cvt_pk_bf16_f32 v176, v176, v177
v_cvt_pk_bf16_f32 v177, v178, v179
s_nop 4
v_cvt_pk_bf16_f32 v178, v192, v193
v_cvt_pk_bf16_f32 v179, v194, v195
v_cvt_pk_bf16_f32 v180, v180, v181
v_cvt_pk_bf16_f32 v181, v182, v183
v_cvt_pk_bf16_f32 v182, v196, v197
v_cvt_pk_bf16_f32 v183, v198, v199
v_cvt_pk_bf16_f32 v184, v184, v185
v_cvt_pk_bf16_f32 v185, v186, v187
v_cvt_pk_bf16_f32 v186, v200, v201
v_cvt_pk_bf16_f32 v187, v202, v203
v_cvt_pk_bf16_f32 v188, v188, v189
v_cvt_pk_bf16_f32 v189, v190, v191
v_cvt_pk_bf16_f32 v190, v204, v205
v_cvt_pk_bf16_f32 v191, v206, v207
s_cmp_eq_u32 s97, 1
s_cbranch_scc1 rekp_49
rekpb_50:
s_waitcnt lgkmcnt(0)
s_branch recurrent_scan__sliding_block_cached__mixer_s_mlp__prompt_kernel_fin
recurrent_scan__sliding_block_cached__mixer_s_mlp__prompt_kernel_c:
v_mfma_f32_16x16x32_bf16 v[168:171], a[192:195], a[176:179], 0
ds_read_b128 a[192:195], v1 offset:8704
v_mov_b32 v14, s8
s_lshl_b32 s100, s2, 5
s_add_u32 s100, s100, s3
s_lshl_b32 s100, s100, 2
s_add_u32 s100, s100, 131072
s_waitcnt vmcnt(0)
s_mov_b64 exec, 1
buffer_store_dword v14, off, s[76:79], s100 sc1
s_mov_b64 exec, -1
v_mfma_f32_16x16x32_bf16 v[168:171], a[196:199], a[180:183], v[168:171]
ds_read_b128 a[196:199], v1 offset:8768
v_mfma_f32_16x16x32_bf16 v[168:171], a[200:203], a[184:187], v[168:171]
ds_read_b128 a[200:203], v1 offset:8832
v_mfma_f32_16x16x32_bf16 v[168:171], a[204:207], a[188:191], v[168:171]
ds_read_b128 a[204:207], v1 offset:8896
v_mfma_f32_16x16x32_bf16 v[172:175], a[208:211], a[176:179], 0
ds_read_b128 a[208:211], v1 offset:13056
v_mfma_f32_16x16x32_bf16 v[172:175], a[212:215], a[180:183], v[172:175]
ds_read_b128 a[212:215], v1 offset:13120
v_mfma_f32_16x16x32_bf16 v[172:175], a[216:219], a[184:187], v[172:175]
ds_read_b128 a[216:219], v1 offset:13184
v_mfma_f32_16x16x32_bf16 v[172:175], a[220:223], a[188:191], v[172:175]
ds_read_b128 a[220:223], v1 offset:13248
s_waitcnt lgkmcnt(7)
v_mfma_f32_16x16x32_bf16 v[176:179], a[192:195], a[128:131], 0
v_exp_f32 v144, v144
v_mfma_f32_16x16x32_bf16 v[184:187], a[192:195], a[144:147], 0
v_exp_f32 v145, v145
v_mfma_f32_16x16x32_bf16 v[192:195], a[192:195], a[160:163], 0
v_cvt_pk_bf16_f32 v208, v144, v145
v_exp_f32 v146, v146
v_mfma_f32_16x16x32_bf16 v[200:203], a[192:195], a[176:179], 0
s_waitcnt lgkmcnt(0)
s_barrier
ds_read_b128 a[192:195], v1 offset:34816
v_exp_f32 v147, v147
v_mfma_f32_16x16x32_bf16 v[200:203], a[196:199], a[180:183], v[200:203]
v_cvt_pk_bf16_f32 v209, v146, v147
v_exp_f32 v148, v148
v_mfma_f32_16x16x32_bf16 v[192:195], a[196:199], a[164:167], v[192:195]
s_add_u32 m0, s99, 103424
s_add_u32 s95, s94, 32768
v_exp_f32 v149, v149
v_mfma_f32_16x16x32_bf16 v[184:187], a[196:199], a[148:151], v[184:187]
buffer_load_dwordx4 v4, s[40:43], s95 offen offset:0 lds
v_cvt_pk_bf16_f32 v210, v148, v149
v_exp_f32 v150, v150
v_mfma_f32_16x16x32_bf16 v[176:179], a[196:199], a[132:135], v[176:179]
ds_read_b128 a[196:199], v1 offset:34880
v_exp_f32 v151, v151
v_mfma_f32_16x16x32_bf16 v[176:179], a[200:203], a[136:139], v[176:179]
v_cvt_pk_bf16_f32 v211, v150, v151
v_exp_f32 v152, v152
v_mfma_f32_16x16x32_bf16 v[184:187], a[200:203], a[152:155], v[184:187]
buffer_load_dwordx4 v5, s[40:43], s95 offen offset:1088 lds
v_exp_f32 v153, v153
v_mfma_f32_16x16x32_bf16 v[192:195], a[200:203], a[168:171], v[192:195]
v_cvt_pk_bf16_f32 v212, v152, v153
v_exp_f32 v154, v154
v_mfma_f32_16x16x32_bf16 v[200:203], a[200:203], a[184:187], v[200:203]
ds_read_b128 a[200:203], v1 offset:34944
buffer_load_dwordx4 v6, s[40:43], s95 offen offset:2176 lds
v_exp_f32 v155, v155
v_mfma_f32_16x16x32_bf16 v[200:203], a[204:207], a[188:191], v[200:203]
v_cvt_pk_bf16_f32 v213, v154, v155
v_exp_f32 v156, v156
v_mfma_f32_16x16x32_bf16 v[192:195], a[204:207], a[172:175], v[192:195]
v_exp_f32 v157, v157
v_mfma_f32_16x16x32_bf16 v[184:187], a[204:207], a[156:159], v[184:187]
buffer_load_dwordx4 v7, s[40:43], s95 offen offset:3264 lds
v_cvt_pk_bf16_f32 v214, v156, v157
v_exp_f32 v158, v158
v_mfma_f32_16x16x32_bf16 v[176:179], a[204:207], a[140:143], v[176:179]
ds_read_b128 a[204:207], v1 offset:35008
v_exp_f32 v159, v159
v_mfma_f32_16x16x32_bf16 v[180:183], a[208:211], a[128:131], 0
v_cvt_pk_bf16_f32 v215, v158, v159
v_exp_f32 v160, v160
v_mfma_f32_16x16x32_bf16 v[188:191], a[208:211], a[144:147], 0
v_exp_f32 v161, v161
v_mfma_f32_16x16x32_bf16 v[196:199], a[208:211], a[160:163], 0
s_add_u32 m0, s96, 86016
v_cvt_pk_bf16_f32 v216, v160, v161
v_exp_f32 v162, v162
v_mfma_f32_16x16x32_bf16 v[204:207], a[208:211], a[176:179], 0
ds_read_b128 a[208:211], v1 offset:39168
s_add_u32 s95, s94, 16384
v_exp_f32 v163, v163
v_mfma_f32_16x16x32_bf16 v[204:207], a[212:215], a[180:183], v[204:207]
buffer_load_dwordx4 v8, s[44:47], s95 offen offset:0 lds
v_cvt_pk_bf16_f32 v217, v162, v163
v_exp_f32 v164, v164
v_mfma_f32_16x16x32_bf16 v[196:199], a[212:215], a[164:167], v[196:199]
v_exp_f32 v165, v165
v_mfma_f32_16x16x32_bf16 v[188:191], a[212:215], a[148:151], v[188:191]
buffer_load_dwordx4 v9, s[44:47], s95 offen offset:1056 lds
v_cvt_pk_bf16_f32 v218, v164, v165
v_exp_f32 v166, v166
v_mfma_f32_16x16x32_bf16 v[180:183], a[212:215], a[132:135], v[180:183]
ds_read_b128 a[212:215], v1 offset:39232
v_exp_f32 v167, v167
v_mfma_f32_16x16x32_bf16 v[180:183], a[216:219], a[136:139], v[180:183]
v_cvt_pk_bf16_f32 v219, v166, v167
v_exp_f32 v168, v168
v_mfma_f32_16x16x32_bf16 v[188:191], a[216:219], a[152:155], v[188:191]
buffer_load_dwordx4 v10, s[44:47], s95 offen offset:2112 lds
v_exp_f32 v169, v169
v_mfma_f32_16x16x32_bf16 v[196:199], a[216:219], a[168:171], v[196:199]
v_cvt_pk_bf16_f32 v220, v168, v169
v_exp_f32 v170, v170
v_mfma_f32_16x16x32_bf16 v[204:207], a[216:219], a[184:187], v[204:207]
ds_read_b128 a[216:219], v1 offset:39296
v_exp_f32 v171, v171
v_mfma_f32_16x16x32_bf16 v[204:207], a[220:223], a[188:191], v[204:207]
v_cvt_pk_bf16_f32 v221, v170, v171
v_exp_f32 v172, v172
v_mfma_f32_16x16x32_bf16 v[196:199], a[220:223], a[172:175], v[196:199]
buffer_load_dwordx4 v11, s[44:47], s95 offen offset:3168 lds
v_exp_f32 v173, v173
v_mfma_f32_16x16x32_bf16 v[188:191], a[220:223], a[156:159], v[188:191]
v_cvt_pk_bf16_f32 v222, v172, v173
v_exp_f32 v174, v174
v_mfma_f32_16x16x32_bf16 v[180:183], a[220:223], a[140:143], v[180:183]
ds_read_b128 a[220:223], v1 offset:39360
v_exp_f32 v175, v175
s_nop 0
v_cvt_pk_bf16_f32 v223, v174, v175
s_waitcnt lgkmcnt(0)
v_mfma_f32_16x16x32_bf16 v[144:147], a[192:195], a[128:131], 0
v_exp_f32 v176, v176
v_mfma_f32_16x16x32_bf16 v[152:155], a[192:195], a[144:147], 0
ds_read_b64_tr_b16 a[224:225], v3 offset:34816
s_lshl_b32 s88, s3, 6
v_add_u32 v252, s88, v0
v_mfma_f32_16x16x32_bf16 v[160:163], a[192:195], a[160:163], 0
v_exp_f32 v177, v177
v_mfma_f32_16x16x32_bf16 v[168:171], a[192:195], a[176:179], 0
ds_read_b64_tr_b16 a[226:227], v3 offset:35328
v_lshlrev_b32 v252, 3, v252
v_cvt_pk_bf16_f32 v224, v176, v177
v_mfma_f32_16x16x32_bf16 v[168:171], a[196:199], a[180:183], v[168:171]
v_exp_f32 v178, v178
v_mfma_f32_16x16x32_bf16 v[160:163], a[196:199], a[164:167], v[160:163]
ds_read_b64_tr_b16 a[228:229], v3 offset:34848
s_lshl_b32 s88, s4, 11
v_mfma_f32_16x16x32_bf16 v[152:155], a[196:199], a[148:151], v[152:155]
s_add_u32 s88, s88, s94
v_exp_f32 v179, v179
v_mfma_f32_16x16x32_bf16 v[144:147], a[196:199], a[132:135], v[144:147]
ds_read_b64_tr_b16 a[230:231], v3 offset:35360
s_add_u32 s88, s88, 458752
v_cvt_pk_bf16_f32 v225, v178, v179
v_mfma_f32_16x16x32_bf16 v[144:147], a[200:203], a[136:139], v[144:147]
v_exp_f32 v180, v180
v_mfma_f32_16x16x32_bf16 v[152:155], a[200:203], a[152:155], v[152:155]
ds_read_b64_tr_b16 a[232:233], v3 offset:34880
buffer_load_dword v253, v252, s[40:43], s88 offen
v_mfma_f32_16x16x32_bf16 v[160:163], a[200:203], a[168:171], v[160:163]
v_exp_f32 v181, v181
v_mfma_f32_16x16x32_bf16 v[168:171], a[200:203], a[184:187], v[168:171]
ds_read_b64_tr_b16 a[234:235], v3 offset:35392
v_cvt_pk_bf16_f32 v226, v180, v181
v_mfma_f32_16x16x32_bf16 v[168:171], a[204:207], a[188:191], v[168:171]
v_exp_f32 v182, v182
v_mfma_f32_16x16x32_bf16 v[160:163], a[204:207], a[172:175], v[160:163]
ds_read_b64_tr_b16 a[236:237], v3 offset:34912
v_mfma_f32_16x16x32_bf16 v[152:155], a[204:207], a[156:159], v[152:155]
v_exp_f32 v183, v183
v_mfma_f32_16x16x32_bf16 v[144:147], a[204:207], a[140:143], v[144:147]
ds_read_b64_tr_b16 a[238:239], v3 offset:35424
v_cvt_pk_bf16_f32 v227, v182, v183
v_mfma_f32_16x16x32_bf16 v[148:151], a[208:211], a[128:131], 0
v_mfma_f32_16x16x32_bf16 v[156:159], a[208:211], a[144:147], 0
v_exp_f32 v184, v184
v_mfma_f32_16x16x32_bf16 v[164:167], a[208:211], a[160:163], 0
ds_read_b64_tr_b16 a[240:241], v3 offset:34944
v_mfma_f32_16x16x32_bf16 v[172:175], a[208:211], a[176:179], 0
v_exp_f32 v185, v185
v_mfma_f32_16x16x32_bf16 v[172:175], a[212:215], a[180:183], v[172:175]
ds_read_b64_tr_b16 a[242:243], v3 offset:35456
v_cvt_pk_bf16_f32 v228, v184, v185
v_mfma_f32_16x16x32_bf16 v[164:167], a[212:215], a[164:167], v[164:167]
v_exp_f32 v186, v186
v_mfma_f32_16x16x32_bf16 v[156:159], a[212:215], a[148:151], v[156:159]
ds_read_b64_tr_b16 a[244:245], v3 offset:34976
buffer_load_dword v253, v252, s[44:47], s88 offen
v_mfma_f32_16x16x32_bf16 v[148:151], a[212:215], a[132:135], v[148:151]
v_exp_f32 v187, v187
v_mfma_f32_16x16x32_bf16 v[148:151], a[216:219], a[136:139], v[148:151]
ds_read_b64_tr_b16 a[246:247], v3 offset:35488
v_cvt_pk_bf16_f32 v229, v186, v187
v_mfma_f32_16x16x32_bf16 v[156:159], a[216:219], a[152:155], v[156:159]
v_exp_f32 v188, v188
v_mfma_f32_16x16x32_bf16 v[164:167], a[216:219], a[168:171], v[164:167]
ds_read_b64_tr_b16 a[248:249], v3 offset:35008
v_mfma_f32_16x16x32_bf16 v[172:175], a[216:219], a[184:187], v[172:175]
v_exp_f32 v189, v189
v_mfma_f32_16x16x32_bf16 v[172:175], a[220:223], a[188:191], v[172:175]
ds_read_b64_tr_b16 a[250:251], v3 offset:35520
v_cvt_pk_bf16_f32 v230, v188, v189
v_mfma_f32_16x16x32_bf16 v[164:167], a[220:223], a[172:175], v[164:167]
v_exp_f32 v190, v190
v_mfma_f32_16x16x32_bf16 v[156:159], a[220:223], a[156:159], v[156:159]
ds_read_b64_tr_b16 a[252:253], v3 offset:35040
v_mfma_f32_16x16x32_bf16 v[148:151], a[220:223], a[140:143], v[148:151]
v_exp_f32 v191, v191
s_waitcnt lgkmcnt(7)
v_mfma_f32_16x16x32_bf16 v[16:19], a[224:227], v[208:211], 0
ds_read_b64_tr_b16 a[254:255], v3 offset:35552
v_cvt_pk_bf16_f32 v231, v190, v191
v_mfma_f32_16x16x32_bf16 v[24:27], a[224:227], v[212:215], 0
v_mfma_f32_16x16x32_bf16 v[32:35], a[224:227], v[216:219], 0
v_exp_f32 v192, v192
v_mfma_f32_16x16x32_bf16 v[40:43], a[224:227], v[220:223], 0
s_lshl_b32 s88, s3, 6
v_mfma_f32_16x16x32_bf16 v[44:47], a[228:231], v[220:223], 0
v_exp_f32 v193, v193
v_mfma_f32_16x16x32_bf16 v[36:39], a[228:231], v[216:219], 0
v_add_u32 v252, s88, v0
v_cvt_pk_bf16_f32 v232, v192, v193
v_mfma_f32_16x16x32_bf16 v[28:31], a[228:231], v[212:215], 0
v_exp_f32 v194, v194
v_mfma_f32_16x16x32_bf16 v[20:23], a[228:231], v[208:211], 0
v_lshlrev_b32 v252, 5, v252
v_mfma_f32_16x16x32_bf16 v[48:51], a[232:235], v[208:211], 0
s_mul_i32 s88, s2, 5504
v_exp_f32 v195, v195
v_mfma_f32_16x16x32_bf16 v[56:59], a[232:235], v[212:215], 0
s_waitcnt lgkmcnt(0)
buffer_load_dword v253, v252, s[64:67], s88 offen
v_cvt_pk_bf16_f32 v233, v194, v195
v_mfma_f32_16x16x32_bf16 v[64:67], a[232:235], v[216:219], 0
v_exp_f32 v196, v196
v_mfma_f32_16x16x32_bf16 v[72:75], a[232:235], v[220:223], 0
ds_read_b128 a[192:195], v1 offset:43520
v_mfma_f32_16x16x32_bf16 v[76:79], a[236:239], v[220:223], 0
v_exp_f32 v197, v197
v_mfma_f32_16x16x32_bf16 v[68:71], a[236:239], v[216:219], 0
ds_read_b128 a[196:199], v1 offset:43584
v_cvt_pk_bf16_f32 v234, v196, v197
v_mfma_f32_16x16x32_bf16 v[60:63], a[236:239], v[212:215], 0
v_exp_f32 v198, v198
v_mfma_f32_16x16x32_bf16 v[52:55], a[236:239], v[208:211], 0
ds_read_b128 a[200:203], v1 offset:43648
v_mfma_f32_16x16x32_bf16 v[80:83], a[240:243], v[208:211], 0
v_exp_f32 v199, v199
v_mfma_f32_16x16x32_bf16 v[88:91], a[240:243], v[212:215], 0
ds_read_b128 a[204:207], v1 offset:43712
v_cvt_pk_bf16_f32 v235, v198, v199
v_mfma_f32_16x16x32_bf16 v[96:99], a[240:243], v[216:219], 0
v_mfma_f32_16x16x32_bf16 v[104:107], a[240:243], v[220:223], 0
v_exp_f32 v200, v200
v_mfma_f32_16x16x32_bf16 v[108:111], a[244:247], v[220:223], 0
ds_read_b128 a[208:211], v1 offset:47872
v_mfma_f32_16x16x32_bf16 v[100:103], a[244:247], v[216:219], 0
v_exp_f32 v201, v201
v_mfma_f32_16x16x32_bf16 v[92:95], a[244:247], v[212:215], 0
ds_read_b128 a[212:215], v1 offset:47936
buffer_load_dword v253, v252, s[68:71], s88 offen offset:128
v_cvt_pk_bf16_f32 v236, v200, v201
v_mfma_f32_16x16x32_bf16 v[84:87], a[244:247], v[208:211], 0
v_exp_f32 v202, v202
v_mfma_f32_16x16x32_bf16 v[112:115], a[248:251], v[208:211], 0
ds_read_b128 a[216:219], v1 offset:48000
v_mfma_f32_16x16x32_bf16 v[120:123], a[248:251], v[212:215], 0
v_exp_f32 v203, v203
v_mfma_f32_16x16x32_bf16 v[128:131], a[248:251], v[216:219], 0
ds_read_b128 a[220:223], v1 offset:48064
v_cvt_pk_bf16_f32 v237, v202, v203
v_mfma_f32_16x16x32_bf16 v[136:139], a[248:251], v[220:223], 0
v_exp_f32 v204, v204
v_mfma_f32_16x16x32_bf16 v[140:143], a[252:255], v[220:223], 0
v_mfma_f32_16x16x32_bf16 v[132:135], a[252:255], v[216:219], 0
v_exp_f32 v205, v205
v_mfma_f32_16x16x32_bf16 v[124:127], a[252:255], v[212:215], 0
v_cvt_pk_bf16_f32 v238, v204, v205
v_mfma_f32_16x16x32_bf16 v[116:119], a[252:255], v[208:211], 0
v_exp_f32 v206, v206
v_mfma_f32_16x16x32_bf16 a[108:111], a[124:127], v[208:211], 0
v_mfma_f32_16x16x32_bf16 a[112:115], a[124:127], v[212:215], 0
v_exp_f32 v207, v207
v_mfma_f32_16x16x32_bf16 a[116:119], a[124:127], v[216:219], 0
v_cvt_pk_bf16_f32 v239, v206, v207
v_mfma_f32_16x16x32_bf16 a[120:123], a[124:127], v[220:223], 0
s_waitcnt lgkmcnt(0)
v_mfma_f32_16x16x32_bf16 v[176:179], a[192:195], a[128:131], 0
v_exp_f32 v144, v144
v_mfma_f32_16x16x32_bf16 v[184:187], a[192:195], a[144:147], 0
ds_read_b64_tr_b16 a[224:225], v3 offset:43264
v_mfma_f32_16x16x32_bf16 v[192:195], a[192:195], a[160:163], 0
v_exp_f32 v145, v145
v_mfma_f32_16x16x32_bf16 v[200:203], a[192:195], a[176:179], 0
ds_read_b64_tr_b16 a[226:227], v3 offset:43776
v_cvt_pk_bf16_f32 v208, v144, v145
v_mfma_f32_16x16x32_bf16 v[200:203], a[196:199], a[180:183], v[200:203]
v_exp_f32 v146, v146
v_mfma_f32_16x16x32_bf16 v[192:195], a[196:199], a[164:167], v[192:195]
ds_read_b64_tr_b16 a[228:229], v3 offset:43296
v_mfma_f32_16x16x32_bf16 v[184:187], a[196:199], a[148:151], v[184:187]
v_exp_f32 v147, v147
v_mfma_f32_16x16x32_bf16 v[176:179], a[196:199], a[132:135], v[176:179]
ds_read_b64_tr_b16 a[230:231], v3 offset:43808
v_cvt_pk_bf16_f32 v209, v146, v147
v_mfma_f32_16x16x32_bf16 v[176:179], a[200:203], a[136:139], v[176:179]
v_exp_f32 v148, v148
v_mfma_f32_16x16x32_bf16 v[184:187], a[200:203], a[152:155], v[184:187]
ds_read_b64_tr_b16 a[232:233], v3 offset:43328
v_mfma_f32_16x16x32_bf16 v[192:195], a[200:203], a[168:171], v[192:195]
v_exp_f32 v149, v149
v_mfma_f32_16x16x32_bf16 v[200:203], a[200:203], a[184:187], v[200:203]
ds_read_b64_tr_b16 a[234:235], v3 offset:43840
v_cvt_pk_bf16_f32 v210, v148, v149
v_mfma_f32_16x16x32_bf16 v[200:203], a[204:207], a[188:191], v[200:203]
v_exp_f32 v150, v150
v_mfma_f32_16x16x32_bf16 v[192:195], a[204:207], a[172:175], v[192:195]
ds_read_b64_tr_b16 a[236:237], v3 offset:43360
v_mfma_f32_16x16x32_bf16 v[184:187], a[204:207], a[156:159], v[184:187]
v_exp_f32 v151, v151
v_mfma_f32_16x16x32_bf16 v[176:179], a[204:207], a[140:143], v[176:179]
ds_read_b64_tr_b16 a[238:239], v3 offset:43872
v_cvt_pk_bf16_f32 v211, v150, v151
v_mfma_f32_16x16x32_bf16 v[180:183], a[208:211], a[128:131], 0
v_mfma_f32_16x16x32_bf16 v[188:191], a[208:211], a[144:147], 0
v_exp_f32 v152, v152
v_mfma_f32_16x16x32_bf16 v[196:199], a[208:211], a[160:163], 0
ds_read_b64_tr_b16 a[240:241], v3 offset:43392
v_mfma_f32_16x16x32_bf16 v[204:207], a[208:211], a[176:179], 0
v_exp_f32 v153, v153
v_mfma_f32_16x16x32_bf16 v[204:207], a[212:215], a[180:183], v[204:207]
ds_read_b64_tr_b16 a[242:243], v3 offset:43904
v_cvt_pk_bf16_f32 v212, v152, v153
v_mfma_f32_16x16x32_bf16 v[196:199], a[212:215], a[164:167], v[196:199]
v_exp_f32 v154, v154
v_mfma_f32_16x16x32_bf16 v[188:191], a[212:215], a[148:151], v[188:191]
ds_read_b64_tr_b16 a[244:245], v3 offset:43424
v_mfma_f32_16x16x32_bf16 v[180:183], a[212:215], a[132:135], v[180:183]
v_exp_f32 v155, v155
v_mfma_f32_16x16x32_bf16 v[180:183], a[216:219], a[136:139], v[180:183]
ds_read_b64_tr_b16 a[246:247], v3 offset:43936
v_cvt_pk_bf16_f32 v213, v154, v155
v_mfma_f32_16x16x32_bf16 v[188:191], a[216:219], a[152:155], v[188:191]
v_exp_f32 v156, v156
v_mfma_f32_16x16x32_bf16 v[196:199], a[216:219], a[168:171], v[196:199]
ds_read_b64_tr_b16 a[248:249], v3 offset:43456
v_mfma_f32_16x16x32_bf16 v[204:207], a[216:219], a[184:187], v[204:207]
v_exp_f32 v157, v157
v_mfma_f32_16x16x32_bf16 v[204:207], a[220:223], a[188:191], v[204:207]
ds_read_b64_tr_b16 a[250:251], v3 offset:43968
v_cvt_pk_bf16_f32 v214, v156, v157
v_mfma_f32_16x16x32_bf16 v[196:199], a[220:223], a[172:175], v[196:199]
v_exp_f32 v158, v158
v_mfma_f32_16x16x32_bf16 v[188:191], a[220:223], a[156:159], v[188:191]
ds_read_b64_tr_b16 a[252:253], v3 offset:43488
v_mfma_f32_16x16x32_bf16 v[180:183], a[220:223], a[140:143], v[180:183]
v_exp_f32 v159, v159
s_waitcnt lgkmcnt(7)
v_mfma_f32_16x16x32_bf16 v[16:19], a[224:227], v[224:227], v[16:19]
ds_read_b64_tr_b16 a[254:255], v3 offset:44000
v_cvt_pk_bf16_f32 v215, v158, v159
v_mfma_f32_16x16x32_bf16 v[24:27], a[224:227], v[228:231], v[24:27]
v_mfma_f32_16x16x32_bf16 v[32:35], a[224:227], v[232:235], v[32:35]
v_exp_f32 v160, v160
v_mfma_f32_16x16x32_bf16 v[40:43], a[224:227], v[236:239], v[40:43]
v_mfma_f32_16x16x32_bf16 v[44:47], a[228:231], v[236:239], v[44:47]
v_exp_f32 v161, v161
v_mfma_f32_16x16x32_bf16 v[36:39], a[228:231], v[232:235], v[36:39]
v_cvt_pk_bf16_f32 v216, v160, v161
v_mfma_f32_16x16x32_bf16 v[28:31], a[228:231], v[228:231], v[28:31]
v_exp_f32 v162, v162
v_mfma_f32_16x16x32_bf16 v[20:23], a[228:231], v[224:227], v[20:23]
v_mfma_f32_16x16x32_bf16 v[48:51], a[232:235], v[224:227], v[48:51]
v_exp_f32 v163, v163
v_mfma_f32_16x16x32_bf16 v[56:59], a[232:235], v[228:231], v[56:59]
s_waitcnt vmcnt(4) lgkmcnt(0)
s_barrier
v_cvt_pk_bf16_f32 v217, v162, v163
v_mfma_f32_16x16x32_bf16 v[64:67], a[232:235], v[232:235], v[64:67]
v_exp_f32 v164, v164
v_mfma_f32_16x16x32_bf16 v[72:75], a[232:235], v[236:239], v[72:75]
ds_read_b128 a[192:195], v1 offset:0
v_mfma_f32_16x16x32_bf16 v[76:79], a[236:239], v[236:239], v[76:79]
v_exp_f32 v165, v165
v_mfma_f32_16x16x32_bf16 v[68:71], a[236:239], v[232:235], v[68:71]
ds_read_b128 a[196:199], v1 offset:64
v_cvt_pk_bf16_f32 v218, v164, v165
v_mfma_f32_16x16x32_bf16 v[60:63], a[236:239], v[228:231], v[60:63]
v_exp_f32 v166, v166
v_mfma_f32_16x16x32_bf16 v[52:55], a[236:239], v[224:227], v[52:55]
ds_read_b128 a[200:203], v1 offset:128
v_mfma_f32_16x16x32_bf16 v[80:83], a[240:243], v[224:227], v[80:83]
v_exp_f32 v167, v167
v_mfma_f32_16x16x32_bf16 v[88:91], a[240:243], v[228:231], v[88:91]
ds_read_b128 a[204:207], v1 offset:192
v_cvt_pk_bf16_f32 v219, v166, v167
v_mfma_f32_16x16x32_bf16 v[96:99], a[240:243], v[232:235], v[96:99]
v_mfma_f32_16x16x32_bf16 v[104:107], a[240:243], v[236:239], v[104:107]
v_exp_f32 v168, v168
v_mfma_f32_16x16x32_bf16 v[108:111], a[244:247], v[236:239], v[108:111]
ds_read_b128 a[208:211], v1 offset:4352
s_add_u32 m0, s99, 138240
s_add_u32 s95, s94, 49152
v_mfma_f32_16x16x32_bf16 v[100:103], a[244:247], v[232:235], v[100:103]
buffer_load_dwordx4 v4, s[40:43], s95 offen offset:0 lds
v_exp_f32 v169, v169
v_mfma_f32_16x16x32_bf16 v[92:95], a[244:247], v[228:231], v[92:95]
ds_read_b128 a[212:215], v1 offset:4416
v_cvt_pk_bf16_f32 v220, v168, v169
v_mfma_f32_16x16x32_bf16 v[84:87], a[244:247], v[224:227], v[84:87]
v_exp_f32 v170, v170
v_mfma_f32_16x16x32_bf16 v[112:115], a[248:251], v[224:227], v[112:115]
ds_read_b128 a[216:219], v1 offset:4480
buffer_load_dwordx4 v5, s[40:43], s95 offen offset:1088 lds
v_mfma_f32_16x16x32_bf16 v[120:123], a[248:251], v[228:231], v[120:123]
v_exp_f32 v171, v171
v_mfma_f32_16x16x32_bf16 v[128:131], a[248:251], v[232:235], v[128:131]
ds_read_b128 a[220:223], v1 offset:4544
v_cvt_pk_bf16_f32 v221, v170, v171
v_mfma_f32_16x16x32_bf16 v[136:139], a[248:251], v[236:239], v[136:139]
v_exp_f32 v172, v172
v_mfma_f32_16x16x32_bf16 v[140:143], a[252:255], v[236:239], v[140:143]
buffer_load_dwordx4 v6, s[40:43], s95 offen offset:2176 lds
v_mfma_f32_16x16x32_bf16 v[132:135], a[252:255], v[232:235], v[132:135]
v_exp_f32 v173, v173
v_mfma_f32_16x16x32_bf16 v[124:127], a[252:255], v[228:231], v[124:127]
v_cvt_pk_bf16_f32 v222, v172, v173
v_mfma_f32_16x16x32_bf16 v[116:119], a[252:255], v[224:227], v[116:119]
v_exp_f32 v174, v174
v_mfma_f32_16x16x32_bf16 a[108:111], a[124:127], v[224:227], a[108:111]
buffer_load_dwordx4 v7, s[40:43], s95 offen offset:3264 lds
v_mfma_f32_16x16x32_bf16 a[112:115], a[124:127], v[228:231], a[112:115]
v_exp_f32 v175, v175
v_mfma_f32_16x16x32_bf16 a[116:119], a[124:127], v[232:235], a[116:119]
v_cvt_pk_bf16_f32 v223, v174, v175
v_mfma_f32_16x16x32_bf16 a[120:123], a[124:127], v[236:239], a[120:123]
s_waitcnt lgkmcnt(0)
v_mfma_f32_16x16x32_bf16 v[144:147], a[192:195], a[128:131], 0
v_exp_f32 v176, v176
v_mfma_f32_16x16x32_bf16 v[152:155], a[192:195], a[144:147], 0
ds_read_b64_tr_b16 a[224:225], v3 offset:0
s_add_u32 m0, s96, 120832
s_add_u32 s95, s94, 32768
v_mfma_f32_16x16x32_bf16 v[160:163], a[192:195], a[160:163], 0
buffer_load_dwordx4 v8, s[44:47], s95 offen offset:0 lds
v_exp_f32 v177, v177
v_mfma_f32_16x16x32_bf16 v[168:171], a[192:195], a[176:179], 0
ds_read_b64_tr_b16 a[226:227], v3 offset:512
v_cvt_pk_bf16_f32 v224, v176, v177
v_mfma_f32_16x16x32_bf16 v[168:171], a[196:199], a[180:183], v[168:171]
v_exp_f32 v178, v178
v_mfma_f32_16x16x32_bf16 v[160:163], a[196:199], a[164:167], v[160:163]
ds_read_b64_tr_b16 a[228:229], v3 offset:32
v_mfma_f32_16x16x32_bf16 v[152:155], a[196:199], a[148:151], v[152:155]
v_exp_f32 v179, v179
v_mfma_f32_16x16x32_bf16 v[144:147], a[196:199], a[132:135], v[144:147]
ds_read_b64_tr_b16 a[230:231], v3 offset:544
v_cvt_pk_bf16_f32 v225, v178, v179
v_mfma_f32_16x16x32_bf16 v[144:147], a[200:203], a[136:139], v[144:147]
v_exp_f32 v180, v180
v_mfma_f32_16x16x32_bf16 v[152:155], a[200:203], a[152:155], v[152:155]
ds_read_b64_tr_b16 a[232:233], v3 offset:64
buffer_load_dwordx4 v9, s[44:47], s95 offen offset:1056 lds
v_mfma_f32_16x16x32_bf16 v[160:163], a[200:203], a[168:171], v[160:163]
v_exp_f32 v181, v181
v_mfma_f32_16x16x32_bf16 v[168:171], a[200:203], a[184:187], v[168:171]
ds_read_b64_tr_b16 a[234:235], v3 offset:576
v_cvt_pk_bf16_f32 v226, v180, v181
v_mfma_f32_16x16x32_bf16 v[168:171], a[204:207], a[188:191], v[168:171]
v_exp_f32 v182, v182
v_mfma_f32_16x16x32_bf16 v[160:163], a[204:207], a[172:175], v[160:163]
ds_read_b64_tr_b16 a[236:237], v3 offset:96
v_mfma_f32_16x16x32_bf16 v[152:155], a[204:207], a[156:159], v[152:155]
v_exp_f32 v183, v183
v_mfma_f32_16x16x32_bf16 v[144:147], a[204:207], a[140:143], v[144:147]
ds_read_b64_tr_b16 a[238:239], v3 offset:608
v_cvt_pk_bf16_f32 v227, v182, v183
v_mfma_f32_16x16x32_bf16 v[148:151], a[208:211], a[128:131], 0
v_mfma_f32_16x16x32_bf16 v[156:159], a[208:211], a[144:147], 0
v_exp_f32 v184, v184
v_mfma_f32_16x16x32_bf16 v[164:167], a[208:211], a[160:163], 0
ds_read_b64_tr_b16 a[240:241], v3 offset:128
buffer_load_dwordx4 v10, s[44:47], s95 offen offset:2112 lds
v_mfma_f32_16x16x32_bf16 v[172:175], a[208:211], a[176:179], 0
v_exp_f32 v185, v185
v_mfma_f32_16x16x32_bf16 v[172:175], a[212:215], a[180:183], v[172:175]
ds_read_b64_tr_b16 a[242:243], v3 offset:640
v_cvt_pk_bf16_f32 v228, v184, v185
v_mfma_f32_16x16x32_bf16 v[164:167], a[212:215], a[164:167], v[164:167]
v_exp_f32 v186, v186
v_mfma_f32_16x16x32_bf16 v[156:159], a[212:215], a[148:151], v[156:159]
ds_read_b64_tr_b16 a[244:245], v3 offset:160
v_mfma_f32_16x16x32_bf16 v[148:151], a[212:215], a[132:135], v[148:151]
v_exp_f32 v187, v187
v_mfma_f32_16x16x32_bf16 v[148:151], a[216:219], a[136:139], v[148:151]
ds_read_b64_tr_b16 a[246:247], v3 offset:672
v_cvt_pk_bf16_f32 v229, v186, v187
v_mfma_f32_16x16x32_bf16 v[156:159], a[216:219], a[152:155], v[156:159]
v_exp_f32 v188, v188
v_mfma_f32_16x16x32_bf16 v[164:167], a[216:219], a[168:171], v[164:167]
ds_read_b64_tr_b16 a[248:249], v3 offset:192
buffer_load_dwordx4 v11, s[44:47], s95 offen offset:3168 lds
v_mfma_f32_16x16x32_bf16 v[172:175], a[216:219], a[184:187], v[172:175]
v_exp_f32 v189, v189
v_mfma_f32_16x16x32_bf16 v[172:175], a[220:223], a[188:191], v[172:175]
ds_read_b64_tr_b16 a[250:251], v3 offset:704
v_cvt_pk_bf16_f32 v230, v188, v189
v_mfma_f32_16x16x32_bf16 v[164:167], a[220:223], a[172:175], v[164:167]
v_exp_f32 v190, v190
v_mfma_f32_16x16x32_bf16 v[156:159], a[220:223], a[156:159], v[156:159]
ds_read_b64_tr_b16 a[252:253], v3 offset:224
v_mfma_f32_16x16x32_bf16 v[148:151], a[220:223], a[140:143], v[148:151]
v_exp_f32 v191, v191
s_waitcnt lgkmcnt(7)
v_mfma_f32_16x16x32_bf16 v[16:19], a[224:227], v[208:211], v[16:19]
ds_read_b64_tr_b16 a[254:255], v3 offset:736
v_cvt_pk_bf16_f32 v231, v190, v191
v_mfma_f32_16x16x32_bf16 v[24:27], a[224:227], v[212:215], v[24:27]
s_lshl_b32 s88, s3, 6
v_add_u32 v252, s88, v0
v_mfma_f32_16x16x32_bf16 v[32:35], a[224:227], v[216:219], v[32:35]
v_exp_f32 v192, v192
v_mfma_f32_16x16x32_bf16 v[40:43], a[224:227], v[220:223], v[40:43]
v_lshlrev_b32 v252, 3, v252
s_lshl_b32 s88, s4, 11
v_mfma_f32_16x16x32_bf16 v[44:47], a[228:231], v[220:223], v[44:47]
v_exp_f32 v193, v193
v_mfma_f32_16x16x32_bf16 v[36:39], a[228:231], v[216:219], v[36:39]
s_add_u32 s88, s88, s94
s_add_u32 s88, s88, 475136
v_cvt_pk_bf16_f32 v232, v192, v193
v_mfma_f32_16x16x32_bf16 v[28:31], a[228:231], v[212:215], v[28:31]
v_exp_f32 v194, v194
v_mfma_f32_16x16x32_bf16 v[20:23], a[228:231], v[208:211], v[20:23]
buffer_load_dword v253, v252, s[40:43], s88 offen
v_mfma_f32_16x16x32_bf16 v[48:51], a[232:235], v[208:211], v[48:51]
v_exp_f32 v195, v195
v_mfma_f32_16x16x32_bf16 v[56:59], a[232:235], v[212:215], v[56:59]
s_waitcnt lgkmcnt(0)
v_cvt_pk_bf16_f32 v233, v194, v195
v_mfma_f32_16x16x32_bf16 v[64:67], a[232:235], v[216:219], v[64:67]
v_exp_f32 v196, v196
v_mfma_f32_16x16x32_bf16 v[72:75], a[232:235], v[220:223], v[72:75]
ds_read_b128 a[192:195], v1 offset:8704
v_mfma_f32_16x16x32_bf16 v[76:79], a[236:239], v[220:223], v[76:79]
v_exp_f32 v197, v197
v_mfma_f32_16x16x32_bf16 v[68:71], a[236:239], v[216:219], v[68:71]
ds_read_b128 a[196:199], v1 offset:8768
v_cvt_pk_bf16_f32 v234, v196, v197
v_mfma_f32_16x16x32_bf16 v[60:63], a[236:239], v[212:215], v[60:63]
v_exp_f32 v198, v198
v_mfma_f32_16x16x32_bf16 v[52:55], a[236:239], v[208:211], v[52:55]
ds_read_b128 a[200:203], v1 offset:8832
buffer_load_dword v253, v252, s[44:47], s88 offen
v_mfma_f32_16x16x32_bf16 v[80:83], a[240:243], v[208:211], v[80:83]
v_exp_f32 v199, v199
v_mfma_f32_16x16x32_bf16 v[88:91], a[240:243], v[212:215], v[88:91]
ds_read_b128 a[204:207], v1 offset:8896
v_cvt_pk_bf16_f32 v235, v198, v199
v_mfma_f32_16x16x32_bf16 v[96:99], a[240:243], v[216:219], v[96:99]
v_mfma_f32_16x16x32_bf16 v[104:107], a[240:243], v[220:223], v[104:107]
v_exp_f32 v200, v200
v_mfma_f32_16x16x32_bf16 v[108:111], a[244:247], v[220:223], v[108:111]
ds_read_b128 a[208:211], v1 offset:13056
v_mfma_f32_16x16x32_bf16 v[100:103], a[244:247], v[216:219], v[100:103]
s_lshl_b32 s88, s3, 6
v_exp_f32 v201, v201
v_mfma_f32_16x16x32_bf16 v[92:95], a[244:247], v[212:215], v[92:95]
ds_read_b128 a[212:215], v1 offset:13120
v_add_u32 v252, s88, v0
v_cvt_pk_bf16_f32 v236, v200, v201
v_mfma_f32_16x16x32_bf16 v[84:87], a[244:247], v[208:211], v[84:87]
v_exp_f32 v202, v202
v_mfma_f32_16x16x32_bf16 v[112:115], a[248:251], v[208:211], v[112:115]
ds_read_b128 a[216:219], v1 offset:13184
v_lshlrev_b32 v252, 6, v252
s_lshr_b32 s89, s2, 3
v_mfma_f32_16x16x32_bf16 v[120:123], a[248:251], v[212:215], v[120:123]
s_lshl_b32 s88, s6, 5
v_exp_f32 v203, v203
v_mfma_f32_16x16x32_bf16 v[128:131], a[248:251], v[216:219], v[128:131]
ds_read_b128 a[220:223], v1 offset:13248
s_add_u32 s88, s88, s89
v_cvt_pk_bf16_f32 v237, v202, v203
v_mfma_f32_16x16x32_bf16 v[136:139], a[248:251], v[220:223], v[136:139]
v_exp_f32 v204, v204
v_mfma_f32_16x16x32_bf16 v[140:143], a[252:255], v[220:223], v[140:143]
s_lshl_b32 s88, s88, 14
buffer_load_dword v253, v252, s[52:55], s88 offen offset:128
v_mfma_f32_16x16x32_bf16 v[132:135], a[252:255], v[216:219], v[132:135]
v_exp_f32 v205, v205
v_mfma_f32_16x16x32_bf16 v[124:127], a[252:255], v[212:215], v[124:127]
v_cvt_pk_bf16_f32 v238, v204, v205
v_mfma_f32_16x16x32_bf16 v[116:119], a[252:255], v[208:211], v[116:119]
v_exp_f32 v206, v206
v_mfma_f32_16x16x32_bf16 a[108:111], a[124:127], v[208:211], a[108:111]
v_mfma_f32_16x16x32_bf16 a[112:115], a[124:127], v[212:215], a[112:115]
v_exp_f32 v207, v207
v_mfma_f32_16x16x32_bf16 a[116:119], a[124:127], v[216:219], a[116:119]
v_cvt_pk_bf16_f32 v239, v206, v207
v_mfma_f32_16x16x32_bf16 a[120:123], a[124:127], v[220:223], a[120:123]
s_waitcnt lgkmcnt(0)
v_mfma_f32_16x16x32_bf16 v[176:179], a[192:195], a[128:131], 0
v_exp_f32 v144, v144
v_mfma_f32_16x16x32_bf16 v[184:187], a[192:195], a[144:147], 0
ds_read_b64_tr_b16 a[224:225], v3 offset:8448
s_mul_i32 s10, s4, 3
s_add_u32 s10, s10, s7
v_mfma_f32_16x16x32_bf16 v[192:195], a[192:195], a[160:163], 0
s_sub_u32 s10, s10, 1
v_exp_f32 v145, v145
v_mfma_f32_16x16x32_bf16 v[200:203], a[192:195], a[176:179], 0
ds_read_b64_tr_b16 a[226:227], v3 offset:8960
s_cmp_lt_u32 s10, 22
s_cselect_b32 s23, 0, 1073741824
s_cselect_b32 s10, s10, 0
v_cvt_pk_bf16_f32 v208, v144, v145
v_mfma_f32_16x16x32_bf16 v[200:203], a[196:199], a[180:183], v[200:203]
v_exp_f32 v146, v146
v_mfma_f32_16x16x32_bf16 v[192:195], a[196:199], a[164:167], v[192:195]
ds_read_b64_tr_b16 a[228:229], v3 offset:8480
s_cmp_ge_u32 s10, 11
s_cselect_b32 s88, 1, 0
s_cselect_b32 s89, 11, 0
v_mfma_f32_16x16x32_bf16 v[184:187], a[196:199], a[148:151], v[184:187]
v_exp_f32 v147, v147
v_mfma_f32_16x16x32_bf16 v[176:179], a[196:199], a[132:135], v[176:179]
ds_read_b64_tr_b16 a[230:231], v3 offset:8992
v_cvt_pk_bf16_f32 v209, v146, v147
v_mfma_f32_16x16x32_bf16 v[176:179], a[200:203], a[136:139], v[176:179]
v_exp_f32 v148, v148
v_mfma_f32_16x16x32_bf16 v[184:187], a[200:203], a[152:155], v[184:187]
ds_read_b64_tr_b16 a[232:233], v3 offset:8512
s_sub_u32 s10, s10, s89
s_lshl_b32 s9, s6, 1
v_mfma_f32_16x16x32_bf16 v[192:195], a[200:203], a[168:171], v[192:195]
s_add_u32 s9, s9, s88
v_exp_f32 v149, v149
v_mfma_f32_16x16x32_bf16 v[200:203], a[200:203], a[184:187], v[200:203]
ds_read_b64_tr_b16 a[234:235], v3 offset:9024
s_lshl_b32 s12, s10, 8
v_cvt_pk_bf16_f32 v210, v148, v149
v_mfma_f32_16x16x32_bf16 v[200:203], a[204:207], a[188:191], v[200:203]
v_exp_f32 v150, v150
v_mfma_f32_16x16x32_bf16 v[192:195], a[204:207], a[172:175], v[192:195]
ds_read_b64_tr_b16 a[236:237], v3 offset:8544
s_lshl_b32 s11, s9, 2
s_add_u32 s11, s11, s3
v_mfma_f32_16x16x32_bf16 v[184:187], a[204:207], a[156:159], v[184:187]
s_lshl_b32 s11, s11, 5
v_exp_f32 v151, v151
v_mfma_f32_16x16x32_bf16 v[176:179], a[204:207], a[140:143], v[176:179]
ds_read_b64_tr_b16 a[238:239], v3 offset:9056
v_cvt_pk_bf16_f32 v211, v150, v151
v_mfma_f32_16x16x32_bf16 v[180:183], a[208:211], a[128:131], 0
v_bfe_u32 v14, v0, 4, 1
v_mul_u32_u24 v14, 16, v14
v_mfma_f32_16x16x32_bf16 v[188:191], a[208:211], a[144:147], 0
v_exp_f32 v152, v152
v_mfma_f32_16x16x32_bf16 v[196:199], a[208:211], a[160:163], 0
ds_read_b64_tr_b16 a[240:241], v3 offset:8576
v_lshrrev_b32 v15, 5, v0
v_mul_u32_u24 v15, 8, v15
v_mfma_f32_16x16x32_bf16 v[204:207], a[208:211], a[176:179], 0
v_add_u32 v14, v14, v15
v_exp_f32 v153, v153
v_mfma_f32_16x16x32_bf16 v[204:207], a[212:215], a[180:183], v[204:207]
ds_read_b64_tr_b16 a[242:243], v3 offset:9088
s_and_b32 s88, s3, 1
v_cvt_pk_bf16_f32 v212, v152, v153
v_mfma_f32_16x16x32_bf16 v[196:199], a[212:215], a[164:167], v[196:199]
v_exp_f32 v154, v154
v_mfma_f32_16x16x32_bf16 v[188:191], a[212:215], a[148:151], v[188:191]
ds_read_b64_tr_b16 a[244:245], v3 offset:8608
s_mul_i32 s88, s88, 4
s_lshr_b32 s89, s3, 1
v_mfma_f32_16x16x32_bf16 v[180:183], a[212:215], a[132:135], v[180:183]
s_lshl_b32 s89, s89, 5
v_exp_f32 v155, v155
v_mfma_f32_16x16x32_bf16 v[180:183], a[216:219], a[136:139], v[180:183]
ds_read_b64_tr_b16 a[246:247], v3 offset:9120
s_add_u32 s88, s88, s89
v_cvt_pk_bf16_f32 v213, v154, v155
v_mfma_f32_16x16x32_bf16 v[188:191], a[216:219], a[152:155], v[188:191]
v_exp_f32 v156, v156
v_mfma_f32_16x16x32_bf16 v[196:199], a[216:219], a[168:171], v[196:199]
ds_read_b64_tr_b16 a[248:249], v3 offset:8640
v_add_u32 v14, s88, v14
s_mov_b32 s89, 2752
v_mfma_f32_16x16x32_bf16 v[204:207], a[216:219], a[184:187], v[204:207]
v_mul_lo_u32 v14, v14, s89
v_exp_f32 v157, v157
v_mfma_f32_16x16x32_bf16 v[204:207], a[220:223], a[188:191], v[204:207]
ds_read_b64_tr_b16 a[250:251], v3 offset:9152
v_and_b32 v15, 15, v0
v_cvt_pk_bf16_f32 v214, v156, v157
v_mfma_f32_16x16x32_bf16 v[196:199], a[220:223], a[172:175], v[196:199]
v_exp_f32 v158, v158
v_mfma_f32_16x16x32_bf16 v[188:191], a[220:223], a[156:159], v[188:191]
ds_read_b64_tr_b16 a[252:253], v3 offset:8672
v_lshl_add_u32 v240, v15, 4, v14
v_add_u32 v241, 1696, v240
v_mfma_f32_16x16x32_bf16 v[180:183], a[220:223], a[140:143], v[180:183]
v_add_u32 v242, 3392, v240
v_exp_f32 v159, v159
s_waitcnt lgkmcnt(7)
v_mfma_f32_16x16x32_bf16 v[16:19], a[224:227], v[224:227], v[16:19]
ds_read_b64_tr_b16 a[254:255], v3 offset:9184
v_cvt_pk_bf16_f32 v215, v158, v159
v_mfma_f32_16x16x32_bf16 v[24:27], a[224:227], v[228:231], v[24:27]
v_add_u32 v243, 5088, v240
v_bfe_u32 v14, v0, 2, 3
v_mfma_f32_16x16x32_bf16 v[32:35], a[224:227], v[232:235], v[32:35]
v_exp_f32 v160, v160
v_mfma_f32_16x16x32_bf16 v[40:43], a[224:227], v[236:239], v[40:43]
v_mul_u32_u24 v14, 1056, v14
v_lshrrev_b32 v15, 5, v0
v_mfma_f32_16x16x32_bf16 v[44:47], a[228:231], v[236:239], v[44:47]
v_exp_f32 v161, v161
v_mfma_f32_16x16x32_bf16 v[36:39], a[228:231], v[232:235], v[36:39]
v_lshl_add_u32 v14, v15, 9, v14
v_and_b32 v15, 3, v0
v_cvt_pk_bf16_f32 v216, v160, v161
v_mfma_f32_16x16x32_bf16 v[28:31], a[228:231], v[228:231], v[28:31]
v_exp_f32 v162, v162
v_mfma_f32_16x16x32_bf16 v[20:23], a[228:231], v[224:227], v[20:23]
v_lshl_add_u32 v248, v15, 3, v14
v_add_u32 v249, 50688, v248
v_mfma_f32_16x16x32_bf16 v[48:51], a[232:235], v[224:227], v[48:51]
v_exp_f32 v163, v163
v_mfma_f32_16x16x32_bf16 v[56:59], a[232:235], v[228:231], v[56:59]
s_waitcnt vmcnt(3) lgkmcnt(0)
s_barrier
v_cvt_pk_bf16_f32 v217, v162, v163
v_mfma_f32_16x16x32_bf16 v[64:67], a[232:235], v[232:235], v[64:67]
v_exp_f32 v164, v164
v_mfma_f32_16x16x32_bf16 v[72:75], a[232:235], v[236:239], v[72:75]
ds_read_b128 a[192:195], v1 offset:34816
v_mfma_f32_16x16x32_bf16 v[76:79], a[236:239], v[236:239], v[76:79]
v_exp_f32 v165, v165
v_mfma_f32_16x16x32_bf16 v[68:71], a[236:239], v[232:235], v[68:71]
ds_read_b128 a[196:199], v1 offset:34880
v_cvt_pk_bf16_f32 v218, v164, v165
v_mfma_f32_16x16x32_bf16 v[60:63], a[236:239], v[228:231], v[60:63]
v_exp_f32 v166, v166
v_mfma_f32_16x16x32_bf16 v[52:55], a[236:239], v[224:227], v[52:55]
ds_read_b128 a[200:203], v1 offset:34944
v_mfma_f32_16x16x32_bf16 v[80:83], a[240:243], v[224:227], v[80:83]
v_exp_f32 v167, v167
v_mfma_f32_16x16x32_bf16 v[88:91], a[240:243], v[228:231], v[88:91]
ds_read_b128 a[204:207], v1 offset:35008
v_cvt_pk_bf16_f32 v219, v166, v167
v_mfma_f32_16x16x32_bf16 v[96:99], a[240:243], v[232:235], v[96:99]
v_mfma_f32_16x16x32_bf16 v[104:107], a[240:243], v[236:239], v[104:107]
v_exp_f32 v168, v168
v_mfma_f32_16x16x32_bf16 v[108:111], a[244:247], v[236:239], v[108:111]
ds_read_b128 a[208:211], v1 offset:39168
s_add_u32 m0, s99, 103424
s_add_u32 s95, s94, 65536
v_mfma_f32_16x16x32_bf16 v[100:103], a[244:247], v[232:235], v[100:103]
buffer_load_dwordx4 v4, s[40:43], s95 offen offset:0 lds
v_exp_f32 v169, v169
v_mfma_f32_16x16x32_bf16 v[92:95], a[244:247], v[228:231], v[92:95]
ds_read_b128 a[212:215], v1 offset:39232
v_cvt_pk_bf16_f32 v220, v168, v169
v_mfma_f32_16x16x32_bf16 v[84:87], a[244:247], v[224:227], v[84:87]
v_exp_f32 v170, v170
v_mfma_f32_16x16x32_bf16 v[112:115], a[248:251], v[224:227], v[112:115]
ds_read_b128 a[216:219], v1 offset:39296
buffer_load_dwordx4 v5, s[40:43], s95 offen offset:1088 lds
v_mfma_f32_16x16x32_bf16 v[120:123], a[248:251], v[228:231], v[120:123]
v_exp_f32 v171, v171
v_mfma_f32_16x16x32_bf16 v[128:131], a[248:251], v[232:235], v[128:131]
ds_read_b128 a[220:223], v1 offset:39360
v_cvt_pk_bf16_f32 v221, v170, v171
v_mfma_f32_16x16x32_bf16 v[136:139], a[248:251], v[236:239], v[136:139]
v_exp_f32 v172, v172
v_mfma_f32_16x16x32_bf16 v[140:143], a[252:255], v[236:239], v[140:143]
buffer_load_dwordx4 v6, s[40:43], s95 offen offset:2176 lds
v_mfma_f32_16x16x32_bf16 v[132:135], a[252:255], v[232:235], v[132:135]
v_exp_f32 v173, v173
v_mfma_f32_16x16x32_bf16 v[124:127], a[252:255], v[228:231], v[124:127]
v_cvt_pk_bf16_f32 v222, v172, v173
v_mfma_f32_16x16x32_bf16 v[116:119], a[252:255], v[224:227], v[116:119]
v_exp_f32 v174, v174
v_mfma_f32_16x16x32_bf16 a[108:111], a[124:127], v[224:227], a[108:111]
buffer_load_dwordx4 v7, s[40:43], s95 offen offset:3264 lds
v_mfma_f32_16x16x32_bf16 a[112:115], a[124:127], v[228:231], a[112:115]
v_exp_f32 v175, v175
v_mfma_f32_16x16x32_bf16 a[116:119], a[124:127], v[232:235], a[116:119]
v_cvt_pk_bf16_f32 v223, v174, v175
v_mfma_f32_16x16x32_bf16 a[120:123], a[124:127], v[236:239], a[120:123]
s_waitcnt lgkmcnt(0)
v_mfma_f32_16x16x32_bf16 v[144:147], a[192:195], a[128:131], 0
v_exp_f32 v176, v176
v_mfma_f32_16x16x32_bf16 v[152:155], a[192:195], a[144:147], 0
ds_read_b64_tr_b16 a[224:225], v3 offset:34816
s_add_u32 m0, s96, 86016
s_add_u32 s95, s94, 49152
v_mfma_f32_16x16x32_bf16 v[160:163], a[192:195], a[160:163], 0
buffer_load_dwordx4 v8, s[44:47], s95 offen offset:0 lds
v_exp_f32 v177, v177
v_mfma_f32_16x16x32_bf16 v[168:171], a[192:195], a[176:179], 0
ds_read_b64_tr_b16 a[226:227], v3 offset:35328
v_cvt_pk_bf16_f32 v224, v176, v177
v_mfma_f32_16x16x32_bf16 v[168:171], a[196:199], a[180:183], v[168:171]
v_exp_f32 v178, v178
v_mfma_f32_16x16x32_bf16 v[160:163], a[196:199], a[164:167], v[160:163]
ds_read_b64_tr_b16 a[228:229], v3 offset:34848
v_mfma_f32_16x16x32_bf16 v[152:155], a[196:199], a[148:151], v[152:155]
buffer_load_dwordx4 v9, s[44:47], s95 offen offset:1056 lds
v_exp_f32 v179, v179
v_mfma_f32_16x16x32_bf16 v[144:147], a[196:199], a[132:135], v[144:147]
ds_read_b64_tr_b16 a[230:231], v3 offset:35360
v_cvt_pk_bf16_f32 v225, v178, v179
v_mfma_f32_16x16x32_bf16 v[144:147], a[200:203], a[136:139], v[144:147]
v_exp_f32 v180, v180
v_mfma_f32_16x16x32_bf16 v[152:155], a[200:203], a[152:155], v[152:155]
ds_read_b64_tr_b16 a[232:233], v3 offset:34880
v_mfma_f32_16x16x32_bf16 v[160:163], a[200:203], a[168:171], v[160:163]
v_exp_f32 v181, v181
v_mfma_f32_16x16x32_bf16 v[168:171], a[200:203], a[184:187], v[168:171]
ds_read_b64_tr_b16 a[234:235], v3 offset:35392
v_cvt_pk_bf16_f32 v226, v180, v181
v_mfma_f32_16x16x32_bf16 v[168:171], a[204:207], a[188:191], v[168:171]
v_exp_f32 v182, v182
v_mfma_f32_16x16x32_bf16 v[160:163], a[204:207], a[172:175], v[160:163]
ds_read_b64_tr_b16 a[236:237], v3 offset:34912
buffer_load_dwordx4 v10, s[44:47], s95 offen offset:2112 lds
v_mfma_f32_16x16x32_bf16 v[152:155], a[204:207], a[156:159], v[152:155]
v_exp_f32 v183, v183
v_mfma_f32_16x16x32_bf16 v[144:147], a[204:207], a[140:143], v[144:147]
ds_read_b64_tr_b16 a[238:239], v3 offset:35424
v_cvt_pk_bf16_f32 v227, v182, v183
v_mfma_f32_16x16x32_bf16 v[148:151], a[208:211], a[128:131], 0
v_mfma_f32_16x16x32_bf16 v[156:159], a[208:211], a[144:147], 0
v_exp_f32 v184, v184
v_mfma_f32_16x16x32_bf16 v[164:167], a[208:211], a[160:163], 0
ds_read_b64_tr_b16 a[240:241], v3 offset:34944
buffer_load_dwordx4 v11, s[44:47], s95 offen offset:3168 lds
v_mfma_f32_16x16x32_bf16 v[172:175], a[208:211], a[176:179], 0
v_exp_f32 v185, v185
v_mfma_f32_16x16x32_bf16 v[172:175], a[212:215], a[180:183], v[172:175]
ds_read_b64_tr_b16 a[242:243], v3 offset:35456
v_cvt_pk_bf16_f32 v228, v184, v185
v_mfma_f32_16x16x32_bf16 v[164:167], a[212:215], a[164:167], v[164:167]
v_exp_f32 v186, v186
v_mfma_f32_16x16x32_bf16 v[156:159], a[212:215], a[148:151], v[156:159]
ds_read_b64_tr_b16 a[244:245], v3 offset:34976
s_lshl_b32 s88, s3, 6
v_mfma_f32_16x16x32_bf16 v[148:151], a[212:215], a[132:135], v[148:151]
v_add_u32 v252, s88, v0
v_exp_f32 v187, v187
v_mfma_f32_16x16x32_bf16 v[148:151], a[216:219], a[136:139], v[148:151]
ds_read_b64_tr_b16 a[246:247], v3 offset:35488
v_lshlrev_b32 v252, 3, v252
v_cvt_pk_bf16_f32 v229, v186, v187
v_mfma_f32_16x16x32_bf16 v[156:159], a[216:219], a[152:155], v[156:159]
s_lshl_b32 s88, s4, 11
v_exp_f32 v188, v188
v_mfma_f32_16x16x32_bf16 v[164:167], a[216:219], a[168:171], v[164:167]
ds_read_b64_tr_b16 a[248:249], v3 offset:35008
s_add_u32 s88, s88, s94
s_add_u32 s88, s88, 491520
v_mfma_f32_16x16x32_bf16 v[172:175], a[216:219], a[184:187], v[172:175]
buffer_load_dword v253, v252, s[40:43], s88 offen
v_exp_f32 v189, v189
v_mfma_f32_16x16x32_bf16 v[172:175], a[220:223], a[188:191], v[172:175]
ds_read_b64_tr_b16 a[250:251], v3 offset:35520
v_cvt_pk_bf16_f32 v230, v188, v189
v_mfma_f32_16x16x32_bf16 v[164:167], a[220:223], a[172:175], v[164:167]
v_exp_f32 v190, v190
v_mfma_f32_16x16x32_bf16 v[156:159], a[220:223], a[156:159], v[156:159]
ds_read_b64_tr_b16 a[252:253], v3 offset:35040
v_mfma_f32_16x16x32_bf16 v[148:151], a[220:223], a[140:143], v[148:151]
v_exp_f32 v191, v191
s_waitcnt lgkmcnt(7)
v_mfma_f32_16x16x32_bf16 v[16:19], a[224:227], v[208:211], v[16:19]
ds_read_b64_tr_b16 a[254:255], v3 offset:35552
v_cvt_pk_bf16_f32 v231, v190, v191
v_mfma_f32_16x16x32_bf16 v[24:27], a[224:227], v[212:215], v[24:27]
buffer_load_dword v253, v252, s[44:47], s88 offen
v_mfma_f32_16x16x32_bf16 v[32:35], a[224:227], v[216:219], v[32:35]
v_exp_f32 v192, v192
v_mfma_f32_16x16x32_bf16 v[40:43], a[224:227], v[220:223], v[40:43]
v_mfma_f32_16x16x32_bf16 v[44:47], a[228:231], v[220:223], v[44:47]
v_exp_f32 v193, v193
v_mfma_f32_16x16x32_bf16 v[36:39], a[228:231], v[216:219], v[36:39]
s_lshl_b32 s25, s6, 19
v_cvt_pk_bf16_f32 v232, v192, v193
v_mfma_f32_16x16x32_bf16 v[28:31], a[228:231], v[212:215], v[28:31]
v_exp_f32 v194, v194
v_mfma_f32_16x16x32_bf16 v[20:23], a[228:231], v[208:211], v[20:23]
s_xor_b32 s88, s7, 0
s_lshl_b32 s88, s88, 8
s_add_u32 s25, s25, s88
v_mfma_f32_16x16x32_bf16 v[48:51], a[232:235], v[208:211], v[48:51]
s_cmp_eq_u32 s7, 1
s_cselect_b32 s13, 2, 1
v_exp_f32 v195, v195
v_mfma_f32_16x16x32_bf16 v[56:59], a[232:235], v[212:215], v[56:59]
s_waitcnt lgkmcnt(0)
s_sub_u32 s88, s7, 1
v_cvt_pk_bf16_f32 v233, v194, v195
v_mfma_f32_16x16x32_bf16 v[64:67], a[232:235], v[216:219], v[64:67]
v_exp_f32 v196, v196
v_mfma_f32_16x16x32_bf16 v[72:75], a[232:235], v[220:223], v[72:75]
ds_read_b128 a[192:195], v1 offset:43520
s_cmp_lt_u32 s88, 2
s_cselect_b32 s14, 3, 2
s_cmp_eq_u32 s7, 0
s_cselect_b32 s15, 3, 0
v_mfma_f32_16x16x32_bf16 v[76:79], a[236:239], v[220:223], v[76:79]
v_exp_f32 v197, v197
v_mfma_f32_16x16x32_bf16 v[68:71], a[236:239], v[216:219], v[68:71]
ds_read_b128 a[196:199], v1 offset:43584
v_bfe_u32 v14, v0, 4, 1
v_cvt_pk_bf16_f32 v234, v196, v197
v_mfma_f32_16x16x32_bf16 v[60:63], a[236:239], v[212:215], v[60:63]
v_exp_f32 v198, v198
v_mfma_f32_16x16x32_bf16 v[52:55], a[236:239], v[208:211], v[52:55]
ds_read_b128 a[200:203], v1 offset:43648
v_mul_u32_u24 v14, 16, v14
v_lshrrev_b32 v15, 5, v0
v_mfma_f32_16x16x32_bf16 v[80:83], a[240:243], v[208:211], v[80:83]
v_mul_u32_u24 v15, 8, v15
v_exp_f32 v199, v199
v_mfma_f32_16x16x32_bf16 v[88:91], a[240:243], v[212:215], v[88:91]
ds_read_b128 a[204:207], v1 offset:43712
v_add_u32 v14, v14, v15
v_cvt_pk_bf16_f32 v235, v198, v199
v_mfma_f32_16x16x32_bf16 v[96:99], a[240:243], v[216:219], v[96:99]
s_and_b32 s88, s3, 1
s_mul_i32 s88, s88, 4
s_lshr_b32 s89, s3, 1
v_mfma_f32_16x16x32_bf16 v[104:107], a[240:243], v[220:223], v[104:107]
s_lshl_b32 s89, s89, 5
v_exp_f32 v200, v200
v_mfma_f32_16x16x32_bf16 v[108:111], a[244:247], v[220:223], v[108:111]
ds_read_b128 a[208:211], v1 offset:47872
s_add_u32 s88, s88, s89
v_add_u32 v14, s88, v14
v_mfma_f32_16x16x32_bf16 v[100:103], a[244:247], v[216:219], v[100:103]
s_mov_b32 s89, 1024
v_exp_f32 v201, v201
v_mfma_f32_16x16x32_bf16 v[92:95], a[244:247], v[212:215], v[92:95]
ds_read_b128 a[212:215], v1 offset:47936
v_mul_lo_u32 v14, v14, s89
v_cvt_pk_bf16_f32 v236, v200, v201
v_mfma_f32_16x16x32_bf16 v[84:87], a[244:247], v[208:211], v[84:87]
v_and_b32 v15, 15, v0
v_exp_f32 v202, v202
v_mfma_f32_16x16x32_bf16 v[112:115], a[248:251], v[208:211], v[112:115]
ds_read_b128 a[216:219], v1 offset:48000
v_lshl_add_u32 v244, v15, 4, v14
v_add_u32 v244, 128, v244
v_mfma_f32_16x16x32_bf16 v[120:123], a[248:251], v[212:215], v[120:123]
v_subrev_u32 v245, 32, v244
v_exp_f32 v203, v203
v_mfma_f32_16x16x32_bf16 v[128:131], a[248:251], v[216:219], v[128:131]
ds_read_b128 a[220:223], v1 offset:48064
v_subrev_u32 v246, 64, v244
v_cvt_pk_bf16_f32 v237, v202, v203
v_mfma_f32_16x16x32_bf16 v[136:139], a[248:251], v[220:223], v[136:139]
v_subrev_u32 v247, 96, v244
v_exp_f32 v204, v204
v_mfma_f32_16x16x32_bf16 v[140:143], a[252:255], v[220:223], v[140:143]
s_lshl_b32 s88, s4, 2
s_add_u32 s88, s88, s3
s_and_b32 s88, s88, 15
v_mfma_f32_16x16x32_bf16 v[132:135], a[252:255], v[216:219], v[132:135]
s_lshl_b32 s88, s88, 10
v_exp_f32 v205, v205
v_mfma_f32_16x16x32_bf16 v[124:127], a[252:255], v[212:215], v[124:127]
v_lshlrev_b32 v252, 4, v0
s_add_u32 s88, s88, recurrent_scan__sliding_block_cached__mixer_s_mlp__prompt_kernel_c8-recurrent_scan__sliding_block_cached__mixer_s_mlp__prompt_kernel_pc
v_cvt_pk_bf16_f32 v238, v204, v205
v_mfma_f32_16x16x32_bf16 v[116:119], a[252:255], v[208:211], v[116:119]
buffer_load_dword v253, v252, s[72:75], s88 offen
v_exp_f32 v206, v206
v_mfma_f32_16x16x32_bf16 a[108:111], a[124:127], v[208:211], a[108:111]
v_mfma_f32_16x16x32_bf16 a[112:115], a[124:127], v[212:215], a[112:115]
v_exp_f32 v207, v207
v_mfma_f32_16x16x32_bf16 a[116:119], a[124:127], v[216:219], a[116:119]
v_cvt_pk_bf16_f32 v239, v206, v207
v_mfma_f32_16x16x32_bf16 a[120:123], a[124:127], v[220:223], a[120:123]
s_waitcnt lgkmcnt(0)
v_mfma_f32_16x16x32_bf16 v[176:179], a[192:195], a[128:131], 0
v_exp_f32 v144, v144
v_mfma_f32_16x16x32_bf16 v[184:187], a[192:195], a[144:147], 0
ds_read_b64_tr_b16 a[224:225], v3 offset:43264
v_mfma_f32_16x16x32_bf16 v[192:195], a[192:195], a[160:163], 0
v_exp_f32 v145, v145
v_mfma_f32_16x16x32_bf16 v[200:203], a[192:195], a[176:179], 0
ds_read_b64_tr_b16 a[226:227], v3 offset:43776
v_cvt_pk_bf16_f32 v208, v144, v145
v_mfma_f32_16x16x32_bf16 v[200:203], a[196:199], a[180:183], v[200:203]
v_exp_f32 v146, v146
v_mfma_f32_16x16x32_bf16 v[192:195], a[196:199], a[164:167], v[192:195]
ds_read_b64_tr_b16 a[228:229], v3 offset:43296
v_mfma_f32_16x16x32_bf16 v[184:187], a[196:199], a[148:151], v[184:187]
v_exp_f32 v147, v147
v_mfma_f32_16x16x32_bf16 v[176:179], a[196:199], a[132:135], v[176:179]
ds_read_b64_tr_b16 a[230:231], v3 offset:43808
v_cvt_pk_bf16_f32 v209, v146, v147
v_mfma_f32_16x16x32_bf16 v[176:179], a[200:203], a[136:139], v[176:179]
v_exp_f32 v148, v148
v_mfma_f32_16x16x32_bf16 v[184:187], a[200:203], a[152:155], v[184:187]
ds_read_b64_tr_b16 a[232:233], v3 offset:43328
v_mfma_f32_16x16x32_bf16 v[192:195], a[200:203], a[168:171], v[192:195]
v_exp_f32 v149, v149
v_mfma_f32_16x16x32_bf16 v[200:203], a[200:203], a[184:187], v[200:203]
ds_read_b64_tr_b16 a[234:235], v3 offset:43840
v_cvt_pk_bf16_f32 v210, v148, v149
v_mfma_f32_16x16x32_bf16 v[200:203], a[204:207], a[188:191], v[200:203]
v_exp_f32 v150, v150
v_mfma_f32_16x16x32_bf16 v[192:195], a[204:207], a[172:175], v[192:195]
ds_read_b64_tr_b16 a[236:237], v3 offset:43360
v_mfma_f32_16x16x32_bf16 v[184:187], a[204:207], a[156:159], v[184:187]
v_exp_f32 v151, v151
v_mfma_f32_16x16x32_bf16 v[176:179], a[204:207], a[140:143], v[176:179]
ds_read_b64_tr_b16 a[238:239], v3 offset:43872
v_cvt_pk_bf16_f32 v211, v150, v151
v_mfma_f32_16x16x32_bf16 v[180:183], a[208:211], a[128:131], 0
v_mfma_f32_16x16x32_bf16 v[188:191], a[208:211], a[144:147], 0
v_exp_f32 v152, v152
v_mfma_f32_16x16x32_bf16 v[196:199], a[208:211], a[160:163], 0
ds_read_b64_tr_b16 a[240:241], v3 offset:43392
v_mfma_f32_16x16x32_bf16 v[204:207], a[208:211], a[176:179], 0
v_exp_f32 v153, v153
v_mfma_f32_16x16x32_bf16 v[204:207], a[212:215], a[180:183], v[204:207]
ds_read_b64_tr_b16 a[242:243], v3 offset:43904
v_cvt_pk_bf16_f32 v212, v152, v153
v_mfma_f32_16x16x32_bf16 v[196:199], a[212:215], a[164:167], v[196:199]
v_exp_f32 v154, v154
v_mfma_f32_16x16x32_bf16 v[188:191], a[212:215], a[148:151], v[188:191]
ds_read_b64_tr_b16 a[244:245], v3 offset:43424
v_mfma_f32_16x16x32_bf16 v[180:183], a[212:215], a[132:135], v[180:183]
v_exp_f32 v155, v155
v_mfma_f32_16x16x32_bf16 v[180:183], a[216:219], a[136:139], v[180:183]
ds_read_b64_tr_b16 a[246:247], v3 offset:43936
v_cvt_pk_bf16_f32 v213, v154, v155
v_mfma_f32_16x16x32_bf16 v[188:191], a[216:219], a[152:155], v[188:191]
v_exp_f32 v156, v156
v_mfma_f32_16x16x32_bf16 v[196:199], a[216:219], a[168:171], v[196:199]
ds_read_b64_tr_b16 a[248:249], v3 offset:43456
v_mfma_f32_16x16x32_bf16 v[204:207], a[216:219], a[184:187], v[204:207]
v_exp_f32 v157, v157
v_mfma_f32_16x16x32_bf16 v[204:207], a[220:223], a[188:191], v[204:207]
ds_read_b64_tr_b16 a[250:251], v3 offset:43968
v_cvt_pk_bf16_f32 v214, v156, v157
v_mfma_f32_16x16x32_bf16 v[196:199], a[220:223], a[172:175], v[196:199]
v_exp_f32 v158, v158
v_mfma_f32_16x16x32_bf16 v[188:191], a[220:223], a[156:159], v[188:191]
ds_read_b64_tr_b16 a[252:253], v3 offset:43488
v_mfma_f32_16x16x32_bf16 v[180:183], a[220:223], a[140:143], v[180:183]
v_exp_f32 v159, v159
s_waitcnt lgkmcnt(7)
v_mfma_f32_16x16x32_bf16 v[16:19], a[224:227], v[224:227], v[16:19]
ds_read_b64_tr_b16 a[254:255], v3 offset:44000
v_cvt_pk_bf16_f32 v215, v158, v159
v_mfma_f32_16x16x32_bf16 v[24:27], a[224:227], v[228:231], v[24:27]
v_mfma_f32_16x16x32_bf16 v[32:35], a[224:227], v[232:235], v[32:35]
v_exp_f32 v160, v160
v_mfma_f32_16x16x32_bf16 v[40:43], a[224:227], v[236:239], v[40:43]
v_mfma_f32_16x16x32_bf16 v[44:47], a[228:231], v[236:239], v[44:47]
v_exp_f32 v161, v161
v_mfma_f32_16x16x32_bf16 v[36:39], a[228:231], v[232:235], v[36:39]
v_cvt_pk_bf16_f32 v216, v160, v161
v_mfma_f32_16x16x32_bf16 v[28:31], a[228:231], v[228:231], v[28:31]
v_exp_f32 v162, v162
v_mfma_f32_16x16x32_bf16 v[20:23], a[228:231], v[224:227], v[20:23]
v_mfma_f32_16x16x32_bf16 v[48:51], a[232:235], v[224:227], v[48:51]
v_exp_f32 v163, v163
v_mfma_f32_16x16x32_bf16 v[56:59], a[232:235], v[228:231], v[56:59]
s_waitcnt vmcnt(3) lgkmcnt(0)
s_barrier
v_cvt_pk_bf16_f32 v217, v162, v163
v_mfma_f32_16x16x32_bf16 v[64:67], a[232:235], v[232:235], v[64:67]
v_exp_f32 v164, v164
v_mfma_f32_16x16x32_bf16 v[72:75], a[232:235], v[236:239], v[72:75]
ds_read_b128 a[192:195], v1 offset:0
v_mfma_f32_16x16x32_bf16 v[76:79], a[236:239], v[236:239], v[76:79]
v_exp_f32 v165, v165
v_mfma_f32_16x16x32_bf16 v[68:71], a[236:239], v[232:235], v[68:71]
ds_read_b128 a[196:199], v1 offset:64
v_cvt_pk_bf16_f32 v218, v164, v165
v_mfma_f32_16x16x32_bf16 v[60:63], a[236:239], v[228:231], v[60:63]
v_exp_f32 v166, v166
v_mfma_f32_16x16x32_bf16 v[52:55], a[236:239], v[224:227], v[52:55]
ds_read_b128 a[200:203], v1 offset:128
v_mfma_f32_16x16x32_bf16 v[80:83], a[240:243], v[224:227], v[80:83]
v_exp_f32 v167, v167
v_mfma_f32_16x16x32_bf16 v[88:91], a[240:243], v[228:231], v[88:91]
ds_read_b128 a[204:207], v1 offset:192
v_cvt_pk_bf16_f32 v219, v166, v167
v_mfma_f32_16x16x32_bf16 v[96:99], a[240:243], v[232:235], v[96:99]
v_mfma_f32_16x16x32_bf16 v[104:107], a[240:243], v[236:239], v[104:107]
v_exp_f32 v168, v168
v_mfma_f32_16x16x32_bf16 v[108:111], a[244:247], v[236:239], v[108:111]
ds_read_b128 a[208:211], v1 offset:4352
s_add_u32 m0, s99, 138240
s_add_u32 s95, s94, 81920
v_mfma_f32_16x16x32_bf16 v[100:103], a[244:247], v[232:235], v[100:103]
buffer_load_dwordx4 v4, s[40:43], s95 offen offset:0 lds
v_exp_f32 v169, v169
v_mfma_f32_16x16x32_bf16 v[92:95], a[244:247], v[228:231], v[92:95]
ds_read_b128 a[212:215], v1 offset:4416
v_cvt_pk_bf16_f32 v220, v168, v169
v_mfma_f32_16x16x32_bf16 v[84:87], a[244:247], v[224:227], v[84:87]
v_exp_f32 v170, v170
v_mfma_f32_16x16x32_bf16 v[112:115], a[248:251], v[224:227], v[112:115]
ds_read_b128 a[216:219], v1 offset:4480
buffer_load_dwordx4 v5, s[40:43], s95 offen offset:1088 lds
v_mfma_f32_16x16x32_bf16 v[120:123], a[248:251], v[228:231], v[120:123]
v_exp_f32 v171, v171
v_mfma_f32_16x16x32_bf16 v[128:131], a[248:251], v[232:235], v[128:131]
ds_read_b128 a[220:223], v1 offset:4544
v_cvt_pk_bf16_f32 v221, v170, v171
v_mfma_f32_16x16x32_bf16 v[136:139], a[248:251], v[236:239], v[136:139]
v_exp_f32 v172, v172
v_mfma_f32_16x16x32_bf16 v[140:143], a[252:255], v[236:239], v[140:143]
buffer_load_dwordx4 v6, s[40:43], s95 offen offset:2176 lds
v_mfma_f32_16x16x32_bf16 v[132:135], a[252:255], v[232:235], v[132:135]
v_exp_f32 v173, v173
v_mfma_f32_16x16x32_bf16 v[124:127], a[252:255], v[228:231], v[124:127]
v_cvt_pk_bf16_f32 v222, v172, v173
v_mfma_f32_16x16x32_bf16 v[116:119], a[252:255], v[224:227], v[116:119]
v_exp_f32 v174, v174
v_mfma_f32_16x16x32_bf16 a[108:111], a[124:127], v[224:227], a[108:111]
buffer_load_dwordx4 v7, s[40:43], s95 offen offset:3264 lds
v_mfma_f32_16x16x32_bf16 a[112:115], a[124:127], v[228:231], a[112:115]
v_exp_f32 v175, v175
v_mfma_f32_16x16x32_bf16 a[116:119], a[124:127], v[232:235], a[116:119]
v_cvt_pk_bf16_f32 v223, v174, v175
v_mfma_f32_16x16x32_bf16 a[120:123], a[124:127], v[236:239], a[120:123]
s_waitcnt lgkmcnt(0)
v_mfma_f32_16x16x32_bf16 v[144:147], a[192:195], a[128:131], 0
v_exp_f32 v176, v176
v_mfma_f32_16x16x32_bf16 v[152:155], a[192:195], a[144:147], 0
ds_read_b64_tr_b16 a[224:225], v3 offset:0
s_add_u32 m0, s96, 120832
s_add_u32 s95, s94, 65536
v_mfma_f32_16x16x32_bf16 v[160:163], a[192:195], a[160:163], 0
buffer_load_dwordx4 v8, s[44:47], s95 offen offset:0 lds
v_exp_f32 v177, v177
v_mfma_f32_16x16x32_bf16 v[168:171], a[192:195], a[176:179], 0
ds_read_b64_tr_b16 a[226:227], v3 offset:512
v_cvt_pk_bf16_f32 v224, v176, v177
v_mfma_f32_16x16x32_bf16 v[168:171], a[196:199], a[180:183], v[168:171]
v_exp_f32 v178, v178
v_mfma_f32_16x16x32_bf16 v[160:163], a[196:199], a[164:167], v[160:163]
ds_read_b64_tr_b16 a[228:229], v3 offset:32
v_mfma_f32_16x16x32_bf16 v[152:155], a[196:199], a[148:151], v[152:155]
v_exp_f32 v179, v179
v_mfma_f32_16x16x32_bf16 v[144:147], a[196:199], a[132:135], v[144:147]
ds_read_b64_tr_b16 a[230:231], v3 offset:544
buffer_load_dwordx4 v9, s[44:47], s95 offen offset:1056 lds
v_cvt_pk_bf16_f32 v225, v178, v179
v_mfma_f32_16x16x32_bf16 v[144:147], a[200:203], a[136:139], v[144:147]
v_exp_f32 v180, v180
v_mfma_f32_16x16x32_bf16 v[152:155], a[200:203], a[152:155], v[152:155]
ds_read_b64_tr_b16 a[232:233], v3 offset:64
v_mfma_f32_16x16x32_bf16 v[160:163], a[200:203], a[168:171], v[160:163]
v_exp_f32 v181, v181
v_mfma_f32_16x16x32_bf16 v[168:171], a[200:203], a[184:187], v[168:171]
ds_read_b64_tr_b16 a[234:235], v3 offset:576
v_cvt_pk_bf16_f32 v226, v180, v181
v_mfma_f32_16x16x32_bf16 v[168:171], a[204:207], a[188:191], v[168:171]
v_exp_f32 v182, v182
v_mfma_f32_16x16x32_bf16 v[160:163], a[204:207], a[172:175], v[160:163]
ds_read_b64_tr_b16 a[236:237], v3 offset:96
buffer_load_dwordx4 v10, s[44:47], s95 offen offset:2112 lds
v_mfma_f32_16x16x32_bf16 v[152:155], a[204:207], a[156:159], v[152:155]
v_exp_f32 v183, v183
v_mfma_f32_16x16x32_bf16 v[144:147], a[204:207], a[140:143], v[144:147]
ds_read_b64_tr_b16 a[238:239], v3 offset:608
v_cvt_pk_bf16_f32 v227, v182, v183
v_mfma_f32_16x16x32_bf16 v[148:151], a[208:211], a[128:131], 0
v_mfma_f32_16x16x32_bf16 v[156:159], a[208:211], a[144:147], 0
v_exp_f32 v184, v184
v_mfma_f32_16x16x32_bf16 v[164:167], a[208:211], a[160:163], 0
ds_read_b64_tr_b16 a[240:241], v3 offset:128
v_mfma_f32_16x16x32_bf16 v[172:175], a[208:211], a[176:179], 0
buffer_load_dwordx4 v11, s[44:47], s95 offen offset:3168 lds
v_exp_f32 v185, v185
v_mfma_f32_16x16x32_bf16 v[172:175], a[212:215], a[180:183], v[172:175]
ds_read_b64_tr_b16 a[242:243], v3 offset:640
v_cvt_pk_bf16_f32 v228, v184, v185
v_mfma_f32_16x16x32_bf16 v[164:167], a[212:215], a[164:167], v[164:167]
v_exp_f32 v186, v186
v_mfma_f32_16x16x32_bf16 v[156:159], a[212:215], a[148:151], v[156:159]
ds_read_b64_tr_b16 a[244:245], v3 offset:160
v_mfma_f32_16x16x32_bf16 v[148:151], a[212:215], a[132:135], v[148:151]
v_exp_f32 v187, v187
v_mfma_f32_16x16x32_bf16 v[148:151], a[216:219], a[136:139], v[148:151]
ds_read_b64_tr_b16 a[246:247], v3 offset:672
v_cvt_pk_bf16_f32 v229, v186, v187
v_mfma_f32_16x16x32_bf16 v[156:159], a[216:219], a[152:155], v[156:159]
v_exp_f32 v188, v188
v_mfma_f32_16x16x32_bf16 v[164:167], a[216:219], a[168:171], v[164:167]
ds_read_b64_tr_b16 a[248:249], v3 offset:192
s_lshl_b32 s88, s3, 6
v_add_u32 v252, s88, v0
v_mfma_f32_16x16x32_bf16 v[172:175], a[216:219], a[184:187], v[172:175]
v_lshlrev_b32 v252, 3, v252
v_exp_f32 v189, v189
v_mfma_f32_16x16x32_bf16 v[172:175], a[220:223], a[188:191], v[172:175]
ds_read_b64_tr_b16 a[250:251], v3 offset:704
s_lshl_b32 s88, s4, 11
v_cvt_pk_bf16_f32 v230, v188, v189
v_mfma_f32_16x16x32_bf16 v[164:167], a[220:223], a[172:175], v[164:167]
s_add_u32 s88, s88, s94
v_exp_f32 v190, v190
v_mfma_f32_16x16x32_bf16 v[156:159], a[220:223], a[156:159], v[156:159]
ds_read_b64_tr_b16 a[252:253], v3 offset:224
s_add_u32 s88, s88, 507904
buffer_load_dword v253, v252, s[40:43], s88 offen
v_mfma_f32_16x16x32_bf16 v[148:151], a[220:223], a[140:143], v[148:151]
v_exp_f32 v191, v191
s_waitcnt lgkmcnt(7)
v_mfma_f32_16x16x32_bf16 v[16:19], a[224:227], v[208:211], v[16:19]
ds_read_b64_tr_b16 a[254:255], v3 offset:736
v_cvt_pk_bf16_f32 v231, v190, v191
v_mfma_f32_16x16x32_bf16 v[24:27], a[224:227], v[212:215], v[24:27]
v_mfma_f32_16x16x32_bf16 v[32:35], a[224:227], v[216:219], v[32:35]
v_exp_f32 v192, v192
v_mfma_f32_16x16x32_bf16 v[40:43], a[224:227], v[220:223], v[40:43]
v_mfma_f32_16x16x32_bf16 v[44:47], a[228:231], v[220:223], v[44:47]
v_exp_f32 v193, v193
v_mfma_f32_16x16x32_bf16 v[36:39], a[228:231], v[216:219], v[36:39]
buffer_load_dword v253, v252, s[44:47], s88 offen
v_cvt_pk_bf16_f32 v232, v192, v193
v_mfma_f32_16x16x32_bf16 v[28:31], a[228:231], v[212:215], v[28:31]
v_exp_f32 v194, v194
v_mfma_f32_16x16x32_bf16 v[20:23], a[228:231], v[208:211], v[20:23]
v_mfma_f32_16x16x32_bf16 v[48:51], a[232:235], v[208:211], v[48:51]
v_exp_f32 v195, v195
v_mfma_f32_16x16x32_bf16 v[56:59], a[232:235], v[212:215], v[56:59]
s_waitcnt lgkmcnt(0)
v_cvt_pk_bf16_f32 v233, v194, v195
v_mfma_f32_16x16x32_bf16 v[64:67], a[232:235], v[216:219], v[64:67]
v_exp_f32 v196, v196
v_mfma_f32_16x16x32_bf16 v[72:75], a[232:235], v[220:223], v[72:75]
ds_read_b128 a[192:195], v1 offset:8704
s_add_u32 s31, s12, 0
s_add_u32 m0, s96, 0
v_mfma_f32_16x16x32_bf16 v[76:79], a[236:239], v[220:223], v[76:79]
buffer_load_dwordx4 v240, s[64:67], s31 offen offset:0 lds
v_exp_f32 v197, v197
v_mfma_f32_16x16x32_bf16 v[68:71], a[236:239], v[216:219], v[68:71]
ds_read_b128 a[196:199], v1 offset:8768
v_cvt_pk_bf16_f32 v234, v196, v197
v_mfma_f32_16x16x32_bf16 v[60:63], a[236:239], v[212:215], v[60:63]
v_exp_f32 v198, v198
v_mfma_f32_16x16x32_bf16 v[52:55], a[236:239], v[208:211], v[52:55]
ds_read_b128 a[200:203], v1 offset:8832
v_mfma_f32_16x16x32_bf16 v[80:83], a[240:243], v[208:211], v[80:83]
v_exp_f32 v199, v199
v_mfma_f32_16x16x32_bf16 v[88:91], a[240:243], v[212:215], v[88:91]
ds_read_b128 a[204:207], v1 offset:8896
v_cvt_pk_bf16_f32 v235, v198, v199
v_mfma_f32_16x16x32_bf16 v[96:99], a[240:243], v[216:219], v[96:99]
buffer_load_dwordx4 v241, s[64:67], s31 offen offset:1056 lds
v_mfma_f32_16x16x32_bf16 v[104:107], a[240:243], v[220:223], v[104:107]
v_exp_f32 v200, v200
v_mfma_f32_16x16x32_bf16 v[108:111], a[244:247], v[220:223], v[108:111]
ds_read_b128 a[208:211], v1 offset:13056
v_mfma_f32_16x16x32_bf16 v[100:103], a[244:247], v[216:219], v[100:103]
v_exp_f32 v201, v201
v_mfma_f32_16x16x32_bf16 v[92:95], a[244:247], v[212:215], v[92:95]
ds_read_b128 a[212:215], v1 offset:13120
v_cvt_pk_bf16_f32 v236, v200, v201
v_mfma_f32_16x16x32_bf16 v[84:87], a[244:247], v[208:211], v[84:87]
v_exp_f32 v202, v202
v_mfma_f32_16x16x32_bf16 v[112:115], a[248:251], v[208:211], v[112:115]
ds_read_b128 a[216:219], v1 offset:13184
buffer_load_dwordx4 v242, s[64:67], s31 offen offset:2112 lds
v_mfma_f32_16x16x32_bf16 v[120:123], a[248:251], v[212:215], v[120:123]
v_exp_f32 v203, v203
v_mfma_f32_16x16x32_bf16 v[128:131], a[248:251], v[216:219], v[128:131]
ds_read_b128 a[220:223], v1 offset:13248
v_cvt_pk_bf16_f32 v237, v202, v203
v_mfma_f32_16x16x32_bf16 v[136:139], a[248:251], v[220:223], v[136:139]
v_exp_f32 v204, v204
v_mfma_f32_16x16x32_bf16 v[140:143], a[252:255], v[220:223], v[140:143]
v_mfma_f32_16x16x32_bf16 v[132:135], a[252:255], v[216:219], v[132:135]
v_exp_f32 v205, v205
v_mfma_f32_16x16x32_bf16 v[124:127], a[252:255], v[212:215], v[124:127]
buffer_load_dwordx4 v243, s[64:67], s31 offen offset:3168 lds
v_cvt_pk_bf16_f32 v238, v204, v205
v_mfma_f32_16x16x32_bf16 v[116:119], a[252:255], v[208:211], v[116:119]
v_exp_f32 v206, v206
v_mfma_f32_16x16x32_bf16 a[108:111], a[124:127], v[208:211], a[108:111]
v_mfma_f32_16x16x32_bf16 a[112:115], a[124:127], v[212:215], a[112:115]
v_exp_f32 v207, v207
v_mfma_f32_16x16x32_bf16 a[116:119], a[124:127], v[216:219], a[116:119]
v_cvt_pk_bf16_f32 v239, v206, v207
v_mfma_f32_16x16x32_bf16 a[120:123], a[124:127], v[220:223], a[120:123]
recurrent_scan__sliding_block_cached__mixer_s_mlp__prompt_kernel_c8:
s_waitcnt lgkmcnt(0)
v_mfma_f32_16x16x32_bf16 v[176:179], a[192:195], a[128:131], 0
v_exp_f32 v144, v144
v_mfma_f32_16x16x32_bf16 v[184:187], a[192:195], a[144:147], 0
ds_read_b64_tr_b16 a[224:225], v3 offset:8448
s_add_u32 s31, s12, 176128
s_add_u32 m0, s96, 16896
v_mfma_f32_16x16x32_bf16 v[192:195], a[192:195], a[160:163], 0
buffer_load_dwordx4 v240, s[64:67], s31 offen offset:0 lds
v_exp_f32 v145, v145
v_mfma_f32_16x16x32_bf16 v[200:203], a[192:195], a[176:179], 0
ds_read_b64_tr_b16 a[226:227], v3 offset:8960
v_cvt_pk_bf16_f32 v208, v144, v145
v_mfma_f32_16x16x32_bf16 v[200:203], a[196:199], a[180:183], v[200:203]
v_exp_f32 v146, v146
v_mfma_f32_16x16x32_bf16 v[192:195], a[196:199], a[164:167], v[192:195]
ds_read_b64_tr_b16 a[228:229], v3 offset:8480
v_mfma_f32_16x16x32_bf16 v[184:187], a[196:199], a[148:151], v[184:187]
v_exp_f32 v147, v147
v_mfma_f32_16x16x32_bf16 v[176:179], a[196:199], a[132:135], v[176:179]
ds_read_b64_tr_b16 a[230:231], v3 offset:8992
v_cvt_pk_bf16_f32 v209, v146, v147
v_mfma_f32_16x16x32_bf16 v[176:179], a[200:203], a[136:139], v[176:179]
v_exp_f32 v148, v148
v_mfma_f32_16x16x32_bf16 v[184:187], a[200:203], a[152:155], v[184:187]
ds_read_b64_tr_b16 a[232:233], v3 offset:8512
v_mfma_f32_16x16x32_bf16 v[192:195], a[200:203], a[168:171], v[192:195]
v_exp_f32 v149, v149
v_mfma_f32_16x16x32_bf16 v[200:203], a[200:203], a[184:187], v[200:203]
ds_read_b64_tr_b16 a[234:235], v3 offset:9024
buffer_load_dwordx4 v241, s[64:67], s31 offen offset:1056 lds
v_cvt_pk_bf16_f32 v210, v148, v149
v_mfma_f32_16x16x32_bf16 v[200:203], a[204:207], a[188:191], v[200:203]
v_exp_f32 v150, v150
v_mfma_f32_16x16x32_bf16 v[192:195], a[204:207], a[172:175], v[192:195]
ds_read_b64_tr_b16 a[236:237], v3 offset:8544
v_mfma_f32_16x16x32_bf16 v[184:187], a[204:207], a[156:159], v[184:187]
v_exp_f32 v151, v151
v_mfma_f32_16x16x32_bf16 v[176:179], a[204:207], a[140:143], v[176:179]
ds_read_b64_tr_b16 a[238:239], v3 offset:9056
v_cvt_pk_bf16_f32 v211, v150, v151
v_mfma_f32_16x16x32_bf16 v[180:183], a[208:211], a[128:131], 0
v_mfma_f32_16x16x32_bf16 v[188:191], a[208:211], a[144:147], 0
v_exp_f32 v152, v152
v_mfma_f32_16x16x32_bf16 v[196:199], a[208:211], a[160:163], 0
ds_read_b64_tr_b16 a[240:241], v3 offset:8576
v_mfma_f32_16x16x32_bf16 v[204:207], a[208:211], a[176:179], 0
v_exp_f32 v153, v153
v_mfma_f32_16x16x32_bf16 v[204:207], a[212:215], a[180:183], v[204:207]
ds_read_b64_tr_b16 a[242:243], v3 offset:9088
v_cvt_pk_bf16_f32 v212, v152, v153
v_mfma_f32_16x16x32_bf16 v[196:199], a[212:215], a[164:167], v[196:199]
v_exp_f32 v154, v154
v_mfma_f32_16x16x32_bf16 v[188:191], a[212:215], a[148:151], v[188:191]
ds_read_b64_tr_b16 a[244:245], v3 offset:8608
buffer_load_dwordx4 v242, s[64:67], s31 offen offset:2112 lds
v_mfma_f32_16x16x32_bf16 v[180:183], a[212:215], a[132:135], v[180:183]
v_exp_f32 v155, v155
v_mfma_f32_16x16x32_bf16 v[180:183], a[216:219], a[136:139], v[180:183]
ds_read_b64_tr_b16 a[246:247], v3 offset:9120
v_cvt_pk_bf16_f32 v213, v154, v155
v_mfma_f32_16x16x32_bf16 v[188:191], a[216:219], a[152:155], v[188:191]
v_exp_f32 v156, v156
v_mfma_f32_16x16x32_bf16 v[196:199], a[216:219], a[168:171], v[196:199]
ds_read_b64_tr_b16 a[248:249], v3 offset:8640
v_mfma_f32_16x16x32_bf16 v[204:207], a[216:219], a[184:187], v[204:207]
v_exp_f32 v157, v157
v_mfma_f32_16x16x32_bf16 v[204:207], a[220:223], a[188:191], v[204:207]
ds_read_b64_tr_b16 a[250:251], v3 offset:9152
v_cvt_pk_bf16_f32 v214, v156, v157
v_mfma_f32_16x16x32_bf16 v[196:199], a[220:223], a[172:175], v[196:199]
v_exp_f32 v158, v158
v_mfma_f32_16x16x32_bf16 v[188:191], a[220:223], a[156:159], v[188:191]
ds_read_b64_tr_b16 a[252:253], v3 offset:8672
v_mfma_f32_16x16x32_bf16 v[180:183], a[220:223], a[140:143], v[180:183]
buffer_load_dwordx4 v243, s[64:67], s31 offen offset:3168 lds
v_exp_f32 v159, v159
s_waitcnt lgkmcnt(7)
v_mfma_f32_16x16x32_bf16 v[16:19], a[224:227], v[224:227], v[16:19]
ds_read_b64_tr_b16 a[254:255], v3 offset:9184
v_cvt_pk_bf16_f32 v215, v158, v159
v_mfma_f32_16x16x32_bf16 v[24:27], a[224:227], v[228:231], v[24:27]
v_mfma_f32_16x16x32_bf16 v[32:35], a[224:227], v[232:235], v[32:35]
v_exp_f32 v160, v160
v_mfma_f32_16x16x32_bf16 v[40:43], a[224:227], v[236:239], v[40:43]
v_mfma_f32_16x16x32_bf16 v[44:47], a[228:231], v[236:239], v[44:47]
v_exp_f32 v161, v161
v_mfma_f32_16x16x32_bf16 v[36:39], a[228:231], v[232:235], v[36:39]
v_cvt_pk_bf16_f32 v216, v160, v161
v_mfma_f32_16x16x32_bf16 v[28:31], a[228:231], v[228:231], v[28:31]
v_exp_f32 v162, v162
v_mfma_f32_16x16x32_bf16 v[20:23], a[228:231], v[224:227], v[20:23]
v_mfma_f32_16x16x32_bf16 v[48:51], a[232:235], v[224:227], v[48:51]
v_exp_f32 v163, v163
v_mfma_f32_16x16x32_bf16 v[56:59], a[232:235], v[228:231], v[56:59]
s_waitcnt vmcnt(10) lgkmcnt(0)
s_barrier
v_cvt_pk_bf16_f32 v217, v162, v163
v_mfma_f32_16x16x32_bf16 v[64:67], a[232:235], v[232:235], v[64:67]
v_exp_f32 v164, v164
v_mfma_f32_16x16x32_bf16 v[72:75], a[232:235], v[236:239], v[72:75]
ds_read_b128 a[192:195], v1 offset:34816
v_mfma_f32_16x16x32_bf16 v[76:79], a[236:239], v[236:239], v[76:79]
v_exp_f32 v165, v165
v_mfma_f32_16x16x32_bf16 v[68:71], a[236:239], v[232:235], v[68:71]
ds_read_b128 a[196:199], v1 offset:34880
v_cvt_pk_bf16_f32 v218, v164, v165
v_mfma_f32_16x16x32_bf16 v[60:63], a[236:239], v[228:231], v[60:63]
v_exp_f32 v166, v166
v_mfma_f32_16x16x32_bf16 v[52:55], a[236:239], v[224:227], v[52:55]
ds_read_b128 a[200:203], v1 offset:34944
v_mfma_f32_16x16x32_bf16 v[80:83], a[240:243], v[224:227], v[80:83]
v_exp_f32 v167, v167
v_mfma_f32_16x16x32_bf16 v[88:91], a[240:243], v[228:231], v[88:91]
ds_read_b128 a[204:207], v1 offset:35008
v_cvt_pk_bf16_f32 v219, v166, v167
v_mfma_f32_16x16x32_bf16 v[96:99], a[240:243], v[232:235], v[96:99]
v_mfma_f32_16x16x32_bf16 v[104:107], a[240:243], v[236:239], v[104:107]
v_exp_f32 v168, v168
v_mfma_f32_16x16x32_bf16 v[108:111], a[244:247], v[236:239], v[108:111]
ds_read_b128 a[208:211], v1 offset:39168
s_add_u32 m0, s99, 103424
s_add_u32 s95, s94, 98304
v_mfma_f32_16x16x32_bf16 v[100:103], a[244:247], v[232:235], v[100:103]
buffer_load_dwordx4 v4, s[40:43], s95 offen offset:0 lds
v_exp_f32 v169, v169
v_mfma_f32_16x16x32_bf16 v[92:95], a[244:247], v[228:231], v[92:95]
ds_read_b128 a[212:215], v1 offset:39232
v_cvt_pk_bf16_f32 v220, v168, v169
v_mfma_f32_16x16x32_bf16 v[84:87], a[244:247], v[224:227], v[84:87]
v_exp_f32 v170, v170
v_mfma_f32_16x16x32_bf16 v[112:115], a[248:251], v[224:227], v[112:115]
ds_read_b128 a[216:219], v1 offset:39296
buffer_load_dwordx4 v5, s[40:43], s95 offen offset:1088 lds
v_mfma_f32_16x16x32_bf16 v[120:123], a[248:251], v[228:231], v[120:123]
v_exp_f32 v171, v171
v_mfma_f32_16x16x32_bf16 v[128:131], a[248:251], v[232:235], v[128:131]
ds_read_b128 a[220:223], v1 offset:39360
v_cvt_pk_bf16_f32 v221, v170, v171
v_mfma_f32_16x16x32_bf16 v[136:139], a[248:251], v[236:239], v[136:139]
v_exp_f32 v172, v172
v_mfma_f32_16x16x32_bf16 v[140:143], a[252:255], v[236:239], v[140:143]
buffer_load_dwordx4 v6, s[40:43], s95 offen offset:2176 lds
v_mfma_f32_16x16x32_bf16 v[132:135], a[252:255], v[232:235], v[132:135]
v_exp_f32 v173, v173
v_mfma_f32_16x16x32_bf16 v[124:127], a[252:255], v[228:231], v[124:127]
v_cvt_pk_bf16_f32 v222, v172, v173
v_mfma_f32_16x16x32_bf16 v[116:119], a[252:255], v[224:227], v[116:119]
v_exp_f32 v174, v174
v_mfma_f32_16x16x32_bf16 a[108:111], a[124:127], v[224:227], a[108:111]
buffer_load_dwordx4 v7, s[40:43], s95 offen offset:3264 lds
v_mfma_f32_16x16x32_bf16 a[112:115], a[124:127], v[228:231], a[112:115]
v_exp_f32 v175, v175
v_mfma_f32_16x16x32_bf16 a[116:119], a[124:127], v[232:235], a[116:119]
v_cvt_pk_bf16_f32 v223, v174, v175
v_mfma_f32_16x16x32_bf16 a[120:123], a[124:127], v[236:239], a[120:123]
s_waitcnt lgkmcnt(0)
v_mfma_f32_16x16x32_bf16 v[144:147], a[192:195], a[128:131], 0
v_exp_f32 v176, v176
v_mfma_f32_16x16x32_bf16 v[152:155], a[192:195], a[144:147], 0
ds_read_b64_tr_b16 a[224:225], v3 offset:34816
s_add_u32 m0, s96, 86016
s_add_u32 s95, s94, 81920
v_mfma_f32_16x16x32_bf16 v[160:163], a[192:195], a[160:163], 0
buffer_load_dwordx4 v8, s[44:47], s95 offen offset:0 lds
v_exp_f32 v177, v177
v_mfma_f32_16x16x32_bf16 v[168:171], a[192:195], a[176:179], 0
ds_read_b64_tr_b16 a[226:227], v3 offset:35328
v_cvt_pk_bf16_f32 v224, v176, v177
v_mfma_f32_16x16x32_bf16 v[168:171], a[196:199], a[180:183], v[168:171]
v_exp_f32 v178, v178
v_mfma_f32_16x16x32_bf16 v[160:163], a[196:199], a[164:167], v[160:163]
ds_read_b64_tr_b16 a[228:229], v3 offset:34848
v_mfma_f32_16x16x32_bf16 v[152:155], a[196:199], a[148:151], v[152:155]
v_exp_f32 v179, v179
v_mfma_f32_16x16x32_bf16 v[144:147], a[196:199], a[132:135], v[144:147]
ds_read_b64_tr_b16 a[230:231], v3 offset:35360
buffer_load_dwordx4 v9, s[44:47], s95 offen offset:1056 lds
v_cvt_pk_bf16_f32 v225, v178, v179
v_mfma_f32_16x16x32_bf16 v[144:147], a[200:203], a[136:139], v[144:147]
v_exp_f32 v180, v180
v_mfma_f32_16x16x32_bf16 v[152:155], a[200:203], a[152:155], v[152:155]
ds_read_b64_tr_b16 a[232:233], v3 offset:34880
v_mfma_f32_16x16x32_bf16 v[160:163], a[200:203], a[168:171], v[160:163]
v_exp_f32 v181, v181
v_mfma_f32_16x16x32_bf16 v[168:171], a[200:203], a[184:187], v[168:171]
ds_read_b64_tr_b16 a[234:235], v3 offset:35392
v_cvt_pk_bf16_f32 v226, v180, v181
v_mfma_f32_16x16x32_bf16 v[168:171], a[204:207], a[188:191], v[168:171]
v_exp_f32 v182, v182
v_mfma_f32_16x16x32_bf16 v[160:163], a[204:207], a[172:175], v[160:163]
ds_read_b64_tr_b16 a[236:237], v3 offset:34912
buffer_load_dwordx4 v10, s[44:47], s95 offen offset:2112 lds
v_mfma_f32_16x16x32_bf16 v[152:155], a[204:207], a[156:159], v[152:155]
v_exp_f32 v183, v183
v_mfma_f32_16x16x32_bf16 v[144:147], a[204:207], a[140:143], v[144:147]
ds_read_b64_tr_b16 a[238:239], v3 offset:35424
v_cvt_pk_bf16_f32 v227, v182, v183
v_mfma_f32_16x16x32_bf16 v[148:151], a[208:211], a[128:131], 0
v_mfma_f32_16x16x32_bf16 v[156:159], a[208:211], a[144:147], 0
v_exp_f32 v184, v184
v_mfma_f32_16x16x32_bf16 v[164:167], a[208:211], a[160:163], 0
ds_read_b64_tr_b16 a[240:241], v3 offset:34944
v_mfma_f32_16x16x32_bf16 v[172:175], a[208:211], a[176:179], 0
buffer_load_dwordx4 v11, s[44:47], s95 offen offset:3168 lds
v_exp_f32 v185, v185
v_mfma_f32_16x16x32_bf16 v[172:175], a[212:215], a[180:183], v[172:175]
ds_read_b64_tr_b16 a[242:243], v3 offset:35456
v_cvt_pk_bf16_f32 v228, v184, v185
v_mfma_f32_16x16x32_bf16 v[164:167], a[212:215], a[164:167], v[164:167]
v_exp_f32 v186, v186
v_mfma_f32_16x16x32_bf16 v[156:159], a[212:215], a[148:151], v[156:159]
ds_read_b64_tr_b16 a[244:245], v3 offset:34976
v_mfma_f32_16x16x32_bf16 v[148:151], a[212:215], a[132:135], v[148:151]
v_exp_f32 v187, v187
v_mfma_f32_16x16x32_bf16 v[148:151], a[216:219], a[136:139], v[148:151]
ds_read_b64_tr_b16 a[246:247], v3 offset:35488
s_add_u32 s31, s12, 352256
v_cvt_pk_bf16_f32 v229, v186, v187
v_mfma_f32_16x16x32_bf16 v[156:159], a[216:219], a[152:155], v[156:159]
v_exp_f32 v188, v188
v_mfma_f32_16x16x32_bf16 v[164:167], a[216:219], a[168:171], v[164:167]
ds_read_b64_tr_b16 a[248:249], v3 offset:35008
s_add_u32 m0, s96, 33792
s_nop 0
buffer_load_dwordx4 v240, s[64:67], s31 offen offset:0 lds
v_mfma_f32_16x16x32_bf16 v[172:175], a[216:219], a[184:187], v[172:175]
v_exp_f32 v189, v189
v_mfma_f32_16x16x32_bf16 v[172:175], a[220:223], a[188:191], v[172:175]
ds_read_b64_tr_b16 a[250:251], v3 offset:35520
v_cvt_pk_bf16_f32 v230, v188, v189
v_mfma_f32_16x16x32_bf16 v[164:167], a[220:223], a[172:175], v[164:167]
v_exp_f32 v190, v190
v_mfma_f32_16x16x32_bf16 v[156:159], a[220:223], a[156:159], v[156:159]
ds_read_b64_tr_b16 a[252:253], v3 offset:35040
v_mfma_f32_16x16x32_bf16 v[148:151], a[220:223], a[140:143], v[148:151]
v_exp_f32 v191, v191
s_waitcnt lgkmcnt(7)
v_mfma_f32_16x16x32_bf16 v[16:19], a[224:227], v[208:211], v[16:19]
ds_read_b64_tr_b16 a[254:255], v3 offset:35552
v_cvt_pk_bf16_f32 v231, v190, v191
v_mfma_f32_16x16x32_bf16 v[24:27], a[224:227], v[212:215], v[24:27]
buffer_load_dwordx4 v241, s[64:67], s31 offen offset:1056 lds
v_mfma_f32_16x16x32_bf16 v[32:35], a[224:227], v[216:219], v[32:35]
v_exp_f32 v192, v192
v_mfma_f32_16x16x32_bf16 v[40:43], a[224:227], v[220:223], v[40:43]
v_mfma_f32_16x16x32_bf16 v[44:47], a[228:231], v[220:223], v[44:47]
v_exp_f32 v193, v193
v_mfma_f32_16x16x32_bf16 v[36:39], a[228:231], v[216:219], v[36:39]
v_cvt_pk_bf16_f32 v232, v192, v193
v_mfma_f32_16x16x32_bf16 v[28:31], a[228:231], v[212:215], v[28:31]
v_exp_f32 v194, v194
v_mfma_f32_16x16x32_bf16 v[20:23], a[228:231], v[208:211], v[20:23]
buffer_load_dwordx4 v242, s[64:67], s31 offen offset:2112 lds
v_mfma_f32_16x16x32_bf16 v[48:51], a[232:235], v[208:211], v[48:51]
v_exp_f32 v195, v195
v_mfma_f32_16x16x32_bf16 v[56:59], a[232:235], v[212:215], v[56:59]
s_waitcnt lgkmcnt(0)
v_cvt_pk_bf16_f32 v233, v194, v195
v_mfma_f32_16x16x32_bf16 v[64:67], a[232:235], v[216:219], v[64:67]
v_exp_f32 v196, v196
v_mfma_f32_16x16x32_bf16 v[72:75], a[232:235], v[220:223], v[72:75]
ds_read_b128 a[192:195], v1 offset:43520
v_mfma_f32_16x16x32_bf16 v[76:79], a[236:239], v[220:223], v[76:79]
buffer_load_dwordx4 v243, s[64:67], s31 offen offset:3168 lds
v_exp_f32 v197, v197
v_mfma_f32_16x16x32_bf16 v[68:71], a[236:239], v[216:219], v[68:71]
ds_read_b128 a[196:199], v1 offset:43584
v_cvt_pk_bf16_f32 v234, v196, v197
v_mfma_f32_16x16x32_bf16 v[60:63], a[236:239], v[212:215], v[60:63]
v_exp_f32 v198, v198
v_mfma_f32_16x16x32_bf16 v[52:55], a[236:239], v[208:211], v[52:55]
ds_read_b128 a[200:203], v1 offset:43648
v_mfma_f32_16x16x32_bf16 v[80:83], a[240:243], v[208:211], v[80:83]
v_exp_f32 v199, v199
v_mfma_f32_16x16x32_bf16 v[88:91], a[240:243], v[212:215], v[88:91]
ds_read_b128 a[204:207], v1 offset:43712
v_cvt_pk_bf16_f32 v235, v198, v199
v_mfma_f32_16x16x32_bf16 v[96:99], a[240:243], v[216:219], v[96:99]
v_min_u32 v14, 42, v0
v_lshlrev_b32 v14, 8, v14
v_mfma_f32_16x16x32_bf16 v[104:107], a[240:243], v[220:223], v[104:107]
v_exp_f32 v200, v200
v_mfma_f32_16x16x32_bf16 v[108:111], a[244:247], v[220:223], v[108:111]
ds_read_b128 a[208:211], v1 offset:47872
v_add_u32 v14, 42, v14
v_mul_u32_u24 v14, 6097, v14
v_mfma_f32_16x16x32_bf16 v[100:103], a[244:247], v[216:219], v[100:103]
v_lshrrev_b32 v14, 18, v14
v_exp_f32 v201, v201
v_mfma_f32_16x16x32_bf16 v[92:95], a[244:247], v[212:215], v[92:95]
ds_read_b128 a[212:215], v1 offset:47936
v_mov_b32 v15, 0
v_cvt_pk_bf16_f32 v236, v200, v201
v_mfma_f32_16x16x32_bf16 v[84:87], a[244:247], v[208:211], v[84:87]
v_lshrrev_b32 v252, 4, v14
v_exp_f32 v202, v202
v_mfma_f32_16x16x32_bf16 v[112:115], a[248:251], v[208:211], v[112:115]
ds_read_b128 a[216:219], v1 offset:48000
v_and_b32 v252, 12, v252
buffer_load_dword v252, v252, s[84:87], 0 offen sc1
v_mfma_f32_16x16x32_bf16 v[120:123], a[248:251], v[212:215], v[120:123]
v_exp_f32 v203, v203
v_mfma_f32_16x16x32_bf16 v[128:131], a[248:251], v[216:219], v[128:131]
ds_read_b128 a[220:223], v1 offset:48064
v_cvt_pk_bf16_f32 v237, v202, v203
v_mfma_f32_16x16x32_bf16 v[136:139], a[248:251], v[220:223], v[136:139]
v_exp_f32 v204, v204
v_mfma_f32_16x16x32_bf16 v[140:143], a[252:255], v[220:223], v[140:143]
v_mfma_f32_16x16x32_bf16 v[132:135], a[252:255], v[216:219], v[132:135]
v_exp_f32 v205, v205
v_mfma_f32_16x16x32_bf16 v[124:127], a[252:255], v[212:215], v[124:127]
v_lshl_add_u32 v14, v14, 7, v15
buffer_load_dword v15, v14, s[76:79], s24 offen offset:0 sc1
v_cvt_pk_bf16_f32 v238, v204, v205
v_mfma_f32_16x16x32_bf16 v[116:119], a[252:255], v[208:211], v[116:119]
v_exp_f32 v206, v206
v_mfma_f32_16x16x32_bf16 a[108:111], a[124:127], v[208:211], a[108:111]
v_mfma_f32_16x16x32_bf16 a[112:115], a[124:127], v[212:215], a[112:115]
v_exp_f32 v207, v207
v_mfma_f32_16x16x32_bf16 a[116:119], a[124:127], v[216:219], a[116:119]
v_cvt_pk_bf16_f32 v239, v206, v207
v_mfma_f32_16x16x32_bf16 a[120:123], a[124:127], v[220:223], a[120:123]
s_waitcnt lgkmcnt(0)
v_mfma_f32_16x16x32_bf16 v[176:179], a[192:195], a[128:131], 0
v_exp_f32 v144, v144
v_mfma_f32_16x16x32_bf16 v[184:187], a[192:195], a[144:147], 0
ds_read_b64_tr_b16 a[224:225], v3 offset:43264
s_add_u32 s31, s12, 528384
s_add_u32 m0, s96, 50688
v_mfma_f32_16x16x32_bf16 v[192:195], a[192:195], a[160:163], 0
buffer_load_dwordx4 v240, s[64:67], s31 offen offset:0 lds
v_exp_f32 v145, v145
v_mfma_f32_16x16x32_bf16 v[200:203], a[192:195], a[176:179], 0
ds_read_b64_tr_b16 a[226:227], v3 offset:43776
v_cvt_pk_bf16_f32 v208, v144, v145
v_mfma_f32_16x16x32_bf16 v[200:203], a[196:199], a[180:183], v[200:203]
v_exp_f32 v146, v146
v_mfma_f32_16x16x32_bf16 v[192:195], a[196:199], a[164:167], v[192:195]
ds_read_b64_tr_b16 a[228:229], v3 offset:43296
v_mfma_f32_16x16x32_bf16 v[184:187], a[196:199], a[148:151], v[184:187]
v_exp_f32 v147, v147
v_mfma_f32_16x16x32_bf16 v[176:179], a[196:199], a[132:135], v[176:179]
ds_read_b64_tr_b16 a[230:231], v3 offset:43808
v_cvt_pk_bf16_f32 v209, v146, v147
v_mfma_f32_16x16x32_bf16 v[176:179], a[200:203], a[136:139], v[176:179]
v_exp_f32 v148, v148
v_mfma_f32_16x16x32_bf16 v[184:187], a[200:203], a[152:155], v[184:187]
ds_read_b64_tr_b16 a[232:233], v3 offset:43328
v_mfma_f32_16x16x32_bf16 v[192:195], a[200:203], a[168:171], v[192:195]
v_exp_f32 v149, v149
v_mfma_f32_16x16x32_bf16 v[200:203], a[200:203], a[184:187], v[200:203]
ds_read_b64_tr_b16 a[234:235], v3 offset:43840
buffer_load_dwordx4 v241, s[64:67], s31 offen offset:1056 lds
v_cvt_pk_bf16_f32 v210, v148, v149
v_mfma_f32_16x16x32_bf16 v[200:203], a[204:207], a[188:191], v[200:203]
v_exp_f32 v150, v150
v_mfma_f32_16x16x32_bf16 v[192:195], a[204:207], a[172:175], v[192:195]
ds_read_b64_tr_b16 a[236:237], v3 offset:43360
v_mfma_f32_16x16x32_bf16 v[184:187], a[204:207], a[156:159], v[184:187]
v_exp_f32 v151, v151
v_mfma_f32_16x16x32_bf16 v[176:179], a[204:207], a[140:143], v[176:179]
ds_read_b64_tr_b16 a[238:239], v3 offset:43872
v_cvt_pk_bf16_f32 v211, v150, v151
v_mfma_f32_16x16x32_bf16 v[180:183], a[208:211], a[128:131], 0
v_mfma_f32_16x16x32_bf16 v[188:191], a[208:211], a[144:147], 0
v_exp_f32 v152, v152
v_mfma_f32_16x16x32_bf16 v[196:199], a[208:211], a[160:163], 0
ds_read_b64_tr_b16 a[240:241], v3 offset:43392
v_mfma_f32_16x16x32_bf16 v[204:207], a[208:211], a[176:179], 0
v_exp_f32 v153, v153
v_mfma_f32_16x16x32_bf16 v[204:207], a[212:215], a[180:183], v[204:207]
ds_read_b64_tr_b16 a[242:243], v3 offset:43904
buffer_load_dwordx4 v242, s[64:67], s31 offen offset:2112 lds
v_cvt_pk_bf16_f32 v212, v152, v153
v_mfma_f32_16x16x32_bf16 v[196:199], a[212:215], a[164:167], v[196:199]
v_exp_f32 v154, v154
v_mfma_f32_16x16x32_bf16 v[188:191], a[212:215], a[148:151], v[188:191]
ds_read_b64_tr_b16 a[244:245], v3 offset:43424
v_mfma_f32_16x16x32_bf16 v[180:183], a[212:215], a[132:135], v[180:183]
v_exp_f32 v155, v155
v_mfma_f32_16x16x32_bf16 v[180:183], a[216:219], a[136:139], v[180:183]
ds_read_b64_tr_b16 a[246:247], v3 offset:43936
v_cvt_pk_bf16_f32 v213, v154, v155
v_mfma_f32_16x16x32_bf16 v[188:191], a[216:219], a[152:155], v[188:191]
v_exp_f32 v156, v156
v_mfma_f32_16x16x32_bf16 v[196:199], a[216:219], a[168:171], v[196:199]
ds_read_b64_tr_b16 a[248:249], v3 offset:43456
v_mfma_f32_16x16x32_bf16 v[204:207], a[216:219], a[184:187], v[204:207]
v_exp_f32 v157, v157
v_mfma_f32_16x16x32_bf16 v[204:207], a[220:223], a[188:191], v[204:207]
ds_read_b64_tr_b16 a[250:251], v3 offset:43968
v_cvt_pk_bf16_f32 v214, v156, v157
v_mfma_f32_16x16x32_bf16 v[196:199], a[220:223], a[172:175], v[196:199]
v_exp_f32 v158, v158
v_mfma_f32_16x16x32_bf16 v[188:191], a[220:223], a[156:159], v[188:191]
ds_read_b64_tr_b16 a[252:253], v3 offset:43488
buffer_load_dwordx4 v243, s[64:67], s31 offen offset:3168 lds
v_mfma_f32_16x16x32_bf16 v[180:183], a[220:223], a[140:143], v[180:183]
v_exp_f32 v159, v159
s_waitcnt lgkmcnt(7)
v_mfma_f32_16x16x32_bf16 v[16:19], a[224:227], v[224:227], v[16:19]
ds_read_b64_tr_b16 a[254:255], v3 offset:44000
v_cvt_pk_bf16_f32 v215, v158, v159
v_mfma_f32_16x16x32_bf16 v[24:27], a[224:227], v[228:231], v[24:27]
v_mfma_f32_16x16x32_bf16 v[32:35], a[224:227], v[232:235], v[32:35]
v_exp_f32 v160, v160
v_mfma_f32_16x16x32_bf16 v[40:43], a[224:227], v[236:239], v[40:43]
v_mfma_f32_16x16x32_bf16 v[44:47], a[228:231], v[236:239], v[44:47]
v_exp_f32 v161, v161
v_mfma_f32_16x16x32_bf16 v[36:39], a[228:231], v[232:235], v[36:39]
v_cvt_pk_bf16_f32 v216, v160, v161
v_mfma_f32_16x16x32_bf16 v[28:31], a[228:231], v[228:231], v[28:31]
v_exp_f32 v162, v162
v_mfma_f32_16x16x32_bf16 v[20:23], a[228:231], v[224:227], v[20:23]
s_waitcnt vmcnt(4)
v_cmp_ne_u32 vcc, v252, v15
s_cbranch_vccnz reslow_51
reback_52:
v_mfma_f32_16x16x32_bf16 v[48:51], a[232:235], v[224:227], v[48:51]
v_exp_f32 v163, v163
v_mfma_f32_16x16x32_bf16 v[56:59], a[232:235], v[228:231], v[56:59]
s_waitcnt lgkmcnt(0)
s_barrier
v_cvt_pk_bf16_f32 v217, v162, v163
v_mfma_f32_16x16x32_bf16 v[64:67], a[232:235], v[232:235], v[64:67]
v_exp_f32 v164, v164
v_mfma_f32_16x16x32_bf16 v[72:75], a[232:235], v[236:239], v[72:75]
ds_read_b128 a[192:195], v1 offset:0
v_mfma_f32_16x16x32_bf16 v[76:79], a[236:239], v[236:239], v[76:79]
v_exp_f32 v165, v165
v_mfma_f32_16x16x32_bf16 v[68:71], a[236:239], v[232:235], v[68:71]
ds_read_b128 a[196:199], v1 offset:64
v_cvt_pk_bf16_f32 v218, v164, v165
v_mfma_f32_16x16x32_bf16 v[60:63], a[236:239], v[228:231], v[60:63]
v_exp_f32 v166, v166
v_mfma_f32_16x16x32_bf16 v[52:55], a[236:239], v[224:227], v[52:55]
ds_read_b128 a[200:203], v1 offset:128
v_mfma_f32_16x16x32_bf16 v[80:83], a[240:243], v[224:227], v[80:83]
v_exp_f32 v167, v167
v_mfma_f32_16x16x32_bf16 v[88:91], a[240:243], v[228:231], v[88:91]
ds_read_b128 a[204:207], v1 offset:192
v_cvt_pk_bf16_f32 v219, v166, v167
v_mfma_f32_16x16x32_bf16 v[96:99], a[240:243], v[232:235], v[96:99]
v_mfma_f32_16x16x32_bf16 v[104:107], a[240:243], v[236:239], v[104:107]
v_exp_f32 v168, v168
v_mfma_f32_16x16x32_bf16 v[108:111], a[244:247], v[236:239], v[108:111]
ds_read_b128 a[208:211], v1 offset:4352
s_add_u32 m0, s99, 138240
s_add_u32 s95, s94, 114688
v_mfma_f32_16x16x32_bf16 v[100:103], a[244:247], v[232:235], v[100:103]
buffer_load_dwordx4 v4, s[40:43], s95 offen offset:0 lds
v_exp_f32 v169, v169
v_mfma_f32_16x16x32_bf16 v[92:95], a[244:247], v[228:231], v[92:95]
ds_read_b128 a[212:215], v1 offset:4416
v_cvt_pk_bf16_f32 v220, v168, v169
v_mfma_f32_16x16x32_bf16 v[84:87], a[244:247], v[224:227], v[84:87]
v_exp_f32 v170, v170
v_mfma_f32_16x16x32_bf16 v[112:115], a[248:251], v[224:227], v[112:115]
ds_read_b128 a[216:219], v1 offset:4480
buffer_load_dwordx4 v5, s[40:43], s95 offen offset:1088 lds
v_mfma_f32_16x16x32_bf16 v[120:123], a[248:251], v[228:231], v[120:123]
v_exp_f32 v171, v171
v_mfma_f32_16x16x32_bf16 v[128:131], a[248:251], v[232:235], v[128:131]
ds_read_b128 a[220:223], v1 offset:4544
v_cvt_pk_bf16_f32 v221, v170, v171
v_mfma_f32_16x16x32_bf16 v[136:139], a[248:251], v[236:239], v[136:139]
v_exp_f32 v172, v172
v_mfma_f32_16x16x32_bf16 v[140:143], a[252:255], v[236:239], v[140:143]
buffer_load_dwordx4 v6, s[40:43], s95 offen offset:2176 lds
v_mfma_f32_16x16x32_bf16 v[132:135], a[252:255], v[232:235], v[132:135]
v_exp_f32 v173, v173
v_mfma_f32_16x16x32_bf16 v[124:127], a[252:255], v[228:231], v[124:127]
v_cvt_pk_bf16_f32 v222, v172, v173
v_mfma_f32_16x16x32_bf16 v[116:119], a[252:255], v[224:227], v[116:119]
v_exp_f32 v174, v174
v_mfma_f32_16x16x32_bf16 a[108:111], a[124:127], v[224:227], a[108:111]
buffer_load_dwordx4 v7, s[40:43], s95 offen offset:3264 lds
v_mfma_f32_16x16x32_bf16 a[112:115], a[124:127], v[228:231], a[112:115]
v_exp_f32 v175, v175
v_mfma_f32_16x16x32_bf16 a[116:119], a[124:127], v[232:235], a[116:119]
v_cvt_pk_bf16_f32 v223, v174, v175
v_mfma_f32_16x16x32_bf16 a[120:123], a[124:127], v[236:239], a[120:123]
s_waitcnt lgkmcnt(0)
v_mfma_f32_16x16x32_bf16 v[144:147], a[192:195], a[128:131], 0
v_exp_f32 v176, v176
v_mfma_f32_16x16x32_bf16 v[152:155], a[192:195], a[144:147], 0
ds_read_b64_tr_b16 a[224:225], v3 offset:0
s_add_u32 m0, s96, 120832
s_add_u32 s95, s94, 98304
v_mfma_f32_16x16x32_bf16 v[160:163], a[192:195], a[160:163], 0
buffer_load_dwordx4 v8, s[44:47], s95 offen offset:0 lds
v_exp_f32 v177, v177
v_mfma_f32_16x16x32_bf16 v[168:171], a[192:195], a[176:179], 0
ds_read_b64_tr_b16 a[226:227], v3 offset:512
v_cvt_pk_bf16_f32 v224, v176, v177
v_mfma_f32_16x16x32_bf16 v[168:171], a[196:199], a[180:183], v[168:171]
v_exp_f32 v178, v178
v_mfma_f32_16x16x32_bf16 v[160:163], a[196:199], a[164:167], v[160:163]
ds_read_b64_tr_b16 a[228:229], v3 offset:32
v_mfma_f32_16x16x32_bf16 v[152:155], a[196:199], a[148:151], v[152:155]
v_exp_f32 v179, v179
v_mfma_f32_16x16x32_bf16 v[144:147], a[196:199], a[132:135], v[144:147]
ds_read_b64_tr_b16 a[230:231], v3 offset:544
v_cvt_pk_bf16_f32 v225, v178, v179
v_mfma_f32_16x16x32_bf16 v[144:147], a[200:203], a[136:139], v[144:147]
v_exp_f32 v180, v180
v_mfma_f32_16x16x32_bf16 v[152:155], a[200:203], a[152:155], v[152:155]
ds_read_b64_tr_b16 a[232:233], v3 offset:64
buffer_load_dwordx4 v9, s[44:47], s95 offen offset:1056 lds
v_mfma_f32_16x16x32_bf16 v[160:163], a[200:203], a[168:171], v[160:163]
v_exp_f32 v181, v181
v_mfma_f32_16x16x32_bf16 v[168:171], a[200:203], a[184:187], v[168:171]
ds_read_b64_tr_b16 a[234:235], v3 offset:576
v_cvt_pk_bf16_f32 v226, v180, v181
v_mfma_f32_16x16x32_bf16 v[168:171], a[204:207], a[188:191], v[168:171]
v_exp_f32 v182, v182
v_mfma_f32_16x16x32_bf16 v[160:163], a[204:207], a[172:175], v[160:163]
ds_read_b64_tr_b16 a[236:237], v3 offset:96
v_mfma_f32_16x16x32_bf16 v[152:155], a[204:207], a[156:159], v[152:155]
v_exp_f32 v183, v183
v_mfma_f32_16x16x32_bf16 v[144:147], a[204:207], a[140:143], v[144:147]
ds_read_b64_tr_b16 a[238:239], v3 offset:608
v_cvt_pk_bf16_f32 v227, v182, v183
v_mfma_f32_16x16x32_bf16 v[148:151], a[208:211], a[128:131], 0
v_mfma_f32_16x16x32_bf16 v[156:159], a[208:211], a[144:147], 0
v_exp_f32 v184, v184
v_mfma_f32_16x16x32_bf16 v[164:167], a[208:211], a[160:163], 0
ds_read_b64_tr_b16 a[240:241], v3 offset:128
buffer_load_dwordx4 v10, s[44:47], s95 offen offset:2112 lds
v_mfma_f32_16x16x32_bf16 v[172:175], a[208:211], a[176:179], 0
v_exp_f32 v185, v185
v_mfma_f32_16x16x32_bf16 v[172:175], a[212:215], a[180:183], v[172:175]
ds_read_b64_tr_b16 a[242:243], v3 offset:640
v_cvt_pk_bf16_f32 v228, v184, v185
v_mfma_f32_16x16x32_bf16 v[164:167], a[212:215], a[164:167], v[164:167]
v_exp_f32 v186, v186
v_mfma_f32_16x16x32_bf16 v[156:159], a[212:215], a[148:151], v[156:159]
ds_read_b64_tr_b16 a[244:245], v3 offset:160
v_mfma_f32_16x16x32_bf16 v[148:151], a[212:215], a[132:135], v[148:151]
v_exp_f32 v187, v187
v_mfma_f32_16x16x32_bf16 v[148:151], a[216:219], a[136:139], v[148:151]
ds_read_b64_tr_b16 a[246:247], v3 offset:672
v_cvt_pk_bf16_f32 v229, v186, v187
v_mfma_f32_16x16x32_bf16 v[156:159], a[216:219], a[152:155], v[156:159]
v_exp_f32 v188, v188
v_mfma_f32_16x16x32_bf16 v[164:167], a[216:219], a[168:171], v[164:167]
ds_read_b64_tr_b16 a[248:249], v3 offset:192
buffer_load_dwordx4 v11, s[44:47], s95 offen offset:3168 lds
v_mfma_f32_16x16x32_bf16 v[172:175], a[216:219], a[184:187], v[172:175]
v_exp_f32 v189, v189
v_mfma_f32_16x16x32_bf16 v[172:175], a[220:223], a[188:191], v[172:175]
ds_read_b64_tr_b16 a[250:251], v3 offset:704
v_cvt_pk_bf16_f32 v230, v188, v189
v_mfma_f32_16x16x32_bf16 v[164:167], a[220:223], a[172:175], v[164:167]
v_exp_f32 v190, v190
v_mfma_f32_16x16x32_bf16 v[156:159], a[220:223], a[156:159], v[156:159]
ds_read_b64_tr_b16 a[252:253], v3 offset:224
v_mfma_f32_16x16x32_bf16 v[148:151], a[220:223], a[140:143], v[148:151]
v_exp_f32 v191, v191
s_waitcnt lgkmcnt(7)
v_mfma_f32_16x16x32_bf16 v[16:19], a[224:227], v[208:211], v[16:19]
ds_read_b64_tr_b16 a[254:255], v3 offset:736
v_cvt_pk_bf16_f32 v231, v190, v191
v_mfma_f32_16x16x32_bf16 v[24:27], a[224:227], v[212:215], v[24:27]
v_mfma_f32_16x16x32_bf16 v[32:35], a[224:227], v[216:219], v[32:35]
v_exp_f32 v192, v192
v_mfma_f32_16x16x32_bf16 v[40:43], a[224:227], v[220:223], v[40:43]
s_add_u32 s31, s12, 704512
s_add_u32 m0, s96, 67584
s_nop 0
buffer_load_dwordx4 v240, s[64:67], s31 offen offset:0 lds
v_mfma_f32_16x16x32_bf16 v[44:47], a[228:231], v[220:223], v[44:47]
v_exp_f32 v193, v193
v_mfma_f32_16x16x32_bf16 v[36:39], a[228:231], v[216:219], v[36:39]
v_cvt_pk_bf16_f32 v232, v192, v193
v_mfma_f32_16x16x32_bf16 v[28:31], a[228:231], v[212:215], v[28:31]
v_exp_f32 v194, v194
v_mfma_f32_16x16x32_bf16 v[20:23], a[228:231], v[208:211], v[20:23]
v_mfma_f32_16x16x32_bf16 v[48:51], a[232:235], v[208:211], v[48:51]
v_exp_f32 v195, v195
v_mfma_f32_16x16x32_bf16 v[56:59], a[232:235], v[212:215], v[56:59]
s_waitcnt lgkmcnt(0)
v_cvt_pk_bf16_f32 v233, v194, v195
v_mfma_f32_16x16x32_bf16 v[64:67], a[232:235], v[216:219], v[64:67]
v_exp_f32 v196, v196
v_mfma_f32_16x16x32_bf16 v[72:75], a[232:235], v[220:223], v[72:75]
ds_read_b128 a[192:195], v1 offset:8704
buffer_load_dwordx4 v241, s[64:67], s31 offen offset:1056 lds
v_mfma_f32_16x16x32_bf16 v[76:79], a[236:239], v[220:223], v[76:79]
v_exp_f32 v197, v197
v_mfma_f32_16x16x32_bf16 v[68:71], a[236:239], v[216:219], v[68:71]
ds_read_b128 a[196:199], v1 offset:8768
v_cvt_pk_bf16_f32 v234, v196, v197
v_mfma_f32_16x16x32_bf16 v[60:63], a[236:239], v[212:215], v[60:63]
v_exp_f32 v198, v198
v_mfma_f32_16x16x32_bf16 v[52:55], a[236:239], v[208:211], v[52:55]
ds_read_b128 a[200:203], v1 offset:8832
v_mfma_f32_16x16x32_bf16 v[80:83], a[240:243], v[208:211], v[80:83]
v_exp_f32 v199, v199
v_mfma_f32_16x16x32_bf16 v[88:91], a[240:243], v[212:215], v[88:91]
ds_read_b128 a[204:207], v1 offset:8896
v_cvt_pk_bf16_f32 v235, v198, v199
v_mfma_f32_16x16x32_bf16 v[96:99], a[240:243], v[216:219], v[96:99]
v_mfma_f32_16x16x32_bf16 v[104:107], a[240:243], v[220:223], v[104:107]
v_exp_f32 v200, v200
v_mfma_f32_16x16x32_bf16 v[108:111], a[244:247], v[220:223], v[108:111]
ds_read_b128 a[208:211], v1 offset:13056
buffer_load_dwordx4 v242, s[64:67], s31 offen offset:2112 lds
v_mfma_f32_16x16x32_bf16 v[100:103], a[244:247], v[216:219], v[100:103]
v_exp_f32 v201, v201
v_mfma_f32_16x16x32_bf16 v[92:95], a[244:247], v[212:215], v[92:95]
ds_read_b128 a[212:215], v1 offset:13120
v_cvt_pk_bf16_f32 v236, v200, v201
v_mfma_f32_16x16x32_bf16 v[84:87], a[244:247], v[208:211], v[84:87]
v_exp_f32 v202, v202
v_mfma_f32_16x16x32_bf16 v[112:115], a[248:251], v[208:211], v[112:115]
ds_read_b128 a[216:219], v1 offset:13184
v_mfma_f32_16x16x32_bf16 v[120:123], a[248:251], v[212:215], v[120:123]
v_exp_f32 v203, v203
v_mfma_f32_16x16x32_bf16 v[128:131], a[248:251], v[216:219], v[128:131]
ds_read_b128 a[220:223], v1 offset:13248
v_cvt_pk_bf16_f32 v237, v202, v203
v_mfma_f32_16x16x32_bf16 v[136:139], a[248:251], v[220:223], v[136:139]
v_exp_f32 v204, v204
v_mfma_f32_16x16x32_bf16 v[140:143], a[252:255], v[220:223], v[140:143]
buffer_load_dwordx4 v243, s[64:67], s31 offen offset:3168 lds
v_mfma_f32_16x16x32_bf16 v[132:135], a[252:255], v[216:219], v[132:135]
v_exp_f32 v205, v205
v_mfma_f32_16x16x32_bf16 v[124:127], a[252:255], v[212:215], v[124:127]
v_cvt_pk_bf16_f32 v238, v204, v205
v_mfma_f32_16x16x32_bf16 v[116:119], a[252:255], v[208:211], v[116:119]
v_exp_f32 v206, v206
v_mfma_f32_16x16x32_bf16 a[108:111], a[124:127], v[208:211], a[108:111]
v_mfma_f32_16x16x32_bf16 a[112:115], a[124:127], v[212:215], a[112:115]
v_exp_f32 v207, v207
v_mfma_f32_16x16x32_bf16 a[116:119], a[124:127], v[216:219], a[116:119]
v_cvt_pk_bf16_f32 v239, v206, v207
v_mfma_f32_16x16x32_bf16 a[120:123], a[124:127], v[220:223], a[120:123]
s_waitcnt lgkmcnt(0)
v_mfma_f32_16x16x32_bf16 v[176:179], a[192:195], a[128:131], 0
v_exp_f32 v144, v144
v_mfma_f32_16x16x32_bf16 v[184:187], a[192:195], a[144:147], 0
ds_read_b64_tr_b16 a[224:225], v3 offset:8448
s_lshl_b32 s88, s3, 6
v_mfma_f32_16x16x32_bf16 v[192:195], a[192:195], a[160:163], 0
v_add_u32 v252, s88, v0
v_exp_f32 v145, v145
v_mfma_f32_16x16x32_bf16 v[200:203], a[192:195], a[176:179], 0
ds_read_b64_tr_b16 a[226:227], v3 offset:8960
v_cvt_pk_bf16_f32 v208, v144, v145
v_mfma_f32_16x16x32_bf16 v[200:203], a[196:199], a[180:183], v[200:203]
v_exp_f32 v146, v146
v_mfma_f32_16x16x32_bf16 v[192:195], a[196:199], a[164:167], v[192:195]
ds_read_b64_tr_b16 a[228:229], v3 offset:8480
v_lshlrev_b32 v252, 6, v252
v_mfma_f32_16x16x32_bf16 v[184:187], a[196:199], a[148:151], v[184:187]
v_exp_f32 v147, v147
v_mfma_f32_16x16x32_bf16 v[176:179], a[196:199], a[132:135], v[176:179]
ds_read_b64_tr_b16 a[230:231], v3 offset:8992
v_cvt_pk_bf16_f32 v209, v146, v147
v_mfma_f32_16x16x32_bf16 v[176:179], a[200:203], a[136:139], v[176:179]
v_exp_f32 v148, v148
v_mfma_f32_16x16x32_bf16 v[184:187], a[200:203], a[152:155], v[184:187]
ds_read_b64_tr_b16 a[232:233], v3 offset:8512
s_lshr_b32 s89, s2, 3
v_mfma_f32_16x16x32_bf16 v[192:195], a[200:203], a[168:171], v[192:195]
s_lshl_b32 s88, s6, 5
v_exp_f32 v149, v149
v_mfma_f32_16x16x32_bf16 v[200:203], a[200:203], a[184:187], v[200:203]
ds_read_b64_tr_b16 a[234:235], v3 offset:9024
v_cvt_pk_bf16_f32 v210, v148, v149
v_mfma_f32_16x16x32_bf16 v[200:203], a[204:207], a[188:191], v[200:203]
v_exp_f32 v150, v150
v_mfma_f32_16x16x32_bf16 v[192:195], a[204:207], a[172:175], v[192:195]
ds_read_b64_tr_b16 a[236:237], v3 offset:8544
s_add_u32 s88, s88, s89
v_mfma_f32_16x16x32_bf16 v[184:187], a[204:207], a[156:159], v[184:187]
v_exp_f32 v151, v151
v_mfma_f32_16x16x32_bf16 v[176:179], a[204:207], a[140:143], v[176:179]
ds_read_b64_tr_b16 a[238:239], v3 offset:9056
v_cvt_pk_bf16_f32 v211, v150, v151
v_mfma_f32_16x16x32_bf16 v[180:183], a[208:211], a[128:131], 0
s_lshl_b32 s88, s88, 14
v_mfma_f32_16x16x32_bf16 v[188:191], a[208:211], a[144:147], 0
v_exp_f32 v152, v152
v_mfma_f32_16x16x32_bf16 v[196:199], a[208:211], a[160:163], 0
ds_read_b64_tr_b16 a[240:241], v3 offset:8576
buffer_load_dword v253, v252, s[52:55], s88 offen offset:128
v_mfma_f32_16x16x32_bf16 v[204:207], a[208:211], a[176:179], 0
v_exp_f32 v153, v153
v_mfma_f32_16x16x32_bf16 v[204:207], a[212:215], a[180:183], v[204:207]
ds_read_b64_tr_b16 a[242:243], v3 offset:9088
v_cvt_pk_bf16_f32 v212, v152, v153
v_mfma_f32_16x16x32_bf16 v[196:199], a[212:215], a[164:167], v[196:199]
v_exp_f32 v154, v154
v_mfma_f32_16x16x32_bf16 v[188:191], a[212:215], a[148:151], v[188:191]
ds_read_b64_tr_b16 a[244:245], v3 offset:8608
v_mfma_f32_16x16x32_bf16 v[180:183], a[212:215], a[132:135], v[180:183]
v_exp_f32 v155, v155
v_mfma_f32_16x16x32_bf16 v[180:183], a[216:219], a[136:139], v[180:183]
ds_read_b64_tr_b16 a[246:247], v3 offset:9120
v_cvt_pk_bf16_f32 v213, v154, v155
v_mfma_f32_16x16x32_bf16 v[188:191], a[216:219], a[152:155], v[188:191]
v_exp_f32 v156, v156
v_mfma_f32_16x16x32_bf16 v[196:199], a[216:219], a[168:171], v[196:199]
ds_read_b64_tr_b16 a[248:249], v3 offset:8640
v_mfma_f32_16x16x32_bf16 v[204:207], a[216:219], a[184:187], v[204:207]
v_exp_f32 v157, v157
v_mfma_f32_16x16x32_bf16 v[204:207], a[220:223], a[188:191], v[204:207]
ds_read_b64_tr_b16 a[250:251], v3 offset:9152
v_cvt_pk_bf16_f32 v214, v156, v157
v_mfma_f32_16x16x32_bf16 v[196:199], a[220:223], a[172:175], v[196:199]
v_exp_f32 v158, v158
v_mfma_f32_16x16x32_bf16 v[188:191], a[220:223], a[156:159], v[188:191]
ds_read_b64_tr_b16 a[252:253], v3 offset:8672
v_mfma_f32_16x16x32_bf16 v[180:183], a[220:223], a[140:143], v[180:183]
v_exp_f32 v159, v159
s_waitcnt lgkmcnt(7)
v_mfma_f32_16x16x32_bf16 v[16:19], a[224:227], v[224:227], v[16:19]
ds_read_b64_tr_b16 a[254:255], v3 offset:9184
v_cvt_pk_bf16_f32 v215, v158, v159
v_mfma_f32_16x16x32_bf16 v[24:27], a[224:227], v[228:231], v[24:27]
v_mfma_f32_16x16x32_bf16 v[32:35], a[224:227], v[232:235], v[32:35]
v_exp_f32 v160, v160
v_mfma_f32_16x16x32_bf16 v[40:43], a[224:227], v[236:239], v[40:43]
v_mfma_f32_16x16x32_bf16 v[44:47], a[228:231], v[236:239], v[44:47]
v_exp_f32 v161, v161
v_mfma_f32_16x16x32_bf16 v[36:39], a[228:231], v[232:235], v[36:39]
v_cvt_pk_bf16_f32 v216, v160, v161
v_mfma_f32_16x16x32_bf16 v[28:31], a[228:231], v[228:231], v[28:31]
v_exp_f32 v162, v162
v_mfma_f32_16x16x32_bf16 v[20:23], a[228:231], v[224:227], v[20:23]
v_mfma_f32_16x16x32_bf16 v[48:51], a[232:235], v[224:227], v[48:51]
v_exp_f32 v163, v163
v_mfma_f32_16x16x32_bf16 v[56:59], a[232:235], v[228:231], v[56:59]
s_waitcnt vmcnt(5) lgkmcnt(0)
s_barrier
v_cvt_pk_bf16_f32 v217, v162, v163
v_mfma_f32_16x16x32_bf16 v[64:67], a[232:235], v[232:235], v[64:67]
v_exp_f32 v164, v164
v_mfma_f32_16x16x32_bf16 v[72:75], a[232:235], v[236:239], v[72:75]
ds_read_b128 a[192:195], v1 offset:34816
v_mfma_f32_16x16x32_bf16 v[76:79], a[236:239], v[236:239], v[76:79]
v_exp_f32 v165, v165
v_mfma_f32_16x16x32_bf16 v[68:71], a[236:239], v[232:235], v[68:71]
ds_read_b128 a[196:199], v1 offset:34880
v_cvt_pk_bf16_f32 v218, v164, v165
v_mfma_f32_16x16x32_bf16 v[60:63], a[236:239], v[228:231], v[60:63]
v_exp_f32 v166, v166
v_mfma_f32_16x16x32_bf16 v[52:55], a[236:239], v[224:227], v[52:55]
ds_read_b128 a[200:203], v1 offset:34944
v_mfma_f32_16x16x32_bf16 v[80:83], a[240:243], v[224:227], v[80:83]
v_exp_f32 v167, v167
v_mfma_f32_16x16x32_bf16 v[88:91], a[240:243], v[228:231], v[88:91]
ds_read_b128 a[204:207], v1 offset:35008
v_cvt_pk_bf16_f32 v219, v166, v167
v_mfma_f32_16x16x32_bf16 v[96:99], a[240:243], v[232:235], v[96:99]
v_mfma_f32_16x16x32_bf16 v[104:107], a[240:243], v[236:239], v[104:107]
v_exp_f32 v168, v168
v_mfma_f32_16x16x32_bf16 v[108:111], a[244:247], v[236:239], v[108:111]
ds_read_b128 a[208:211], v1 offset:39168
s_add_u32 m0, s96, 86016
s_add_u32 s95, s94, 114688
v_mfma_f32_16x16x32_bf16 v[100:103], a[244:247], v[232:235], v[100:103]
buffer_load_dwordx4 v8, s[44:47], s95 offen offset:0 lds
v_exp_f32 v169, v169
v_mfma_f32_16x16x32_bf16 v[92:95], a[244:247], v[228:231], v[92:95]
ds_read_b128 a[212:215], v1 offset:39232
v_cvt_pk_bf16_f32 v220, v168, v169
v_mfma_f32_16x16x32_bf16 v[84:87], a[244:247], v[224:227], v[84:87]
v_exp_f32 v170, v170
v_mfma_f32_16x16x32_bf16 v[112:115], a[248:251], v[224:227], v[112:115]
ds_read_b128 a[216:219], v1 offset:39296
buffer_load_dwordx4 v9, s[44:47], s95 offen offset:1056 lds
v_mfma_f32_16x16x32_bf16 v[120:123], a[248:251], v[228:231], v[120:123]
v_exp_f32 v171, v171
v_mfma_f32_16x16x32_bf16 v[128:131], a[248:251], v[232:235], v[128:131]
ds_read_b128 a[220:223], v1 offset:39360
v_cvt_pk_bf16_f32 v221, v170, v171
v_mfma_f32_16x16x32_bf16 v[136:139], a[248:251], v[236:239], v[136:139]
v_exp_f32 v172, v172
v_mfma_f32_16x16x32_bf16 v[140:143], a[252:255], v[236:239], v[140:143]
buffer_load_dwordx4 v10, s[44:47], s95 offen offset:2112 lds
v_mfma_f32_16x16x32_bf16 v[132:135], a[252:255], v[232:235], v[132:135]
v_exp_f32 v173, v173
v_mfma_f32_16x16x32_bf16 v[124:127], a[252:255], v[228:231], v[124:127]
v_cvt_pk_bf16_f32 v222, v172, v173
v_mfma_f32_16x16x32_bf16 v[116:119], a[252:255], v[224:227], v[116:119]
v_exp_f32 v174, v174
v_mfma_f32_16x16x32_bf16 a[108:111], a[124:127], v[224:227], a[108:111]
buffer_load_dwordx4 v11, s[44:47], s95 offen offset:3168 lds
v_mfma_f32_16x16x32_bf16 a[112:115], a[124:127], v[228:231], a[112:115]
v_exp_f32 v175, v175
v_mfma_f32_16x16x32_bf16 a[116:119], a[124:127], v[232:235], a[116:119]
v_cvt_pk_bf16_f32 v223, v174, v175
v_mfma_f32_16x16x32_bf16 a[120:123], a[124:127], v[236:239], a[120:123]
s_waitcnt lgkmcnt(0)
v_mfma_f32_16x16x32_bf16 v[144:147], a[192:195], a[128:131], 0
v_exp_f32 v176, v176
v_mfma_f32_16x16x32_bf16 v[152:155], a[192:195], a[144:147], 0
ds_read_b64_tr_b16 a[224:225], v3 offset:34816
s_lshl_b32 s88, s4, 2
v_mfma_f32_16x16x32_bf16 v[160:163], a[192:195], a[160:163], 0
s_add_u32 s88, s88, s3
v_exp_f32 v177, v177
v_mfma_f32_16x16x32_bf16 v[168:171], a[192:195], a[176:179], 0
ds_read_b64_tr_b16 a[226:227], v3 offset:35328
v_cvt_pk_bf16_f32 v224, v176, v177
v_mfma_f32_16x16x32_bf16 v[168:171], a[196:199], a[180:183], v[168:171]
v_exp_f32 v178, v178
v_mfma_f32_16x16x32_bf16 v[160:163], a[196:199], a[164:167], v[160:163]
ds_read_b64_tr_b16 a[228:229], v3 offset:34848
s_and_b32 s88, s88, 15
v_mfma_f32_16x16x32_bf16 v[152:155], a[196:199], a[148:151], v[152:155]
v_exp_f32 v179, v179
v_mfma_f32_16x16x32_bf16 v[144:147], a[196:199], a[132:135], v[144:147]
ds_read_b64_tr_b16 a[230:231], v3 offset:35360
v_cvt_pk_bf16_f32 v225, v178, v179
v_mfma_f32_16x16x32_bf16 v[144:147], a[200:203], a[136:139], v[144:147]
v_exp_f32 v180, v180
v_mfma_f32_16x16x32_bf16 v[152:155], a[200:203], a[152:155], v[152:155]
ds_read_b64_tr_b16 a[232:233], v3 offset:34880
s_lshl_b32 s88, s88, 10
v_mfma_f32_16x16x32_bf16 v[160:163], a[200:203], a[168:171], v[160:163]
v_lshlrev_b32 v252, 4, v0
v_exp_f32 v181, v181
v_mfma_f32_16x16x32_bf16 v[168:171], a[200:203], a[184:187], v[168:171]
ds_read_b64_tr_b16 a[234:235], v3 offset:35392
v_cvt_pk_bf16_f32 v226, v180, v181
v_mfma_f32_16x16x32_bf16 v[168:171], a[204:207], a[188:191], v[168:171]
v_exp_f32 v182, v182
v_mfma_f32_16x16x32_bf16 v[160:163], a[204:207], a[172:175], v[160:163]
ds_read_b64_tr_b16 a[236:237], v3 offset:34912
s_add_u32 s88, s88, recurrent_scan__sliding_block_cached__mixer_s_mlp__prompt_kernel_co-recurrent_scan__sliding_block_cached__mixer_s_mlp__prompt_kernel_pc
v_mfma_f32_16x16x32_bf16 v[152:155], a[204:207], a[156:159], v[152:155]
v_exp_f32 v183, v183
v_mfma_f32_16x16x32_bf16 v[144:147], a[204:207], a[140:143], v[144:147]
ds_read_b64_tr_b16 a[238:239], v3 offset:35424
v_cvt_pk_bf16_f32 v227, v182, v183
v_mfma_f32_16x16x32_bf16 v[148:151], a[208:211], a[128:131], 0
v_mfma_f32_16x16x32_bf16 v[156:159], a[208:211], a[144:147], 0
v_exp_f32 v184, v184
v_mfma_f32_16x16x32_bf16 v[164:167], a[208:211], a[160:163], 0
ds_read_b64_tr_b16 a[240:241], v3 offset:34944
v_mfma_f32_16x16x32_bf16 v[172:175], a[208:211], a[176:179], 0
v_exp_f32 v185, v185
v_mfma_f32_16x16x32_bf16 v[172:175], a[212:215], a[180:183], v[172:175]
ds_read_b64_tr_b16 a[242:243], v3 offset:35456
buffer_load_dword v253, v252, s[72:75], s88 offen
v_cvt_pk_bf16_f32 v228, v184, v185
v_mfma_f32_16x16x32_bf16 v[164:167], a[212:215], a[164:167], v[164:167]
v_exp_f32 v186, v186
v_mfma_f32_16x16x32_bf16 v[156:159], a[212:215], a[148:151], v[156:159]
ds_read_b64_tr_b16 a[244:245], v3 offset:34976
v_mfma_f32_16x16x32_bf16 v[148:151], a[212:215], a[132:135], v[148:151]
v_exp_f32 v187, v187
v_mfma_f32_16x16x32_bf16 v[148:151], a[216:219], a[136:139], v[148:151]
ds_read_b64_tr_b16 a[246:247], v3 offset:35488
v_cvt_pk_bf16_f32 v229, v186, v187
v_mfma_f32_16x16x32_bf16 v[156:159], a[216:219], a[152:155], v[156:159]
v_exp_f32 v188, v188
v_mfma_f32_16x16x32_bf16 v[164:167], a[216:219], a[168:171], v[164:167]
ds_read_b64_tr_b16 a[248:249], v3 offset:35008
v_mfma_f32_16x16x32_bf16 v[172:175], a[216:219], a[184:187], v[172:175]
v_exp_f32 v189, v189
v_mfma_f32_16x16x32_bf16 v[172:175], a[220:223], a[188:191], v[172:175]
ds_read_b64_tr_b16 a[250:251], v3 offset:35520
v_cvt_pk_bf16_f32 v230, v188, v189
v_mfma_f32_16x16x32_bf16 v[164:167], a[220:223], a[172:175], v[164:167]
v_exp_f32 v190, v190
v_mfma_f32_16x16x32_bf16 v[156:159], a[220:223], a[156:159], v[156:159]
ds_read_b64_tr_b16 a[252:253], v3 offset:35040
v_mfma_f32_16x16x32_bf16 v[148:151], a[220:223], a[140:143], v[148:151]
v_exp_f32 v191, v191
s_waitcnt lgkmcnt(7)
v_mfma_f32_16x16x32_bf16 v[16:19], a[224:227], v[208:211], v[16:19]
ds_read_b64_tr_b16 a[254:255], v3 offset:35552
v_cvt_pk_bf16_f32 v231, v190, v191
v_mfma_f32_16x16x32_bf16 v[24:27], a[224:227], v[212:215], v[24:27]
v_mfma_f32_16x16x32_bf16 v[32:35], a[224:227], v[216:219], v[32:35]
v_exp_f32 v192, v192
v_mfma_f32_16x16x32_bf16 v[40:43], a[224:227], v[220:223], v[40:43]
v_mfma_f32_16x16x32_bf16 v[44:47], a[228:231], v[220:223], v[44:47]
v_exp_f32 v193, v193
v_mfma_f32_16x16x32_bf16 v[36:39], a[228:231], v[216:219], v[36:39]
v_cvt_pk_bf16_f32 v232, v192, v193
v_mfma_f32_16x16x32_bf16 v[28:31], a[228:231], v[212:215], v[28:31]
v_exp_f32 v194, v194
v_mfma_f32_16x16x32_bf16 v[20:23], a[228:231], v[208:211], v[20:23]
v_mfma_f32_16x16x32_bf16 v[48:51], a[232:235], v[208:211], v[48:51]
v_exp_f32 v195, v195
v_mfma_f32_16x16x32_bf16 v[56:59], a[232:235], v[212:215], v[56:59]
s_waitcnt lgkmcnt(0)
v_cvt_pk_bf16_f32 v233, v194, v195
v_mfma_f32_16x16x32_bf16 v[64:67], a[232:235], v[216:219], v[64:67]
v_exp_f32 v196, v196
v_mfma_f32_16x16x32_bf16 v[72:75], a[232:235], v[220:223], v[72:75]
ds_read_b128 a[192:195], v1 offset:43520
s_add_u32 s88, s88, 16384
v_mfma_f32_16x16x32_bf16 v[76:79], a[236:239], v[220:223], v[76:79]
v_exp_f32 v197, v197
v_mfma_f32_16x16x32_bf16 v[68:71], a[236:239], v[216:219], v[68:71]
ds_read_b128 a[196:199], v1 offset:43584
buffer_load_dword v253, v252, s[72:75], s88 offen
v_cvt_pk_bf16_f32 v234, v196, v197
v_mfma_f32_16x16x32_bf16 v[60:63], a[236:239], v[212:215], v[60:63]
v_exp_f32 v198, v198
v_mfma_f32_16x16x32_bf16 v[52:55], a[236:239], v[208:211], v[52:55]
ds_read_b128 a[200:203], v1 offset:43648
v_mfma_f32_16x16x32_bf16 v[80:83], a[240:243], v[208:211], v[80:83]
v_exp_f32 v199, v199
v_mfma_f32_16x16x32_bf16 v[88:91], a[240:243], v[212:215], v[88:91]
ds_read_b128 a[204:207], v1 offset:43712
v_cvt_pk_bf16_f32 v235, v198, v199
v_mfma_f32_16x16x32_bf16 v[96:99], a[240:243], v[216:219], v[96:99]
v_mfma_f32_16x16x32_bf16 v[104:107], a[240:243], v[220:223], v[104:107]
v_exp_f32 v200, v200
v_mfma_f32_16x16x32_bf16 v[108:111], a[244:247], v[220:223], v[108:111]
ds_read_b128 a[208:211], v1 offset:47872
v_mfma_f32_16x16x32_bf16 v[100:103], a[244:247], v[216:219], v[100:103]
v_exp_f32 v201, v201
v_mfma_f32_16x16x32_bf16 v[92:95], a[244:247], v[212:215], v[92:95]
ds_read_b128 a[212:215], v1 offset:47936
v_cvt_pk_bf16_f32 v236, v200, v201
v_mfma_f32_16x16x32_bf16 v[84:87], a[244:247], v[208:211], v[84:87]
v_exp_f32 v202, v202
v_mfma_f32_16x16x32_bf16 v[112:115], a[248:251], v[208:211], v[112:115]
ds_read_b128 a[216:219], v1 offset:48000
v_mfma_f32_16x16x32_bf16 v[120:123], a[248:251], v[212:215], v[120:123]
v_exp_f32 v203, v203
v_mfma_f32_16x16x32_bf16 v[128:131], a[248:251], v[216:219], v[128:131]
ds_read_b128 a[220:223], v1 offset:48064
v_cvt_pk_bf16_f32 v237, v202, v203
v_mfma_f32_16x16x32_bf16 v[136:139], a[248:251], v[220:223], v[136:139]
v_exp_f32 v204, v204
v_mfma_f32_16x16x32_bf16 v[140:143], a[252:255], v[220:223], v[140:143]
v_mfma_f32_16x16x32_bf16 v[132:135], a[252:255], v[216:219], v[132:135]
v_exp_f32 v205, v205
v_mfma_f32_16x16x32_bf16 v[124:127], a[252:255], v[212:215], v[124:127]
v_cvt_pk_bf16_f32 v238, v204, v205
v_mfma_f32_16x16x32_bf16 v[116:119], a[252:255], v[208:211], v[116:119]
v_exp_f32 v206, v206
v_mfma_f32_16x16x32_bf16 a[108:111], a[124:127], v[208:211], a[108:111]
v_mfma_f32_16x16x32_bf16 a[112:115], a[124:127], v[212:215], a[112:115]
v_exp_f32 v207, v207
v_mfma_f32_16x16x32_bf16 a[116:119], a[124:127], v[216:219], a[116:119]
v_cvt_pk_bf16_f32 v239, v206, v207
v_mfma_f32_16x16x32_bf16 a[120:123], a[124:127], v[220:223], a[120:123]
s_waitcnt lgkmcnt(0)
v_mfma_f32_16x16x32_bf16 v[176:179], a[192:195], a[128:131], 0
v_exp_f32 v144, v144
v_mfma_f32_16x16x32_bf16 v[184:187], a[192:195], a[144:147], 0
ds_read_b64_tr_b16 a[224:225], v3 offset:43264
s_and_b32 s88, s9, 1
v_mfma_f32_16x16x32_bf16 v[192:195], a[192:195], a[160:163], 0
s_lshl_b32 s88, s88, 7
v_exp_f32 v145, v145
v_mfma_f32_16x16x32_bf16 v[200:203], a[192:195], a[176:179], 0
ds_read_b64_tr_b16 a[226:227], v3 offset:43776
v_cvt_pk_bf16_f32 v208, v144, v145
v_mfma_f32_16x16x32_bf16 v[200:203], a[196:199], a[180:183], v[200:203]
v_exp_f32 v146, v146
v_mfma_f32_16x16x32_bf16 v[192:195], a[196:199], a[164:167], v[192:195]
ds_read_b64_tr_b16 a[228:229], v3 offset:43296
s_add_u32 s88, s88, s6
v_mfma_f32_16x16x32_bf16 v[184:187], a[196:199], a[148:151], v[184:187]
v_exp_f32 v147, v147
v_mfma_f32_16x16x32_bf16 v[176:179], a[196:199], a[132:135], v[176:179]
ds_read_b64_tr_b16 a[230:231], v3 offset:43808
v_and_b32 v14, 3, v0
v_cvt_pk_bf16_f32 v209, v146, v147
v_mfma_f32_16x16x32_bf16 v[176:179], a[200:203], a[136:139], v[176:179]
v_exp_f32 v148, v148
v_mfma_f32_16x16x32_bf16 v[184:187], a[200:203], a[152:155], v[184:187]
ds_read_b64_tr_b16 a[232:233], v3 offset:43328
v_mfma_f32_16x16x32_bf16 v[192:195], a[200:203], a[168:171], v[192:195]
v_lshl_add_u32 v14, v14, 5, s88
v_exp_f32 v149, v149
v_mfma_f32_16x16x32_bf16 v[200:203], a[200:203], a[184:187], v[200:203]
ds_read_b64_tr_b16 a[234:235], v3 offset:43840
v_cvt_pk_bf16_f32 v210, v148, v149
v_mfma_f32_16x16x32_bf16 v[200:203], a[204:207], a[188:191], v[200:203]
v_exp_f32 v150, v150
v_mfma_f32_16x16x32_bf16 v[192:195], a[204:207], a[172:175], v[192:195]
ds_read_b64_tr_b16 a[236:237], v3 offset:43360
s_lshl_b32 s89, s3, 2
v_mfma_f32_16x16x32_bf16 v[184:187], a[204:207], a[156:159], v[184:187]
v_exp_f32 v151, v151
v_mfma_f32_16x16x32_bf16 v[176:179], a[204:207], a[140:143], v[176:179]
ds_read_b64_tr_b16 a[238:239], v3 offset:43872
v_cvt_pk_bf16_f32 v211, v150, v151
v_mfma_f32_16x16x32_bf16 v[180:183], a[208:211], a[128:131], 0
v_mov_b32 v15, s89
v_mfma_f32_16x16x32_bf16 v[188:191], a[208:211], a[144:147], 0
v_exp_f32 v152, v152
v_mfma_f32_16x16x32_bf16 v[196:199], a[208:211], a[160:163], 0
ds_read_b64_tr_b16 a[240:241], v3 offset:43392
v_lshrrev_b32 v252, 4, v14
v_mfma_f32_16x16x32_bf16 v[204:207], a[208:211], a[176:179], 0
v_exp_f32 v153, v153
v_mfma_f32_16x16x32_bf16 v[204:207], a[212:215], a[180:183], v[204:207]
ds_read_b64_tr_b16 a[242:243], v3 offset:43904
v_and_b32 v252, 12, v252
v_cvt_pk_bf16_f32 v212, v152, v153
v_mfma_f32_16x16x32_bf16 v[196:199], a[212:215], a[164:167], v[196:199]
v_exp_f32 v154, v154
v_mfma_f32_16x16x32_bf16 v[188:191], a[212:215], a[148:151], v[188:191]
ds_read_b64_tr_b16 a[244:245], v3 offset:43424
buffer_load_dword v252, v252, s[84:87], 0 offen sc1
v_mfma_f32_16x16x32_bf16 v[180:183], a[212:215], a[132:135], v[180:183]
v_exp_f32 v155, v155
v_mfma_f32_16x16x32_bf16 v[180:183], a[216:219], a[136:139], v[180:183]
ds_read_b64_tr_b16 a[246:247], v3 offset:43936
v_cvt_pk_bf16_f32 v213, v154, v155
v_mfma_f32_16x16x32_bf16 v[188:191], a[216:219], a[152:155], v[188:191]
v_exp_f32 v156, v156
v_mfma_f32_16x16x32_bf16 v[196:199], a[216:219], a[168:171], v[196:199]
ds_read_b64_tr_b16 a[248:249], v3 offset:43456
v_mfma_f32_16x16x32_bf16 v[204:207], a[216:219], a[184:187], v[204:207]
v_exp_f32 v157, v157
v_mfma_f32_16x16x32_bf16 v[204:207], a[220:223], a[188:191], v[204:207]
ds_read_b64_tr_b16 a[250:251], v3 offset:43968
v_cvt_pk_bf16_f32 v214, v156, v157
v_mfma_f32_16x16x32_bf16 v[196:199], a[220:223], a[172:175], v[196:199]
v_exp_f32 v158, v158
v_mfma_f32_16x16x32_bf16 v[188:191], a[220:223], a[156:159], v[188:191]
ds_read_b64_tr_b16 a[252:253], v3 offset:43488
v_mfma_f32_16x16x32_bf16 v[180:183], a[220:223], a[140:143], v[180:183]
v_exp_f32 v159, v159
s_waitcnt lgkmcnt(7)
v_mfma_f32_16x16x32_bf16 v[16:19], a[224:227], v[224:227], v[16:19]
ds_read_b64_tr_b16 a[254:255], v3 offset:44000
v_cvt_pk_bf16_f32 v215, v158, v159
v_mfma_f32_16x16x32_bf16 v[24:27], a[224:227], v[228:231], v[24:27]
v_mfma_f32_16x16x32_bf16 v[32:35], a[224:227], v[232:235], v[32:35]
v_exp_f32 v160, v160
v_mfma_f32_16x16x32_bf16 v[40:43], a[224:227], v[236:239], v[40:43]
v_mfma_f32_16x16x32_bf16 v[44:47], a[228:231], v[236:239], v[44:47]
v_exp_f32 v161, v161
v_mfma_f32_16x16x32_bf16 v[36:39], a[228:231], v[232:235], v[36:39]
v_cvt_pk_bf16_f32 v216, v160, v161
v_mfma_f32_16x16x32_bf16 v[28:31], a[228:231], v[228:231], v[28:31]
v_exp_f32 v162, v162
v_mfma_f32_16x16x32_bf16 v[20:23], a[228:231], v[224:227], v[20:23]
v_mfma_f32_16x16x32_bf16 v[48:51], a[232:235], v[224:227], v[48:51]
v_exp_f32 v163, v163
v_mfma_f32_16x16x32_bf16 v[56:59], a[232:235], v[228:231], v[56:59]
s_waitcnt vmcnt(3) lgkmcnt(0)
s_barrier
v_cvt_pk_bf16_f32 v217, v162, v163
v_mfma_f32_16x16x32_bf16 v[64:67], a[232:235], v[232:235], v[64:67]
ds_read_b64_tr_b16 a[224:225], v3 offset:0
v_exp_f32 v164, v164
v_mfma_f32_16x16x32_bf16 v[72:75], a[232:235], v[236:239], v[72:75]
ds_read_b64_tr_b16 a[228:229], v3 offset:32
ds_read_b64_tr_b16 a[232:233], v3 offset:64
v_mfma_f32_16x16x32_bf16 v[76:79], a[236:239], v[236:239], v[76:79]
ds_read_b64_tr_b16 a[226:227], v3 offset:512
v_lshl_add_u32 v14, v14, 7, v15
v_exp_f32 v165, v165
v_mfma_f32_16x16x32_bf16 v[68:71], a[236:239], v[232:235], v[68:71]
ds_read_b64_tr_b16 a[230:231], v3 offset:544
ds_read_b64_tr_b16 a[234:235], v3 offset:576
v_cvt_pk_bf16_f32 v218, v164, v165
v_mfma_f32_16x16x32_bf16 v[60:63], a[236:239], v[228:231], v[60:63]
v_exp_f32 v166, v166
v_mfma_f32_16x16x32_bf16 v[52:55], a[236:239], v[224:227], v[52:55]
ds_read_b64_tr_b16 a[236:237], v3 offset:96
buffer_load_dword v15, v14, s[76:79], s24 offen offset:16 sc1
v_mfma_f32_16x16x32_bf16 v[80:83], a[240:243], v[224:227], v[80:83]
v_exp_f32 v167, v167
v_mfma_f32_16x16x32_bf16 v[88:91], a[240:243], v[228:231], v[88:91]
ds_read_b64_tr_b16 a[238:239], v3 offset:608
v_cvt_pk_bf16_f32 v219, v166, v167
v_mfma_f32_16x16x32_bf16 v[96:99], a[240:243], v[232:235], v[96:99]
v_mfma_f32_16x16x32_bf16 v[104:107], a[240:243], v[236:239], v[104:107]
ds_read_b64_tr_b16 a[240:241], v3 offset:128
v_exp_f32 v168, v168
v_mfma_f32_16x16x32_bf16 v[108:111], a[244:247], v[236:239], v[108:111]
v_mfma_f32_16x16x32_bf16 v[100:103], a[244:247], v[232:235], v[100:103]
ds_read_b64_tr_b16 a[242:243], v3 offset:640
v_exp_f32 v169, v169
v_mfma_f32_16x16x32_bf16 v[92:95], a[244:247], v[228:231], v[92:95]
v_cvt_pk_bf16_f32 v220, v168, v169
v_mfma_f32_16x16x32_bf16 v[84:87], a[244:247], v[224:227], v[84:87]
ds_read_b64_tr_b16 a[244:245], v3 offset:160
v_exp_f32 v170, v170
v_mfma_f32_16x16x32_bf16 v[112:115], a[248:251], v[224:227], v[112:115]
v_mfma_f32_16x16x32_bf16 v[120:123], a[248:251], v[228:231], v[120:123]
ds_read_b64_tr_b16 a[246:247], v3 offset:672
v_exp_f32 v171, v171
v_mfma_f32_16x16x32_bf16 v[128:131], a[248:251], v[232:235], v[128:131]
v_cvt_pk_bf16_f32 v221, v170, v171
v_mfma_f32_16x16x32_bf16 v[136:139], a[248:251], v[236:239], v[136:139]
ds_read_b64_tr_b16 a[248:249], v3 offset:192
v_exp_f32 v172, v172
v_mfma_f32_16x16x32_bf16 v[140:143], a[252:255], v[236:239], v[140:143]
v_mfma_f32_16x16x32_bf16 v[132:135], a[252:255], v[232:235], v[132:135]
ds_read_b64_tr_b16 a[250:251], v3 offset:704
v_exp_f32 v173, v173
v_mfma_f32_16x16x32_bf16 v[124:127], a[252:255], v[228:231], v[124:127]
v_cvt_pk_bf16_f32 v222, v172, v173
v_mfma_f32_16x16x32_bf16 v[116:119], a[252:255], v[224:227], v[116:119]
ds_read_b64_tr_b16 a[252:253], v3 offset:224
v_exp_f32 v174, v174
v_mfma_f32_16x16x32_bf16 a[108:111], a[124:127], v[224:227], a[108:111]
v_mfma_f32_16x16x32_bf16 a[112:115], a[124:127], v[228:231], a[112:115]
ds_read_b64_tr_b16 a[254:255], v3 offset:736
v_exp_f32 v175, v175
v_mfma_f32_16x16x32_bf16 a[116:119], a[124:127], v[232:235], a[116:119]
v_cvt_pk_bf16_f32 v223, v174, v175
v_mfma_f32_16x16x32_bf16 a[120:123], a[124:127], v[236:239], a[120:123]
s_waitcnt lgkmcnt(12)
v_mfma_f32_16x16x32_bf16 v[16:19], a[224:227], v[208:211], v[16:19]
s_add_u32 s31, s12, 1232896
v_exp_f32 v176, v176
v_mfma_f32_16x16x32_bf16 v[24:27], a[224:227], v[212:215], v[24:27]
s_add_u32 m0, s96, 118272
s_nop 0
buffer_load_dwordx4 v240, s[64:67], s31 offen offset:0 lds
v_exp_f32 v177, v177
v_mfma_f32_16x16x32_bf16 v[32:35], a[224:227], v[216:219], v[32:35]
v_cvt_pk_bf16_f32 v224, v176, v177
v_exp_f32 v178, v178
v_mfma_f32_16x16x32_bf16 v[40:43], a[224:227], v[220:223], v[40:43]
ds_read_b64_tr_b16 a[224:225], v3 offset:8448
buffer_load_dwordx4 v241, s[64:67], s31 offen offset:1056 lds
v_exp_f32 v179, v179
s_waitcnt lgkmcnt(12)
v_mfma_f32_16x16x32_bf16 v[44:47], a[228:231], v[220:223], v[44:47]
v_cvt_pk_bf16_f32 v225, v178, v179
v_exp_f32 v180, v180
v_mfma_f32_16x16x32_bf16 v[36:39], a[228:231], v[216:219], v[36:39]
ds_read_b64_tr_b16 a[226:227], v3 offset:8960
v_exp_f32 v181, v181
v_mfma_f32_16x16x32_bf16 v[28:31], a[228:231], v[212:215], v[28:31]
buffer_load_dwordx4 v242, s[64:67], s31 offen offset:2112 lds
v_cvt_pk_bf16_f32 v226, v180, v181
v_exp_f32 v182, v182
v_mfma_f32_16x16x32_bf16 v[20:23], a[228:231], v[208:211], v[20:23]
ds_read_b64_tr_b16 a[228:229], v3 offset:8480
v_exp_f32 v183, v183
s_waitcnt lgkmcnt(13)
v_mfma_f32_16x16x32_bf16 v[48:51], a[232:235], v[208:211], v[48:51]
buffer_load_dwordx4 v243, s[64:67], s31 offen offset:3168 lds
v_cvt_pk_bf16_f32 v227, v182, v183
v_mfma_f32_16x16x32_bf16 v[56:59], a[232:235], v[212:215], v[56:59]
ds_read_b64_tr_b16 a[230:231], v3 offset:8992
v_exp_f32 v184, v184
v_mfma_f32_16x16x32_bf16 v[64:67], a[232:235], v[216:219], v[64:67]
v_exp_f32 v185, v185
v_mfma_f32_16x16x32_bf16 v[72:75], a[232:235], v[220:223], v[72:75]
ds_read_b64_tr_b16 a[232:233], v3 offset:8512
v_cvt_pk_bf16_f32 v228, v184, v185
v_exp_f32 v186, v186
s_waitcnt lgkmcnt(13)
v_mfma_f32_16x16x32_bf16 v[76:79], a[236:239], v[220:223], v[76:79]
s_waitcnt vmcnt(4)
v_cmp_ne_u32 vcc, v252, v15
s_cbranch_vccnz reslow_54
reback_55:
s_lshl_b32 s27, s11, 10
s_add_u32 s27, s27, 4194304
v_exp_f32 v187, v187
v_mfma_f32_16x16x32_bf16 v[68:71], a[236:239], v[216:219], v[68:71]
ds_read_b64_tr_b16 a[234:235], v3 offset:9024
v_cvt_pk_bf16_f32 v229, v186, v187
v_exp_f32 v188, v188
v_mfma_f32_16x16x32_bf16 v[60:63], a[236:239], v[212:215], v[60:63]
s_or_b32 s27, s27, s23
s_add_u32 s28, s27, 16384
buffer_load_dwordx4 a[0:3], v251, s[76:79], s27 offen offset:0 sc1
v_exp_f32 v189, v189
v_mfma_f32_16x16x32_bf16 v[52:55], a[236:239], v[208:211], v[52:55]
ds_read_b64_tr_b16 a[236:237], v3 offset:8544
v_cvt_pk_bf16_f32 v230, v188, v189
v_exp_f32 v190, v190
s_waitcnt lgkmcnt(13)
v_mfma_f32_16x16x32_bf16 v[80:83], a[240:243], v[208:211], v[80:83]
buffer_load_dwordx4 a[4:7], v251, s[76:79], s28 offen offset:0 sc1
v_exp_f32 v191, v191
v_mfma_f32_16x16x32_bf16 v[88:91], a[240:243], v[212:215], v[88:91]
ds_read_b64_tr_b16 a[238:239], v3 offset:9056
v_cvt_pk_bf16_f32 v231, v190, v191
v_mfma_f32_16x16x32_bf16 v[96:99], a[240:243], v[216:219], v[96:99]
v_exp_f32 v192, v192
v_mfma_f32_16x16x32_bf16 v[104:107], a[240:243], v[220:223], v[104:107]
ds_read_b64_tr_b16 a[240:241], v3 offset:8576
buffer_load_dwordx4 a[8:11], v251, s[76:79], s27 offen offset:1024 sc1
v_exp_f32 v193, v193
s_waitcnt lgkmcnt(13)
v_mfma_f32_16x16x32_bf16 v[108:111], a[244:247], v[220:223], v[108:111]
v_cvt_pk_bf16_f32 v232, v192, v193
v_exp_f32 v194, v194
v_mfma_f32_16x16x32_bf16 v[100:103], a[244:247], v[216:219], v[100:103]
ds_read_b64_tr_b16 a[242:243], v3 offset:9088
buffer_load_dwordx4 a[12:15], v251, s[76:79], s28 offen offset:1024 sc1
v_exp_f32 v195, v195
v_mfma_f32_16x16x32_bf16 v[92:95], a[244:247], v[212:215], v[92:95]
v_cvt_pk_bf16_f32 v233, v194, v195
v_exp_f32 v196, v196
v_mfma_f32_16x16x32_bf16 v[84:87], a[244:247], v[208:211], v[84:87]
ds_read_b64_tr_b16 a[244:245], v3 offset:8608
v_exp_f32 v197, v197
s_waitcnt lgkmcnt(13)
v_mfma_f32_16x16x32_bf16 v[112:115], a[248:251], v[208:211], v[112:115]
buffer_load_dwordx4 a[16:19], v251, s[76:79], s27 offen offset:2048 sc1
v_cvt_pk_bf16_f32 v234, v196, v197
v_exp_f32 v198, v198
v_mfma_f32_16x16x32_bf16 v[120:123], a[248:251], v[212:215], v[120:123]
ds_read_b64_tr_b16 a[246:247], v3 offset:9120
v_exp_f32 v199, v199
v_mfma_f32_16x16x32_bf16 v[128:131], a[248:251], v[216:219], v[128:131]
v_cvt_pk_bf16_f32 v235, v198, v199
v_mfma_f32_16x16x32_bf16 v[136:139], a[248:251], v[220:223], v[136:139]
ds_read_b64_tr_b16 a[248:249], v3 offset:8640
v_exp_f32 v200, v200
s_waitcnt lgkmcnt(13)
v_mfma_f32_16x16x32_bf16 v[140:143], a[252:255], v[220:223], v[140:143]
buffer_load_dwordx4 a[20:23], v251, s[76:79], s28 offen offset:2048 sc1
v_exp_f32 v201, v201
v_mfma_f32_16x16x32_bf16 v[132:135], a[252:255], v[216:219], v[132:135]
ds_read_b64_tr_b16 a[250:251], v3 offset:9152
v_cvt_pk_bf16_f32 v236, v200, v201
v_exp_f32 v202, v202
v_mfma_f32_16x16x32_bf16 v[124:127], a[252:255], v[212:215], v[124:127]
buffer_load_dwordx4 a[24:27], v251, s[76:79], s27 offen offset:3072 sc1
v_exp_f32 v203, v203
v_mfma_f32_16x16x32_bf16 v[116:119], a[252:255], v[208:211], v[116:119]
ds_read_b64_tr_b16 a[252:253], v3 offset:8672
v_cvt_pk_bf16_f32 v237, v202, v203
v_exp_f32 v204, v204
v_mfma_f32_16x16x32_bf16 a[108:111], a[124:127], v[208:211], a[108:111]
buffer_load_dwordx4 a[28:31], v251, s[76:79], s28 offen offset:3072 sc1
v_exp_f32 v205, v205
v_mfma_f32_16x16x32_bf16 a[112:115], a[124:127], v[212:215], a[112:115]
ds_read_b64_tr_b16 a[254:255], v3 offset:9184
v_cvt_pk_bf16_f32 v238, v204, v205
v_exp_f32 v206, v206
v_mfma_f32_16x16x32_bf16 a[116:119], a[124:127], v[216:219], a[116:119]
v_exp_f32 v207, v207
v_mfma_f32_16x16x32_bf16 a[120:123], a[124:127], v[220:223], a[120:123]
s_add_u32 s27, s27, 4096
v_cvt_pk_bf16_f32 v239, v206, v207
s_waitcnt lgkmcnt(14)
v_mfma_f32_16x16x32_bf16 v[16:19], a[224:227], v[224:227], v[16:19]
s_add_u32 s28, s28, 4096
v_mfma_f32_16x16x32_bf16 v[24:27], a[224:227], v[228:231], v[24:27]
buffer_load_dwordx4 a[32:35], v251, s[76:79], s27 offen offset:0 sc1
v_mfma_f32_16x16x32_bf16 v[32:35], a[224:227], v[232:235], v[32:35]
buffer_load_dwordx4 a[36:39], v251, s[76:79], s28 offen offset:0 sc1
v_mfma_f32_16x16x32_bf16 v[40:43], a[224:227], v[236:239], v[40:43]
s_waitcnt lgkmcnt(12)
v_mfma_f32_16x16x32_bf16 v[44:47], a[228:231], v[236:239], v[44:47]
buffer_load_dwordx4 a[40:43], v251, s[76:79], s27 offen offset:1024 sc1
v_mfma_f32_16x16x32_bf16 v[36:39], a[228:231], v[232:235], v[36:39]
v_mfma_f32_16x16x32_bf16 v[28:31], a[228:231], v[228:231], v[28:31]
buffer_load_dwordx4 a[44:47], v251, s[76:79], s28 offen offset:1024 sc1
v_mfma_f32_16x16x32_bf16 v[20:23], a[228:231], v[224:227], v[20:23]
s_waitcnt lgkmcnt(10)
v_mfma_f32_16x16x32_bf16 v[48:51], a[232:235], v[224:227], v[48:51]
buffer_load_dwordx4 a[48:51], v251, s[76:79], s27 offen offset:2048 sc1
v_mfma_f32_16x16x32_bf16 v[56:59], a[232:235], v[228:231], v[56:59]
v_mfma_f32_16x16x32_bf16 v[64:67], a[232:235], v[232:235], v[64:67]
buffer_load_dwordx4 a[52:55], v251, s[76:79], s28 offen offset:2048 sc1
v_mfma_f32_16x16x32_bf16 v[72:75], a[232:235], v[236:239], v[72:75]
s_waitcnt lgkmcnt(8)
v_mfma_f32_16x16x32_bf16 v[76:79], a[236:239], v[236:239], v[76:79]
buffer_load_dwordx4 a[56:59], v251, s[76:79], s27 offen offset:3072 sc1
v_mfma_f32_16x16x32_bf16 v[68:71], a[236:239], v[232:235], v[68:71]
v_mfma_f32_16x16x32_bf16 v[60:63], a[236:239], v[228:231], v[60:63]
buffer_load_dwordx4 a[60:63], v251, s[76:79], s28 offen offset:3072 sc1
v_mfma_f32_16x16x32_bf16 v[52:55], a[236:239], v[224:227], v[52:55]
s_waitcnt lgkmcnt(6)
v_mfma_f32_16x16x32_bf16 v[80:83], a[240:243], v[224:227], v[80:83]
s_add_u32 s27, s27, 4096
v_mfma_f32_16x16x32_bf16 v[88:91], a[240:243], v[228:231], v[88:91]
s_add_u32 s28, s28, 4096
v_mfma_f32_16x16x32_bf16 v[96:99], a[240:243], v[232:235], v[96:99]
buffer_load_dwordx4 a[64:67], v251, s[76:79], s27 offen offset:0 sc1
v_mfma_f32_16x16x32_bf16 v[104:107], a[240:243], v[236:239], v[104:107]
buffer_load_dwordx4 a[68:71], v251, s[76:79], s28 offen offset:0 sc1
s_waitcnt lgkmcnt(4)
v_mfma_f32_16x16x32_bf16 v[108:111], a[244:247], v[236:239], v[108:111]
v_mfma_f32_16x16x32_bf16 v[100:103], a[244:247], v[232:235], v[100:103]
buffer_load_dwordx4 a[72:75], v251, s[76:79], s27 offen offset:1024 sc1
v_mfma_f32_16x16x32_bf16 v[92:95], a[244:247], v[228:231], v[92:95]
v_mfma_f32_16x16x32_bf16 v[84:87], a[244:247], v[224:227], v[84:87]
buffer_load_dwordx4 a[76:79], v251, s[76:79], s28 offen offset:1024 sc1
s_waitcnt lgkmcnt(2)
v_mfma_f32_16x16x32_bf16 v[112:115], a[248:251], v[224:227], v[112:115]
v_mfma_f32_16x16x32_bf16 v[120:123], a[248:251], v[228:231], v[120:123]
buffer_load_dwordx4 a[80:83], v251, s[76:79], s27 offen offset:2048 sc1
v_mfma_f32_16x16x32_bf16 v[128:131], a[248:251], v[232:235], v[128:131]
v_mfma_f32_16x16x32_bf16 v[136:139], a[248:251], v[236:239], v[136:139]
s_lshl_b32 s22, s7, 17
s_waitcnt lgkmcnt(0)
v_mfma_f32_16x16x32_bf16 v[140:143], a[252:255], v[236:239], v[140:143]
s_add_u32 s22, s22, s25
v_mfma_f32_16x16x32_bf16 v[132:135], a[252:255], v[232:235], v[132:135]
s_add_u32 m0, s96, 135168
v_mfma_f32_16x16x32_bf16 v[124:127], a[252:255], v[228:231], v[124:127]
buffer_load_dwordx4 v244, s[52:55], s22 offen offset:0 lds
v_mfma_f32_16x16x32_bf16 v[116:119], a[252:255], v[224:227], v[116:119]
buffer_load_dwordx4 v245, s[52:55], s22 offen offset:1056 lds
v_mfma_f32_16x16x32_bf16 a[108:111], a[124:127], v[224:227], a[108:111]
buffer_load_dwordx4 v246, s[52:55], s22 offen offset:2112 lds
v_mfma_f32_16x16x32_bf16 a[112:115], a[124:127], v[228:231], a[112:115]
buffer_load_dwordx4 v247, s[52:55], s22 offen offset:3168 lds
v_mfma_f32_16x16x32_bf16 a[116:119], a[124:127], v[232:235], a[116:119]
v_mfma_f32_16x16x32_bf16 a[120:123], a[124:127], v[236:239], a[120:123]
recurrent_scan__sliding_block_cached__mixer_s_mlp__prompt_kernel_co:
recurrent_scan__sliding_block_cached__mixer_s_mlp__prompt_kernel_redoc:
s_nop 2
v_accvgpr_read_b32 v148, a108
s_nop 0
v_accvgpr_read_b32 v149, a112
s_nop 0
v_accvgpr_read_b32 v150, a116
v_accvgpr_read_b32 v151, a120
v_rcp_f32 v144, v148
v_rcp_f32 v145, v149
v_rcp_f32 v146, v150
v_rcp_f32 v147, v151
v_min3_f32 v152, v148, v149, v150
v_add_f32 v153, v148, v149
v_min_f32 v152, v152, v151
v_add_f32 v153, v153, v150
s_mov_b32 s88, 0x4e800000
v_add_f32 v153, v153, v151
s_mov_b32 s89, 0x30800000
v_cmp_nge_f32 s[32:33], s88, v153
v_cmp_nle_f32 vcc, s89, v152
v_mov_b32 v154, 159744
s_or_b64 vcc, vcc, s[32:33]
s_cbranch_vccz revote_57
ds_write_b32 v154, v154
revote_57:
s_waitcnt lgkmcnt(0)
s_barrier
ds_read_b32 v155, v154
v_pk_mul_f32 v[16:17], v[16:17], v[144:145] op_sel:[0,0] op_sel_hi:[1,0]
v_pk_mul_f32 v[18:19], v[18:19], v[144:145] op_sel:[0,0] op_sel_hi:[1,0]
v_pk_mul_f32 v[20:21], v[20:21], v[144:145] op_sel:[0,0] op_sel_hi:[1,0]
v_pk_mul_f32 v[22:23], v[22:23], v[144:145] op_sel:[0,0] op_sel_hi:[1,0]
v_cvt_pk_bf16_f32 v16, v16, v17
v_cvt_pk_bf16_f32 v17, v18, v19
v_cvt_pk_bf16_f32 v18, v20, v21
v_cvt_pk_bf16_f32 v19, v22, v23
v_pk_mul_f32 v[24:25], v[24:25], v[144:145] op_sel:[0,1] op_sel_hi:[1,1]
v_pk_mul_f32 v[26:27], v[26:27], v[144:145] op_sel:[0,1] op_sel_hi:[1,1]
v_pk_mul_f32 v[28:29], v[28:29], v[144:145] op_sel:[0,1] op_sel_hi:[1,1]
v_pk_mul_f32 v[30:31], v[30:31], v[144:145] op_sel:[0,1] op_sel_hi:[1,1]
v_cvt_pk_bf16_f32 v24, v24, v25
v_cvt_pk_bf16_f32 v25, v26, v27
v_cvt_pk_bf16_f32 v26, v28, v29
v_cvt_pk_bf16_f32 v27, v30, v31
v_pk_mul_f32 v[32:33], v[32:33], v[146:147] op_sel:[0,0] op_sel_hi:[1,0]
v_pk_mul_f32 v[34:35], v[34:35], v[146:147] op_sel:[0,0] op_sel_hi:[1,0]
v_pk_mul_f32 v[36:37], v[36:37], v[146:147] op_sel:[0,0] op_sel_hi:[1,0]
v_pk_mul_f32 v[38:39], v[38:39], v[146:147] op_sel:[0,0] op_sel_hi:[1,0]
v_cvt_pk_bf16_f32 v32, v32, v33
v_cvt_pk_bf16_f32 v33, v34, v35
v_cvt_pk_bf16_f32 v34, v36, v37
v_cvt_pk_bf16_f32 v35, v38, v39
v_pk_mul_f32 v[40:41], v[40:41], v[146:147] op_sel:[0,1] op_sel_hi:[1,1]
v_pk_mul_f32 v[42:43], v[42:43], v[146:147] op_sel:[0,1] op_sel_hi:[1,1]
v_pk_mul_f32 v[44:45], v[44:45], v[146:147] op_sel:[0,1] op_sel_hi:[1,1]
v_pk_mul_f32 v[46:47], v[46:47], v[146:147] op_sel:[0,1] op_sel_hi:[1,1]
s_waitcnt lgkmcnt(0)
v_readfirstlane_b32 s88, v155
s_nop 0
s_andn2_b32 s88, s88, s16
s_cmp_lg_u32 s88, 0
s_cbranch_scc1 recurrent_scan__sliding_block_cached__mixer_s_mlp__prompt_kernel_fb
v_cvt_pk_bf16_f32 v40, v40, v41
v_add_u32 v250, 101376, v248
buffer_load_dwordx4 a[84:87], v251, s[76:79], s28 offen offset:2048 sc1
v_cvt_pk_bf16_f32 v41, v42, v43
v_cvt_pk_bf16_f32 v42, v44, v45
v_cvt_pk_bf16_f32 v43, v46, v47
v_pk_mul_f32 v[48:49], v[48:49], v[144:145] op_sel:[0,0] op_sel_hi:[1,0]
v_pk_mul_f32 v[50:51], v[50:51], v[144:145] op_sel:[0,0] op_sel_hi:[1,0]
buffer_load_dwordx4 a[88:91], v251, s[76:79], s27 offen offset:3072 sc1
v_pk_mul_f32 v[52:53], v[52:53], v[144:145] op_sel:[0,0] op_sel_hi:[1,0]
v_pk_mul_f32 v[54:55], v[54:55], v[144:145] op_sel:[0,0] op_sel_hi:[1,0]
v_cvt_pk_bf16_f32 v48, v48, v49
v_cvt_pk_bf16_f32 v49, v50, v51
v_cvt_pk_bf16_f32 v50, v52, v53
buffer_load_dwordx4 a[92:95], v251, s[76:79], s28 offen offset:3072 sc1
v_cvt_pk_bf16_f32 v51, v54, v55
v_pk_mul_f32 v[56:57], v[56:57], v[144:145] op_sel:[0,1] op_sel_hi:[1,1]
v_pk_mul_f32 v[58:59], v[58:59], v[144:145] op_sel:[0,1] op_sel_hi:[1,1]
v_pk_mul_f32 v[60:61], v[60:61], v[144:145] op_sel:[0,1] op_sel_hi:[1,1]
v_pk_mul_f32 v[62:63], v[62:63], v[144:145] op_sel:[0,1] op_sel_hi:[1,1]
s_add_u32 s27, s27, 4096
v_cvt_pk_bf16_f32 v56, v56, v57
s_add_u32 s28, s28, 4096
buffer_load_dwordx4 a[96:99], v251, s[76:79], s27 offen offset:0 sc1
v_cvt_pk_bf16_f32 v57, v58, v59
v_cvt_pk_bf16_f32 v58, v60, v61
v_cvt_pk_bf16_f32 v59, v62, v63
v_pk_mul_f32 v[64:65], v[64:65], v[146:147] op_sel:[0,0] op_sel_hi:[1,0]
v_pk_mul_f32 v[66:67], v[66:67], v[146:147] op_sel:[0,0] op_sel_hi:[1,0]
buffer_load_dwordx4 a[100:103], v251, s[76:79], s28 offen offset:0 sc1
v_pk_mul_f32 v[68:69], v[68:69], v[146:147] op_sel:[0,0] op_sel_hi:[1,0]
v_pk_mul_f32 v[70:71], v[70:71], v[146:147] op_sel:[0,0] op_sel_hi:[1,0]
v_cvt_pk_bf16_f32 v64, v64, v65
v_cvt_pk_bf16_f32 v65, v66, v67
v_cvt_pk_bf16_f32 v66, v68, v69
buffer_load_dwordx4 a[104:107], v251, s[76:79], s27 offen offset:1024 sc1
v_cvt_pk_bf16_f32 v67, v70, v71
v_pk_mul_f32 v[72:73], v[72:73], v[146:147] op_sel:[0,1] op_sel_hi:[1,1]
v_pk_mul_f32 v[74:75], v[74:75], v[146:147] op_sel:[0,1] op_sel_hi:[1,1]
v_pk_mul_f32 v[76:77], v[76:77], v[146:147] op_sel:[0,1] op_sel_hi:[1,1]
v_pk_mul_f32 v[78:79], v[78:79], v[146:147] op_sel:[0,1] op_sel_hi:[1,1]
buffer_load_dwordx4 a[108:111], v251, s[76:79], s28 offen offset:1024 sc1
v_cvt_pk_bf16_f32 v72, v72, v73
v_cvt_pk_bf16_f32 v73, v74, v75
v_cvt_pk_bf16_f32 v74, v76, v77
v_cvt_pk_bf16_f32 v75, v78, v79
v_pk_mul_f32 v[80:81], v[80:81], v[144:145] op_sel:[0,0] op_sel_hi:[1,0]
buffer_load_dwordx4 a[112:115], v251, s[76:79], s27 offen offset:2048 sc1
v_pk_mul_f32 v[82:83], v[82:83], v[144:145] op_sel:[0,0] op_sel_hi:[1,0]
v_pk_mul_f32 v[84:85], v[84:85], v[144:145] op_sel:[0,0] op_sel_hi:[1,0]
v_pk_mul_f32 v[86:87], v[86:87], v[144:145] op_sel:[0,0] op_sel_hi:[1,0]
v_cvt_pk_bf16_f32 v80, v80, v81
v_cvt_pk_bf16_f32 v81, v82, v83
buffer_load_dwordx4 a[116:119], v251, s[76:79], s28 offen offset:2048 sc1
v_cvt_pk_bf16_f32 v82, v84, v85
v_cvt_pk_bf16_f32 v83, v86, v87
v_pk_mul_f32 v[88:89], v[88:89], v[144:145] op_sel:[0,1] op_sel_hi:[1,1]
v_pk_mul_f32 v[90:91], v[90:91], v[144:145] op_sel:[0,1] op_sel_hi:[1,1]
v_pk_mul_f32 v[92:93], v[92:93], v[144:145] op_sel:[0,1] op_sel_hi:[1,1]
buffer_load_dwordx4 a[120:123], v251, s[76:79], s27 offen offset:3072 sc1
v_pk_mul_f32 v[94:95], v[94:95], v[144:145] op_sel:[0,1] op_sel_hi:[1,1]
v_cvt_pk_bf16_f32 v88, v88, v89
v_cvt_pk_bf16_f32 v89, v90, v91
v_cvt_pk_bf16_f32 v90, v92, v93
v_cvt_pk_bf16_f32 v91, v94, v95
buffer_load_dwordx4 a[124:127], v251, s[76:79], s28 offen offset:3072 sc1
v_pk_mul_f32 v[96:97], v[96:97], v[146:147] op_sel:[0,0] op_sel_hi:[1,0]
v_pk_mul_f32 v[98:99], v[98:99], v[146:147] op_sel:[0,0] op_sel_hi:[1,0]
v_pk_mul_f32 v[100:101], v[100:101], v[146:147] op_sel:[0,0] op_sel_hi:[1,0]
v_pk_mul_f32 v[102:103], v[102:103], v[146:147] op_sel:[0,0] op_sel_hi:[1,0]
v_cvt_pk_bf16_f32 v96, v96, v97
s_add_u32 s31, s12, 880640
v_cvt_pk_bf16_f32 v97, v98, v99
s_add_u32 m0, s96, 84480
s_nop 0
buffer_load_dwordx4 v240, s[64:67], s31 offen offset:0 lds
v_cvt_pk_bf16_f32 v98, v100, v101
v_cvt_pk_bf16_f32 v99, v102, v103
v_pk_mul_f32 v[104:105], v[104:105], v[146:147] op_sel:[0,1] op_sel_hi:[1,1]
v_pk_mul_f32 v[106:107], v[106:107], v[146:147] op_sel:[0,1] op_sel_hi:[1,1]
v_pk_mul_f32 v[108:109], v[108:109], v[146:147] op_sel:[0,1] op_sel_hi:[1,1]
buffer_load_dwordx4 v241, s[64:67], s31 offen offset:1056 lds
v_pk_mul_f32 v[110:111], v[110:111], v[146:147] op_sel:[0,1] op_sel_hi:[1,1]
v_cvt_pk_bf16_f32 v104, v104, v105
v_cvt_pk_bf16_f32 v105, v106, v107
v_cvt_pk_bf16_f32 v106, v108, v109
v_cvt_pk_bf16_f32 v107, v110, v111
buffer_load_dwordx4 v242, s[64:67], s31 offen offset:2112 lds
v_pk_mul_f32 v[112:113], v[112:113], v[144:145] op_sel:[0,0] op_sel_hi:[1,0]
v_pk_mul_f32 v[114:115], v[114:115], v[144:145] op_sel:[0,0] op_sel_hi:[1,0]
v_pk_mul_f32 v[116:117], v[116:117], v[144:145] op_sel:[0,0] op_sel_hi:[1,0]
v_pk_mul_f32 v[118:119], v[118:119], v[144:145] op_sel:[0,0] op_sel_hi:[1,0]
v_cvt_pk_bf16_f32 v112, v112, v113
buffer_load_dwordx4 v243, s[64:67], s31 offen offset:3168 lds
v_cvt_pk_bf16_f32 v113, v114, v115
v_cvt_pk_bf16_f32 v114, v116, v117
v_cvt_pk_bf16_f32 v115, v118, v119
v_pk_mul_f32 v[120:121], v[120:121], v[144:145] op_sel:[0,1] op_sel_hi:[1,1]
v_pk_mul_f32 v[122:123], v[122:123], v[144:145] op_sel:[0,1] op_sel_hi:[1,1]
s_add_u32 s31, s12, 1056768
v_pk_mul_f32 v[124:125], v[124:125], v[144:145] op_sel:[0,1] op_sel_hi:[1,1]
s_add_u32 m0, s96, 101376
v_pk_mul_f32 v[126:127], v[126:127], v[144:145] op_sel:[0,1] op_sel_hi:[1,1]
buffer_load_dwordx4 v240, s[64:67], s31 offen offset:0 lds
v_cvt_pk_bf16_f32 v120, v120, v121
v_cvt_pk_bf16_f32 v121, v122, v123
v_cvt_pk_bf16_f32 v122, v124, v125
v_cvt_pk_bf16_f32 v123, v126, v127
v_pk_mul_f32 v[128:129], v[128:129], v[146:147] op_sel:[0,0] op_sel_hi:[1,0]
buffer_load_dwordx4 v241, s[64:67], s31 offen offset:1056 lds
v_pk_mul_f32 v[130:131], v[130:131], v[146:147] op_sel:[0,0] op_sel_hi:[1,0]
v_pk_mul_f32 v[132:133], v[132:133], v[146:147] op_sel:[0,0] op_sel_hi:[1,0]
v_pk_mul_f32 v[134:135], v[134:135], v[146:147] op_sel:[0,0] op_sel_hi:[1,0]
v_cvt_pk_bf16_f32 v128, v128, v129
v_cvt_pk_bf16_f32 v129, v130, v131
buffer_load_dwordx4 v242, s[64:67], s31 offen offset:2112 lds
v_cvt_pk_bf16_f32 v130, v132, v133
v_cvt_pk_bf16_f32 v131, v134, v135
v_pk_mul_f32 v[136:137], v[136:137], v[146:147] op_sel:[0,1] op_sel_hi:[1,1]
v_pk_mul_f32 v[138:139], v[138:139], v[146:147] op_sel:[0,1] op_sel_hi:[1,1]
v_pk_mul_f32 v[140:141], v[140:141], v[146:147] op_sel:[0,1] op_sel_hi:[1,1]
buffer_load_dwordx4 v243, s[64:67], s31 offen offset:3168 lds
v_pk_mul_f32 v[142:143], v[142:143], v[146:147] op_sel:[0,1] op_sel_hi:[1,1]
v_cvt_pk_bf16_f32 v136, v136, v137
v_cvt_pk_bf16_f32 v137, v138, v139
v_cvt_pk_bf16_f32 v138, v140, v141
v_cvt_pk_bf16_f32 v139, v142, v143
v_mov_b32 v15, 0x3f803f80
v_accvgpr_write_b32 a224, v15
v_accvgpr_write_b32 a225, v15
v_accvgpr_write_b32 a226, v15
v_accvgpr_write_b32 a227, v15
s_xor_b32 s88, s3, 0
s_lshl_b32 s88, s88, 6
v_add_u32 v216, s88, v248
v_add_u32 v220, s88, v249
v_add_u32 v224, s88, v250
s_xor_b32 s88, s3, 1
s_lshl_b32 s88, s88, 6
v_add_u32 v217, s88, v248
v_add_u32 v221, s88, v249
v_add_u32 v225, s88, v250
s_xor_b32 s88, s3, 2
s_lshl_b32 s88, s88, 6
v_add_u32 v218, s88, v248
v_add_u32 v222, s88, v249
v_add_u32 v226, s88, v250
s_xor_b32 s88, s3, 3
s_lshl_b32 s88, s88, 6
v_add_u32 v219, s88, v248
v_add_u32 v223, s88, v249
v_add_u32 v227, s88, v250
ds_read_b64_tr_b16 a[192:193], v216 offset:0
ds_read_b64_tr_b16 a[194:195], v216 offset:256
ds_read_b64_tr_b16 a[196:197], v216 offset:32
ds_read_b64_tr_b16 a[198:199], v216 offset:288
ds_read_b64_tr_b16 a[200:201], v217 offset:0
ds_read_b64_tr_b16 a[202:203], v217 offset:256
ds_read_b64_tr_b16 a[204:205], v217 offset:32
ds_read_b64_tr_b16 a[206:207], v217 offset:288
ds_read_b64_tr_b16 a[208:209], v218 offset:0
ds_read_b64_tr_b16 a[210:211], v218 offset:256
ds_read_b64_tr_b16 a[212:213], v218 offset:32
ds_read_b64_tr_b16 a[214:215], v218 offset:288
ds_read_b64_tr_b16 a[216:217], v219 offset:0
ds_read_b64_tr_b16 a[218:219], v219 offset:256
ds_read_b64_tr_b16 a[220:221], v219 offset:32
ds_read_b64_tr_b16 a[222:223], v219 offset:288
s_waitcnt vmcnt(43) lgkmcnt(14)
v_mfma_f32_16x16x32_bf16 v[144:147], a[192:195], a[0:3], 0
s_waitcnt vmcnt(42)
v_mfma_f32_16x16x32_bf16 v[148:151], a[192:195], a[4:7], 0
v_and_b32 v14, 15, v0
v_lshlrev_b32 v14, 5, v14
s_lshl_b32 s88, s11, 5
v_mfma_f32_16x16x32_bf16 v[208:211], a[192:195], a[224:227], 0
ds_read_b64_tr_b16 a[192:193], v216 offset:8448
s_add_u32 s88, s88, 65536
buffer_load_dwordx4 a[232:235], v14, s[76:79], s88 offen offset:0 sc1
s_waitcnt lgkmcnt(13)
v_mfma_f32_16x16x32_bf16 v[156:159], a[196:199], a[4:7], 0
ds_read_b64_tr_b16 a[194:195], v216 offset:8704
v_mfma_f32_16x16x32_bf16 v[152:155], a[196:199], a[0:3], 0
v_mfma_f32_16x16x32_bf16 v[212:215], a[196:199], a[224:227], 0
ds_read_b64_tr_b16 a[196:197], v216 offset:8480
buffer_load_dwordx4 a[236:239], v14, s[76:79], s88 offen offset:16 sc1
s_waitcnt lgkmcnt(13)
v_mfma_f32_16x16x32_bf16 v[160:163], a[200:203], a[0:3], 0
ds_read_b64_tr_b16 a[198:199], v216 offset:8736
v_mfma_f32_16x16x32_bf16 v[164:167], a[200:203], a[4:7], 0
ds_read_b64_tr_b16 a[200:201], v217 offset:8448
s_waitcnt lgkmcnt(13)
v_mfma_f32_16x16x32_bf16 v[172:175], a[204:207], a[4:7], 0
ds_read_b64_tr_b16 a[202:203], v217 offset:8704
buffer_load_dwordx4 a[240:243], v14, s[76:79], s88 offen offset:512 sc1
v_mfma_f32_16x16x32_bf16 v[168:171], a[204:207], a[0:3], 0
ds_read_b64_tr_b16 a[204:205], v217 offset:8480
s_waitcnt lgkmcnt(8)
v_mfma_f32_16x16x32_bf16 v[176:179], a[208:211], a[0:3], 0
ds_read_b64_tr_b16 a[206:207], v217 offset:8736
v_mfma_f32_16x16x32_bf16 v[180:183], a[208:211], a[4:7], 0
ds_read_b64_tr_b16 a[208:209], v218 offset:8448
buffer_load_dwordx4 a[244:247], v14, s[76:79], s88 offen offset:528 sc1
v_mfma_f32_16x16x32_bf16 v[188:191], a[212:215], a[4:7], 0
ds_read_b64_tr_b16 a[210:211], v218 offset:8704
v_mfma_f32_16x16x32_bf16 v[184:187], a[212:215], a[0:3], 0
ds_read_b64_tr_b16 a[212:213], v218 offset:8480
v_mfma_f32_16x16x32_bf16 v[192:195], a[216:219], a[0:3], 0
ds_read_b64_tr_b16 a[214:215], v218 offset:8736
s_lshl_b32 s29, s6, 2
v_mfma_f32_16x16x32_bf16 v[196:199], a[216:219], a[4:7], 0
ds_read_b64_tr_b16 a[216:217], v219 offset:8448
s_add_u32 s29, s29, s7
s_lshl_b32 s29, s29, 3
s_waitcnt lgkmcnt(13)
v_mfma_f32_16x16x32_bf16 v[204:207], a[220:223], a[4:7], 0
ds_read_b64_tr_b16 a[218:219], v219 offset:8704
s_add_u32 s29, s29, s4
s_lshl_b32 s29, s29, 2
s_add_u32 s29, s29, s3
v_mfma_f32_16x16x32_bf16 v[200:203], a[220:223], a[0:3], 0
ds_read_b64_tr_b16 a[220:221], v219 offset:8480
s_lshl_b32 s29, s29, 14
s_add_u32 s29, s29, 16777216
s_waitcnt lgkmcnt(8)
s_waitcnt vmcnt(45)
v_mfma_f32_16x16x32_bf16 v[144:147], a[192:195], a[8:11], v[144:147]
ds_read_b64_tr_b16 a[222:223], v219 offset:8736
s_waitcnt vmcnt(44)
v_mfma_f32_16x16x32_bf16 v[148:151], a[192:195], a[12:15], v[148:151]
buffer_store_dwordx4 v[16:19], v251, s[76:79], s29 offen offset:0 sc1
v_mfma_f32_16x16x32_bf16 v[208:211], a[192:195], a[224:227], v[208:211]
s_barrier
ds_read_b64_tr_b16 a[192:193], v216 offset:16896
v_mfma_f32_16x16x32_bf16 v[156:159], a[196:199], a[12:15], v[156:159]
ds_read_b64_tr_b16 a[194:195], v216 offset:17152
v_mfma_f32_16x16x32_bf16 v[152:155], a[196:199], a[8:11], v[152:155]
v_mfma_f32_16x16x32_bf16 v[212:215], a[196:199], a[224:227], v[212:215]
ds_read_b64_tr_b16 a[196:197], v216 offset:16928
v_mfma_f32_16x16x32_bf16 v[160:163], a[200:203], a[8:11], v[160:163]
ds_read_b64_tr_b16 a[198:199], v216 offset:17184
v_mfma_f32_16x16x32_bf16 v[164:167], a[200:203], a[12:15], v[164:167]
ds_read_b64_tr_b16 a[200:201], v217 offset:16896
s_waitcnt lgkmcnt(13)
v_mfma_f32_16x16x32_bf16 v[172:175], a[204:207], a[12:15], v[172:175]
ds_read_b64_tr_b16 a[202:203], v217 offset:17152
v_mfma_f32_16x16x32_bf16 v[168:171], a[204:207], a[8:11], v[168:171]
ds_read_b64_tr_b16 a[204:205], v217 offset:16928
s_waitcnt lgkmcnt(8)
v_mfma_f32_16x16x32_bf16 v[176:179], a[208:211], a[8:11], v[176:179]
ds_read_b64_tr_b16 a[206:207], v217 offset:17184
v_mfma_f32_16x16x32_bf16 v[180:183], a[208:211], a[12:15], v[180:183]
ds_read_b64_tr_b16 a[208:209], v218 offset:16896
buffer_store_dwordx4 v[24:27], v251, s[76:79], s29 offen offset:1024 sc1
v_mfma_f32_16x16x32_bf16 v[188:191], a[212:215], a[12:15], v[188:191]
ds_read_b64_tr_b16 a[210:211], v218 offset:17152
v_mfma_f32_16x16x32_bf16 v[184:187], a[212:215], a[8:11], v[184:187]
ds_read_b64_tr_b16 a[212:213], v218 offset:16928
v_mfma_f32_16x16x32_bf16 v[192:195], a[216:219], a[8:11], v[192:195]
ds_read_b64_tr_b16 a[214:215], v218 offset:17184
v_mfma_f32_16x16x32_bf16 v[196:199], a[216:219], a[12:15], v[196:199]
ds_read_b64_tr_b16 a[216:217], v219 offset:16896
s_waitcnt lgkmcnt(13)
v_mfma_f32_16x16x32_bf16 v[204:207], a[220:223], a[12:15], v[204:207]
ds_read_b64_tr_b16 a[218:219], v219 offset:17152
v_mfma_f32_16x16x32_bf16 v[200:203], a[220:223], a[8:11], v[200:203]
ds_read_b64_tr_b16 a[220:221], v219 offset:16928
s_waitcnt lgkmcnt(8)
s_waitcnt vmcnt(45)
v_mfma_f32_16x16x32_bf16 v[144:147], a[192:195], a[16:19], v[144:147]
ds_read_b64_tr_b16 a[222:223], v219 offset:17184
s_waitcnt vmcnt(44)
v_mfma_f32_16x16x32_bf16 v[148:151], a[192:195], a[20:23], v[148:151]
v_mfma_f32_16x16x32_bf16 v[208:211], a[192:195], a[224:227], v[208:211]
ds_read_b64_tr_b16 a[192:193], v216 offset:25344
v_mfma_f32_16x16x32_bf16 v[156:159], a[196:199], a[20:23], v[156:159]
ds_read_b64_tr_b16 a[194:195], v216 offset:25600
v_mfma_f32_16x16x32_bf16 v[152:155], a[196:199], a[16:19], v[152:155]
buffer_store_dwordx4 v[32:35], v251, s[76:79], s29 offen offset:2048 sc1
v_mfma_f32_16x16x32_bf16 v[212:215], a[196:199], a[224:227], v[212:215]
ds_read_b64_tr_b16 a[196:197], v216 offset:25376
v_mfma_f32_16x16x32_bf16 v[160:163], a[200:203], a[16:19], v[160:163]
ds_read_b64_tr_b16 a[198:199], v216 offset:25632
v_mfma_f32_16x16x32_bf16 v[164:167], a[200:203], a[20:23], v[164:167]
ds_read_b64_tr_b16 a[200:201], v217 offset:25344
s_waitcnt lgkmcnt(13)
v_mfma_f32_16x16x32_bf16 v[172:175], a[204:207], a[20:23], v[172:175]
ds_read_b64_tr_b16 a[202:203], v217 offset:25600
v_mfma_f32_16x16x32_bf16 v[168:171], a[204:207], a[16:19], v[168:171]
ds_read_b64_tr_b16 a[204:205], v217 offset:25376
s_waitcnt lgkmcnt(8)
v_mfma_f32_16x16x32_bf16 v[176:179], a[208:211], a[16:19], v[176:179]
ds_read_b64_tr_b16 a[206:207], v217 offset:25632
v_mfma_f32_16x16x32_bf16 v[180:183], a[208:211], a[20:23], v[180:183]
ds_read_b64_tr_b16 a[208:209], v218 offset:25344
v_mfma_f32_16x16x32_bf16 v[188:191], a[212:215], a[20:23], v[188:191]
ds_read_b64_tr_b16 a[210:211], v218 offset:25600
v_mfma_f32_16x16x32_bf16 v[184:187], a[212:215], a[16:19], v[184:187]
ds_read_b64_tr_b16 a[212:213], v218 offset:25376
v_mfma_f32_16x16x32_bf16 v[192:195], a[216:219], a[16:19], v[192:195]
ds_read_b64_tr_b16 a[214:215], v218 offset:25632
v_mfma_f32_16x16x32_bf16 v[196:199], a[216:219], a[20:23], v[196:199]
ds_read_b64_tr_b16 a[216:217], v219 offset:25344
buffer_store_dwordx4 v[40:43], v251, s[76:79], s29 offen offset:3072 sc1
s_waitcnt lgkmcnt(13)
v_mfma_f32_16x16x32_bf16 v[204:207], a[220:223], a[20:23], v[204:207]
ds_read_b64_tr_b16 a[218:219], v219 offset:25600
v_mfma_f32_16x16x32_bf16 v[200:203], a[220:223], a[16:19], v[200:203]
ds_read_b64_tr_b16 a[220:221], v219 offset:25376
s_waitcnt lgkmcnt(8)
s_waitcnt vmcnt(45)
v_mfma_f32_16x16x32_bf16 v[144:147], a[192:195], a[24:27], v[144:147]
ds_read_b64_tr_b16 a[222:223], v219 offset:25632
s_waitcnt vmcnt(44)
v_mfma_f32_16x16x32_bf16 v[148:151], a[192:195], a[28:31], v[148:151]
s_waitcnt vmcnt(7)
v_accvgpr_read_b32 v232, a232
v_mfma_f32_16x16x32_bf16 v[208:211], a[192:195], a[224:227], v[208:211]
s_barrier
ds_read_b64_tr_b16 a[192:193], v216 offset:33792
v_mfma_f32_16x16x32_bf16 v[156:159], a[196:199], a[28:31], v[156:159]
ds_read_b64_tr_b16 a[194:195], v216 offset:34048
v_accvgpr_read_b32 v233, a233
v_mfma_f32_16x16x32_bf16 v[152:155], a[196:199], a[24:27], v[152:155]
v_mfma_f32_16x16x32_bf16 v[212:215], a[196:199], a[224:227], v[212:215]
ds_read_b64_tr_b16 a[196:197], v216 offset:33824
v_accvgpr_read_b32 v234, a234
v_mfma_f32_16x16x32_bf16 v[160:163], a[200:203], a[24:27], v[160:163]
ds_read_b64_tr_b16 a[198:199], v216 offset:34080
v_mfma_f32_16x16x32_bf16 v[164:167], a[200:203], a[28:31], v[164:167]
ds_read_b64_tr_b16 a[200:201], v217 offset:33792
v_accvgpr_read_b32 v235, a235
s_waitcnt lgkmcnt(13)
v_mfma_f32_16x16x32_bf16 v[172:175], a[204:207], a[28:31], v[172:175]
ds_read_b64_tr_b16 a[202:203], v217 offset:34048
s_add_u32 s29, s29, 4096
v_mfma_f32_16x16x32_bf16 v[168:171], a[204:207], a[24:27], v[168:171]
ds_read_b64_tr_b16 a[204:205], v217 offset:33824
s_waitcnt vmcnt(6)
v_accvgpr_read_b32 v236, a236
s_waitcnt lgkmcnt(8)
v_mfma_f32_16x16x32_bf16 v[176:179], a[208:211], a[24:27], v[176:179]
ds_read_b64_tr_b16 a[206:207], v217 offset:34080
buffer_store_dwordx4 v[48:51], v251, s[76:79], s29 offen offset:0 sc1
v_mfma_f32_16x16x32_bf16 v[180:183], a[208:211], a[28:31], v[180:183]
ds_read_b64_tr_b16 a[208:209], v218 offset:33792
v_accvgpr_read_b32 v237, a237
v_mfma_f32_16x16x32_bf16 v[188:191], a[212:215], a[28:31], v[188:191]
ds_read_b64_tr_b16 a[210:211], v218 offset:34048
v_mfma_f32_16x16x32_bf16 v[184:187], a[212:215], a[24:27], v[184:187]
ds_read_b64_tr_b16 a[212:213], v218 offset:33824
v_accvgpr_read_b32 v238, a238
v_mfma_f32_16x16x32_bf16 v[192:195], a[216:219], a[24:27], v[192:195]
ds_read_b64_tr_b16 a[214:215], v218 offset:34080
v_mfma_f32_16x16x32_bf16 v[196:199], a[216:219], a[28:31], v[196:199]
ds_read_b64_tr_b16 a[216:217], v219 offset:33792
v_accvgpr_read_b32 v239, a239
s_waitcnt lgkmcnt(13)
v_mfma_f32_16x16x32_bf16 v[204:207], a[220:223], a[28:31], v[204:207]
ds_read_b64_tr_b16 a[218:219], v219 offset:34048
v_mfma_f32_16x16x32_bf16 v[200:203], a[220:223], a[24:27], v[200:203]
ds_read_b64_tr_b16 a[220:221], v219 offset:33824
buffer_store_dwordx4 v[56:59], v251, s[76:79], s29 offen offset:1024 sc1
s_waitcnt lgkmcnt(8)
v_mfma_f32_16x16x32_bf16 v[144:147], a[192:195], a[32:35], v[144:147]
ds_read_b64_tr_b16 a[222:223], v219 offset:34080
v_add_f32 v232, v232, v234
v_mfma_f32_16x16x32_bf16 v[148:151], a[192:195], a[36:39], v[148:151]
v_mfma_f32_16x16x32_bf16 v[208:211], a[192:195], a[224:227], v[208:211]
ds_read_b64_tr_b16 a[192:193], v216 offset:42240
v_add_f32 v233, v233, v235
v_mfma_f32_16x16x32_bf16 v[156:159], a[196:199], a[36:39], v[156:159]
ds_read_b64_tr_b16 a[194:195], v216 offset:42496
v_mfma_f32_16x16x32_bf16 v[152:155], a[196:199], a[32:35], v[152:155]
v_add_f32 v236, v236, v238
v_mfma_f32_16x16x32_bf16 v[212:215], a[196:199], a[224:227], v[212:215]
ds_read_b64_tr_b16 a[196:197], v216 offset:42272
v_mfma_f32_16x16x32_bf16 v[160:163], a[200:203], a[32:35], v[160:163]
ds_read_b64_tr_b16 a[198:199], v216 offset:42528
v_add_f32 v237, v237, v239
v_mfma_f32_16x16x32_bf16 v[164:167], a[200:203], a[36:39], v[164:167]
ds_read_b64_tr_b16 a[200:201], v217 offset:42240
s_lshl_b32 s22, s7, 17
s_waitcnt lgkmcnt(13)
v_mfma_f32_16x16x32_bf16 v[172:175], a[204:207], a[36:39], v[172:175]
ds_read_b64_tr_b16 a[202:203], v217 offset:42496
s_add_u32 s22, s22, s25
s_add_u32 s22, s22, 65536
s_add_u32 m0, s96, 0
v_add_f32 v232, v232, v236
v_mfma_f32_16x16x32_bf16 v[168:171], a[204:207], a[32:35], v[168:171]
ds_read_b64_tr_b16 a[204:205], v217 offset:42272
buffer_load_dwordx4 v244, s[52:55], s22 offen offset:0 lds
s_waitcnt lgkmcnt(8)
v_mfma_f32_16x16x32_bf16 v[176:179], a[208:211], a[32:35], v[176:179]
ds_read_b64_tr_b16 a[206:207], v217 offset:42528
v_add_f32 v233, v233, v237
v_mfma_f32_16x16x32_bf16 v[180:183], a[208:211], a[36:39], v[180:183]
ds_read_b64_tr_b16 a[208:209], v218 offset:42240
buffer_load_dwordx4 v245, s[52:55], s22 offen offset:1056 lds
v_mfma_f32_16x16x32_bf16 v[188:191], a[212:215], a[36:39], v[188:191]
ds_read_b64_tr_b16 a[210:211], v218 offset:42496
v_mul_f32 v228, 0x3b000000, v232
v_mfma_f32_16x16x32_bf16 v[184:187], a[212:215], a[32:35], v[184:187]
ds_read_b64_tr_b16 a[212:213], v218 offset:42272
v_mfma_f32_16x16x32_bf16 v[192:195], a[216:219], a[32:35], v[192:195]
ds_read_b64_tr_b16 a[214:215], v218 offset:42528
buffer_load_dwordx4 v246, s[52:55], s22 offen offset:2112 lds
v_mfma_f32_16x16x32_bf16 v[196:199], a[216:219], a[36:39], v[196:199]
ds_read_b64_tr_b16 a[216:217], v219 offset:42240
v_mul_f32 v229, 0x3b000000, v233
s_waitcnt lgkmcnt(13)
v_mfma_f32_16x16x32_bf16 v[204:207], a[220:223], a[36:39], v[204:207]
ds_read_b64_tr_b16 a[218:219], v219 offset:42496
v_mfma_f32_16x16x32_bf16 v[200:203], a[220:223], a[32:35], v[200:203]
ds_read_b64_tr_b16 a[220:221], v219 offset:42272
buffer_load_dwordx4 v247, s[52:55], s22 offen offset:3168 lds
v_fma_f32 v229, -v228, v228, v229
s_waitcnt lgkmcnt(8)
v_mfma_f32_16x16x32_bf16 v[144:147], a[192:195], a[40:43], v[144:147]
ds_read_b64_tr_b16 a[222:223], v219 offset:42528
v_mfma_f32_16x16x32_bf16 v[148:151], a[192:195], a[44:47], v[148:151]
buffer_store_dwordx4 v[64:67], v251, s[76:79], s29 offen offset:2048 sc1
v_max_f32 v229, 0, v229
v_mfma_f32_16x16x32_bf16 v[208:211], a[192:195], a[224:227], v[208:211]
s_barrier
ds_read_b64_tr_b16 a[192:193], v220 offset:0
v_mfma_f32_16x16x32_bf16 v[156:159], a[196:199], a[44:47], v[156:159]
ds_read_b64_tr_b16 a[194:195], v220 offset:256
v_add_f32 v229, 0x3727c5ac, v229
v_mfma_f32_16x16x32_bf16 v[152:155], a[196:199], a[40:43], v[152:155]
v_mfma_f32_16x16x32_bf16 v[212:215], a[196:199], a[224:227], v[212:215]
ds_read_b64_tr_b16 a[196:197], v220 offset:32
v_rsq_f32 v4, v229
v_mfma_f32_16x16x32_bf16 v[160:163], a[200:203], a[40:43], v[160:163]
ds_read_b64_tr_b16 a[198:199], v220 offset:288
v_mfma_f32_16x16x32_bf16 v[164:167], a[200:203], a[44:47], v[164:167]
ds_read_b64_tr_b16 a[200:201], v221 offset:0
v_mul_f32 v229, v229, v4
s_waitcnt lgkmcnt(13)
v_mfma_f32_16x16x32_bf16 v[172:175], a[204:207], a[44:47], v[172:175]
ds_read_b64_tr_b16 a[202:203], v221 offset:256
v_mfma_f32_16x16x32_bf16 v[168:171], a[204:207], a[40:43], v[168:171]
ds_read_b64_tr_b16 a[204:205], v221 offset:32
buffer_store_dwordx4 v[72:75], v251, s[76:79], s29 offen offset:3072 sc1
v_mul_f32 v5, v4, v4
s_waitcnt lgkmcnt(8)
v_mfma_f32_16x16x32_bf16 v[176:179], a[208:211], a[40:43], v[176:179]
ds_read_b64_tr_b16 a[206:207], v221 offset:288
v_mfma_f32_16x16x32_bf16 v[180:183], a[208:211], a[44:47], v[180:183]
ds_read_b64_tr_b16 a[208:209], v222 offset:0
v_mfma_f32_16x16x32_bf16 v[188:191], a[212:215], a[44:47], v[188:191]
ds_read_b64_tr_b16 a[210:211], v222 offset:256
v_mul_f32 v5, v5, v4
v_mfma_f32_16x16x32_bf16 v[184:187], a[212:215], a[40:43], v[184:187]
ds_read_b64_tr_b16 a[212:213], v222 offset:32
v_mfma_f32_16x16x32_bf16 v[192:195], a[216:219], a[40:43], v[192:195]
ds_read_b64_tr_b16 a[214:215], v222 offset:288
v_mul_f32 v4, 0xc0135761, v4
v_mfma_f32_16x16x32_bf16 v[196:199], a[216:219], a[44:47], v[196:199]
ds_read_b64_tr_b16 a[216:217], v223 offset:0
s_waitcnt lgkmcnt(13)
v_mfma_f32_16x16x32_bf16 v[204:207], a[220:223], a[44:47], v[204:207]
ds_read_b64_tr_b16 a[218:219], v223 offset:256
v_mul_f32 v5, 0xbdd2d3e8, v5
v_mfma_f32_16x16x32_bf16 v[200:203], a[220:223], a[40:43], v[200:203]
ds_read_b64_tr_b16 a[220:221], v223 offset:32
s_add_u32 s29, s29, 4096
s_waitcnt lgkmcnt(8)
v_mfma_f32_16x16x32_bf16 v[144:147], a[192:195], a[48:51], v[144:147]
ds_read_b64_tr_b16 a[222:223], v223 offset:288
s_waitcnt vmcnt(13)
v_accvgpr_read_b32 v232, a240
v_mfma_f32_16x16x32_bf16 v[148:151], a[192:195], a[52:55], v[148:151]
buffer_store_dwordx4 v[80:83], v251, s[76:79], s29 offen offset:0 sc1
v_mfma_f32_16x16x32_bf16 v[208:211], a[192:195], a[224:227], v[208:211]
ds_read_b64_tr_b16 a[192:193], v220 offset:8448
v_accvgpr_read_b32 v233, a241
v_mfma_f32_16x16x32_bf16 v[156:159], a[196:199], a[52:55], v[156:159]
ds_read_b64_tr_b16 a[194:195], v220 offset:8704
v_mfma_f32_16x16x32_bf16 v[152:155], a[196:199], a[48:51], v[152:155]
v_accvgpr_read_b32 v234, a242
v_mfma_f32_16x16x32_bf16 v[212:215], a[196:199], a[224:227], v[212:215]
ds_read_b64_tr_b16 a[196:197], v220 offset:8480
v_mfma_f32_16x16x32_bf16 v[160:163], a[200:203], a[48:51], v[160:163]
ds_read_b64_tr_b16 a[198:199], v220 offset:8736
v_accvgpr_read_b32 v235, a243
v_mfma_f32_16x16x32_bf16 v[164:167], a[200:203], a[52:55], v[164:167]
ds_read_b64_tr_b16 a[200:201], v221 offset:8448
s_waitcnt lgkmcnt(13)
v_mfma_f32_16x16x32_bf16 v[172:175], a[204:207], a[52:55], v[172:175]
ds_read_b64_tr_b16 a[202:203], v221 offset:8704
v_mfma_f32_16x16x32_bf16 v[168:171], a[204:207], a[48:51], v[168:171]
ds_read_b64_tr_b16 a[204:205], v221 offset:8480
buffer_store_dwordx4 v[88:91], v251, s[76:79], s29 offen offset:1024 sc1
s_waitcnt vmcnt(14)
v_accvgpr_read_b32 v236, a244
s_waitcnt lgkmcnt(8)
v_mfma_f32_16x16x32_bf16 v[176:179], a[208:211], a[48:51], v[176:179]
ds_read_b64_tr_b16 a[206:207], v221 offset:8736
v_mfma_f32_16x16x32_bf16 v[180:183], a[208:211], a[52:55], v[180:183]
ds_read_b64_tr_b16 a[208:209], v222 offset:8448
v_accvgpr_read_b32 v237, a245
v_mfma_f32_16x16x32_bf16 v[188:191], a[212:215], a[52:55], v[188:191]
ds_read_b64_tr_b16 a[210:211], v222 offset:8704
v_mfma_f32_16x16x32_bf16 v[184:187], a[212:215], a[48:51], v[184:187]
ds_read_b64_tr_b16 a[212:213], v222 offset:8480
v_accvgpr_read_b32 v238, a246
v_mfma_f32_16x16x32_bf16 v[192:195], a[216:219], a[48:51], v[192:195]
ds_read_b64_tr_b16 a[214:215], v222 offset:8736
v_mfma_f32_16x16x32_bf16 v[196:199], a[216:219], a[52:55], v[196:199]
ds_read_b64_tr_b16 a[216:217], v223 offset:8448
v_accvgpr_read_b32 v239, a247
s_waitcnt lgkmcnt(13)
v_mfma_f32_16x16x32_bf16 v[204:207], a[220:223], a[52:55], v[204:207]
ds_read_b64_tr_b16 a[218:219], v223 offset:8704
v_mfma_f32_16x16x32_bf16 v[200:203], a[220:223], a[48:51], v[200:203]
ds_read_b64_tr_b16 a[220:221], v223 offset:8480
s_lshl_b32 s22, s13, 17
s_add_u32 s22, s22, s25
s_add_u32 m0, s96, 16896
s_nop 0
buffer_load_dwordx4 v244, s[52:55], s22 offen offset:0 lds
v_add_f32 v232, v232, v234
s_waitcnt lgkmcnt(8)
v_mfma_f32_16x16x32_bf16 v[144:147], a[192:195], a[56:59], v[144:147]
ds_read_b64_tr_b16 a[222:223], v223 offset:8736
v_mfma_f32_16x16x32_bf16 v[148:151], a[192:195], a[60:63], v[148:151]
v_add_f32 v233, v233, v235
v_mfma_f32_16x16x32_bf16 v[208:211], a[192:195], a[224:227], v[208:211]
s_barrier
ds_read_b64_tr_b16 a[192:193], v220 offset:16896
buffer_load_dwordx4 v245, s[52:55], s22 offen offset:1056 lds
v_mfma_f32_16x16x32_bf16 v[156:159], a[196:199], a[60:63], v[156:159]
ds_read_b64_tr_b16 a[194:195], v220 offset:17152
v_add_f32 v236, v236, v238
v_mfma_f32_16x16x32_bf16 v[152:155], a[196:199], a[56:59], v[152:155]
v_mfma_f32_16x16x32_bf16 v[212:215], a[196:199], a[224:227], v[212:215]
ds_read_b64_tr_b16 a[196:197], v220 offset:16928
buffer_load_dwordx4 v246, s[52:55], s22 offen offset:2112 lds
v_mfma_f32_16x16x32_bf16 v[160:163], a[200:203], a[56:59], v[160:163]
ds_read_b64_tr_b16 a[198:199], v220 offset:17184
v_add_f32 v237, v237, v239
v_mfma_f32_16x16x32_bf16 v[164:167], a[200:203], a[60:63], v[164:167]
ds_read_b64_tr_b16 a[200:201], v221 offset:16896
buffer_load_dwordx4 v247, s[52:55], s22 offen offset:3168 lds
s_waitcnt lgkmcnt(13)
v_mfma_f32_16x16x32_bf16 v[172:175], a[204:207], a[60:63], v[172:175]
ds_read_b64_tr_b16 a[202:203], v221 offset:17152
v_add_f32 v232, v232, v236
v_mfma_f32_16x16x32_bf16 v[168:171], a[204:207], a[56:59], v[168:171]
ds_read_b64_tr_b16 a[204:205], v221 offset:16928
s_waitcnt lgkmcnt(8)
v_mfma_f32_16x16x32_bf16 v[176:179], a[208:211], a[56:59], v[176:179]
ds_read_b64_tr_b16 a[206:207], v221 offset:17184
buffer_store_dwordx4 v[96:99], v251, s[76:79], s29 offen offset:2048 sc1
v_add_f32 v233, v233, v237
v_mfma_f32_16x16x32_bf16 v[180:183], a[208:211], a[60:63], v[180:183]
ds_read_b64_tr_b16 a[208:209], v222 offset:16896
v_mfma_f32_16x16x32_bf16 v[188:191], a[212:215], a[60:63], v[188:191]
ds_read_b64_tr_b16 a[210:211], v222 offset:17152
v_mul_f32 v230, 0x3b000000, v232
v_mfma_f32_16x16x32_bf16 v[184:187], a[212:215], a[56:59], v[184:187]
ds_read_b64_tr_b16 a[212:213], v222 offset:16928
v_mfma_f32_16x16x32_bf16 v[192:195], a[216:219], a[56:59], v[192:195]
ds_read_b64_tr_b16 a[214:215], v222 offset:17184
v_mul_f32 v231, 0x3b000000, v233
v_mfma_f32_16x16x32_bf16 v[196:199], a[216:219], a[60:63], v[196:199]
ds_read_b64_tr_b16 a[216:217], v223 offset:16896
s_waitcnt lgkmcnt(13)
v_mfma_f32_16x16x32_bf16 v[204:207], a[220:223], a[60:63], v[204:207]
ds_read_b64_tr_b16 a[218:219], v223 offset:17152
v_fma_f32 v231, -v230, v230, v231
v_mfma_f32_16x16x32_bf16 v[200:203], a[220:223], a[56:59], v[200:203]
ds_read_b64_tr_b16 a[220:221], v223 offset:16928
s_waitcnt lgkmcnt(8)
v_mfma_f32_16x16x32_bf16 v[144:147], a[192:195], a[64:67], v[144:147]
ds_read_b64_tr_b16 a[222:223], v223 offset:17184
buffer_store_dwordx4 v[104:107], v251, s[76:79], s29 offen offset:3072 sc1
v_max_f32 v231, 0, v231
v_mfma_f32_16x16x32_bf16 v[148:151], a[192:195], a[68:71], v[148:151]
v_mfma_f32_16x16x32_bf16 v[208:211], a[192:195], a[224:227], v[208:211]
ds_read_b64_tr_b16 a[192:193], v220 offset:25344
v_mfma_f32_16x16x32_bf16 v[156:159], a[196:199], a[68:71], v[156:159]
ds_read_b64_tr_b16 a[194:195], v220 offset:25600
v_add_f32 v231, 0x3727c5ac, v231
v_mfma_f32_16x16x32_bf16 v[152:155], a[196:199], a[64:67], v[152:155]
v_mfma_f32_16x16x32_bf16 v[212:215], a[196:199], a[224:227], v[212:215]
ds_read_b64_tr_b16 a[196:197], v220 offset:25376
v_rsq_f32 v6, v231
v_mfma_f32_16x16x32_bf16 v[160:163], a[200:203], a[64:67], v[160:163]
ds_read_b64_tr_b16 a[198:199], v220 offset:25632
v_mfma_f32_16x16x32_bf16 v[164:167], a[200:203], a[68:71], v[164:167]
ds_read_b64_tr_b16 a[200:201], v221 offset:25344
v_mul_f32 v231, v231, v6
s_waitcnt lgkmcnt(13)
v_mfma_f32_16x16x32_bf16 v[172:175], a[204:207], a[68:71], v[172:175]
ds_read_b64_tr_b16 a[202:203], v221 offset:25600
s_add_u32 s29, s29, 4096
v_mfma_f32_16x16x32_bf16 v[168:171], a[204:207], a[64:67], v[168:171]
ds_read_b64_tr_b16 a[204:205], v221 offset:25376
v_mul_f32 v7, v6, v6
s_waitcnt lgkmcnt(8)
v_mfma_f32_16x16x32_bf16 v[176:179], a[208:211], a[64:67], v[176:179]
ds_read_b64_tr_b16 a[206:207], v221 offset:25632
buffer_store_dwordx4 v[112:115], v251, s[76:79], s29 offen offset:0 sc1
v_mfma_f32_16x16x32_bf16 v[180:183], a[208:211], a[68:71], v[180:183]
ds_read_b64_tr_b16 a[208:209], v222 offset:25344
v_mul_f32 v7, v7, v6
v_mfma_f32_16x16x32_bf16 v[188:191], a[212:215], a[68:71], v[188:191]
ds_read_b64_tr_b16 a[210:211], v222 offset:25600
v_mfma_f32_16x16x32_bf16 v[184:187], a[212:215], a[64:67], v[184:187]
ds_read_b64_tr_b16 a[212:213], v222 offset:25376
v_mul_f32 v6, 0xc0135761, v6
v_mfma_f32_16x16x32_bf16 v[192:195], a[216:219], a[64:67], v[192:195]
ds_read_b64_tr_b16 a[214:215], v222 offset:25632
v_mfma_f32_16x16x32_bf16 v[196:199], a[216:219], a[68:71], v[196:199]
ds_read_b64_tr_b16 a[216:217], v223 offset:25344
v_mul_f32 v7, 0xbdd2d3e8, v7
s_waitcnt lgkmcnt(13)
v_mfma_f32_16x16x32_bf16 v[204:207], a[220:223], a[68:71], v[204:207]
ds_read_b64_tr_b16 a[218:219], v223 offset:25600
v_mfma_f32_16x16x32_bf16 v[200:203], a[220:223], a[64:67], v[200:203]
ds_read_b64_tr_b16 a[220:221], v223 offset:25376
s_waitcnt lgkmcnt(8)
v_mfma_f32_16x16x32_bf16 v[144:147], a[192:195], a[72:75], v[144:147]
ds_read_b64_tr_b16 a[222:223], v223 offset:25632
buffer_store_dwordx4 v[120:123], v251, s[76:79], s29 offen offset:1024 sc1
v_mfma_f32_16x16x32_bf16 v[148:151], a[192:195], a[76:79], v[148:151]
v_and_b32 v232, 48, v0
v_mfma_f32_16x16x32_bf16 v[208:211], a[192:195], a[224:227], v[208:211]
s_barrier
ds_read_b64_tr_b16 a[192:193], v220 offset:33792
v_add_u32 v232, 155648, v232
v_mfma_f32_16x16x32_bf16 v[156:159], a[196:199], a[76:79], v[156:159]
ds_read_b64_tr_b16 a[194:195], v220 offset:34048
v_mfma_f32_16x16x32_bf16 v[152:155], a[196:199], a[72:75], v[152:155]
s_lshl_b32 s88, s3, 7
v_mfma_f32_16x16x32_bf16 v[212:215], a[196:199], a[224:227], v[212:215]
ds_read_b64_tr_b16 a[196:197], v220 offset:33824
v_add_u32 v233, s88, v232
v_mfma_f32_16x16x32_bf16 v[160:163], a[200:203], a[72:75], v[160:163]
ds_read_b64_tr_b16 a[198:199], v220 offset:34080
v_mfma_f32_16x16x32_bf16 v[164:167], a[200:203], a[76:79], v[164:167]
ds_read_b64_tr_b16 a[200:201], v221 offset:33792
s_cmp_eq_u32 s10, 10
s_cselect_b32 s28, 3, 7
s_waitcnt lgkmcnt(13)
v_mfma_f32_16x16x32_bf16 v[172:175], a[204:207], a[76:79], v[172:175]
ds_read_b64_tr_b16 a[202:203], v221 offset:34048
s_lshl_b32 s22, s13, 17
s_add_u32 s22, s22, s25
s_add_u32 s22, s22, 65536
s_add_u32 m0, s96, 33792
v_mfma_f32_16x16x32_bf16 v[168:171], a[204:207], a[72:75], v[168:171]
ds_read_b64_tr_b16 a[204:205], v221 offset:33824
buffer_load_dwordx4 v244, s[52:55], s22 offen offset:0 lds
s_waitcnt lgkmcnt(8)
v_mfma_f32_16x16x32_bf16 v[176:179], a[208:211], a[72:75], v[176:179]
ds_read_b64_tr_b16 a[206:207], v221 offset:34080
v_mfma_f32_16x16x32_bf16 v[180:183], a[208:211], a[76:79], v[180:183]
ds_read_b64_tr_b16 a[208:209], v222 offset:33792
buffer_load_dwordx4 v245, s[52:55], s22 offen offset:1056 lds
s_xor_b32 s88, s3, 0
v_mfma_f32_16x16x32_bf16 v[188:191], a[212:215], a[76:79], v[188:191]
ds_read_b64_tr_b16 a[210:211], v222 offset:34048
v_mfma_f32_16x16x32_bf16 v[184:187], a[212:215], a[72:75], v[184:187]
ds_read_b64_tr_b16 a[212:213], v222 offset:33824
s_lshl_b32 s89, s88, 7
v_mfma_f32_16x16x32_bf16 v[192:195], a[216:219], a[72:75], v[192:195]
ds_read_b64_tr_b16 a[214:215], v222 offset:34080
buffer_load_dwordx4 v246, s[52:55], s22 offen offset:2112 lds
v_mfma_f32_16x16x32_bf16 v[196:199], a[216:219], a[76:79], v[196:199]
ds_read_b64_tr_b16 a[216:217], v223 offset:33792
v_add_u32 v8, s89, v232
s_waitcnt lgkmcnt(13)
v_mfma_f32_16x16x32_bf16 v[204:207], a[220:223], a[76:79], v[204:207]
ds_read_b64_tr_b16 a[218:219], v223 offset:34048
s_lshl_b32 s89, s88, 10
v_mfma_f32_16x16x32_bf16 v[200:203], a[220:223], a[72:75], v[200:203]
ds_read_b64_tr_b16 a[220:221], v223 offset:33824
buffer_load_dwordx4 v247, s[52:55], s22 offen offset:3168 lds
s_waitcnt lgkmcnt(8)
v_mfma_f32_16x16x32_bf16 v[144:147], a[192:195], a[80:83], v[144:147]
ds_read_b64_tr_b16 a[222:223], v223 offset:34080
s_cmp_eq_u32 s88, s28
s_cselect_b32 s89, 1073741824, s89
v_mfma_f32_16x16x32_bf16 v[148:151], a[192:195], a[84:87], v[148:151]
buffer_store_dwordx4 v[128:131], v251, s[76:79], s29 offen offset:2048 sc1
v_mfma_f32_16x16x32_bf16 v[208:211], a[192:195], a[224:227], v[208:211]
ds_read_b64_tr_b16 a[192:193], v220 offset:42240
v_mfma_f32_16x16x32_bf16 v[156:159], a[196:199], a[84:87], v[156:159]
ds_read_b64_tr_b16 a[194:195], v220 offset:42496
v_mfma_f32_16x16x32_bf16 v[152:155], a[196:199], a[80:83], v[152:155]
v_add_u32 v236, s89, v251
v_mfma_f32_16x16x32_bf16 v[212:215], a[196:199], a[224:227], v[212:215]
ds_read_b64_tr_b16 a[196:197], v220 offset:42272
v_mfma_f32_16x16x32_bf16 v[160:163], a[200:203], a[80:83], v[160:163]
ds_read_b64_tr_b16 a[198:199], v220 offset:42528
s_xor_b32 s88, s3, 1
v_mfma_f32_16x16x32_bf16 v[164:167], a[200:203], a[84:87], v[164:167]
ds_read_b64_tr_b16 a[200:201], v221 offset:42240
s_lshl_b32 s89, s88, 7
s_waitcnt lgkmcnt(13)
v_mfma_f32_16x16x32_bf16 v[172:175], a[204:207], a[84:87], v[172:175]
ds_read_b64_tr_b16 a[202:203], v221 offset:42496
v_mfma_f32_16x16x32_bf16 v[168:171], a[204:207], a[80:83], v[168:171]
ds_read_b64_tr_b16 a[204:205], v221 offset:42272
buffer_store_dwordx4 v[136:139], v251, s[76:79], s29 offen offset:3072 sc1
v_add_u32 v9, s89, v232
s_waitcnt lgkmcnt(8)
v_mfma_f32_16x16x32_bf16 v[176:179], a[208:211], a[80:83], v[176:179]
ds_read_b64_tr_b16 a[206:207], v221 offset:42528
v_mfma_f32_16x16x32_bf16 v[180:183], a[208:211], a[84:87], v[180:183]
ds_read_b64_tr_b16 a[208:209], v222 offset:42240
s_lshl_b32 s89, s88, 10
v_mfma_f32_16x16x32_bf16 v[188:191], a[212:215], a[84:87], v[188:191]
ds_read_b64_tr_b16 a[210:211], v222 offset:42496
s_cmp_eq_u32 s88, s28
s_cselect_b32 s89, 1073741824, s89
v_mfma_f32_16x16x32_bf16 v[184:187], a[212:215], a[80:83], v[184:187]
ds_read_b64_tr_b16 a[212:213], v222 offset:42272
v_mfma_f32_16x16x32_bf16 v[192:195], a[216:219], a[80:83], v[192:195]
ds_read_b64_tr_b16 a[214:215], v222 offset:42528
v_mfma_f32_16x16x32_bf16 v[196:199], a[216:219], a[84:87], v[196:199]
ds_read_b64_tr_b16 a[216:217], v223 offset:42240
s_waitcnt lgkmcnt(13)
v_mfma_f32_16x16x32_bf16 v[204:207], a[220:223], a[84:87], v[204:207]
ds_read_b64_tr_b16 a[218:219], v223 offset:42496
v_add_u32 v237, s89, v251
v_mfma_f32_16x16x32_bf16 v[200:203], a[220:223], a[80:83], v[200:203]
ds_read_b64_tr_b16 a[220:221], v223 offset:42272
s_waitcnt lgkmcnt(8)
v_mfma_f32_16x16x32_bf16 v[144:147], a[192:195], a[88:91], v[144:147]
ds_read_b64_tr_b16 a[222:223], v223 offset:42528
s_xor_b32 s88, s3, 2
v_mfma_f32_16x16x32_bf16 v[148:151], a[192:195], a[92:95], v[148:151]
v_mfma_f32_16x16x32_bf16 v[208:211], a[192:195], a[224:227], v[208:211]
s_barrier
ds_read_b64_tr_b16 a[192:193], v224 offset:0
s_lshl_b32 s89, s88, 7
v_mfma_f32_16x16x32_bf16 v[156:159], a[196:199], a[92:95], v[156:159]
ds_read_b64_tr_b16 a[194:195], v224 offset:256
v_add_u32 v10, s89, v232
v_mfma_f32_16x16x32_bf16 v[152:155], a[196:199], a[88:91], v[152:155]
v_mfma_f32_16x16x32_bf16 v[212:215], a[196:199], a[224:227], v[212:215]
ds_read_b64_tr_b16 a[196:197], v224 offset:32
s_lshl_b32 s89, s88, 10
v_mfma_f32_16x16x32_bf16 v[160:163], a[200:203], a[88:91], v[160:163]
ds_read_b64_tr_b16 a[198:199], v224 offset:288
v_mfma_f32_16x16x32_bf16 v[164:167], a[200:203], a[92:95], v[164:167]
ds_read_b64_tr_b16 a[200:201], v225 offset:0
s_cmp_eq_u32 s88, s28
s_cselect_b32 s89, 1073741824, s89
s_waitcnt lgkmcnt(13)
v_mfma_f32_16x16x32_bf16 v[172:175], a[204:207], a[92:95], v[172:175]
ds_read_b64_tr_b16 a[202:203], v225 offset:256
v_mfma_f32_16x16x32_bf16 v[168:171], a[204:207], a[88:91], v[168:171]
ds_read_b64_tr_b16 a[204:205], v225 offset:32
s_waitcnt lgkmcnt(8)
v_mfma_f32_16x16x32_bf16 v[176:179], a[208:211], a[88:91], v[176:179]
ds_read_b64_tr_b16 a[206:207], v225 offset:288
v_mfma_f32_16x16x32_bf16 v[180:183], a[208:211], a[92:95], v[180:183]
ds_read_b64_tr_b16 a[208:209], v226 offset:0
v_add_u32 v238, s89, v251
v_mfma_f32_16x16x32_bf16 v[188:191], a[212:215], a[92:95], v[188:191]
ds_read_b64_tr_b16 a[210:211], v226 offset:256
s_xor_b32 s88, s3, 3
v_mfma_f32_16x16x32_bf16 v[184:187], a[212:215], a[88:91], v[184:187]
ds_read_b64_tr_b16 a[212:213], v226 offset:32
v_mfma_f32_16x16x32_bf16 v[192:195], a[216:219], a[88:91], v[192:195]
ds_read_b64_tr_b16 a[214:215], v226 offset:288
s_lshl_b32 s89, s88, 7
v_mfma_f32_16x16x32_bf16 v[196:199], a[216:219], a[92:95], v[196:199]
ds_read_b64_tr_b16 a[216:217], v227 offset:0
s_waitcnt lgkmcnt(13)
v_mfma_f32_16x16x32_bf16 v[204:207], a[220:223], a[92:95], v[204:207]
ds_read_b64_tr_b16 a[218:219], v227 offset:256
v_add_u32 v11, s89, v232
v_mfma_f32_16x16x32_bf16 v[200:203], a[220:223], a[88:91], v[200:203]
ds_read_b64_tr_b16 a[220:221], v227 offset:32
s_lshl_b32 s89, s88, 10
s_waitcnt lgkmcnt(8)
v_mfma_f32_16x16x32_bf16 v[144:147], a[192:195], a[96:99], v[144:147]
ds_read_b64_tr_b16 a[222:223], v227 offset:288
v_mfma_f32_16x16x32_bf16 v[148:151], a[192:195], a[100:103], v[148:151]
s_cmp_eq_u32 s88, s28
s_cselect_b32 s89, 1073741824, s89
v_mfma_f32_16x16x32_bf16 v[208:211], a[192:195], a[224:227], v[208:211]
ds_read_b64_tr_b16 a[192:193], v224 offset:8448
v_mfma_f32_16x16x32_bf16 v[156:159], a[196:199], a[100:103], v[156:159]
ds_read_b64_tr_b16 a[194:195], v224 offset:8704
v_mfma_f32_16x16x32_bf16 v[152:155], a[196:199], a[96:99], v[152:155]
v_mfma_f32_16x16x32_bf16 v[212:215], a[196:199], a[224:227], v[212:215]
ds_read_b64_tr_b16 a[196:197], v224 offset:8480
v_add_u32 v239, s89, v251
v_mfma_f32_16x16x32_bf16 v[160:163], a[200:203], a[96:99], v[160:163]
ds_read_b64_tr_b16 a[198:199], v224 offset:8736
v_mfma_f32_16x16x32_bf16 v[164:167], a[200:203], a[100:103], v[164:167]
ds_read_b64_tr_b16 a[200:201], v225 offset:8448
s_lshr_b32 s88, s11, 4
s_waitcnt lgkmcnt(13)
v_mfma_f32_16x16x32_bf16 v[172:175], a[204:207], a[100:103], v[172:175]
ds_read_b64_tr_b16 a[202:203], v225 offset:8704
v_mfma_f32_16x16x32_bf16 v[168:171], a[204:207], a[96:99], v[168:171]
ds_read_b64_tr_b16 a[204:205], v225 offset:8480
s_mul_i32 s88, s88, 44032
s_waitcnt lgkmcnt(8)
v_mfma_f32_16x16x32_bf16 v[176:179], a[208:211], a[96:99], v[176:179]
ds_read_b64_tr_b16 a[206:207], v225 offset:8736
s_lshl_b32 s89, s10, 12
v_mfma_f32_16x16x32_bf16 v[180:183], a[208:211], a[100:103], v[180:183]
ds_read_b64_tr_b16 a[208:209], v226 offset:8448
v_mfma_f32_16x16x32_bf16 v[188:191], a[212:215], a[100:103], v[188:191]
ds_read_b64_tr_b16 a[210:211], v226 offset:8704
s_add_u32 s88, s88, s89
v_mfma_f32_16x16x32_bf16 v[184:187], a[212:215], a[96:99], v[184:187]
ds_read_b64_tr_b16 a[212:213], v226 offset:8480
v_mfma_f32_16x16x32_bf16 v[192:195], a[216:219], a[96:99], v[192:195]
ds_read_b64_tr_b16 a[214:215], v226 offset:8736
s_add_u32 s88, s88, 6291456
v_mfma_f32_16x16x32_bf16 v[196:199], a[216:219], a[100:103], v[196:199]
ds_read_b64_tr_b16 a[216:217], v227 offset:8448
s_or_b32 s97, s88, s23
s_waitcnt lgkmcnt(13)
v_mfma_f32_16x16x32_bf16 v[204:207], a[220:223], a[100:103], v[204:207]
ds_read_b64_tr_b16 a[218:219], v227 offset:8704
v_mfma_f32_16x16x32_bf16 v[200:203], a[220:223], a[96:99], v[200:203]
ds_read_b64_tr_b16 a[220:221], v227 offset:8480
s_add_u32 s98, s97, 44032
s_waitcnt lgkmcnt(8)
v_mfma_f32_16x16x32_bf16 v[144:147], a[192:195], a[104:107], v[144:147]
ds_read_b64_tr_b16 a[222:223], v227 offset:8736
v_mfma_f32_16x16x32_bf16 v[148:151], a[192:195], a[108:111], v[148:151]
v_mfma_f32_16x16x32_bf16 v[208:211], a[192:195], a[224:227], v[208:211]
s_barrier
ds_read_b64_tr_b16 a[192:193], v224 offset:16896
v_mfma_f32_16x16x32_bf16 v[156:159], a[196:199], a[108:111], v[156:159]
ds_read_b64_tr_b16 a[194:195], v224 offset:17152
v_mfma_f32_16x16x32_bf16 v[152:155], a[196:199], a[104:107], v[152:155]
s_lshr_b32 s88, s6, 1
s_lshl_b32 s17, s4, 2
v_mfma_f32_16x16x32_bf16 v[212:215], a[196:199], a[224:227], v[212:215]
ds_read_b64_tr_b16 a[196:197], v224 offset:16928
s_add_u32 s17, s17, s88
s_and_b32 s88, s6, 1
v_mfma_f32_16x16x32_bf16 v[160:163], a[200:203], a[104:107], v[160:163]
ds_read_b64_tr_b16 a[198:199], v224 offset:17184
s_xor_b32 s88, s88, 1
v_mfma_f32_16x16x32_bf16 v[164:167], a[200:203], a[108:111], v[164:167]
ds_read_b64_tr_b16 a[200:201], v225 offset:16896
s_xor_b32 s18, s7, 0
s_lshl_b32 s18, s18, 1
s_waitcnt lgkmcnt(13)
v_mfma_f32_16x16x32_bf16 v[172:175], a[204:207], a[108:111], v[172:175]
ds_read_b64_tr_b16 a[202:203], v225 offset:17152
s_add_u32 s18, s18, s88
v_mfma_f32_16x16x32_bf16 v[168:171], a[204:207], a[104:107], v[168:171]
ds_read_b64_tr_b16 a[204:205], v225 offset:16928
s_lshr_b32 s89, s3, 1
s_mul_i32 s26, s89, 21
s_waitcnt lgkmcnt(8)
v_mfma_f32_16x16x32_bf16 v[176:179], a[208:211], a[104:107], v[176:179]
ds_read_b64_tr_b16 a[206:207], v225 offset:17184
s_and_b32 s88, s3, 1
v_mfma_f32_16x16x32_bf16 v[180:183], a[208:211], a[108:111], v[180:183]
ds_read_b64_tr_b16 a[208:209], v226 offset:16896
s_lshl_b32 s19, s88, 1
s_add_u32 s19, s19, s89
v_mfma_f32_16x16x32_bf16 v[188:191], a[212:215], a[108:111], v[188:191]
ds_read_b64_tr_b16 a[210:211], v226 offset:17152
s_add_u32 s12, s26, s88
v_mfma_f32_16x16x32_bf16 v[184:187], a[212:215], a[104:107], v[184:187]
ds_read_b64_tr_b16 a[212:213], v226 offset:16928
s_lshl_b32 s88, s18, 7
s_movk_i32 s92, 0x400
v_mfma_f32_16x16x32_bf16 v[192:195], a[216:219], a[104:107], v[192:195]
ds_read_b64_tr_b16 a[214:215], v226 offset:17184
s_add_u32 s32, s76, 1044480
s_addc_u32 s33, s77, 0
s_cmp_eq_u32 s18, 3
s_cselect_b32 s68, s32, s68
s_cselect_b32 s69, s33, s69
s_cselect_b32 s70, 180224, s70
s_cselect_b32 s89, 0x80, s92
s_cselect_b32 s88, 0, s88
v_mfma_f32_16x16x32_bf16 v[196:199], a[216:219], a[108:111], v[196:199]
ds_read_b64_tr_b16 a[216:217], v227 offset:16896
s_waitcnt lgkmcnt(13)
v_mfma_f32_16x16x32_bf16 v[204:207], a[220:223], a[108:111], v[204:207]
ds_read_b64_tr_b16 a[218:219], v227 offset:17152
s_mul_i32 s12, s12, s89
s_lshl_b32 s12, s12, 5
v_mfma_f32_16x16x32_bf16 v[200:203], a[220:223], a[104:107], v[200:203]
ds_read_b64_tr_b16 a[220:221], v227 offset:16928
s_add_u32 s12, s12, s88
s_waitcnt lgkmcnt(8)
v_mfma_f32_16x16x32_bf16 v[144:147], a[192:195], a[112:115], v[144:147]
ds_read_b64_tr_b16 a[222:223], v227 offset:17184
s_lshl_b32 s92, s89, 6
s_cmp_eq_u32 s89, 0x80
s_movk_i32 s88, 128
s_cselect_b32 s88, 4096, s88
v_mfma_f32_16x16x32_bf16 v[148:151], a[192:195], a[116:119], v[148:151]
v_mfma_f32_16x16x32_bf16 v[208:211], a[192:195], a[224:227], v[208:211]
ds_read_b64_tr_b16 a[192:193], v224 offset:25344
v_bfe_u32 v14, v0, 3, 1
v_mfma_f32_16x16x32_bf16 v[156:159], a[196:199], a[116:119], v[156:159]
ds_read_b64_tr_b16 a[194:195], v224 offset:25600
v_lshlrev_b32 v14, 2, v14
v_bfe_u32 v15, v0, 4, 1
v_mfma_f32_16x16x32_bf16 v[152:155], a[196:199], a[112:115], v[152:155]
v_lshl_add_u32 v14, v15, 4, v14
v_mfma_f32_16x16x32_bf16 v[212:215], a[196:199], a[224:227], v[212:215]
ds_read_b64_tr_b16 a[196:197], v224 offset:25376
v_lshrrev_b32 v15, 5, v0
v_lshl_add_u32 v14, v15, 3, v14
v_mfma_f32_16x16x32_bf16 v[160:163], a[200:203], a[112:115], v[160:163]
ds_read_b64_tr_b16 a[198:199], v224 offset:25632
v_mul_u32_u24 v14, s89, v14
v_mfma_f32_16x16x32_bf16 v[164:167], a[200:203], a[116:119], v[164:167]
ds_read_b64_tr_b16 a[200:201], v225 offset:25344
v_and_b32 v15, 7, v0
v_lshl_add_u32 v14, v15, 4, v14
s_waitcnt lgkmcnt(13)
v_mfma_f32_16x16x32_bf16 v[172:175], a[204:207], a[116:119], v[172:175]
ds_read_b64_tr_b16 a[202:203], v225 offset:25600
v_add_u32 v240, s88, v14
v_mfma_f32_16x16x32_bf16 v[168:171], a[204:207], a[112:115], v[168:171]
ds_read_b64_tr_b16 a[204:205], v225 offset:25376
s_sub_u32 s89, 1056, s89
v_subrev_u32 v241, s89, v240
s_waitcnt lgkmcnt(8)
v_mfma_f32_16x16x32_bf16 v[176:179], a[208:211], a[112:115], v[176:179]
ds_read_b64_tr_b16 a[206:207], v225 offset:25632
v_subrev_u32 v242, s89, v241
v_mfma_f32_16x16x32_bf16 v[180:183], a[208:211], a[116:119], v[180:183]
ds_read_b64_tr_b16 a[208:209], v226 offset:25344
v_subrev_u32 v243, s89, v242
s_lshl_b32 s22, s14, 17
v_mfma_f32_16x16x32_bf16 v[188:191], a[212:215], a[116:119], v[188:191]
ds_read_b64_tr_b16 a[210:211], v226 offset:25600
s_add_u32 s22, s22, s25
v_mfma_f32_16x16x32_bf16 v[184:187], a[212:215], a[112:115], v[184:187]
ds_read_b64_tr_b16 a[212:213], v226 offset:25376
s_add_u32 m0, s96, 50688
s_nop 0
buffer_load_dwordx4 v244, s[52:55], s22 offen offset:0 lds
v_mfma_f32_16x16x32_bf16 v[192:195], a[216:219], a[112:115], v[192:195]
ds_read_b64_tr_b16 a[214:215], v226 offset:25632
v_mfma_f32_16x16x32_bf16 v[196:199], a[216:219], a[116:119], v[196:199]
ds_read_b64_tr_b16 a[216:217], v227 offset:25344
s_waitcnt lgkmcnt(13)
v_mfma_f32_16x16x32_bf16 v[204:207], a[220:223], a[116:119], v[204:207]
ds_read_b64_tr_b16 a[218:219], v227 offset:25600
v_mfma_f32_16x16x32_bf16 v[200:203], a[220:223], a[112:115], v[200:203]
ds_read_b64_tr_b16 a[220:221], v227 offset:25376
s_waitcnt lgkmcnt(8)
v_mfma_f32_16x16x32_bf16 v[144:147], a[192:195], a[120:123], v[144:147]
ds_read_b64_tr_b16 a[222:223], v227 offset:25632
v_mfma_f32_16x16x32_bf16 v[148:151], a[192:195], a[124:127], v[148:151]
buffer_load_dwordx4 v245, s[52:55], s22 offen offset:1056 lds
v_mfma_f32_16x16x32_bf16 v[208:211], a[192:195], a[224:227], v[208:211]
v_mfma_f32_16x16x32_bf16 v[156:159], a[196:199], a[124:127], v[156:159]
v_mfma_f32_16x16x32_bf16 v[152:155], a[196:199], a[120:123], v[152:155]
v_mfma_f32_16x16x32_bf16 v[212:215], a[196:199], a[224:227], v[212:215]
v_mfma_f32_16x16x32_bf16 v[160:163], a[200:203], a[120:123], v[160:163]
buffer_load_dwordx4 v246, s[52:55], s22 offen offset:2112 lds
v_mfma_f32_16x16x32_bf16 v[164:167], a[200:203], a[124:127], v[164:167]
s_waitcnt lgkmcnt(8)
v_mfma_f32_16x16x32_bf16 v[172:175], a[204:207], a[124:127], v[172:175]
v_mfma_f32_16x16x32_bf16 v[168:171], a[204:207], a[120:123], v[168:171]
s_waitcnt lgkmcnt(6)
v_mfma_f32_16x16x32_bf16 v[176:179], a[208:211], a[120:123], v[176:179]
v_mfma_f32_16x16x32_bf16 v[180:183], a[208:211], a[124:127], v[180:183]
s_waitcnt lgkmcnt(4)
v_mfma_f32_16x16x32_bf16 v[188:191], a[212:215], a[124:127], v[188:191]
buffer_load_dwordx4 v247, s[52:55], s22 offen offset:3168 lds
v_mfma_f32_16x16x32_bf16 v[184:187], a[212:215], a[120:123], v[184:187]
s_waitcnt lgkmcnt(2)
v_mfma_f32_16x16x32_bf16 v[192:195], a[216:219], a[120:123], v[192:195]
v_mfma_f32_16x16x32_bf16 v[196:199], a[216:219], a[124:127], v[196:199]
s_waitcnt lgkmcnt(0)
v_mfma_f32_16x16x32_bf16 v[204:207], a[220:223], a[124:127], v[204:207]
v_mfma_f32_16x16x32_bf16 v[200:203], a[220:223], a[120:123], v[200:203]
ds_write_b128 v233, v[208:211] offset:0
ds_write_b128 v233, v[212:215] offset:64
s_waitcnt lgkmcnt(0)
s_barrier
ds_read_b128 v[20:23], v8 offset:0
ds_read_b128 v[28:31], v8 offset:64
ds_read_b128 v[36:39], v9 offset:0
ds_read_b128 v[44:47], v9 offset:64
ds_read_b128 v[52:55], v10 offset:0
ds_read_b128 v[60:63], v10 offset:64
ds_read_b128 v[68:71], v11 offset:0
ds_read_b128 v[76:79], v11 offset:64
s_waitcnt lgkmcnt(7)
v_pk_fma_f32 v[144:145], v[228:229], v[20:21], v[144:145] op_sel_hi:[0,1,1] neg_lo:[1,0,0] neg_hi:[1,0,0]
s_lshl_b32 s22, s14, 17
s_add_u32 s22, s22, s25
v_pk_fma_f32 v[146:147], v[228:229], v[22:23], v[146:147] op_sel_hi:[0,1,1] neg_lo:[1,0,0] neg_hi:[1,0,0]
s_add_u32 s22, s22, 65536
v_pk_fma_f32 v[148:149], v[230:231], v[20:21], v[148:149] op_sel_hi:[0,1,1] neg_lo:[1,0,0] neg_hi:[1,0,0]
s_add_u32 m0, s96, 67584
v_pk_fma_f32 v[150:151], v[230:231], v[22:23], v[150:151] op_sel_hi:[0,1,1] neg_lo:[1,0,0] neg_hi:[1,0,0]
buffer_load_dwordx4 v244, s[52:55], s22 offen offset:0 lds
v_pk_mul_f32 v[216:217], v[144:145], v[144:145]
v_pk_mul_f32 v[218:219], v[146:147], v[146:147]
v_pk_mul_f32 v[220:221], v[148:149], v[148:149]
v_pk_mul_f32 v[222:223], v[150:151], v[150:151]
v_pk_fma_f32 v[216:217], v[216:217], v[4:5], v[4:5] op_sel:[0,1,0] op_sel_hi:[1,1,0]
v_pk_fma_f32 v[218:219], v[218:219], v[4:5], v[4:5] op_sel:[0,1,0] op_sel_hi:[1,1,0]
buffer_load_dwordx4 v245, s[52:55], s22 offen offset:1056 lds
v_pk_fma_f32 v[220:221], v[220:221], v[6:7], v[6:7] op_sel:[0,1,0] op_sel_hi:[1,1,0]
v_pk_fma_f32 v[222:223], v[222:223], v[6:7], v[6:7] op_sel:[0,1,0] op_sel_hi:[1,1,0]
v_pk_mul_f32 v[216:217], v[216:217], v[144:145]
v_pk_mul_f32 v[218:219], v[218:219], v[146:147]
v_pk_mul_f32 v[220:221], v[220:221], v[148:149]
v_pk_mul_f32 v[222:223], v[222:223], v[150:151]
v_exp_f32 v216, v216
buffer_load_dwordx4 v246, s[52:55], s22 offen offset:2112 lds
v_exp_f32 v217, v217
v_exp_f32 v218, v218
v_exp_f32 v219, v219
v_exp_f32 v220, v220
v_exp_f32 v221, v221
v_exp_f32 v222, v222
buffer_load_dwordx4 v247, s[52:55], s22 offen offset:3168 lds
v_exp_f32 v223, v223
v_pk_fma_f32 v[216:217], v[216:217], v[228:229], v[228:229] op_sel:[0,1,1] op_sel_hi:[1,1,1]
v_pk_fma_f32 v[218:219], v[218:219], v[228:229], v[228:229] op_sel:[0,1,1] op_sel_hi:[1,1,1]
v_pk_fma_f32 v[220:221], v[220:221], v[230:231], v[230:231] op_sel:[0,1,1] op_sel_hi:[1,1,1]
v_pk_fma_f32 v[222:223], v[222:223], v[230:231], v[230:231] op_sel:[0,1,1] op_sel_hi:[1,1,1]
v_rcp_f32 v216, v216
v_rcp_f32 v217, v217
s_lshl_b32 s22, s15, 17
v_rcp_f32 v218, v218
s_add_u32 s22, s22, s25
v_rcp_f32 v219, v219
s_add_u32 m0, s96, 84480
s_nop 0
buffer_load_dwordx4 v244, s[52:55], s22 offen offset:0 lds
v_rcp_f32 v220, v220
v_rcp_f32 v221, v221
v_rcp_f32 v222, v222
v_rcp_f32 v223, v223
v_mov_b32 v14, s8
s_lshl_b32 s100, s2, 5
s_add_u32 s100, s100, s3
s_lshl_b32 s100, s100, 2
s_add_u32 s100, s100, 131104
s_waitcnt vmcnt(9)
s_mov_b64 exec, 1
buffer_store_dword v14, off, s[76:79], s100 sc1
s_mov_b64 exec, -1
v_pk_mul_f32 v[144:145], v[144:145], v[216:217]
v_pk_mul_f32 v[146:147], v[146:147], v[218:219]
v_pk_mul_f32 v[148:149], v[148:149], v[220:221]
buffer_load_dwordx4 v245, s[52:55], s22 offen offset:1056 lds
v_pk_mul_f32 v[150:151], v[150:151], v[222:223]
s_waitcnt lgkmcnt(6)
v_pk_fma_f32 v[152:153], v[228:229], v[28:29], v[152:153] op_sel_hi:[0,1,1] neg_lo:[1,0,0] neg_hi:[1,0,0]
v_pk_fma_f32 v[154:155], v[228:229], v[30:31], v[154:155] op_sel_hi:[0,1,1] neg_lo:[1,0,0] neg_hi:[1,0,0]
v_pk_fma_f32 v[156:157], v[230:231], v[28:29], v[156:157] op_sel_hi:[0,1,1] neg_lo:[1,0,0] neg_hi:[1,0,0]
v_pk_fma_f32 v[158:159], v[230:231], v[30:31], v[158:159] op_sel_hi:[0,1,1] neg_lo:[1,0,0] neg_hi:[1,0,0]
v_pk_mul_f32 v[216:217], v[152:153], v[152:153]
v_pk_mul_f32 v[218:219], v[154:155], v[154:155]
buffer_load_dwordx4 v246, s[52:55], s22 offen offset:2112 lds
v_pk_mul_f32 v[220:221], v[156:157], v[156:157]
v_pk_mul_f32 v[222:223], v[158:159], v[158:159]
v_pk_fma_f32 v[216:217], v[216:217], v[4:5], v[4:5] op_sel:[0,1,0] op_sel_hi:[1,1,0]
v_pk_fma_f32 v[218:219], v[218:219], v[4:5], v[4:5] op_sel:[0,1,0] op_sel_hi:[1,1,0]
v_pk_fma_f32 v[220:221], v[220:221], v[6:7], v[6:7] op_sel:[0,1,0] op_sel_hi:[1,1,0]
v_pk_fma_f32 v[222:223], v[222:223], v[6:7], v[6:7] op_sel:[0,1,0] op_sel_hi:[1,1,0]
buffer_load_dwordx4 v247, s[52:55], s22 offen offset:3168 lds
v_pk_mul_f32 v[216:217], v[216:217], v[152:153]
v_pk_mul_f32 v[218:219], v[218:219], v[154:155]
v_pk_mul_f32 v[220:221], v[220:221], v[156:157]
v_pk_mul_f32 v[222:223], v[222:223], v[158:159]
v_exp_f32 v216, v216
v_exp_f32 v217, v217
v_exp_f32 v218, v218
s_lshl_b32 s22, s15, 17
v_exp_f32 v219, v219
s_add_u32 s22, s22, s25
s_add_u32 s22, s22, 65536
v_exp_f32 v220, v220
s_add_u32 m0, s96, 101376
v_exp_f32 v221, v221
buffer_load_dwordx4 v244, s[52:55], s22 offen offset:0 lds
v_exp_f32 v222, v222
v_exp_f32 v223, v223
v_pk_fma_f32 v[216:217], v[216:217], v[228:229], v[228:229] op_sel:[0,1,1] op_sel_hi:[1,1,1]
v_pk_fma_f32 v[218:219], v[218:219], v[228:229], v[228:229] op_sel:[0,1,1] op_sel_hi:[1,1,1]
v_pk_fma_f32 v[220:221], v[220:221], v[230:231], v[230:231] op_sel:[0,1,1] op_sel_hi:[1,1,1]
v_pk_fma_f32 v[222:223], v[222:223], v[230:231], v[230:231] op_sel:[0,1,1] op_sel_hi:[1,1,1]
v_rcp_f32 v216, v216
buffer_load_dwordx4 v245, s[52:55], s22 offen offset:1056 lds
v_rcp_f32 v217, v217
v_rcp_f32 v218, v218
v_rcp_f32 v219, v219
v_rcp_f32 v220, v220
v_rcp_f32 v221, v221
v_rcp_f32 v222, v222
buffer_load_dwordx4 v246, s[52:55], s22 offen offset:2112 lds
v_rcp_f32 v223, v223
v_pk_mul_f32 v[152:153], v[152:153], v[216:217]
v_pk_mul_f32 v[154:155], v[154:155], v[218:219]
v_pk_mul_f32 v[156:157], v[156:157], v[220:221]
v_pk_mul_f32 v[158:159], v[158:159], v[222:223]
v_cvt_pk_bf16_f32 v144, v144, v145
v_cvt_pk_bf16_f32 v145, v146, v147
buffer_load_dwordx4 v247, s[52:55], s22 offen offset:3168 lds
v_cvt_pk_bf16_f32 v146, v152, v153
v_cvt_pk_bf16_f32 v147, v154, v155
buffer_store_dwordx4 v[144:147], v236, s[76:79], s97 offen sc1
v_cvt_pk_bf16_f32 v148, v148, v149
v_cvt_pk_bf16_f32 v149, v150, v151
v_cvt_pk_bf16_f32 v150, v156, v157
v_cvt_pk_bf16_f32 v151, v158, v159
buffer_store_dwordx4 v[148:151], v236, s[76:79], s98 offen sc1
s_waitcnt lgkmcnt(5)
v_pk_fma_f32 v[160:161], v[228:229], v[36:37], v[160:161] op_sel_hi:[0,1,1] neg_lo:[1,0,0] neg_hi:[1,0,0]
v_pk_fma_f32 v[162:163], v[228:229], v[38:39], v[162:163] op_sel_hi:[0,1,1] neg_lo:[1,0,0] neg_hi:[1,0,0]
v_pk_fma_f32 v[164:165], v[230:231], v[36:37], v[164:165] op_sel_hi:[0,1,1] neg_lo:[1,0,0] neg_hi:[1,0,0]
v_pk_fma_f32 v[166:167], v[230:231], v[38:39], v[166:167] op_sel_hi:[0,1,1] neg_lo:[1,0,0] neg_hi:[1,0,0]
v_pk_mul_f32 v[216:217], v[160:161], v[160:161]
s_mul_i32 s31, s92, 0
s_add_u32 s31, s31, s12
v_pk_mul_f32 v[218:219], v[162:163], v[162:163]
s_add_u32 m0, s96, 118272
v_pk_mul_f32 v[220:221], v[164:165], v[164:165]
buffer_load_dwordx4 v240, s[68:71], s31 offen offset:0 lds
v_pk_mul_f32 v[222:223], v[166:167], v[166:167]
v_pk_fma_f32 v[216:217], v[216:217], v[4:5], v[4:5] op_sel:[0,1,0] op_sel_hi:[1,1,0]
v_pk_fma_f32 v[218:219], v[218:219], v[4:5], v[4:5] op_sel:[0,1,0] op_sel_hi:[1,1,0]
v_pk_fma_f32 v[220:221], v[220:221], v[6:7], v[6:7] op_sel:[0,1,0] op_sel_hi:[1,1,0]
v_pk_fma_f32 v[222:223], v[222:223], v[6:7], v[6:7] op_sel:[0,1,0] op_sel_hi:[1,1,0]
v_pk_mul_f32 v[216:217], v[216:217], v[160:161]
buffer_load_dwordx4 v241, s[68:71], s31 offen offset:1056 lds
v_pk_mul_f32 v[218:219], v[218:219], v[162:163]
v_pk_mul_f32 v[220:221], v[220:221], v[164:165]
v_pk_mul_f32 v[222:223], v[222:223], v[166:167]
v_exp_f32 v216, v216
v_exp_f32 v217, v217
v_exp_f32 v218, v218
buffer_load_dwordx4 v242, s[68:71], s31 offen offset:2112 lds
v_exp_f32 v219, v219
v_exp_f32 v220, v220
v_exp_f32 v221, v221
v_exp_f32 v222, v222
v_exp_f32 v223, v223
v_pk_fma_f32 v[216:217], v[216:217], v[228:229], v[228:229] op_sel:[0,1,1] op_sel_hi:[1,1,1]
buffer_load_dwordx4 v243, s[68:71], s31 offen offset:3168 lds
v_pk_fma_f32 v[218:219], v[218:219], v[228:229], v[228:229] op_sel:[0,1,1] op_sel_hi:[1,1,1]
v_pk_fma_f32 v[220:221], v[220:221], v[230:231], v[230:231] op_sel:[0,1,1] op_sel_hi:[1,1,1]
v_pk_fma_f32 v[222:223], v[222:223], v[230:231], v[230:231] op_sel:[0,1,1] op_sel_hi:[1,1,1]
v_rcp_f32 v216, v216
v_rcp_f32 v217, v217
v_rcp_f32 v218, v218
v_rcp_f32 v219, v219
v_rcp_f32 v220, v220
v_rcp_f32 v221, v221
v_rcp_f32 v222, v222
v_rcp_f32 v223, v223
v_pk_mul_f32 v[160:161], v[160:161], v[216:217]
v_pk_mul_f32 v[162:163], v[162:163], v[218:219]
v_pk_mul_f32 v[164:165], v[164:165], v[220:221]
v_pk_mul_f32 v[166:167], v[166:167], v[222:223]
s_waitcnt lgkmcnt(4)
v_pk_fma_f32 v[168:169], v[228:229], v[44:45], v[168:169] op_sel_hi:[0,1,1] neg_lo:[1,0,0] neg_hi:[1,0,0]
v_pk_fma_f32 v[170:171], v[228:229], v[46:47], v[170:171] op_sel_hi:[0,1,1] neg_lo:[1,0,0] neg_hi:[1,0,0]
v_pk_fma_f32 v[172:173], v[230:231], v[44:45], v[172:173] op_sel_hi:[0,1,1] neg_lo:[1,0,0] neg_hi:[1,0,0]
v_pk_fma_f32 v[174:175], v[230:231], v[46:47], v[174:175] op_sel_hi:[0,1,1] neg_lo:[1,0,0] neg_hi:[1,0,0]
v_pk_mul_f32 v[216:217], v[168:169], v[168:169]
v_pk_mul_f32 v[218:219], v[170:171], v[170:171]
v_pk_mul_f32 v[220:221], v[172:173], v[172:173]
v_pk_mul_f32 v[222:223], v[174:175], v[174:175]
v_pk_fma_f32 v[216:217], v[216:217], v[4:5], v[4:5] op_sel:[0,1,0] op_sel_hi:[1,1,0]
v_pk_fma_f32 v[218:219], v[218:219], v[4:5], v[4:5] op_sel:[0,1,0] op_sel_hi:[1,1,0]
v_pk_fma_f32 v[220:221], v[220:221], v[6:7], v[6:7] op_sel:[0,1,0] op_sel_hi:[1,1,0]
v_pk_fma_f32 v[222:223], v[222:223], v[6:7], v[6:7] op_sel:[0,1,0] op_sel_hi:[1,1,0]
v_pk_mul_f32 v[216:217], v[216:217], v[168:169]
v_pk_mul_f32 v[218:219], v[218:219], v[170:171]
v_pk_mul_f32 v[220:221], v[220:221], v[172:173]
v_pk_mul_f32 v[222:223], v[222:223], v[174:175]
v_exp_f32 v216, v216
v_exp_f32 v217, v217
v_exp_f32 v218, v218
v_exp_f32 v219, v219
v_exp_f32 v220, v220
v_exp_f32 v221, v221
v_exp_f32 v222, v222
v_exp_f32 v223, v223
v_pk_fma_f32 v[216:217], v[216:217], v[228:229], v[228:229] op_sel:[0,1,1] op_sel_hi:[1,1,1]
v_pk_fma_f32 v[218:219], v[218:219], v[228:229], v[228:229] op_sel:[0,1,1] op_sel_hi:[1,1,1]
v_pk_fma_f32 v[220:221], v[220:221], v[230:231], v[230:231] op_sel:[0,1,1] op_sel_hi:[1,1,1]
v_pk_fma_f32 v[222:223], v[222:223], v[230:231], v[230:231] op_sel:[0,1,1] op_sel_hi:[1,1,1]
v_rcp_f32 v216, v216
v_rcp_f32 v217, v217
v_rcp_f32 v218, v218
v_rcp_f32 v219, v219
v_rcp_f32 v220, v220
v_rcp_f32 v221, v221
v_rcp_f32 v222, v222
v_rcp_f32 v223, v223
v_pk_mul_f32 v[168:169], v[168:169], v[216:217]
v_pk_mul_f32 v[170:171], v[170:171], v[218:219]
v_pk_mul_f32 v[172:173], v[172:173], v[220:221]
v_pk_mul_f32 v[174:175], v[174:175], v[222:223]
v_cvt_pk_bf16_f32 v160, v160, v161
v_cvt_pk_bf16_f32 v161, v162, v163
v_cvt_pk_bf16_f32 v162, v168, v169
v_cvt_pk_bf16_f32 v163, v170, v171
buffer_store_dwordx4 v[160:163], v237, s[76:79], s97 offen sc1
v_cvt_pk_bf16_f32 v164, v164, v165
v_cvt_pk_bf16_f32 v165, v166, v167
v_cvt_pk_bf16_f32 v166, v172, v173
v_cvt_pk_bf16_f32 v167, v174, v175
buffer_store_dwordx4 v[164:167], v237, s[76:79], s98 offen sc1
s_waitcnt lgkmcnt(3)
v_pk_fma_f32 v[176:177], v[228:229], v[52:53], v[176:177] op_sel_hi:[0,1,1] neg_lo:[1,0,0] neg_hi:[1,0,0]
v_pk_fma_f32 v[178:179], v[228:229], v[54:55], v[178:179] op_sel_hi:[0,1,1] neg_lo:[1,0,0] neg_hi:[1,0,0]
v_pk_fma_f32 v[180:181], v[230:231], v[52:53], v[180:181] op_sel_hi:[0,1,1] neg_lo:[1,0,0] neg_hi:[1,0,0]
v_pk_fma_f32 v[182:183], v[230:231], v[54:55], v[182:183] op_sel_hi:[0,1,1] neg_lo:[1,0,0] neg_hi:[1,0,0]
v_pk_mul_f32 v[216:217], v[176:177], v[176:177]
v_pk_mul_f32 v[218:219], v[178:179], v[178:179]
v_pk_mul_f32 v[220:221], v[180:181], v[180:181]
v_pk_mul_f32 v[222:223], v[182:183], v[182:183]
v_pk_fma_f32 v[216:217], v[216:217], v[4:5], v[4:5] op_sel:[0,1,0] op_sel_hi:[1,1,0]
v_pk_fma_f32 v[218:219], v[218:219], v[4:5], v[4:5] op_sel:[0,1,0] op_sel_hi:[1,1,0]
v_pk_fma_f32 v[220:221], v[220:221], v[6:7], v[6:7] op_sel:[0,1,0] op_sel_hi:[1,1,0]
v_pk_fma_f32 v[222:223], v[222:223], v[6:7], v[6:7] op_sel:[0,1,0] op_sel_hi:[1,1,0]
v_pk_mul_f32 v[216:217], v[216:217], v[176:177]
v_pk_mul_f32 v[218:219], v[218:219], v[178:179]
v_pk_mul_f32 v[220:221], v[220:221], v[180:181]
v_pk_mul_f32 v[222:223], v[222:223], v[182:183]
v_exp_f32 v216, v216
v_exp_f32 v217, v217
v_exp_f32 v218, v218
v_exp_f32 v219, v219
v_exp_f32 v220, v220
v_exp_f32 v221, v221
v_exp_f32 v222, v222
v_exp_f32 v223, v223
v_pk_fma_f32 v[216:217], v[216:217], v[228:229], v[228:229] op_sel:[0,1,1] op_sel_hi:[1,1,1]
v_pk_fma_f32 v[218:219], v[218:219], v[228:229], v[228:229] op_sel:[0,1,1] op_sel_hi:[1,1,1]
v_pk_fma_f32 v[220:221], v[220:221], v[230:231], v[230:231] op_sel:[0,1,1] op_sel_hi:[1,1,1]
v_pk_fma_f32 v[222:223], v[222:223], v[230:231], v[230:231] op_sel:[0,1,1] op_sel_hi:[1,1,1]
v_rcp_f32 v216, v216
v_rcp_f32 v217, v217
v_rcp_f32 v218, v218
v_rcp_f32 v219, v219
v_rcp_f32 v220, v220
v_rcp_f32 v221, v221
v_rcp_f32 v222, v222
v_rcp_f32 v223, v223
v_pk_mul_f32 v[176:177], v[176:177], v[216:217]
v_pk_mul_f32 v[178:179], v[178:179], v[218:219]
v_pk_mul_f32 v[180:181], v[180:181], v[220:221]
v_pk_mul_f32 v[182:183], v[182:183], v[222:223]
s_waitcnt lgkmcnt(2)
v_pk_fma_f32 v[184:185], v[228:229], v[60:61], v[184:185] op_sel_hi:[0,1,1] neg_lo:[1,0,0] neg_hi:[1,0,0]
v_pk_fma_f32 v[186:187], v[228:229], v[62:63], v[186:187] op_sel_hi:[0,1,1] neg_lo:[1,0,0] neg_hi:[1,0,0]
v_pk_fma_f32 v[188:189], v[230:231], v[60:61], v[188:189] op_sel_hi:[0,1,1] neg_lo:[1,0,0] neg_hi:[1,0,0]
v_pk_fma_f32 v[190:191], v[230:231], v[62:63], v[190:191] op_sel_hi:[0,1,1] neg_lo:[1,0,0] neg_hi:[1,0,0]
v_pk_mul_f32 v[216:217], v[184:185], v[184:185]
v_pk_mul_f32 v[218:219], v[186:187], v[186:187]
v_pk_mul_f32 v[220:221], v[188:189], v[188:189]
v_pk_mul_f32 v[222:223], v[190:191], v[190:191]
v_pk_fma_f32 v[216:217], v[216:217], v[4:5], v[4:5] op_sel:[0,1,0] op_sel_hi:[1,1,0]
v_pk_fma_f32 v[218:219], v[218:219], v[4:5], v[4:5] op_sel:[0,1,0] op_sel_hi:[1,1,0]
v_pk_fma_f32 v[220:221], v[220:221], v[6:7], v[6:7] op_sel:[0,1,0] op_sel_hi:[1,1,0]
v_pk_fma_f32 v[222:223], v[222:223], v[6:7], v[6:7] op_sel:[0,1,0] op_sel_hi:[1,1,0]
v_pk_mul_f32 v[216:217], v[216:217], v[184:185]
v_pk_mul_f32 v[218:219], v[218:219], v[186:187]
v_pk_mul_f32 v[220:221], v[220:221], v[188:189]
v_pk_mul_f32 v[222:223], v[222:223], v[190:191]
v_exp_f32 v216, v216
v_exp_f32 v217, v217
v_exp_f32 v218, v218
v_exp_f32 v219, v219
v_exp_f32 v220, v220
v_exp_f32 v221, v221
v_exp_f32 v222, v222
v_exp_f32 v223, v223
v_pk_fma_f32 v[216:217], v[216:217], v[228:229], v[228:229] op_sel:[0,1,1] op_sel_hi:[1,1,1]
v_pk_fma_f32 v[218:219], v[218:219], v[228:229], v[228:229] op_sel:[0,1,1] op_sel_hi:[1,1,1]
v_pk_fma_f32 v[220:221], v[220:221], v[230:231], v[230:231] op_sel:[0,1,1] op_sel_hi:[1,1,1]
v_pk_fma_f32 v[222:223], v[222:223], v[230:231], v[230:231] op_sel:[0,1,1] op_sel_hi:[1,1,1]
v_rcp_f32 v216, v216
v_rcp_f32 v217, v217
v_rcp_f32 v218, v218
v_rcp_f32 v219, v219
v_rcp_f32 v220, v220
v_rcp_f32 v221, v221
v_rcp_f32 v222, v222
v_rcp_f32 v223, v223
v_pk_mul_f32 v[184:185], v[184:185], v[216:217]
v_pk_mul_f32 v[186:187], v[186:187], v[218:219]
v_pk_mul_f32 v[188:189], v[188:189], v[220:221]
v_pk_mul_f32 v[190:191], v[190:191], v[222:223]
v_cvt_pk_bf16_f32 v176, v176, v177
v_cvt_pk_bf16_f32 v177, v178, v179
v_cvt_pk_bf16_f32 v178, v184, v185
v_cvt_pk_bf16_f32 v179, v186, v187
buffer_store_dwordx4 v[176:179], v238, s[76:79], s97 offen sc1
v_cvt_pk_bf16_f32 v180, v180, v181
v_cvt_pk_bf16_f32 v181, v182, v183
v_cvt_pk_bf16_f32 v182, v188, v189
v_cvt_pk_bf16_f32 v183, v190, v191
buffer_store_dwordx4 v[180:183], v238, s[76:79], s98 offen sc1
s_waitcnt lgkmcnt(1)
v_pk_fma_f32 v[192:193], v[228:229], v[68:69], v[192:193] op_sel_hi:[0,1,1] neg_lo:[1,0,0] neg_hi:[1,0,0]
v_pk_fma_f32 v[194:195], v[228:229], v[70:71], v[194:195] op_sel_hi:[0,1,1] neg_lo:[1,0,0] neg_hi:[1,0,0]
v_pk_fma_f32 v[196:197], v[230:231], v[68:69], v[196:197] op_sel_hi:[0,1,1] neg_lo:[1,0,0] neg_hi:[1,0,0]
v_pk_fma_f32 v[198:199], v[230:231], v[70:71], v[198:199] op_sel_hi:[0,1,1] neg_lo:[1,0,0] neg_hi:[1,0,0]
v_pk_mul_f32 v[216:217], v[192:193], v[192:193]
v_pk_mul_f32 v[218:219], v[194:195], v[194:195]
v_pk_mul_f32 v[220:221], v[196:197], v[196:197]
v_pk_mul_f32 v[222:223], v[198:199], v[198:199]
v_pk_fma_f32 v[216:217], v[216:217], v[4:5], v[4:5] op_sel:[0,1,0] op_sel_hi:[1,1,0]
v_pk_fma_f32 v[218:219], v[218:219], v[4:5], v[4:5] op_sel:[0,1,0] op_sel_hi:[1,1,0]
v_pk_fma_f32 v[220:221], v[220:221], v[6:7], v[6:7] op_sel:[0,1,0] op_sel_hi:[1,1,0]
v_pk_fma_f32 v[222:223], v[222:223], v[6:7], v[6:7] op_sel:[0,1,0] op_sel_hi:[1,1,0]
v_pk_mul_f32 v[216:217], v[216:217], v[192:193]
v_pk_mul_f32 v[218:219], v[218:219], v[194:195]
v_pk_mul_f32 v[220:221], v[220:221], v[196:197]
v_pk_mul_f32 v[222:223], v[222:223], v[198:199]
v_exp_f32 v216, v216
v_exp_f32 v217, v217
v_exp_f32 v218, v218
v_exp_f32 v219, v219
v_exp_f32 v220, v220
v_exp_f32 v221, v221
v_exp_f32 v222, v222
v_exp_f32 v223, v223
v_pk_fma_f32 v[216:217], v[216:217], v[228:229], v[228:229] op_sel:[0,1,1] op_sel_hi:[1,1,1]
v_pk_fma_f32 v[218:219], v[218:219], v[228:229], v[228:229] op_sel:[0,1,1] op_sel_hi:[1,1,1]
v_pk_fma_f32 v[220:221], v[220:221], v[230:231], v[230:231] op_sel:[0,1,1] op_sel_hi:[1,1,1]
v_pk_fma_f32 v[222:223], v[222:223], v[230:231], v[230:231] op_sel:[0,1,1] op_sel_hi:[1,1,1]
v_rcp_f32 v216, v216
v_rcp_f32 v217, v217
v_rcp_f32 v218, v218
v_rcp_f32 v219, v219
v_rcp_f32 v220, v220
v_rcp_f32 v221, v221
v_rcp_f32 v222, v222
v_rcp_f32 v223, v223
s_and_b32 s88, s2, 0xe7
v_pk_mul_f32 v[192:193], v[192:193], v[216:217]
v_mov_b32 v14, s13
v_pk_mul_f32 v[194:195], v[194:195], v[218:219]
v_mov_b32 v15, s14
v_pk_mul_f32 v[196:197], v[196:197], v[220:221]
v_cmp_lt_u32 vcc, 15, v0
v_pk_mul_f32 v[198:199], v[198:199], v[222:223]
s_nop 0
v_cndmask_b32 v14, v14, v15, vcc
s_waitcnt lgkmcnt(0)
v_pk_fma_f32 v[200:201], v[228:229], v[76:77], v[200:201] op_sel_hi:[0,1,1] neg_lo:[1,0,0] neg_hi:[1,0,0]
v_pk_fma_f32 v[202:203], v[228:229], v[78:79], v[202:203] op_sel_hi:[0,1,1] neg_lo:[1,0,0] neg_hi:[1,0,0]
v_lshl_add_u32 v14, v14, 3, s88
v_pk_fma_f32 v[204:205], v[230:231], v[76:77], v[204:205] op_sel_hi:[0,1,1] neg_lo:[1,0,0] neg_hi:[1,0,0]
s_lshl_b32 s89, s3, 2
v_pk_fma_f32 v[206:207], v[230:231], v[78:79], v[206:207] op_sel_hi:[0,1,1] neg_lo:[1,0,0] neg_hi:[1,0,0]
v_mov_b32 v15, s89
v_pk_mul_f32 v[216:217], v[200:201], v[200:201]
v_lshrrev_b32 v252, 4, v14
v_pk_mul_f32 v[218:219], v[202:203], v[202:203]
v_pk_mul_f32 v[220:221], v[204:205], v[204:205]
v_and_b32 v252, 12, v252
v_pk_mul_f32 v[222:223], v[206:207], v[206:207]
buffer_load_dword v252, v252, s[84:87], 0 offen sc1
v_pk_fma_f32 v[216:217], v[216:217], v[4:5], v[4:5] op_sel:[0,1,0] op_sel_hi:[1,1,0]
v_lshl_add_u32 v14, v14, 7, v15
v_pk_fma_f32 v[218:219], v[218:219], v[4:5], v[4:5] op_sel:[0,1,0] op_sel_hi:[1,1,0]
buffer_load_dword v15, v14, s[76:79], s24 offen offset:32 sc1
v_pk_fma_f32 v[220:221], v[220:221], v[6:7], v[6:7] op_sel:[0,1,0] op_sel_hi:[1,1,0]
v_pk_fma_f32 v[222:223], v[222:223], v[6:7], v[6:7] op_sel:[0,1,0] op_sel_hi:[1,1,0]
v_pk_mul_f32 v[216:217], v[216:217], v[200:201]
v_pk_mul_f32 v[218:219], v[218:219], v[202:203]
v_pk_mul_f32 v[220:221], v[220:221], v[204:205]
v_pk_mul_f32 v[222:223], v[222:223], v[206:207]
v_exp_f32 v216, v216
v_exp_f32 v217, v217
v_exp_f32 v218, v218
v_exp_f32 v219, v219
v_exp_f32 v220, v220
v_exp_f32 v221, v221
v_exp_f32 v222, v222
v_exp_f32 v223, v223
v_pk_fma_f32 v[216:217], v[216:217], v[228:229], v[228:229] op_sel:[0,1,1] op_sel_hi:[1,1,1]
v_pk_fma_f32 v[218:219], v[218:219], v[228:229], v[228:229] op_sel:[0,1,1] op_sel_hi:[1,1,1]
v_pk_fma_f32 v[220:221], v[220:221], v[230:231], v[230:231] op_sel:[0,1,1] op_sel_hi:[1,1,1]
v_pk_fma_f32 v[222:223], v[222:223], v[230:231], v[230:231] op_sel:[0,1,1] op_sel_hi:[1,1,1]
v_rcp_f32 v216, v216
v_rcp_f32 v217, v217
v_rcp_f32 v218, v218
v_rcp_f32 v219, v219
v_rcp_f32 v220, v220
v_rcp_f32 v221, v221
v_rcp_f32 v222, v222
v_rcp_f32 v223, v223
v_pk_mul_f32 v[200:201], v[200:201], v[216:217]
v_pk_mul_f32 v[202:203], v[202:203], v[218:219]
v_pk_mul_f32 v[204:205], v[204:205], v[220:221]
v_pk_mul_f32 v[206:207], v[206:207], v[222:223]
v_cvt_pk_bf16_f32 v192, v192, v193
v_cvt_pk_bf16_f32 v193, v194, v195
v_cvt_pk_bf16_f32 v194, v200, v201
v_cvt_pk_bf16_f32 v195, v202, v203
buffer_store_dwordx4 v[192:195], v239, s[76:79], s97 offen sc1
v_cvt_pk_bf16_f32 v196, v196, v197
v_cvt_pk_bf16_f32 v197, v198, v199
v_cvt_pk_bf16_f32 v198, v204, v205
v_cvt_pk_bf16_f32 v199, v206, v207
buffer_store_dwordx4 v[196:199], v239, s[76:79], s98 offen sc1
recurrent_scan__sliding_block_cached__mixer_s_mlp__prompt_kernel_cop:
s_barrier
ds_read_b64_tr_b16 a[192:193], v250 offset:33792
ds_read_b64_tr_b16 a[194:195], v250 offset:34048
ds_read_b64_tr_b16 a[196:197], v250 offset:33824
ds_read_b64_tr_b16 a[198:199], v250 offset:34080
ds_read_b64_tr_b16 a[200:201], v250 offset:33856
ds_read_b64_tr_b16 a[202:203], v250 offset:34112
ds_read_b64_tr_b16 a[204:205], v250 offset:33888
ds_read_b64_tr_b16 a[206:207], v250 offset:34144
ds_read_b64_tr_b16 a[208:209], v250 offset:33920
ds_read_b64_tr_b16 a[210:211], v250 offset:34176
ds_read_b64_tr_b16 a[212:213], v250 offset:33952
ds_read_b64_tr_b16 a[214:215], v250 offset:34208
ds_read_b64_tr_b16 a[216:217], v250 offset:33984
ds_read_b64_tr_b16 a[218:219], v250 offset:34240
ds_read_b64_tr_b16 a[220:221], v250 offset:34016
ds_read_b64_tr_b16 a[222:223], v250 offset:34272
s_waitcnt lgkmcnt(14)
v_mfma_f32_16x16x32_bf16 v[20:23], a[192:195], v[16:19], 0
v_mfma_f32_16x16x32_bf16 v[28:31], a[192:195], v[24:27], 0
s_waitcnt vmcnt(2)
v_cmp_ne_u32 vcc, v252, v15
s_cbranch_vccnz reslow_58
reback_59:
v_mfma_f32_16x16x32_bf16 v[36:39], a[192:195], v[32:35], 0
s_lshl_b32 s27, s6, 2
s_add_u32 s27, s27, s13
v_mfma_f32_16x16x32_bf16 v[44:47], a[192:195], v[40:43], 0
ds_read_b64_tr_b16 a[192:193], v250 offset:42240
s_lshl_b32 s27, s27, 3
s_waitcnt lgkmcnt(13)
v_mfma_f32_16x16x32_bf16 v[76:79], a[196:199], v[40:43], 0
ds_read_b64_tr_b16 a[194:195], v250 offset:42496
v_mfma_f32_16x16x32_bf16 v[68:71], a[196:199], v[32:35], 0
s_add_u32 s27, s27, s4
v_mfma_f32_16x16x32_bf16 v[60:63], a[196:199], v[24:27], 0
s_lshl_b32 s27, s27, 2
s_add_u32 s27, s27, s3
v_mfma_f32_16x16x32_bf16 v[52:55], a[196:199], v[16:19], 0
ds_read_b64_tr_b16 a[196:197], v250 offset:42272
s_lshl_b32 s27, s27, 14
s_waitcnt lgkmcnt(13)
v_mfma_f32_16x16x32_bf16 v[84:87], a[200:203], v[16:19], 0
ds_read_b64_tr_b16 a[198:199], v250 offset:42528
v_mfma_f32_16x16x32_bf16 v[92:95], a[200:203], v[24:27], 0
s_add_u32 s27, s27, 16777216
buffer_load_dwordx4 a[128:131], v251, s[76:79], s27 offen offset:0 sc1
v_mfma_f32_16x16x32_bf16 v[100:103], a[200:203], v[32:35], 0
buffer_load_dwordx4 a[132:135], v251, s[76:79], s27 offen offset:1024 sc1
v_mfma_f32_16x16x32_bf16 v[108:111], a[200:203], v[40:43], 0
ds_read_b64_tr_b16 a[200:201], v250 offset:42304
s_waitcnt lgkmcnt(13)
v_mfma_f32_16x16x32_bf16 v[140:143], a[204:207], v[40:43], 0
ds_read_b64_tr_b16 a[202:203], v250 offset:42560
v_mfma_f32_16x16x32_bf16 v[132:135], a[204:207], v[32:35], 0
buffer_load_dwordx4 a[136:139], v251, s[76:79], s27 offen offset:2048 sc1
v_mfma_f32_16x16x32_bf16 v[124:127], a[204:207], v[24:27], 0
v_mfma_f32_16x16x32_bf16 v[116:119], a[204:207], v[16:19], 0
ds_read_b64_tr_b16 a[204:205], v250 offset:42336
s_waitcnt lgkmcnt(8)
v_mfma_f32_16x16x32_bf16 v[144:147], a[208:211], v[16:19], 0
ds_read_b64_tr_b16 a[206:207], v250 offset:42592
v_mfma_f32_16x16x32_bf16 v[148:151], a[208:211], v[24:27], 0
buffer_load_dwordx4 a[140:143], v251, s[76:79], s27 offen offset:3072 sc1
v_mfma_f32_16x16x32_bf16 v[152:155], a[208:211], v[32:35], 0
v_mfma_f32_16x16x32_bf16 v[156:159], a[208:211], v[40:43], 0
ds_read_b64_tr_b16 a[208:209], v250 offset:42368
v_mfma_f32_16x16x32_bf16 v[172:175], a[212:215], v[40:43], 0
ds_read_b64_tr_b16 a[210:211], v250 offset:42624
v_mfma_f32_16x16x32_bf16 v[168:171], a[212:215], v[32:35], 0
s_add_u32 s27, s27, 4096
v_mfma_f32_16x16x32_bf16 v[164:167], a[212:215], v[24:27], 0
buffer_load_dwordx4 a[144:147], v251, s[76:79], s27 offen offset:0 sc1
v_mfma_f32_16x16x32_bf16 v[160:163], a[212:215], v[16:19], 0
ds_read_b64_tr_b16 a[212:213], v250 offset:42400
v_mfma_f32_16x16x32_bf16 v[176:179], a[216:219], v[16:19], 0
ds_read_b64_tr_b16 a[214:215], v250 offset:42656
v_mfma_f32_16x16x32_bf16 v[180:183], a[216:219], v[24:27], 0
buffer_load_dwordx4 a[148:151], v251, s[76:79], s27 offen offset:1024 sc1
v_mfma_f32_16x16x32_bf16 v[184:187], a[216:219], v[32:35], 0
buffer_load_dwordx4 a[152:155], v251, s[76:79], s27 offen offset:2048 sc1
v_mfma_f32_16x16x32_bf16 v[188:191], a[216:219], v[40:43], 0
ds_read_b64_tr_b16 a[216:217], v250 offset:42432
s_waitcnt lgkmcnt(13)
v_mfma_f32_16x16x32_bf16 v[204:207], a[220:223], v[40:43], 0
ds_read_b64_tr_b16 a[218:219], v250 offset:42688
v_mfma_f32_16x16x32_bf16 v[200:203], a[220:223], v[32:35], 0
v_mfma_f32_16x16x32_bf16 v[196:199], a[220:223], v[24:27], 0
buffer_load_dwordx4 a[156:159], v251, s[76:79], s27 offen offset:3072 sc1
v_mfma_f32_16x16x32_bf16 v[192:195], a[220:223], v[16:19], 0
ds_read_b64_tr_b16 a[220:221], v250 offset:42464
s_waitcnt lgkmcnt(8)
v_mfma_f32_16x16x32_bf16 v[20:23], a[192:195], v[48:51], v[20:23]
ds_read_b64_tr_b16 a[222:223], v250 offset:42720
v_mfma_f32_16x16x32_bf16 v[28:31], a[192:195], v[56:59], v[28:31]
s_add_u32 s27, s27, 4096
v_mfma_f32_16x16x32_bf16 v[36:39], a[192:195], v[64:67], v[36:39]
buffer_load_dwordx4 a[160:163], v251, s[76:79], s27 offen offset:0 sc1
v_mfma_f32_16x16x32_bf16 v[44:47], a[192:195], v[72:75], v[44:47]
s_barrier
ds_read_b64_tr_b16 a[192:193], v248 offset:0
v_mfma_f32_16x16x32_bf16 v[76:79], a[196:199], v[72:75], v[76:79]
ds_read_b64_tr_b16 a[194:195], v248 offset:256
v_mfma_f32_16x16x32_bf16 v[68:71], a[196:199], v[64:67], v[68:71]
buffer_load_dwordx4 a[164:167], v251, s[76:79], s27 offen offset:1024 sc1
v_mfma_f32_16x16x32_bf16 v[60:63], a[196:199], v[56:59], v[60:63]
v_mfma_f32_16x16x32_bf16 v[52:55], a[196:199], v[48:51], v[52:55]
ds_read_b64_tr_b16 a[196:197], v248 offset:32
v_mfma_f32_16x16x32_bf16 v[84:87], a[200:203], v[48:51], v[84:87]
ds_read_b64_tr_b16 a[198:199], v248 offset:288
v_mfma_f32_16x16x32_bf16 v[92:95], a[200:203], v[56:59], v[92:95]
buffer_load_dwordx4 a[168:171], v251, s[76:79], s27 offen offset:2048 sc1
v_mfma_f32_16x16x32_bf16 v[100:103], a[200:203], v[64:67], v[100:103]
v_mfma_f32_16x16x32_bf16 v[108:111], a[200:203], v[72:75], v[108:111]
ds_read_b64_tr_b16 a[200:201], v248 offset:64
s_waitcnt lgkmcnt(13)
v_mfma_f32_16x16x32_bf16 v[140:143], a[204:207], v[72:75], v[140:143]
ds_read_b64_tr_b16 a[202:203], v248 offset:320
v_mfma_f32_16x16x32_bf16 v[132:135], a[204:207], v[64:67], v[132:135]
buffer_load_dwordx4 a[172:175], v251, s[76:79], s27 offen offset:3072 sc1
v_mfma_f32_16x16x32_bf16 v[124:127], a[204:207], v[56:59], v[124:127]
v_mfma_f32_16x16x32_bf16 v[116:119], a[204:207], v[48:51], v[116:119]
ds_read_b64_tr_b16 a[204:205], v248 offset:96
s_waitcnt lgkmcnt(8)
v_mfma_f32_16x16x32_bf16 v[144:147], a[208:211], v[48:51], v[144:147]
ds_read_b64_tr_b16 a[206:207], v248 offset:352
v_mfma_f32_16x16x32_bf16 v[148:151], a[208:211], v[56:59], v[148:151]
s_add_u32 s27, s27, 4096
v_mfma_f32_16x16x32_bf16 v[152:155], a[208:211], v[64:67], v[152:155]
buffer_load_dwordx4 a[176:179], v251, s[76:79], s27 offen offset:0 sc1
v_mfma_f32_16x16x32_bf16 v[156:159], a[208:211], v[72:75], v[156:159]
ds_read_b64_tr_b16 a[208:209], v248 offset:128
v_mfma_f32_16x16x32_bf16 v[172:175], a[212:215], v[72:75], v[172:175]
ds_read_b64_tr_b16 a[210:211], v248 offset:384
v_mfma_f32_16x16x32_bf16 v[168:171], a[212:215], v[64:67], v[168:171]
buffer_load_dwordx4 a[180:183], v251, s[76:79], s27 offen offset:1024 sc1
v_mfma_f32_16x16x32_bf16 v[164:167], a[212:215], v[56:59], v[164:167]
v_mfma_f32_16x16x32_bf16 v[160:163], a[212:215], v[48:51], v[160:163]
ds_read_b64_tr_b16 a[212:213], v248 offset:160
v_mfma_f32_16x16x32_bf16 v[176:179], a[216:219], v[48:51], v[176:179]
ds_read_b64_tr_b16 a[214:215], v248 offset:416
v_mfma_f32_16x16x32_bf16 v[180:183], a[216:219], v[56:59], v[180:183]
buffer_load_dwordx4 a[184:187], v251, s[76:79], s27 offen offset:2048 sc1
v_mfma_f32_16x16x32_bf16 v[184:187], a[216:219], v[64:67], v[184:187]
v_mfma_f32_16x16x32_bf16 v[188:191], a[216:219], v[72:75], v[188:191]
ds_read_b64_tr_b16 a[216:217], v248 offset:192
s_waitcnt lgkmcnt(13)
v_mfma_f32_16x16x32_bf16 v[204:207], a[220:223], v[72:75], v[204:207]
ds_read_b64_tr_b16 a[218:219], v248 offset:448
v_mfma_f32_16x16x32_bf16 v[200:203], a[220:223], v[64:67], v[200:203]
buffer_load_dwordx4 a[188:191], v251, s[76:79], s27 offen offset:3072 sc1
v_mfma_f32_16x16x32_bf16 v[196:199], a[220:223], v[56:59], v[196:199]
v_mov_b32 v4, s8
s_lshl_b32 s100, s2, 5
s_add_u32 s100, s100, s3
s_lshl_b32 s100, s100, 2
s_add_u32 s100, s100, 131088
s_waitcnt vmcnt(16)
s_mov_b64 exec, 1
buffer_store_dword v4, off, s[76:79], s100 sc1
s_mov_b64 exec, -1
v_mfma_f32_16x16x32_bf16 v[192:195], a[220:223], v[48:51], v[192:195]
ds_read_b64_tr_b16 a[220:221], v248 offset:224
s_waitcnt lgkmcnt(8)
v_mfma_f32_16x16x32_bf16 v[20:23], a[192:195], v[80:83], v[20:23]
ds_read_b64_tr_b16 a[222:223], v248 offset:480
v_mfma_f32_16x16x32_bf16 v[28:31], a[192:195], v[88:91], v[28:31]
s_lshl_b32 s27, s6, 2
v_mfma_f32_16x16x32_bf16 v[36:39], a[192:195], v[96:99], v[36:39]
s_add_u32 s27, s27, s14
s_lshl_b32 s27, s27, 3
v_mfma_f32_16x16x32_bf16 v[44:47], a[192:195], v[104:107], v[44:47]
ds_read_b64_tr_b16 a[192:193], v248 offset:8448
s_add_u32 s27, s27, s4
v_mfma_f32_16x16x32_bf16 v[76:79], a[196:199], v[104:107], v[76:79]
ds_read_b64_tr_b16 a[194:195], v248 offset:8704
v_mfma_f32_16x16x32_bf16 v[68:71], a[196:199], v[96:99], v[68:71]
s_lshl_b32 s27, s27, 2
v_mfma_f32_16x16x32_bf16 v[60:63], a[196:199], v[88:91], v[60:63]
s_add_u32 s27, s27, s3
s_lshl_b32 s27, s27, 14
v_mfma_f32_16x16x32_bf16 v[52:55], a[196:199], v[80:83], v[52:55]
ds_read_b64_tr_b16 a[196:197], v248 offset:8480
s_add_u32 s27, s27, 16777216
v_mfma_f32_16x16x32_bf16 v[84:87], a[200:203], v[80:83], v[84:87]
ds_read_b64_tr_b16 a[198:199], v248 offset:8736
buffer_load_dwordx4 a[0:3], v251, s[76:79], s27 offen offset:0 sc1
v_mfma_f32_16x16x32_bf16 v[92:95], a[200:203], v[88:91], v[92:95]
buffer_load_dwordx4 a[4:7], v251, s[76:79], s27 offen offset:1024 sc1
v_mfma_f32_16x16x32_bf16 v[100:103], a[200:203], v[96:99], v[100:103]
v_mfma_f32_16x16x32_bf16 v[108:111], a[200:203], v[104:107], v[108:111]
ds_read_b64_tr_b16 a[200:201], v248 offset:8512
s_waitcnt lgkmcnt(13)
v_mfma_f32_16x16x32_bf16 v[140:143], a[204:207], v[104:107], v[140:143]
ds_read_b64_tr_b16 a[202:203], v248 offset:8768
v_mfma_f32_16x16x32_bf16 v[132:135], a[204:207], v[96:99], v[132:135]
buffer_load_dwordx4 a[8:11], v251, s[76:79], s27 offen offset:2048 sc1
v_mfma_f32_16x16x32_bf16 v[124:127], a[204:207], v[88:91], v[124:127]
v_mfma_f32_16x16x32_bf16 v[116:119], a[204:207], v[80:83], v[116:119]
ds_read_b64_tr_b16 a[204:205], v248 offset:8544
s_waitcnt lgkmcnt(8)
v_mfma_f32_16x16x32_bf16 v[144:147], a[208:211], v[80:83], v[144:147]
ds_read_b64_tr_b16 a[206:207], v248 offset:8800
v_mfma_f32_16x16x32_bf16 v[148:151], a[208:211], v[88:91], v[148:151]
buffer_load_dwordx4 a[12:15], v251, s[76:79], s27 offen offset:3072 sc1
v_mfma_f32_16x16x32_bf16 v[152:155], a[208:211], v[96:99], v[152:155]
v_mfma_f32_16x16x32_bf16 v[156:159], a[208:211], v[104:107], v[156:159]
ds_read_b64_tr_b16 a[208:209], v248 offset:8576
v_mfma_f32_16x16x32_bf16 v[172:175], a[212:215], v[104:107], v[172:175]
ds_read_b64_tr_b16 a[210:211], v248 offset:8832
v_mfma_f32_16x16x32_bf16 v[168:171], a[212:215], v[96:99], v[168:171]
s_add_u32 s27, s27, 4096
v_mfma_f32_16x16x32_bf16 v[164:167], a[212:215], v[88:91], v[164:167]
s_and_b32 s88, s2, 0xe7
v_mov_b32 v14, s15
v_mfma_f32_16x16x32_bf16 v[160:163], a[212:215], v[80:83], v[160:163]
ds_read_b64_tr_b16 a[212:213], v248 offset:8608
v_lshl_add_u32 v14, v14, 3, s88
v_mfma_f32_16x16x32_bf16 v[176:179], a[216:219], v[80:83], v[176:179]
ds_read_b64_tr_b16 a[214:215], v248 offset:8864
v_mfma_f32_16x16x32_bf16 v[180:183], a[216:219], v[88:91], v[180:183]
s_lshl_b32 s89, s3, 2
v_mfma_f32_16x16x32_bf16 v[184:187], a[216:219], v[96:99], v[184:187]
v_mov_b32 v15, s89
v_lshrrev_b32 v252, 4, v14
v_mfma_f32_16x16x32_bf16 v[188:191], a[216:219], v[104:107], v[188:191]
ds_read_b64_tr_b16 a[216:217], v248 offset:8640
v_and_b32 v252, 12, v252
s_waitcnt lgkmcnt(13)
v_mfma_f32_16x16x32_bf16 v[204:207], a[220:223], v[104:107], v[204:207]
ds_read_b64_tr_b16 a[218:219], v248 offset:8896
buffer_load_dword v252, v252, s[84:87], 0 offen sc1
v_mfma_f32_16x16x32_bf16 v[200:203], a[220:223], v[96:99], v[200:203]
v_lshl_add_u32 v14, v14, 7, v15
v_mfma_f32_16x16x32_bf16 v[196:199], a[220:223], v[88:91], v[196:199]
buffer_load_dword v15, v14, s[76:79], s24 offen offset:32 sc1
v_mfma_f32_16x16x32_bf16 v[192:195], a[220:223], v[80:83], v[192:195]
ds_read_b64_tr_b16 a[220:221], v248 offset:8672
s_waitcnt lgkmcnt(8)
v_mfma_f32_16x16x32_bf16 v[20:23], a[192:195], v[112:115], v[20:23]
ds_read_b64_tr_b16 a[222:223], v248 offset:8928
v_mfma_f32_16x16x32_bf16 v[28:31], a[192:195], v[120:123], v[28:31]
buffer_load_dwordx4 a[16:19], v251, s[76:79], s27 offen offset:0 sc1
v_mfma_f32_16x16x32_bf16 v[36:39], a[192:195], v[128:131], v[36:39]
v_mfma_f32_16x16x32_bf16 v[44:47], a[192:195], v[136:139], v[44:47]
s_barrier
ds_read_b64_tr_b16 a[192:193], v248 offset:16896
v_mfma_f32_16x16x32_bf16 v[76:79], a[196:199], v[136:139], v[76:79]
ds_read_b64_tr_b16 a[194:195], v248 offset:17152
v_mfma_f32_16x16x32_bf16 v[68:71], a[196:199], v[128:131], v[68:71]
buffer_load_dwordx4 a[20:23], v251, s[76:79], s27 offen offset:1024 sc1
v_mfma_f32_16x16x32_bf16 v[60:63], a[196:199], v[120:123], v[60:63]
v_mfma_f32_16x16x32_bf16 v[52:55], a[196:199], v[112:115], v[52:55]
ds_read_b64_tr_b16 a[196:197], v248 offset:16928
v_mfma_f32_16x16x32_bf16 v[84:87], a[200:203], v[112:115], v[84:87]
ds_read_b64_tr_b16 a[198:199], v248 offset:17184
v_mfma_f32_16x16x32_bf16 v[92:95], a[200:203], v[120:123], v[92:95]
buffer_load_dwordx4 a[24:27], v251, s[76:79], s27 offen offset:2048 sc1
v_mfma_f32_16x16x32_bf16 v[100:103], a[200:203], v[128:131], v[100:103]
v_mfma_f32_16x16x32_bf16 v[108:111], a[200:203], v[136:139], v[108:111]
ds_read_b64_tr_b16 a[200:201], v248 offset:16960
s_waitcnt lgkmcnt(13)
v_mfma_f32_16x16x32_bf16 v[140:143], a[204:207], v[136:139], v[140:143]
ds_read_b64_tr_b16 a[202:203], v248 offset:17216
v_mfma_f32_16x16x32_bf16 v[132:135], a[204:207], v[128:131], v[132:135]
buffer_load_dwordx4 a[28:31], v251, s[76:79], s27 offen offset:3072 sc1
v_mfma_f32_16x16x32_bf16 v[124:127], a[204:207], v[120:123], v[124:127]
v_mfma_f32_16x16x32_bf16 v[116:119], a[204:207], v[112:115], v[116:119]
ds_read_b64_tr_b16 a[204:205], v248 offset:16992
s_waitcnt lgkmcnt(8)
v_mfma_f32_16x16x32_bf16 v[144:147], a[208:211], v[112:115], v[144:147]
ds_read_b64_tr_b16 a[206:207], v248 offset:17248
v_mfma_f32_16x16x32_bf16 v[148:151], a[208:211], v[120:123], v[148:151]
s_add_u32 s27, s27, 4096
v_mfma_f32_16x16x32_bf16 v[152:155], a[208:211], v[128:131], v[152:155]
buffer_load_dwordx4 a[32:35], v251, s[76:79], s27 offen offset:0 sc1
v_mfma_f32_16x16x32_bf16 v[156:159], a[208:211], v[136:139], v[156:159]
ds_read_b64_tr_b16 a[208:209], v248 offset:17024
v_mfma_f32_16x16x32_bf16 v[172:175], a[212:215], v[136:139], v[172:175]
ds_read_b64_tr_b16 a[210:211], v248 offset:17280
v_mfma_f32_16x16x32_bf16 v[168:171], a[212:215], v[128:131], v[168:171]
buffer_load_dwordx4 a[36:39], v251, s[76:79], s27 offen offset:1024 sc1
v_mfma_f32_16x16x32_bf16 v[164:167], a[212:215], v[120:123], v[164:167]
v_mfma_f32_16x16x32_bf16 v[160:163], a[212:215], v[112:115], v[160:163]
ds_read_b64_tr_b16 a[212:213], v248 offset:17056
v_mfma_f32_16x16x32_bf16 v[176:179], a[216:219], v[112:115], v[176:179]
ds_read_b64_tr_b16 a[214:215], v248 offset:17312
v_mfma_f32_16x16x32_bf16 v[180:183], a[216:219], v[120:123], v[180:183]
buffer_load_dwordx4 a[40:43], v251, s[76:79], s27 offen offset:2048 sc1
v_mfma_f32_16x16x32_bf16 v[184:187], a[216:219], v[128:131], v[184:187]
v_mfma_f32_16x16x32_bf16 v[188:191], a[216:219], v[136:139], v[188:191]
ds_read_b64_tr_b16 a[216:217], v248 offset:17088
s_waitcnt lgkmcnt(13)
v_mfma_f32_16x16x32_bf16 v[204:207], a[220:223], v[136:139], v[204:207]
ds_read_b64_tr_b16 a[218:219], v248 offset:17344
v_mfma_f32_16x16x32_bf16 v[200:203], a[220:223], v[128:131], v[200:203]
buffer_load_dwordx4 a[44:47], v251, s[76:79], s27 offen offset:3072 sc1
v_mfma_f32_16x16x32_bf16 v[196:199], a[220:223], v[120:123], v[196:199]
v_mfma_f32_16x16x32_bf16 v[192:195], a[220:223], v[112:115], v[192:195]
ds_read_b64_tr_b16 a[220:221], v248 offset:17120
s_waitcnt lgkmcnt(8)
s_waitcnt vmcnt(30)
v_mfma_f32_16x16x32_bf16 v[20:23], a[192:195], a[128:131], v[20:23]
ds_read_b64_tr_b16 a[222:223], v248 offset:17376
s_waitcnt vmcnt(29)
v_mfma_f32_16x16x32_bf16 v[28:31], a[192:195], a[132:135], v[28:31]
s_add_u32 s27, s27, 4096
s_waitcnt vmcnt(28)
v_mfma_f32_16x16x32_bf16 v[36:39], a[192:195], a[136:139], v[36:39]
buffer_load_dwordx4 a[48:51], v251, s[76:79], s27 offen offset:0 sc1
s_waitcnt vmcnt(28)
v_mfma_f32_16x16x32_bf16 v[44:47], a[192:195], a[140:143], v[44:47]
ds_read_b64_tr_b16 a[192:193], v248 offset:25344
v_mfma_f32_16x16x32_bf16 v[76:79], a[196:199], a[140:143], v[76:79]
ds_read_b64_tr_b16 a[194:195], v248 offset:25600
v_mfma_f32_16x16x32_bf16 v[68:71], a[196:199], a[136:139], v[68:71]
buffer_load_dwordx4 a[52:55], v251, s[76:79], s27 offen offset:1024 sc1
v_mfma_f32_16x16x32_bf16 v[60:63], a[196:199], a[132:135], v[60:63]
v_mfma_f32_16x16x32_bf16 v[52:55], a[196:199], a[128:131], v[52:55]
ds_read_b64_tr_b16 a[196:197], v248 offset:25376
v_mfma_f32_16x16x32_bf16 v[84:87], a[200:203], a[128:131], v[84:87]
ds_read_b64_tr_b16 a[198:199], v248 offset:25632
v_mfma_f32_16x16x32_bf16 v[92:95], a[200:203], a[132:135], v[92:95]
buffer_load_dwordx4 a[56:59], v251, s[76:79], s27 offen offset:2048 sc1
v_mfma_f32_16x16x32_bf16 v[100:103], a[200:203], a[136:139], v[100:103]
v_mfma_f32_16x16x32_bf16 v[108:111], a[200:203], a[140:143], v[108:111]
ds_read_b64_tr_b16 a[200:201], v248 offset:25408
s_waitcnt lgkmcnt(13)
v_mfma_f32_16x16x32_bf16 v[140:143], a[204:207], a[140:143], v[140:143]
ds_read_b64_tr_b16 a[202:203], v248 offset:25664
v_mfma_f32_16x16x32_bf16 v[132:135], a[204:207], a[136:139], v[132:135]
buffer_load_dwordx4 a[60:63], v251, s[76:79], s27 offen offset:3072 sc1
v_mfma_f32_16x16x32_bf16 v[124:127], a[204:207], a[132:135], v[124:127]
v_mfma_f32_16x16x32_bf16 v[116:119], a[204:207], a[128:131], v[116:119]
ds_read_b64_tr_b16 a[204:205], v248 offset:25440
s_waitcnt lgkmcnt(8)
v_mfma_f32_16x16x32_bf16 v[144:147], a[208:211], a[128:131], v[144:147]
ds_read_b64_tr_b16 a[206:207], v248 offset:25696
v_mfma_f32_16x16x32_bf16 v[148:151], a[208:211], a[132:135], v[148:151]
s_waitcnt vmcnt(12)
v_cmp_ne_u32 vcc, v252, v15
s_cbranch_vccnz reslow_61
reback_62:
v_mfma_f32_16x16x32_bf16 v[152:155], a[208:211], a[136:139], v[152:155]
s_lshl_b32 s27, s6, 2
s_add_u32 s27, s27, s15
v_mfma_f32_16x16x32_bf16 v[156:159], a[208:211], a[140:143], v[156:159]
ds_read_b64_tr_b16 a[208:209], v248 offset:25472
s_lshl_b32 s27, s27, 3
v_mfma_f32_16x16x32_bf16 v[172:175], a[212:215], a[140:143], v[172:175]
ds_read_b64_tr_b16 a[210:211], v248 offset:25728
v_mfma_f32_16x16x32_bf16 v[168:171], a[212:215], a[136:139], v[168:171]
s_add_u32 s27, s27, s4
v_mfma_f32_16x16x32_bf16 v[164:167], a[212:215], a[132:135], v[164:167]
s_lshl_b32 s27, s27, 2
s_add_u32 s27, s27, s3
v_mfma_f32_16x16x32_bf16 v[160:163], a[212:215], a[128:131], v[160:163]
ds_read_b64_tr_b16 a[212:213], v248 offset:25504
s_lshl_b32 s27, s27, 14
v_mfma_f32_16x16x32_bf16 v[176:179], a[216:219], a[128:131], v[176:179]
ds_read_b64_tr_b16 a[214:215], v248 offset:25760
v_mfma_f32_16x16x32_bf16 v[180:183], a[216:219], a[132:135], v[180:183]
s_add_u32 s27, s27, 16777216
buffer_load_dwordx4 a[64:67], v251, s[76:79], s27 offen offset:0 sc1
v_mfma_f32_16x16x32_bf16 v[184:187], a[216:219], a[136:139], v[184:187]
buffer_load_dwordx4 a[68:71], v251, s[76:79], s27 offen offset:1024 sc1
v_mfma_f32_16x16x32_bf16 v[188:191], a[216:219], a[140:143], v[188:191]
ds_read_b64_tr_b16 a[216:217], v248 offset:25536
s_waitcnt lgkmcnt(13)
v_mfma_f32_16x16x32_bf16 v[204:207], a[220:223], a[140:143], v[204:207]
ds_read_b64_tr_b16 a[218:219], v248 offset:25792
v_mfma_f32_16x16x32_bf16 v[200:203], a[220:223], a[136:139], v[200:203]
buffer_load_dwordx4 a[72:75], v251, s[76:79], s27 offen offset:2048 sc1
v_mfma_f32_16x16x32_bf16 v[196:199], a[220:223], a[132:135], v[196:199]
v_mfma_f32_16x16x32_bf16 v[192:195], a[220:223], a[128:131], v[192:195]
ds_read_b64_tr_b16 a[220:221], v248 offset:25568
s_waitcnt lgkmcnt(8)
v_mfma_f32_16x16x32_bf16 v[20:23], a[192:195], a[144:147], v[20:23]
ds_read_b64_tr_b16 a[222:223], v248 offset:25824
v_mfma_f32_16x16x32_bf16 v[28:31], a[192:195], a[148:151], v[28:31]
buffer_load_dwordx4 a[76:79], v251, s[76:79], s27 offen offset:3072 sc1
v_mfma_f32_16x16x32_bf16 v[36:39], a[192:195], a[152:155], v[36:39]
v_mfma_f32_16x16x32_bf16 v[44:47], a[192:195], a[156:159], v[44:47]
s_barrier
ds_read_b64_tr_b16 a[192:193], v248 offset:33792
v_mfma_f32_16x16x32_bf16 v[76:79], a[196:199], a[156:159], v[76:79]
ds_read_b64_tr_b16 a[194:195], v248 offset:34048
v_mfma_f32_16x16x32_bf16 v[68:71], a[196:199], a[152:155], v[68:71]
s_add_u32 s27, s27, 4096
v_mfma_f32_16x16x32_bf16 v[60:63], a[196:199], a[148:151], v[60:63]
buffer_load_dwordx4 a[80:83], v251, s[76:79], s27 offen offset:0 sc1
v_mfma_f32_16x16x32_bf16 v[52:55], a[196:199], a[144:147], v[52:55]
ds_read_b64_tr_b16 a[196:197], v248 offset:33824
v_mfma_f32_16x16x32_bf16 v[84:87], a[200:203], a[144:147], v[84:87]
ds_read_b64_tr_b16 a[198:199], v248 offset:34080
v_mfma_f32_16x16x32_bf16 v[92:95], a[200:203], a[148:151], v[92:95]
buffer_load_dwordx4 a[84:87], v251, s[76:79], s27 offen offset:1024 sc1
v_mfma_f32_16x16x32_bf16 v[100:103], a[200:203], a[152:155], v[100:103]
v_mfma_f32_16x16x32_bf16 v[108:111], a[200:203], a[156:159], v[108:111]
ds_read_b64_tr_b16 a[200:201], v248 offset:33856
s_waitcnt lgkmcnt(13)
v_mfma_f32_16x16x32_bf16 v[140:143], a[204:207], a[156:159], v[140:143]
ds_read_b64_tr_b16 a[202:203], v248 offset:34112
v_mfma_f32_16x16x32_bf16 v[132:135], a[204:207], a[152:155], v[132:135]
buffer_load_dwordx4 a[88:91], v251, s[76:79], s27 offen offset:2048 sc1
v_mfma_f32_16x16x32_bf16 v[124:127], a[204:207], a[148:151], v[124:127]
buffer_load_dwordx4 a[92:95], v251, s[76:79], s27 offen offset:3072 sc1
v_mfma_f32_16x16x32_bf16 v[116:119], a[204:207], a[144:147], v[116:119]
ds_read_b64_tr_b16 a[204:205], v248 offset:33888
s_waitcnt lgkmcnt(8)
v_mfma_f32_16x16x32_bf16 v[144:147], a[208:211], a[144:147], v[144:147]
ds_read_b64_tr_b16 a[206:207], v248 offset:34144
v_mfma_f32_16x16x32_bf16 v[148:151], a[208:211], a[148:151], v[148:151]
v_mfma_f32_16x16x32_bf16 v[152:155], a[208:211], a[152:155], v[152:155]
s_add_u32 s27, s27, 4096
buffer_load_dwordx4 a[96:99], v251, s[76:79], s27 offen offset:0 sc1
v_mfma_f32_16x16x32_bf16 v[156:159], a[208:211], a[156:159], v[156:159]
ds_read_b64_tr_b16 a[208:209], v248 offset:33920
v_mfma_f32_16x16x32_bf16 v[172:175], a[212:215], a[156:159], v[172:175]
ds_read_b64_tr_b16 a[210:211], v248 offset:34176
v_mfma_f32_16x16x32_bf16 v[168:171], a[212:215], a[152:155], v[168:171]
v_mfma_f32_16x16x32_bf16 v[164:167], a[212:215], a[148:151], v[164:167]
buffer_load_dwordx4 a[100:103], v251, s[76:79], s27 offen offset:1024 sc1
v_mfma_f32_16x16x32_bf16 v[160:163], a[212:215], a[144:147], v[160:163]
ds_read_b64_tr_b16 a[212:213], v248 offset:33952
v_mfma_f32_16x16x32_bf16 v[176:179], a[216:219], a[144:147], v[176:179]
ds_read_b64_tr_b16 a[214:215], v248 offset:34208
v_mfma_f32_16x16x32_bf16 v[180:183], a[216:219], a[148:151], v[180:183]
buffer_load_dwordx4 a[104:107], v251, s[76:79], s27 offen offset:2048 sc1
v_mfma_f32_16x16x32_bf16 v[184:187], a[216:219], a[152:155], v[184:187]
v_mfma_f32_16x16x32_bf16 v[188:191], a[216:219], a[156:159], v[188:191]
ds_read_b64_tr_b16 a[216:217], v248 offset:33984
s_waitcnt lgkmcnt(13)
v_mfma_f32_16x16x32_bf16 v[204:207], a[220:223], a[156:159], v[204:207]
ds_read_b64_tr_b16 a[218:219], v248 offset:34240
v_mfma_f32_16x16x32_bf16 v[200:203], a[220:223], a[152:155], v[200:203]
buffer_load_dwordx4 a[108:111], v251, s[76:79], s27 offen offset:3072 sc1
v_mfma_f32_16x16x32_bf16 v[196:199], a[220:223], a[148:151], v[196:199]
v_mfma_f32_16x16x32_bf16 v[192:195], a[220:223], a[144:147], v[192:195]
ds_read_b64_tr_b16 a[220:221], v248 offset:34016
s_waitcnt lgkmcnt(8)
v_mfma_f32_16x16x32_bf16 v[20:23], a[192:195], a[160:163], v[20:23]
ds_read_b64_tr_b16 a[222:223], v248 offset:34272
v_mfma_f32_16x16x32_bf16 v[28:31], a[192:195], a[164:167], v[28:31]
s_add_u32 s27, s27, 4096
v_mfma_f32_16x16x32_bf16 v[36:39], a[192:195], a[168:171], v[36:39]
buffer_load_dwordx4 a[112:115], v251, s[76:79], s27 offen offset:0 sc1
v_mfma_f32_16x16x32_bf16 v[44:47], a[192:195], a[172:175], v[44:47]
ds_read_b64_tr_b16 a[192:193], v248 offset:42240
v_mfma_f32_16x16x32_bf16 v[76:79], a[196:199], a[172:175], v[76:79]
ds_read_b64_tr_b16 a[194:195], v248 offset:42496
v_mfma_f32_16x16x32_bf16 v[68:71], a[196:199], a[168:171], v[68:71]
buffer_load_dwordx4 a[116:119], v251, s[76:79], s27 offen offset:1024 sc1
v_mfma_f32_16x16x32_bf16 v[60:63], a[196:199], a[164:167], v[60:63]
v_mfma_f32_16x16x32_bf16 v[52:55], a[196:199], a[160:163], v[52:55]
ds_read_b64_tr_b16 a[196:197], v248 offset:42272
v_mfma_f32_16x16x32_bf16 v[84:87], a[200:203], a[160:163], v[84:87]
ds_read_b64_tr_b16 a[198:199], v248 offset:42528
v_mfma_f32_16x16x32_bf16 v[92:95], a[200:203], a[164:167], v[92:95]
buffer_load_dwordx4 a[120:123], v251, s[76:79], s27 offen offset:2048 sc1
v_mfma_f32_16x16x32_bf16 v[100:103], a[200:203], a[168:171], v[100:103]
v_mfma_f32_16x16x32_bf16 v[108:111], a[200:203], a[172:175], v[108:111]
ds_read_b64_tr_b16 a[200:201], v248 offset:42304
s_waitcnt lgkmcnt(13)
v_mfma_f32_16x16x32_bf16 v[140:143], a[204:207], a[172:175], v[140:143]
ds_read_b64_tr_b16 a[202:203], v248 offset:42560
v_mfma_f32_16x16x32_bf16 v[132:135], a[204:207], a[168:171], v[132:135]
buffer_load_dwordx4 a[124:127], v251, s[76:79], s27 offen offset:3072 sc1
v_mfma_f32_16x16x32_bf16 v[124:127], a[204:207], a[164:167], v[124:127]
v_mfma_f32_16x16x32_bf16 v[116:119], a[204:207], a[160:163], v[116:119]
ds_read_b64_tr_b16 a[204:205], v248 offset:42336
s_waitcnt lgkmcnt(8)
v_mfma_f32_16x16x32_bf16 v[144:147], a[208:211], a[160:163], v[144:147]
ds_read_b64_tr_b16 a[206:207], v248 offset:42592
v_mfma_f32_16x16x32_bf16 v[148:151], a[208:211], a[164:167], v[148:151]
s_bfe_u32 s88, s17, 0x10001
v_mfma_f32_16x16x32_bf16 v[152:155], a[208:211], a[168:171], v[152:155]
s_mul_i32 s89, s88, 11
v_lshrrev_b32 v14, 1, v0
v_mfma_f32_16x16x32_bf16 v[156:159], a[208:211], a[172:175], v[156:159]
ds_read_b64_tr_b16 a[208:209], v248 offset:42368
v_min_u32 v14, 10, v14
v_mfma_f32_16x16x32_bf16 v[172:175], a[212:215], a[172:175], v[172:175]
ds_read_b64_tr_b16 a[210:211], v248 offset:42624
v_add_u32 v14, s89, v14
v_mfma_f32_16x16x32_bf16 v[168:171], a[212:215], a[168:171], v[168:171]
v_mul_u32_u24 v15, 86, v14
v_lshrrev_b32 v15, 8, v15
v_mfma_f32_16x16x32_bf16 v[164:167], a[212:215], a[164:167], v[164:167]
v_add3_u32 v14, v14, v15, 1
s_lshl_b32 s88, s88, 2
v_mfma_f32_16x16x32_bf16 v[160:163], a[212:215], a[160:163], v[160:163]
ds_read_b64_tr_b16 a[212:213], v248 offset:42400
s_lshr_b32 s89, s18, 1
s_add_u32 s88, s88, s89
s_lshl_b32 s88, s88, 2
v_mfma_f32_16x16x32_bf16 v[176:179], a[216:219], a[160:163], v[176:179]
ds_read_b64_tr_b16 a[214:215], v248 offset:42656
v_mov_b32 v15, s88
v_cmp_gt_u32 vcc, 22, v0
v_mfma_f32_16x16x32_bf16 v[180:183], a[216:219], a[164:167], v[180:183]
s_nop 0
v_cndmask_b32 v14, v15, v14, vcc
v_lshl_add_u32 v14, v14, 3, s4
s_and_b32 s88, s17, 1
v_mfma_f32_16x16x32_bf16 v[184:187], a[216:219], a[168:171], v[184:187]
s_lshl_b32 s88, s88, 3
v_and_b32 v15, 1, v0
v_mfma_f32_16x16x32_bf16 v[188:191], a[216:219], a[172:175], v[188:191]
ds_read_b64_tr_b16 a[216:217], v248 offset:42432
v_lshl_add_u32 v15, v15, 2, s88
v_lshrrev_b32 v252, 4, v14
s_waitcnt lgkmcnt(13)
v_mfma_f32_16x16x32_bf16 v[204:207], a[220:223], a[172:175], v[204:207]
ds_read_b64_tr_b16 a[218:219], v248 offset:42688
v_and_b32 v252, 12, v252
buffer_load_dword v252, v252, s[84:87], 0 offen sc1
v_mfma_f32_16x16x32_bf16 v[200:203], a[220:223], a[168:171], v[200:203]
v_lshl_add_u32 v14, v14, 7, v15
v_mfma_f32_16x16x32_bf16 v[196:199], a[220:223], a[164:167], v[196:199]
buffer_load_dword v15, v14, s[76:79], s24 offen offset:16 sc1
v_mfma_f32_16x16x32_bf16 v[192:195], a[220:223], a[160:163], v[192:195]
ds_read_b64_tr_b16 a[220:221], v248 offset:42464
s_waitcnt lgkmcnt(8)
v_mfma_f32_16x16x32_bf16 v[20:23], a[192:195], a[176:179], v[20:23]
ds_read_b64_tr_b16 a[222:223], v248 offset:42720
v_mfma_f32_16x16x32_bf16 v[28:31], a[192:195], a[180:183], v[28:31]
s_lshl_b32 s88, s4, 2
v_mfma_f32_16x16x32_bf16 v[36:39], a[192:195], a[184:187], v[36:39]
s_add_u32 s88, s88, s3
s_and_b32 s88, s88, 15
s_lshl_b32 s88, s88, 10
v_lshlrev_b32 v8, 4, v0
s_add_u32 s88, s88, recurrent_scan__sliding_block_cached__mixer_s_mlp__prompt_kernel_fin-recurrent_scan__sliding_block_cached__mixer_s_mlp__prompt_kernel_pc
v_mfma_f32_16x16x32_bf16 v[44:47], a[192:195], a[188:191], v[44:47]
s_barrier
ds_read_b64_tr_b16 a[192:193], v249 offset:0
v_mfma_f32_16x16x32_bf16 v[76:79], a[196:199], a[188:191], v[76:79]
ds_read_b64_tr_b16 a[194:195], v249 offset:256
v_mfma_f32_16x16x32_bf16 v[68:71], a[196:199], a[184:187], v[68:71]
buffer_load_dword v253, v8, s[72:75], s88 offen
v_mfma_f32_16x16x32_bf16 v[60:63], a[196:199], a[180:183], v[60:63]
s_lshl_b32 s27, s4, 2
v_mfma_f32_16x16x32_bf16 v[52:55], a[196:199], a[176:179], v[52:55]
ds_read_b64_tr_b16 a[196:197], v249 offset:8448
v_mfma_f32_16x16x32_bf16 v[84:87], a[200:203], a[176:179], v[84:87]
ds_read_b64_tr_b16 a[198:199], v249 offset:8704
v_mfma_f32_16x16x32_bf16 v[92:95], a[200:203], a[180:183], v[92:95]
s_add_u32 s27, s27, s3
v_mfma_f32_16x16x32_bf16 v[100:103], a[200:203], a[184:187], v[100:103]
s_lshl_b32 s27, s27, 16
s_xor_b32 s88, s7, 0
v_mfma_f32_16x16x32_bf16 v[108:111], a[200:203], a[188:191], v[108:111]
ds_read_b64_tr_b16 a[200:201], v249 offset:16896
s_lshl_b32 s88, s88, 12
s_waitcnt lgkmcnt(13)
v_mfma_f32_16x16x32_bf16 v[140:143], a[204:207], a[188:191], v[140:143]
ds_read_b64_tr_b16 a[202:203], v249 offset:17152
s_add_u32 s27, s27, s88
s_lshl_b32 s88, s6, 21
v_mfma_f32_16x16x32_bf16 v[132:135], a[204:207], a[184:187], v[132:135]
s_add_u32 s27, s27, s88
s_add_u32 s27, s27, 33554432
s_lshr_b32 s88, s6, 1
v_mfma_f32_16x16x32_bf16 v[124:127], a[204:207], a[180:183], v[124:127]
s_and_b32 s89, s18, 1
s_cmp_eq_u32 s88, s3
s_cselect_b32 s97, s89, 2
s_cmp_eq_u32 s97, 1
s_cselect_b32 s98, 1073741824, s27
s_cmp_eq_u32 s97, 0
s_cselect_b32 s27, 1073741824, s27
v_mfma_f32_16x16x32_bf16 v[116:119], a[204:207], a[176:179], v[116:119]
ds_read_b64_tr_b16 a[204:205], v249 offset:25344
v_add_u32 v5, 155648, v251
s_waitcnt lgkmcnt(8)
v_mfma_f32_16x16x32_bf16 v[144:147], a[208:211], a[176:179], v[144:147]
ds_read_b64_tr_b16 a[206:207], v249 offset:25600
v_mfma_f32_16x16x32_bf16 v[148:151], a[208:211], a[180:183], v[148:151]
s_mul_i32 s31, s92, 1
v_mfma_f32_16x16x32_bf16 v[152:155], a[208:211], a[184:187], v[152:155]
s_add_u32 s31, s31, s12
s_add_u32 m0, s96, 135168
s_nop 0
buffer_load_dwordx4 v240, s[68:71], s31 offen offset:0 lds
v_mfma_f32_16x16x32_bf16 v[156:159], a[208:211], a[188:191], v[156:159]
ds_read_b64_tr_b16 a[208:209], v249 offset:33792
buffer_load_dwordx4 v241, s[68:71], s31 offen offset:1056 lds
v_mfma_f32_16x16x32_bf16 v[172:175], a[212:215], a[188:191], v[172:175]
ds_read_b64_tr_b16 a[210:211], v249 offset:34048
v_mfma_f32_16x16x32_bf16 v[168:171], a[212:215], a[184:187], v[168:171]
buffer_load_dwordx4 v242, s[68:71], s31 offen offset:2112 lds
v_mfma_f32_16x16x32_bf16 v[164:167], a[212:215], a[180:183], v[164:167]
v_mfma_f32_16x16x32_bf16 v[160:163], a[212:215], a[176:179], v[160:163]
ds_read_b64_tr_b16 a[212:213], v249 offset:42240
v_mfma_f32_16x16x32_bf16 v[176:179], a[216:219], a[176:179], v[176:179]
ds_read_b64_tr_b16 a[214:215], v249 offset:42496
v_mfma_f32_16x16x32_bf16 v[180:183], a[216:219], a[180:183], v[180:183]
buffer_load_dwordx4 v243, s[68:71], s31 offen offset:3168 lds
v_mfma_f32_16x16x32_bf16 v[184:187], a[216:219], a[184:187], v[184:187]
s_waitcnt vmcnt(5)
v_cmp_ne_u32 vcc, v252, v15
s_cbranch_vccnz reslow_64
reback_65:
v_mfma_f32_16x16x32_bf16 v[188:191], a[216:219], a[188:191], v[188:191]
ds_read_b64_tr_b16 a[216:217], v250 offset:0
s_waitcnt lgkmcnt(13)
v_mfma_f32_16x16x32_bf16 v[204:207], a[220:223], a[188:191], v[204:207]
ds_read_b64_tr_b16 a[218:219], v250 offset:256
v_mfma_f32_16x16x32_bf16 v[200:203], a[220:223], a[184:187], v[200:203]
s_mul_i32 s31, s92, 2
v_mfma_f32_16x16x32_bf16 v[196:199], a[220:223], a[180:183], v[196:199]
s_add_u32 s31, s31, s12
s_add_u32 m0, s96, 0
v_mfma_f32_16x16x32_bf16 v[192:195], a[220:223], a[176:179], v[192:195]
ds_read_b64_tr_b16 a[220:221], v250 offset:8448
buffer_load_dwordx4 v240, s[68:71], s31 offen offset:0 lds
s_waitcnt lgkmcnt(8)
v_mfma_f32_16x16x32_bf16 v[20:23], a[192:195], a[0:3], v[20:23]
ds_read_b64_tr_b16 a[222:223], v250 offset:8704
v_mfma_f32_16x16x32_bf16 v[28:31], a[192:195], a[4:7], v[28:31]
buffer_load_dwordx4 v241, s[68:71], s31 offen offset:1056 lds
v_mfma_f32_16x16x32_bf16 v[36:39], a[192:195], a[8:11], v[36:39]
buffer_load_dwordx4 v242, s[68:71], s31 offen offset:2112 lds
v_mfma_f32_16x16x32_bf16 v[44:47], a[192:195], a[12:15], v[44:47]
ds_read_b64_tr_b16 a[192:193], v249 offset:32
v_mfma_f32_16x16x32_bf16 v[44:47], a[196:199], a[28:31], v[44:47]
ds_read_b64_tr_b16 a[194:195], v249 offset:288
v_mfma_f32_16x16x32_bf16 v[36:39], a[196:199], a[24:27], v[36:39]
buffer_load_dwordx4 v243, s[68:71], s31 offen offset:3168 lds
v_mfma_f32_16x16x32_bf16 v[28:31], a[196:199], a[20:23], v[28:31]
v_mfma_f32_16x16x32_bf16 v[20:23], a[196:199], a[16:19], v[20:23]
ds_read_b64_tr_b16 a[196:197], v249 offset:8480
v_mfma_f32_16x16x32_bf16 v[20:23], a[200:203], a[32:35], v[20:23]
ds_read_b64_tr_b16 a[198:199], v249 offset:8736
v_mfma_f32_16x16x32_bf16 v[28:31], a[200:203], a[36:39], v[28:31]
s_lshl_b32 s88, s17, 2
v_mfma_f32_16x16x32_bf16 v[36:39], a[200:203], a[40:43], v[36:39]
s_add_u32 s88, s88, s19
s_xor_b32 s89, s88, 1
v_mfma_f32_16x16x32_bf16 v[44:47], a[200:203], a[44:47], v[44:47]
ds_read_b64_tr_b16 a[200:201], v249 offset:16928
s_mul_i32 s20, s88, 44032
s_waitcnt lgkmcnt(13)
v_mfma_f32_16x16x32_bf16 v[44:47], a[204:207], a[60:63], v[44:47]
ds_read_b64_tr_b16 a[202:203], v249 offset:17184
v_mfma_f32_16x16x32_bf16 v[36:39], a[204:207], a[56:59], v[36:39]
s_mul_i32 s93, s89, 44032
v_mfma_f32_16x16x32_bf16 v[28:31], a[204:207], a[52:55], v[28:31]
s_lshl_b32 s88, s26, 10
s_add_u32 s88, s88, 6291456
v_mfma_f32_16x16x32_bf16 v[20:23], a[204:207], a[48:51], v[20:23]
ds_read_b64_tr_b16 a[204:205], v249 offset:25376
s_add_u32 s20, s20, s88
s_add_u32 s93, s93, s88
s_cmp_ge_u32 s3, 2
s_cselect_b32 s89, 1073741824, 0
s_waitcnt lgkmcnt(8)
v_mfma_f32_16x16x32_bf16 v[20:23], a[208:211], a[64:67], v[20:23]
ds_read_b64_tr_b16 a[206:207], v249 offset:25632
v_mfma_f32_16x16x32_bf16 v[28:31], a[208:211], a[68:71], v[28:31]
s_or_b32 s88, s20, s89
buffer_load_dwordx4 a[224:227], v251, s[76:79], s88 offen sc1
v_mfma_f32_16x16x32_bf16 v[36:39], a[208:211], a[72:75], v[36:39]
s_or_b32 s88, s93, s89
buffer_load_dwordx4 a[228:231], v251, s[76:79], s88 offen sc1
v_mfma_f32_16x16x32_bf16 v[44:47], a[208:211], a[76:79], v[44:47]
ds_read_b64_tr_b16 a[208:209], v249 offset:33824
v_mfma_f32_16x16x32_bf16 v[44:47], a[212:215], a[92:95], v[44:47]
ds_read_b64_tr_b16 a[210:211], v249 offset:34080
v_mfma_f32_16x16x32_bf16 v[36:39], a[212:215], a[88:91], v[36:39]
buffer_load_dwordx4 a[232:235], v251, s[76:79], s20 offen offset:1024 sc1
v_mfma_f32_16x16x32_bf16 v[28:31], a[212:215], a[84:87], v[28:31]
buffer_load_dwordx4 a[236:239], v251, s[76:79], s93 offen offset:1024 sc1
v_mfma_f32_16x16x32_bf16 v[20:23], a[212:215], a[80:83], v[20:23]
ds_read_b64_tr_b16 a[212:213], v249 offset:42272
v_mfma_f32_16x16x32_bf16 v[20:23], a[216:219], a[96:99], v[20:23]
ds_read_b64_tr_b16 a[214:215], v249 offset:42528
v_mfma_f32_16x16x32_bf16 v[28:31], a[216:219], a[100:103], v[28:31]
buffer_load_dwordx4 a[240:243], v251, s[76:79], s20 offen offset:2048 sc1
v_mfma_f32_16x16x32_bf16 v[36:39], a[216:219], a[104:107], v[36:39]
v_mfma_f32_16x16x32_bf16 v[44:47], a[216:219], a[108:111], v[44:47]
ds_read_b64_tr_b16 a[216:217], v250 offset:32
s_waitcnt lgkmcnt(13)
v_mfma_f32_16x16x32_bf16 v[44:47], a[220:223], a[124:127], v[44:47]
ds_read_b64_tr_b16 a[218:219], v250 offset:288
v_mfma_f32_16x16x32_bf16 v[36:39], a[220:223], a[120:123], v[36:39]
buffer_load_dwordx4 a[244:247], v251, s[76:79], s93 offen offset:2048 sc1
v_mfma_f32_16x16x32_bf16 v[28:31], a[220:223], a[116:119], v[28:31]
v_mfma_f32_16x16x32_bf16 v[20:23], a[220:223], a[112:115], v[20:23]
ds_read_b64_tr_b16 a[220:221], v250 offset:8480
s_waitcnt lgkmcnt(8)
v_mfma_f32_16x16x32_bf16 v[52:55], a[192:195], a[0:3], v[52:55]
ds_read_b64_tr_b16 a[222:223], v250 offset:8736
v_mfma_f32_16x16x32_bf16 v[60:63], a[192:195], a[4:7], v[60:63]
buffer_load_dwordx4 a[248:251], v251, s[76:79], s20 offen offset:3072 sc1
v_mfma_f32_16x16x32_bf16 v[68:71], a[192:195], a[8:11], v[68:71]
buffer_load_dwordx4 a[252:255], v251, s[76:79], s93 offen offset:3072 sc1
v_mfma_f32_16x16x32_bf16 v[76:79], a[192:195], a[12:15], v[76:79]
s_barrier
ds_read_b64_tr_b16 a[192:193], v249 offset:64
v_mfma_f32_16x16x32_bf16 v[76:79], a[196:199], a[28:31], v[76:79]
ds_read_b64_tr_b16 a[194:195], v249 offset:320
v_mfma_f32_16x16x32_bf16 v[68:71], a[196:199], a[24:27], v[68:71]
v_mfma_f32_16x16x32_bf16 v[60:63], a[196:199], a[20:23], v[60:63]
v_mfma_f32_16x16x32_bf16 v[52:55], a[196:199], a[16:19], v[52:55]
ds_read_b64_tr_b16 a[196:197], v249 offset:8512
v_mfma_f32_16x16x32_bf16 v[52:55], a[200:203], a[32:35], v[52:55]
ds_read_b64_tr_b16 a[198:199], v249 offset:8768
v_mfma_f32_16x16x32_bf16 v[60:63], a[200:203], a[36:39], v[60:63]
s_mul_i32 s31, s92, 3
v_mfma_f32_16x16x32_bf16 v[68:71], a[200:203], a[40:43], v[68:71]
s_add_u32 s31, s31, s12
s_add_u32 m0, s96, 16896
v_mfma_f32_16x16x32_bf16 v[76:79], a[200:203], a[44:47], v[76:79]
ds_read_b64_tr_b16 a[200:201], v249 offset:16960
buffer_load_dwordx4 v240, s[68:71], s31 offen offset:0 lds
s_waitcnt lgkmcnt(13)
v_mfma_f32_16x16x32_bf16 v[76:79], a[204:207], a[60:63], v[76:79]
ds_read_b64_tr_b16 a[202:203], v249 offset:17216
v_mfma_f32_16x16x32_bf16 v[68:71], a[204:207], a[56:59], v[68:71]
buffer_load_dwordx4 v241, s[68:71], s31 offen offset:1056 lds
v_mfma_f32_16x16x32_bf16 v[60:63], a[204:207], a[52:55], v[60:63]
v_mfma_f32_16x16x32_bf16 v[52:55], a[204:207], a[48:51], v[52:55]
ds_read_b64_tr_b16 a[204:205], v249 offset:25408
s_waitcnt lgkmcnt(8)
v_mfma_f32_16x16x32_bf16 v[52:55], a[208:211], a[64:67], v[52:55]
ds_read_b64_tr_b16 a[206:207], v249 offset:25664
v_mfma_f32_16x16x32_bf16 v[60:63], a[208:211], a[68:71], v[60:63]
v_mfma_f32_16x16x32_bf16 v[68:71], a[208:211], a[72:75], v[68:71]
buffer_load_dwordx4 v242, s[68:71], s31 offen offset:2112 lds
v_mfma_f32_16x16x32_bf16 v[76:79], a[208:211], a[76:79], v[76:79]
ds_read_b64_tr_b16 a[208:209], v249 offset:33856
v_mfma_f32_16x16x32_bf16 v[76:79], a[212:215], a[92:95], v[76:79]
ds_read_b64_tr_b16 a[210:211], v249 offset:34112
v_mfma_f32_16x16x32_bf16 v[68:71], a[212:215], a[88:91], v[68:71]
v_mfma_f32_16x16x32_bf16 v[60:63], a[212:215], a[84:87], v[60:63]
v_mfma_f32_16x16x32_bf16 v[52:55], a[212:215], a[80:83], v[52:55]
ds_read_b64_tr_b16 a[212:213], v249 offset:42304
v_mfma_f32_16x16x32_bf16 v[52:55], a[216:219], a[96:99], v[52:55]
ds_read_b64_tr_b16 a[214:215], v249 offset:42560
v_mfma_f32_16x16x32_bf16 v[60:63], a[216:219], a[100:103], v[60:63]
buffer_load_dwordx4 v243, s[68:71], s31 offen offset:3168 lds
v_mfma_f32_16x16x32_bf16 v[68:71], a[216:219], a[104:107], v[68:71]
v_mfma_f32_16x16x32_bf16 v[76:79], a[216:219], a[108:111], v[76:79]
ds_read_b64_tr_b16 a[216:217], v250 offset:64
s_waitcnt lgkmcnt(13)
v_mfma_f32_16x16x32_bf16 v[76:79], a[220:223], a[124:127], v[76:79]
ds_read_b64_tr_b16 a[218:219], v250 offset:320
v_mfma_f32_16x16x32_bf16 v[68:71], a[220:223], a[120:123], v[68:71]
s_mul_i32 s31, s92, 4
v_mfma_f32_16x16x32_bf16 v[60:63], a[220:223], a[116:119], v[60:63]
s_add_u32 s31, s31, s12
s_add_u32 m0, s96, 33792
v_mfma_f32_16x16x32_bf16 v[52:55], a[220:223], a[112:115], v[52:55]
ds_read_b64_tr_b16 a[220:221], v250 offset:8512
buffer_load_dwordx4 v240, s[68:71], s31 offen offset:0 lds
s_waitcnt lgkmcnt(8)
v_mfma_f32_16x16x32_bf16 v[84:87], a[192:195], a[0:3], v[84:87]
ds_read_b64_tr_b16 a[222:223], v250 offset:8768
v_mfma_f32_16x16x32_bf16 v[92:95], a[192:195], a[4:7], v[92:95]
v_bfe_u32 v10, v0, 2, 2
v_mfma_f32_16x16x32_bf16 v[100:103], a[192:195], a[8:11], v[100:103]
buffer_load_dwordx4 v241, s[68:71], s31 offen offset:1056 lds
v_mfma_f32_16x16x32_bf16 v[108:111], a[192:195], a[12:15], v[108:111]
ds_read_b64_tr_b16 a[192:193], v249 offset:96
v_mfma_f32_16x16x32_bf16 v[108:111], a[196:199], a[28:31], v[108:111]
ds_read_b64_tr_b16 a[194:195], v249 offset:352
v_mfma_f32_16x16x32_bf16 v[100:103], a[196:199], a[24:27], v[100:103]
v_mul_u32_u24 v10, 1056, v10
v_mfma_f32_16x16x32_bf16 v[92:95], a[196:199], a[20:23], v[92:95]
v_cvt_pk_bf16_f32 v20, v20, v21
v_bfe_u32 v11, v0, 4, 1
v_mfma_f32_16x16x32_bf16 v[84:87], a[196:199], a[16:19], v[84:87]
ds_read_b64_tr_b16 a[196:197], v249 offset:8544
v_cvt_pk_bf16_f32 v21, v22, v23
v_mfma_f32_16x16x32_bf16 v[84:87], a[200:203], a[32:35], v[84:87]
ds_read_b64_tr_b16 a[198:199], v249 offset:8800
v_mfma_f32_16x16x32_bf16 v[92:95], a[200:203], a[36:39], v[92:95]
v_cvt_pk_bf16_f32 v22, v52, v53
v_mfma_f32_16x16x32_bf16 v[100:103], a[200:203], a[40:43], v[100:103]
buffer_load_dwordx4 v242, s[68:71], s31 offen offset:2112 lds
v_cvt_pk_bf16_f32 v23, v54, v55
v_mfma_f32_16x16x32_bf16 v[108:111], a[200:203], a[44:47], v[108:111]
ds_read_b64_tr_b16 a[200:201], v249 offset:16992
v_lshl_add_u32 v10, v11, 7, v10
s_waitcnt lgkmcnt(13)
v_mfma_f32_16x16x32_bf16 v[108:111], a[204:207], a[60:63], v[108:111]
ds_read_b64_tr_b16 a[202:203], v249 offset:17248
v_cvt_pk_bf16_f32 v28, v28, v29
s_add_u32 s30, s27, 0
buffer_store_dwordx4 v[20:23], v251, s[76:79], s30 offen offset:0 sc1
v_mfma_f32_16x16x32_bf16 v[100:103], a[204:207], a[56:59], v[100:103]
v_cvt_pk_bf16_f32 v29, v30, v31
v_mfma_f32_16x16x32_bf16 v[92:95], a[204:207], a[52:55], v[92:95]
v_lshrrev_b32 v11, 5, v0
v_cvt_pk_bf16_f32 v30, v60, v61
v_mfma_f32_16x16x32_bf16 v[84:87], a[204:207], a[48:51], v[84:87]
ds_read_b64_tr_b16 a[204:205], v249 offset:25440
v_cvt_pk_bf16_f32 v31, v62, v63
s_waitcnt lgkmcnt(8)
v_mfma_f32_16x16x32_bf16 v[84:87], a[208:211], a[64:67], v[84:87]
ds_read_b64_tr_b16 a[206:207], v249 offset:25696
buffer_load_dwordx4 v243, s[68:71], s31 offen offset:3168 lds
v_lshl_add_u32 v10, v11, 9, v10
v_cvt_pk_bf16_f32 v36, v36, v37
v_mfma_f32_16x16x32_bf16 v[92:95], a[208:211], a[68:71], v[92:95]
v_cvt_pk_bf16_f32 v37, v38, v39
v_mfma_f32_16x16x32_bf16 v[100:103], a[208:211], a[72:75], v[100:103]
v_cvt_pk_bf16_f32 v38, v68, v69
v_and_b32 v11, 3, v0
v_mfma_f32_16x16x32_bf16 v[108:111], a[208:211], a[76:79], v[108:111]
ds_read_b64_tr_b16 a[208:209], v249 offset:33888
v_cvt_pk_bf16_f32 v39, v70, v71
v_mfma_f32_16x16x32_bf16 v[108:111], a[212:215], a[92:95], v[108:111]
ds_read_b64_tr_b16 a[210:211], v249 offset:34144
v_cvt_pk_bf16_f32 v44, v44, v45
v_mfma_f32_16x16x32_bf16 v[100:103], a[212:215], a[88:91], v[100:103]
s_add_u32 s20, s20, 4096
s_add_u32 s93, s93, 4096
v_lshl_add_u32 v10, v11, 3, v10
v_cvt_pk_bf16_f32 v45, v46, v47
v_mfma_f32_16x16x32_bf16 v[92:95], a[212:215], a[84:87], v[92:95]
buffer_load_dwordx4 v[16:19], v251, s[76:79], s20 offen offset:0 sc1
v_cvt_pk_bf16_f32 v46, v76, v77
v_mfma_f32_16x16x32_bf16 v[84:87], a[212:215], a[80:83], v[84:87]
ds_read_b64_tr_b16 a[212:213], v249 offset:42336
v_cvt_pk_bf16_f32 v47, v78, v79
v_mfma_f32_16x16x32_bf16 v[84:87], a[216:219], a[96:99], v[84:87]
ds_read_b64_tr_b16 a[214:215], v249 offset:42592
s_lshr_b32 s88, s3, 1
s_cmp_eq_u32 s97, 0
s_cbranch_scc1 rekp_67
rekpb_68:
v_mfma_f32_16x16x32_bf16 v[92:95], a[216:219], a[100:103], v[92:95]
s_mul_i32 s88, s88, 8448
v_mfma_f32_16x16x32_bf16 v[100:103], a[216:219], a[104:107], v[100:103]
buffer_load_dwordx4 v[24:27], v251, s[76:79], s93 offen offset:0 sc1
v_add_u32 v244, s88, v10
v_mfma_f32_16x16x32_bf16 v[108:111], a[216:219], a[108:111], v[108:111]
ds_read_b64_tr_b16 a[216:217], v250 offset:96
s_add_u32 s30, s27, 16384
s_waitcnt lgkmcnt(13)
v_mfma_f32_16x16x32_bf16 v[108:111], a[220:223], a[124:127], v[108:111]
ds_read_b64_tr_b16 a[218:219], v250 offset:352
v_mfma_f32_16x16x32_bf16 v[100:103], a[220:223], a[120:123], v[100:103]
buffer_store_dwordx4 v[28:31], v251, s[76:79], s30 offen offset:0 sc1
v_mfma_f32_16x16x32_bf16 v[92:95], a[220:223], a[116:119], v[92:95]
buffer_load_dwordx4 v[32:35], v251, s[76:79], s20 offen offset:1024 sc1
v_add_u32 v245, 50688, v244
v_mfma_f32_16x16x32_bf16 v[84:87], a[220:223], a[112:115], v[84:87]
ds_read_b64_tr_b16 a[220:221], v250 offset:8544
v_add_u32 v246, 101376, v244
s_waitcnt lgkmcnt(8)
v_mfma_f32_16x16x32_bf16 v[116:119], a[192:195], a[0:3], v[116:119]
ds_read_b64_tr_b16 a[222:223], v250 offset:8800
v_mfma_f32_16x16x32_bf16 v[124:127], a[192:195], a[4:7], v[124:127]
buffer_load_dwordx4 v[40:43], v251, s[76:79], s93 offen offset:1024 sc1
v_mfma_f32_16x16x32_bf16 v[132:135], a[192:195], a[8:11], v[132:135]
v_mfma_f32_16x16x32_bf16 v[140:143], a[192:195], a[12:15], v[140:143]
ds_read_b64_tr_b16 a[192:193], v249 offset:128
v_mfma_f32_16x16x32_bf16 v[140:143], a[196:199], a[28:31], v[140:143]
ds_read_b64_tr_b16 a[194:195], v249 offset:384
v_mfma_f32_16x16x32_bf16 v[132:135], a[196:199], a[24:27], v[132:135]
buffer_load_dwordx4 v[48:51], v251, s[76:79], s20 offen offset:2048 sc1
v_mfma_f32_16x16x32_bf16 v[124:127], a[196:199], a[20:23], v[124:127]
v_mfma_f32_16x16x32_bf16 v[116:119], a[196:199], a[16:19], v[116:119]
ds_read_b64_tr_b16 a[196:197], v249 offset:8576
v_mfma_f32_16x16x32_bf16 v[116:119], a[200:203], a[32:35], v[116:119]
ds_read_b64_tr_b16 a[198:199], v249 offset:8832
v_mfma_f32_16x16x32_bf16 v[124:127], a[200:203], a[36:39], v[124:127]
v_mfma_f32_16x16x32_bf16 v[132:135], a[200:203], a[40:43], v[132:135]
buffer_load_dwordx4 v[56:59], v251, s[76:79], s93 offen offset:2048 sc1
v_mfma_f32_16x16x32_bf16 v[140:143], a[200:203], a[44:47], v[140:143]
ds_read_b64_tr_b16 a[200:201], v249 offset:17024
s_waitcnt lgkmcnt(13)
v_mfma_f32_16x16x32_bf16 v[140:143], a[204:207], a[60:63], v[140:143]
ds_read_b64_tr_b16 a[202:203], v249 offset:17280
v_mfma_f32_16x16x32_bf16 v[132:135], a[204:207], a[56:59], v[132:135]
s_add_u32 s30, s27, 32768
v_mfma_f32_16x16x32_bf16 v[124:127], a[204:207], a[52:55], v[124:127]
buffer_store_dwordx4 v[36:39], v251, s[76:79], s30 offen offset:0 sc1
v_mfma_f32_16x16x32_bf16 v[116:119], a[204:207], a[48:51], v[116:119]
ds_read_b64_tr_b16 a[204:205], v249 offset:25472
s_waitcnt lgkmcnt(8)
v_mfma_f32_16x16x32_bf16 v[116:119], a[208:211], a[64:67], v[116:119]
ds_read_b64_tr_b16 a[206:207], v249 offset:25728
v_mfma_f32_16x16x32_bf16 v[124:127], a[208:211], a[68:71], v[124:127]
buffer_load_dwordx4 v[64:67], v251, s[76:79], s20 offen offset:3072 sc1
v_mfma_f32_16x16x32_bf16 v[132:135], a[208:211], a[72:75], v[132:135]
v_mfma_f32_16x16x32_bf16 v[140:143], a[208:211], a[76:79], v[140:143]
ds_read_b64_tr_b16 a[208:209], v249 offset:33920
v_mfma_f32_16x16x32_bf16 v[140:143], a[212:215], a[92:95], v[140:143]
ds_read_b64_tr_b16 a[210:211], v249 offset:34176
v_mfma_f32_16x16x32_bf16 v[132:135], a[212:215], a[88:91], v[132:135]
buffer_load_dwordx4 v[72:75], v251, s[76:79], s93 offen offset:3072 sc1
v_mfma_f32_16x16x32_bf16 v[124:127], a[212:215], a[84:87], v[124:127]
v_mfma_f32_16x16x32_bf16 v[116:119], a[212:215], a[80:83], v[116:119]
ds_read_b64_tr_b16 a[212:213], v249 offset:42368
v_mfma_f32_16x16x32_bf16 v[116:119], a[216:219], a[96:99], v[116:119]
ds_read_b64_tr_b16 a[214:215], v249 offset:42624
v_mfma_f32_16x16x32_bf16 v[124:127], a[216:219], a[100:103], v[124:127]
s_add_u32 s20, s20, 4096
v_mfma_f32_16x16x32_bf16 v[132:135], a[216:219], a[104:107], v[132:135]
s_add_u32 s93, s93, 4096
buffer_load_dwordx4 v[80:83], v251, s[76:79], s20 offen offset:0 sc1
v_mfma_f32_16x16x32_bf16 v[140:143], a[216:219], a[108:111], v[140:143]
ds_read_b64_tr_b16 a[216:217], v250 offset:128
s_waitcnt lgkmcnt(13)
v_mfma_f32_16x16x32_bf16 v[140:143], a[220:223], a[124:127], v[140:143]
ds_read_b64_tr_b16 a[218:219], v250 offset:384
v_mfma_f32_16x16x32_bf16 v[132:135], a[220:223], a[120:123], v[132:135]
v_mfma_f32_16x16x32_bf16 v[124:127], a[220:223], a[116:119], v[124:127]
buffer_load_dwordx4 v[88:91], v251, s[76:79], s93 offen offset:0 sc1
s_add_u32 s30, s27, 49152
v_mfma_f32_16x16x32_bf16 v[116:119], a[220:223], a[112:115], v[116:119]
ds_read_b64_tr_b16 a[220:221], v250 offset:8576
buffer_store_dwordx4 v[44:47], v251, s[76:79], s30 offen offset:0 sc1
s_waitcnt lgkmcnt(8)
v_mfma_f32_16x16x32_bf16 v[144:147], a[192:195], a[0:3], v[144:147]
ds_read_b64_tr_b16 a[222:223], v250 offset:8832
v_mfma_f32_16x16x32_bf16 v[148:151], a[192:195], a[4:7], v[148:151]
v_mfma_f32_16x16x32_bf16 v[152:155], a[192:195], a[8:11], v[152:155]
v_mfma_f32_16x16x32_bf16 v[156:159], a[192:195], a[12:15], v[156:159]
ds_read_b64_tr_b16 a[192:193], v249 offset:160
v_mfma_f32_16x16x32_bf16 v[156:159], a[196:199], a[28:31], v[156:159]
ds_read_b64_tr_b16 a[194:195], v249 offset:416
v_mfma_f32_16x16x32_bf16 v[152:155], a[196:199], a[24:27], v[152:155]
buffer_load_dwordx4 v[96:99], v251, s[76:79], s20 offen offset:1024 sc1
v_mfma_f32_16x16x32_bf16 v[148:151], a[196:199], a[20:23], v[148:151]
v_cvt_pk_bf16_f32 v84, v84, v85
v_cvt_pk_bf16_f32 v85, v86, v87
v_mfma_f32_16x16x32_bf16 v[144:147], a[196:199], a[16:19], v[144:147]
ds_read_b64_tr_b16 a[196:197], v249 offset:8608
v_cvt_pk_bf16_f32 v86, v116, v117
v_mfma_f32_16x16x32_bf16 v[144:147], a[200:203], a[32:35], v[144:147]
ds_read_b64_tr_b16 a[198:199], v249 offset:8864
v_mfma_f32_16x16x32_bf16 v[148:151], a[200:203], a[36:39], v[148:151]
v_cvt_pk_bf16_f32 v87, v118, v119
v_mfma_f32_16x16x32_bf16 v[152:155], a[200:203], a[40:43], v[152:155]
buffer_load_dwordx4 v[104:107], v251, s[76:79], s93 offen offset:1024 sc1
v_cvt_pk_bf16_f32 v92, v92, v93
v_mfma_f32_16x16x32_bf16 v[156:159], a[200:203], a[44:47], v[156:159]
ds_read_b64_tr_b16 a[200:201], v249 offset:17056
v_cvt_pk_bf16_f32 v93, v94, v95
s_waitcnt lgkmcnt(13)
v_mfma_f32_16x16x32_bf16 v[156:159], a[204:207], a[60:63], v[156:159]
ds_read_b64_tr_b16 a[202:203], v249 offset:17312
v_mfma_f32_16x16x32_bf16 v[152:155], a[204:207], a[56:59], v[152:155]
v_cvt_pk_bf16_f32 v94, v124, v125
v_mfma_f32_16x16x32_bf16 v[148:151], a[204:207], a[52:55], v[148:151]
v_cvt_pk_bf16_f32 v95, v126, v127
v_cvt_pk_bf16_f32 v100, v100, v101
v_mfma_f32_16x16x32_bf16 v[144:147], a[204:207], a[48:51], v[144:147]
ds_read_b64_tr_b16 a[204:205], v249 offset:25504
buffer_load_dwordx4 v[112:115], v251, s[76:79], s20 offen offset:2048 sc1
s_waitcnt lgkmcnt(8)
v_mfma_f32_16x16x32_bf16 v[144:147], a[208:211], a[64:67], v[144:147]
ds_read_b64_tr_b16 a[206:207], v249 offset:25760
v_mfma_f32_16x16x32_bf16 v[148:151], a[208:211], a[68:71], v[148:151]
v_cvt_pk_bf16_f32 v101, v102, v103
v_mfma_f32_16x16x32_bf16 v[152:155], a[208:211], a[72:75], v[152:155]
v_cvt_pk_bf16_f32 v102, v132, v133
v_cvt_pk_bf16_f32 v103, v134, v135
v_mfma_f32_16x16x32_bf16 v[156:159], a[208:211], a[76:79], v[156:159]
ds_read_b64_tr_b16 a[208:209], v249 offset:33952
v_cvt_pk_bf16_f32 v108, v108, v109
v_mfma_f32_16x16x32_bf16 v[156:159], a[212:215], a[92:95], v[156:159]
ds_read_b64_tr_b16 a[210:211], v249 offset:34208
s_add_u32 s30, s27, 0
buffer_store_dwordx4 v[84:87], v251, s[76:79], s30 offen offset:1024 sc1
v_mfma_f32_16x16x32_bf16 v[152:155], a[212:215], a[88:91], v[152:155]
v_cvt_pk_bf16_f32 v109, v110, v111
v_mfma_f32_16x16x32_bf16 v[148:151], a[212:215], a[84:87], v[148:151]
buffer_load_dwordx4 v[120:123], v251, s[76:79], s93 offen offset:2048 sc1
v_cvt_pk_bf16_f32 v110, v140, v141
v_mfma_f32_16x16x32_bf16 v[144:147], a[212:215], a[80:83], v[144:147]
ds_read_b64_tr_b16 a[212:213], v249 offset:42400
v_cvt_pk_bf16_f32 v111, v142, v143
s_cmp_eq_u32 s97, 0
s_cbranch_scc1 rekp_69
rekpb_70:
v_mfma_f32_16x16x32_bf16 v[144:147], a[216:219], a[96:99], v[144:147]
ds_read_b64_tr_b16 a[214:215], v249 offset:42656
v_mfma_f32_16x16x32_bf16 v[148:151], a[216:219], a[100:103], v[148:151]
buffer_load_dwordx4 v[128:131], v251, s[76:79], s20 offen offset:3072 sc1
v_mfma_f32_16x16x32_bf16 v[152:155], a[216:219], a[104:107], v[152:155]
v_mfma_f32_16x16x32_bf16 v[156:159], a[216:219], a[108:111], v[156:159]
ds_read_b64_tr_b16 a[216:217], v250 offset:160
s_waitcnt lgkmcnt(13)
v_mfma_f32_16x16x32_bf16 v[156:159], a[220:223], a[124:127], v[156:159]
ds_read_b64_tr_b16 a[218:219], v250 offset:416
v_mfma_f32_16x16x32_bf16 v[152:155], a[220:223], a[120:123], v[152:155]
buffer_load_dwordx4 v[136:139], v251, s[76:79], s93 offen offset:3072 sc1
v_mfma_f32_16x16x32_bf16 v[148:151], a[220:223], a[116:119], v[148:151]
v_mfma_f32_16x16x32_bf16 v[144:147], a[220:223], a[112:115], v[144:147]
ds_read_b64_tr_b16 a[220:221], v250 offset:8608
s_waitcnt lgkmcnt(8)
v_mfma_f32_16x16x32_bf16 v[160:163], a[192:195], a[0:3], v[160:163]
ds_read_b64_tr_b16 a[222:223], v250 offset:8864
v_mfma_f32_16x16x32_bf16 v[164:167], a[192:195], a[4:7], v[164:167]
s_add_u32 s20, s20, 4096
v_mfma_f32_16x16x32_bf16 v[168:171], a[192:195], a[8:11], v[168:171]
s_add_u32 s93, s93, 4096
buffer_load_dwordx4 a[128:131], v251, s[76:79], s20 offen offset:0 sc1
v_mfma_f32_16x16x32_bf16 v[172:175], a[192:195], a[12:15], v[172:175]
ds_read_b64_tr_b16 a[192:193], v249 offset:192
s_add_u32 s30, s27, 16384
v_mfma_f32_16x16x32_bf16 v[172:175], a[196:199], a[28:31], v[172:175]
ds_read_b64_tr_b16 a[194:195], v249 offset:448
v_mfma_f32_16x16x32_bf16 v[168:171], a[196:199], a[24:27], v[168:171]
buffer_store_dwordx4 v[92:95], v251, s[76:79], s30 offen offset:1024 sc1
v_mfma_f32_16x16x32_bf16 v[164:167], a[196:199], a[20:23], v[164:167]
buffer_load_dwordx4 a[132:135], v251, s[76:79], s93 offen offset:0 sc1
v_mfma_f32_16x16x32_bf16 v[160:163], a[196:199], a[16:19], v[160:163]
ds_read_b64_tr_b16 a[196:197], v249 offset:8640
v_mfma_f32_16x16x32_bf16 v[160:163], a[200:203], a[32:35], v[160:163]
ds_read_b64_tr_b16 a[198:199], v249 offset:8896
v_mfma_f32_16x16x32_bf16 v[164:167], a[200:203], a[36:39], v[164:167]
v_mfma_f32_16x16x32_bf16 v[168:171], a[200:203], a[40:43], v[168:171]
v_mfma_f32_16x16x32_bf16 v[172:175], a[200:203], a[44:47], v[172:175]
ds_read_b64_tr_b16 a[200:201], v249 offset:17088
s_waitcnt lgkmcnt(13)
v_mfma_f32_16x16x32_bf16 v[172:175], a[204:207], a[60:63], v[172:175]
ds_read_b64_tr_b16 a[202:203], v249 offset:17344
v_mfma_f32_16x16x32_bf16 v[168:171], a[204:207], a[56:59], v[168:171]
buffer_load_dwordx4 a[136:139], v251, s[76:79], s20 offen offset:1024 sc1
v_mfma_f32_16x16x32_bf16 v[164:167], a[204:207], a[52:55], v[164:167]
v_mfma_f32_16x16x32_bf16 v[160:163], a[204:207], a[48:51], v[160:163]
ds_read_b64_tr_b16 a[204:205], v249 offset:25536
s_waitcnt lgkmcnt(8)
v_mfma_f32_16x16x32_bf16 v[160:163], a[208:211], a[64:67], v[160:163]
ds_read_b64_tr_b16 a[206:207], v249 offset:25792
v_mfma_f32_16x16x32_bf16 v[164:167], a[208:211], a[68:71], v[164:167]
buffer_load_dwordx4 a[140:143], v251, s[76:79], s93 offen offset:1024 sc1
v_mfma_f32_16x16x32_bf16 v[168:171], a[208:211], a[72:75], v[168:171]
v_mfma_f32_16x16x32_bf16 v[172:175], a[208:211], a[76:79], v[172:175]
ds_read_b64_tr_b16 a[208:209], v249 offset:33984
v_mfma_f32_16x16x32_bf16 v[172:175], a[212:215], a[92:95], v[172:175]
ds_read_b64_tr_b16 a[210:211], v249 offset:34240
v_mfma_f32_16x16x32_bf16 v[168:171], a[212:215], a[88:91], v[168:171]
buffer_load_dwordx4 a[144:147], v251, s[76:79], s20 offen offset:2048 sc1
v_mfma_f32_16x16x32_bf16 v[164:167], a[212:215], a[84:87], v[164:167]
s_add_u32 s30, s27, 32768
buffer_store_dwordx4 v[100:103], v251, s[76:79], s30 offen offset:1024 sc1
v_mfma_f32_16x16x32_bf16 v[160:163], a[212:215], a[80:83], v[160:163]
ds_read_b64_tr_b16 a[212:213], v249 offset:42432
v_mfma_f32_16x16x32_bf16 v[160:163], a[216:219], a[96:99], v[160:163]
ds_read_b64_tr_b16 a[214:215], v249 offset:42688
v_mfma_f32_16x16x32_bf16 v[164:167], a[216:219], a[100:103], v[164:167]
buffer_load_dwordx4 a[148:151], v251, s[76:79], s93 offen offset:2048 sc1
v_mfma_f32_16x16x32_bf16 v[168:171], a[216:219], a[104:107], v[168:171]
v_mfma_f32_16x16x32_bf16 v[172:175], a[216:219], a[108:111], v[172:175]
ds_read_b64_tr_b16 a[216:217], v250 offset:192
s_waitcnt lgkmcnt(13)
v_mfma_f32_16x16x32_bf16 v[172:175], a[220:223], a[124:127], v[172:175]
ds_read_b64_tr_b16 a[218:219], v250 offset:448
v_mfma_f32_16x16x32_bf16 v[168:171], a[220:223], a[120:123], v[168:171]
v_mfma_f32_16x16x32_bf16 v[164:167], a[220:223], a[116:119], v[164:167]
buffer_load_dwordx4 a[152:155], v251, s[76:79], s20 offen offset:3072 sc1
v_mfma_f32_16x16x32_bf16 v[160:163], a[220:223], a[112:115], v[160:163]
ds_read_b64_tr_b16 a[220:221], v250 offset:8640
s_waitcnt lgkmcnt(8)
v_mfma_f32_16x16x32_bf16 v[176:179], a[192:195], a[0:3], v[176:179]
ds_read_b64_tr_b16 a[222:223], v250 offset:8896
v_mfma_f32_16x16x32_bf16 v[180:183], a[192:195], a[4:7], v[180:183]
v_mfma_f32_16x16x32_bf16 v[184:187], a[192:195], a[8:11], v[184:187]
v_mfma_f32_16x16x32_bf16 v[188:191], a[192:195], a[12:15], v[188:191]
ds_read_b64_tr_b16 a[192:193], v249 offset:224
v_mfma_f32_16x16x32_bf16 v[188:191], a[196:199], a[28:31], v[188:191]
ds_read_b64_tr_b16 a[194:195], v249 offset:480
v_mfma_f32_16x16x32_bf16 v[184:187], a[196:199], a[24:27], v[184:187]
buffer_load_dwordx4 a[156:159], v251, s[76:79], s93 offen offset:3072 sc1
v_mfma_f32_16x16x32_bf16 v[180:183], a[196:199], a[20:23], v[180:183]
v_cvt_pk_bf16_f32 v144, v144, v145
v_cvt_pk_bf16_f32 v145, v146, v147
v_mfma_f32_16x16x32_bf16 v[176:179], a[196:199], a[16:19], v[176:179]
ds_read_b64_tr_b16 a[196:197], v249 offset:8672
v_cvt_pk_bf16_f32 v146, v160, v161
v_mfma_f32_16x16x32_bf16 v[176:179], a[200:203], a[32:35], v[176:179]
ds_read_b64_tr_b16 a[198:199], v249 offset:8928
v_mfma_f32_16x16x32_bf16 v[180:183], a[200:203], a[36:39], v[180:183]
s_add_u32 s30, s27, 49152
v_mfma_f32_16x16x32_bf16 v[184:187], a[200:203], a[40:43], v[184:187]
buffer_store_dwordx4 v[108:111], v251, s[76:79], s30 offen offset:1024 sc1
v_cvt_pk_bf16_f32 v147, v162, v163
v_mfma_f32_16x16x32_bf16 v[188:191], a[200:203], a[44:47], v[188:191]
ds_read_b64_tr_b16 a[200:201], v249 offset:17120
s_add_u32 s20, s20, 4096
s_waitcnt lgkmcnt(13)
v_mfma_f32_16x16x32_bf16 v[188:191], a[204:207], a[60:63], v[188:191]
ds_read_b64_tr_b16 a[202:203], v249 offset:17376
s_add_u32 s93, s93, 4096
v_cvt_pk_bf16_f32 v148, v148, v149
v_mfma_f32_16x16x32_bf16 v[184:187], a[204:207], a[56:59], v[184:187]
buffer_load_dwordx4 a[160:163], v251, s[76:79], s20 offen offset:0 sc1
v_cvt_pk_bf16_f32 v149, v150, v151
v_mfma_f32_16x16x32_bf16 v[180:183], a[204:207], a[52:55], v[180:183]
v_cvt_pk_bf16_f32 v150, v164, v165
v_cvt_pk_bf16_f32 v151, v166, v167
v_mfma_f32_16x16x32_bf16 v[176:179], a[204:207], a[48:51], v[176:179]
ds_read_b64_tr_b16 a[204:205], v249 offset:25568
v_cvt_pk_bf16_f32 v152, v152, v153
s_waitcnt lgkmcnt(8)
v_mfma_f32_16x16x32_bf16 v[176:179], a[208:211], a[64:67], v[176:179]
ds_read_b64_tr_b16 a[206:207], v249 offset:25824
v_mfma_f32_16x16x32_bf16 v[180:183], a[208:211], a[68:71], v[180:183]
v_cvt_pk_bf16_f32 v153, v154, v155
v_mfma_f32_16x16x32_bf16 v[184:187], a[208:211], a[72:75], v[184:187]
buffer_load_dwordx4 a[164:167], v251, s[76:79], s93 offen offset:0 sc1
v_cvt_pk_bf16_f32 v154, v168, v169
v_mfma_f32_16x16x32_bf16 v[188:191], a[208:211], a[76:79], v[188:191]
ds_read_b64_tr_b16 a[208:209], v249 offset:34016
v_cvt_pk_bf16_f32 v155, v170, v171
v_mfma_f32_16x16x32_bf16 v[188:191], a[212:215], a[92:95], v[188:191]
ds_read_b64_tr_b16 a[210:211], v249 offset:34272
v_cvt_pk_bf16_f32 v156, v156, v157
v_mfma_f32_16x16x32_bf16 v[184:187], a[212:215], a[88:91], v[184:187]
v_cvt_pk_bf16_f32 v157, v158, v159
v_mfma_f32_16x16x32_bf16 v[180:183], a[212:215], a[84:87], v[180:183]
v_cvt_pk_bf16_f32 v158, v172, v173
buffer_load_dwordx4 a[168:171], v251, s[76:79], s20 offen offset:1024 sc1
v_mfma_f32_16x16x32_bf16 v[176:179], a[212:215], a[80:83], v[176:179]
ds_read_b64_tr_b16 a[212:213], v249 offset:42464
v_cvt_pk_bf16_f32 v159, v174, v175
s_cmp_eq_u32 s97, 1
s_cbranch_scc1 rekp_71
rekpb_72:
v_mfma_f32_16x16x32_bf16 v[176:179], a[216:219], a[96:99], v[176:179]
ds_read_b64_tr_b16 a[214:215], v249 offset:42720
v_mfma_f32_16x16x32_bf16 v[180:183], a[216:219], a[100:103], v[180:183]
buffer_load_dwordx4 a[172:175], v251, s[76:79], s93 offen offset:1024 sc1
v_mfma_f32_16x16x32_bf16 v[184:187], a[216:219], a[104:107], v[184:187]
s_add_u32 s30, s98, 0
buffer_store_dwordx4 v[144:147], v251, s[76:79], s30 offen offset:2048 sc1
v_mfma_f32_16x16x32_bf16 v[188:191], a[216:219], a[108:111], v[188:191]
ds_read_b64_tr_b16 a[216:217], v250 offset:224
s_waitcnt lgkmcnt(13)
v_mfma_f32_16x16x32_bf16 v[188:191], a[220:223], a[124:127], v[188:191]
ds_read_b64_tr_b16 a[218:219], v250 offset:480
v_mfma_f32_16x16x32_bf16 v[184:187], a[220:223], a[120:123], v[184:187]
buffer_load_dwordx4 a[176:179], v251, s[76:79], s20 offen offset:2048 sc1
v_mfma_f32_16x16x32_bf16 v[180:183], a[220:223], a[116:119], v[180:183]
v_mfma_f32_16x16x32_bf16 v[176:179], a[220:223], a[112:115], v[176:179]
ds_read_b64_tr_b16 a[220:221], v250 offset:8672
s_waitcnt lgkmcnt(8)
v_mfma_f32_16x16x32_bf16 v[192:195], a[192:195], a[0:3], v[192:195]
ds_read_b64_tr_b16 a[222:223], v250 offset:8928
v_mfma_f32_16x16x32_bf16 v[196:199], a[192:195], a[4:7], v[196:199]
buffer_load_dwordx4 a[180:183], v251, s[76:79], s93 offen offset:2048 sc1
v_mfma_f32_16x16x32_bf16 v[200:203], a[192:195], a[8:11], v[200:203]
v_mfma_f32_16x16x32_bf16 v[204:207], a[192:195], a[12:15], v[204:207]
v_mfma_f32_16x16x32_bf16 v[204:207], a[196:199], a[28:31], v[204:207]
v_mfma_f32_16x16x32_bf16 v[200:203], a[196:199], a[24:27], v[200:203]
v_mfma_f32_16x16x32_bf16 v[196:199], a[196:199], a[20:23], v[196:199]
buffer_load_dwordx4 a[184:187], v251, s[76:79], s20 offen offset:3072 sc1
v_mfma_f32_16x16x32_bf16 v[192:195], a[196:199], a[16:19], v[192:195]
v_mfma_f32_16x16x32_bf16 v[192:195], a[200:203], a[32:35], v[192:195]
v_mfma_f32_16x16x32_bf16 v[196:199], a[200:203], a[36:39], v[196:199]
v_mfma_f32_16x16x32_bf16 v[200:203], a[200:203], a[40:43], v[200:203]
s_add_u32 s30, s98, 16384
v_mfma_f32_16x16x32_bf16 v[204:207], a[200:203], a[44:47], v[204:207]
buffer_store_dwordx4 v[148:151], v251, s[76:79], s30 offen offset:2048 sc1
s_waitcnt lgkmcnt(8)
v_mfma_f32_16x16x32_bf16 v[204:207], a[204:207], a[60:63], v[204:207]
buffer_load_dwordx4 a[188:191], v251, s[76:79], s93 offen offset:3072 sc1
v_mfma_f32_16x16x32_bf16 v[200:203], a[204:207], a[56:59], v[200:203]
v_mfma_f32_16x16x32_bf16 v[196:199], a[204:207], a[52:55], v[196:199]
v_mfma_f32_16x16x32_bf16 v[192:195], a[204:207], a[48:51], v[192:195]
s_waitcnt lgkmcnt(0)
s_barrier
v_mfma_f32_16x16x32_bf16 v[192:195], a[208:211], a[64:67], v[192:195]
v_mfma_f32_16x16x32_bf16 v[196:199], a[208:211], a[68:71], v[196:199]
v_mfma_f32_16x16x32_bf16 v[200:203], a[208:211], a[72:75], v[200:203]
v_mfma_f32_16x16x32_bf16 v[204:207], a[208:211], a[76:79], v[204:207]
v_mfma_f32_16x16x32_bf16 v[204:207], a[212:215], a[92:95], v[204:207]
v_mfma_f32_16x16x32_bf16 v[200:203], a[212:215], a[88:91], v[200:203]
v_mfma_f32_16x16x32_bf16 v[196:199], a[212:215], a[84:87], v[196:199]
v_mfma_f32_16x16x32_bf16 v[192:195], a[212:215], a[80:83], v[192:195]
v_mfma_f32_16x16x32_bf16 v[192:195], a[216:219], a[96:99], v[192:195]
v_mfma_f32_16x16x32_bf16 v[196:199], a[216:219], a[100:103], v[196:199]
v_mfma_f32_16x16x32_bf16 v[200:203], a[216:219], a[104:107], v[200:203]
v_mfma_f32_16x16x32_bf16 v[204:207], a[216:219], a[108:111], v[204:207]
v_mfma_f32_16x16x32_bf16 v[204:207], a[220:223], a[124:127], v[204:207]
s_add_u32 s30, s98, 32768
v_mfma_f32_16x16x32_bf16 v[200:203], a[220:223], a[120:123], v[200:203]
buffer_store_dwordx4 v[152:155], v251, s[76:79], s30 offen offset:2048 sc1
v_mfma_f32_16x16x32_bf16 v[196:199], a[220:223], a[116:119], v[196:199]
v_mfma_f32_16x16x32_bf16 v[192:195], a[220:223], a[112:115], v[192:195]
s_load_dwordx2 s[72:73], s[0:1], 80
v_cvt_pk_bf16_f32 v176, v176, v177
v_cvt_pk_bf16_f32 v177, v178, v179
s_nop 4
v_cvt_pk_bf16_f32 v178, v192, v193
v_cvt_pk_bf16_f32 v179, v194, v195
v_cvt_pk_bf16_f32 v180, v180, v181
v_cvt_pk_bf16_f32 v181, v182, v183
v_cvt_pk_bf16_f32 v182, v196, v197
v_cvt_pk_bf16_f32 v183, v198, v199
v_cvt_pk_bf16_f32 v184, v184, v185
v_cvt_pk_bf16_f32 v185, v186, v187
v_cvt_pk_bf16_f32 v186, v200, v201
v_cvt_pk_bf16_f32 v187, v202, v203
v_cvt_pk_bf16_f32 v188, v188, v189
v_cvt_pk_bf16_f32 v189, v190, v191
v_cvt_pk_bf16_f32 v190, v204, v205
v_cvt_pk_bf16_f32 v191, v206, v207
s_cmp_eq_u32 s97, 1
s_cbranch_scc1 rekp_73
rekpb_74:
s_waitcnt lgkmcnt(0)
recurrent_scan__sliding_block_cached__mixer_s_mlp__prompt_kernel_fin:
s_waitcnt lgkmcnt(0)
s_and_b32 s73, s73, 0xffff
s_mov_b32 s74, 2097152
s_barrier
ds_read_b64_tr_b16 a[192:193], v246 offset:16896
ds_read_b64_tr_b16 a[194:195], v246 offset:17152
ds_read_b64_tr_b16 a[196:197], v246 offset:16928
ds_read_b64_tr_b16 a[198:199], v246 offset:17184
ds_read_b64_tr_b16 a[200:201], v246 offset:16960
ds_read_b64_tr_b16 a[202:203], v246 offset:17216
ds_read_b64_tr_b16 a[204:205], v246 offset:16992
ds_read_b64_tr_b16 a[206:207], v246 offset:17248
ds_read_b64_tr_b16 a[208:209], v246 offset:21120
ds_read_b64_tr_b16 a[210:211], v246 offset:21376
ds_read_b64_tr_b16 a[212:213], v246 offset:21152
ds_read_b64_tr_b16 a[214:215], v246 offset:21408
ds_read_b64_tr_b16 a[216:217], v246 offset:21184
ds_read_b64_tr_b16 a[218:219], v246 offset:21440
ds_read_b64_tr_b16 a[220:221], v246 offset:21216
ds_read_b64_tr_b16 a[222:223], v246 offset:21472
s_waitcnt vmcnt(58) lgkmcnt(14)
v_mfma_f32_16x16x32_bf16 v[208:211], a[192:195], a[224:227], 0
s_waitcnt vmcnt(57)
v_mfma_f32_16x16x32_bf16 v[224:227], a[192:195], a[228:231], 0
s_barrier
ds_read_b64_tr_b16 a[192:193], v246 offset:33792
s_mul_i32 s31, s92, 5
s_add_u32 s31, s31, s12
s_add_u32 m0, s96, 50688
s_nop 0
buffer_load_dwordx4 v240, s[68:71], s31 offen offset:0 lds
s_lshl_b32 s99, s19, 11
s_add_u32 s99, s99, 155648
s_waitcnt lgkmcnt(13)
v_mfma_f32_16x16x32_bf16 v[228:231], a[196:199], a[228:231], 0
ds_read_b64_tr_b16 a[194:195], v246 offset:34048
buffer_load_dwordx4 v241, s[68:71], s31 offen offset:1056 lds
v_add_u32 v4, s99, v251
ds_read_b128 a[120:123], v4 offset:0
v_mfma_f32_16x16x32_bf16 v[212:215], a[196:199], a[224:227], 0
ds_read_b64_tr_b16 a[196:197], v246 offset:33824
ds_read_b128 a[124:127], v4 offset:1024
s_waitcnt lgkmcnt(15)
v_mfma_f32_16x16x32_bf16 v[216:219], a[200:203], a[224:227], 0
ds_read_b64_tr_b16 a[198:199], v246 offset:34080
buffer_load_dwordx4 v242, s[68:71], s31 offen offset:2112 lds
v_mfma_f32_16x16x32_bf16 v[232:235], a[200:203], a[228:231], 0
ds_read_b64_tr_b16 a[200:201], v246 offset:33856
buffer_load_dwordx4 v243, s[68:71], s31 offen offset:3168 lds
s_waitcnt lgkmcnt(15)
v_mfma_f32_16x16x32_bf16 v[236:239], a[204:207], a[228:231], 0
ds_read_b64_tr_b16 a[202:203], v246 offset:34112
v_mfma_f32_16x16x32_bf16 v[220:223], a[204:207], a[224:227], 0
ds_read_b64_tr_b16 a[204:205], v246 offset:33888
s_waitcnt lgkmcnt(8)
s_waitcnt vmcnt(60)
v_mfma_f32_16x16x32_bf16 v[208:211], a[208:211], a[232:235], v[208:211]
ds_read_b64_tr_b16 a[206:207], v246 offset:34144
s_mul_i32 s31, s92, 6
s_add_u32 s31, s31, s12
s_add_u32 m0, s96, 67584
s_nop 0
buffer_load_dwordx4 v240, s[68:71], s31 offen offset:0 lds
s_waitcnt vmcnt(60)
v_mfma_f32_16x16x32_bf16 v[224:227], a[208:211], a[236:239], v[224:227]
ds_read_b64_tr_b16 a[208:209], v246 offset:38016
v_lshrrev_b32 v10, 4, v0
v_mfma_f32_16x16x32_bf16 v[228:231], a[212:215], a[236:239], v[228:231]
ds_read_b64_tr_b16 a[210:211], v246 offset:38272
buffer_load_dwordx4 v241, s[68:71], s31 offen offset:1056 lds
v_bfe_u32 v11, v0, 2, 2
v_mfma_f32_16x16x32_bf16 v[212:215], a[212:215], a[232:235], v[212:215]
ds_read_b64_tr_b16 a[212:213], v246 offset:38048
buffer_load_dwordx4 v242, s[68:71], s31 offen offset:2112 lds
v_cmp_eq_u32 s[32:33], v10, v11
v_mfma_f32_16x16x32_bf16 v[216:219], a[216:219], a[232:235], v[216:219]
ds_read_b64_tr_b16 a[214:215], v246 offset:38304
v_mfma_f32_16x16x32_bf16 v[232:235], a[216:219], a[236:239], v[232:235]
ds_read_b64_tr_b16 a[216:217], v246 offset:38080
buffer_load_dwordx4 v243, s[68:71], s31 offen offset:3168 lds
v_and_b32 v10, 1, v0
v_mfma_f32_16x16x32_bf16 v[236:239], a[220:223], a[236:239], v[236:239]
ds_read_b64_tr_b16 a[218:219], v246 offset:38336
v_lshlrev_b32 v10, 4, v10
v_mfma_f32_16x16x32_bf16 v[220:223], a[220:223], a[232:235], v[220:223]
ds_read_b64_tr_b16 a[220:221], v246 offset:38112
s_waitcnt lgkmcnt(8)
s_waitcnt vmcnt(62)
v_mfma_f32_16x16x32_bf16 v[208:211], a[192:195], a[240:243], v[208:211]
ds_read_b64_tr_b16 a[222:223], v246 offset:38368
s_add_u32 s30, s98, 49152
buffer_store_dwordx4 v[156:159], v251, s[76:79], s30 offen offset:2048 sc1
v_mov_b32 v11, 0x3f80
s_waitcnt vmcnt(62)
v_mfma_f32_16x16x32_bf16 v[224:227], a[192:195], a[244:247], v[224:227]
s_barrier
ds_read_b64_tr_b16 a[192:193], v244 offset:0
v_lshlrev_b32 v10, v10, v11
v_mfma_f32_16x16x32_bf16 v[228:231], a[196:199], a[244:247], v[228:231]
ds_read_b64_tr_b16 a[194:195], v244 offset:256
v_cndmask_b32 v10, 0, v10, s[32:33]
v_mfma_f32_16x16x32_bf16 v[212:215], a[196:199], a[240:243], v[212:215]
ds_read_b64_tr_b16 a[196:197], v244 offset:32
v_mfma_f32_16x16x32_bf16 v[216:219], a[200:203], a[240:243], v[216:219]
ds_read_b64_tr_b16 a[198:199], v244 offset:288
v_and_b32 v11, 2, v0
v_mfma_f32_16x16x32_bf16 v[232:235], a[200:203], a[244:247], v[232:235]
ds_read_b64_tr_b16 a[200:201], v244 offset:64
v_cmp_eq_u32 s[32:33], 0, v11
s_waitcnt lgkmcnt(13)
v_mfma_f32_16x16x32_bf16 v[236:239], a[204:207], a[244:247], v[236:239]
ds_read_b64_tr_b16 a[202:203], v244 offset:320
v_mfma_f32_16x16x32_bf16 v[220:223], a[204:207], a[240:243], v[220:223]
ds_read_b64_tr_b16 a[204:205], v244 offset:96
v_mov_b32 v162, 0
s_waitcnt lgkmcnt(8)
s_waitcnt vmcnt(61)
v_mfma_f32_16x16x32_bf16 v[208:211], a[208:211], a[248:251], v[208:211]
ds_read_b64_tr_b16 a[206:207], v244 offset:352
v_mov_b32 v163, 0
s_waitcnt vmcnt(60)
v_mfma_f32_16x16x32_bf16 v[224:227], a[208:211], a[252:255], v[224:227]
ds_read_b64_tr_b16 a[208:209], v244 offset:4224
v_mov_b32 v1, s8
s_lshl_b32 s100, s2, 5
s_add_u32 s100, s100, s3
s_lshl_b32 s100, s100, 2
s_add_u32 s100, s100, 131120
s_waitcnt vmcnt(20)
s_mov_b64 exec, 1
buffer_store_dword v1, off, s[76:79], s100 sc1
s_mov_b64 exec, -1
v_mov_b32 v164, 0
v_mfma_f32_16x16x32_bf16 v[228:231], a[212:215], a[252:255], v[228:231]
ds_read_b64_tr_b16 a[210:211], v244 offset:4480
v_mfma_f32_16x16x32_bf16 v[212:215], a[212:215], a[248:251], v[212:215]
ds_read_b64_tr_b16 a[212:213], v244 offset:4256
s_add_u32 s30, s98, 0
buffer_store_dwordx4 v[176:179], v251, s[76:79], s30 offen offset:3072 sc1
v_mov_b32 v165, 0
v_mfma_f32_16x16x32_bf16 v[216:219], a[216:219], a[248:251], v[216:219]
ds_read_b64_tr_b16 a[214:215], v244 offset:4512
v_cndmask_b32 v160, 0, v10, s[32:33]
v_mfma_f32_16x16x32_bf16 v[232:235], a[216:219], a[252:255], v[232:235]
ds_read_b64_tr_b16 a[216:217], v244 offset:4288
s_waitcnt lgkmcnt(13)
v_mfma_f32_16x16x32_bf16 v[236:239], a[220:223], a[252:255], v[236:239]
ds_read_b64_tr_b16 a[218:219], v244 offset:4544
v_cndmask_b32 v161, v10, 0, s[32:33]
v_mfma_f32_16x16x32_bf16 v[220:223], a[220:223], a[248:251], v[220:223]
ds_read_b64_tr_b16 a[220:221], v244 offset:4320
v_mov_b32 v166, v160
s_waitcnt lgkmcnt(8)
v_mfma_f32_16x16x32_bf16 v[208:211], a[192:195], v[16:19], v[208:211]
ds_read_b64_tr_b16 a[222:223], v244 offset:4576
v_mov_b32 v167, v161
v_mfma_f32_16x16x32_bf16 v[224:227], a[192:195], v[24:27], v[224:227]
s_barrier
ds_read_b64_tr_b16 a[192:193], v244 offset:16896
v_mfma_f32_16x16x32_bf16 v[228:231], a[196:199], v[24:27], v[228:231]
ds_read_b64_tr_b16 a[194:195], v244 offset:17152
v_add_u32 v8, s96, v251
v_mfma_f32_16x16x32_bf16 v[212:215], a[196:199], v[16:19], v[212:215]
ds_read_b64_tr_b16 a[196:197], v244 offset:16928
s_xor_b32 s28, s3, 2
v_mfma_f32_16x16x32_bf16 v[216:219], a[200:203], v[16:19], v[216:219]
ds_read_b64_tr_b16 a[198:199], v244 offset:17184
v_mfma_f32_16x16x32_bf16 v[232:235], a[200:203], v[24:27], v[232:235]
ds_read_b64_tr_b16 a[200:201], v244 offset:16960
s_mul_i32 s28, s28, 4224
s_waitcnt lgkmcnt(13)
v_mfma_f32_16x16x32_bf16 v[236:239], a[204:207], v[24:27], v[236:239]
ds_read_b64_tr_b16 a[202:203], v244 offset:17216
v_add_u32 v9, s28, v251
v_mfma_f32_16x16x32_bf16 v[220:223], a[204:207], v[16:19], v[220:223]
ds_read_b64_tr_b16 a[204:205], v244 offset:16992
s_add_u32 s30, s98, 16384
buffer_store_dwordx4 v[180:183], v251, s[76:79], s30 offen offset:3072 sc1
s_waitcnt lgkmcnt(8)
v_mfma_f32_16x16x32_bf16 v[208:211], a[208:211], v[32:35], v[208:211]
ds_read_b64_tr_b16 a[206:207], v244 offset:17248
v_mfma_f32_16x16x32_bf16 v[224:227], a[208:211], v[40:43], v[224:227]
ds_read_b64_tr_b16 a[208:209], v244 offset:21120
v_mfma_f32_16x16x32_bf16 v[228:231], a[212:215], v[40:43], v[228:231]
ds_read_b64_tr_b16 a[210:211], v244 offset:21376
v_mfma_f32_16x16x32_bf16 v[212:215], a[212:215], v[32:35], v[212:215]
ds_read_b64_tr_b16 a[212:213], v244 offset:21152
v_mfma_f32_16x16x32_bf16 v[216:219], a[216:219], v[32:35], v[216:219]
ds_read_b64_tr_b16 a[214:215], v244 offset:21408
v_mfma_f32_16x16x32_bf16 v[232:235], a[216:219], v[40:43], v[232:235]
ds_read_b64_tr_b16 a[216:217], v244 offset:21184
s_waitcnt lgkmcnt(13)
v_mfma_f32_16x16x32_bf16 v[236:239], a[220:223], v[40:43], v[236:239]
ds_read_b64_tr_b16 a[218:219], v244 offset:21440
v_mfma_f32_16x16x32_bf16 v[220:223], a[220:223], v[32:35], v[220:223]
ds_read_b64_tr_b16 a[220:221], v244 offset:21216
s_waitcnt lgkmcnt(8)
v_mfma_f32_16x16x32_bf16 v[208:211], a[192:195], v[48:51], v[208:211]
ds_read_b64_tr_b16 a[222:223], v244 offset:21472
v_mfma_f32_16x16x32_bf16 v[224:227], a[192:195], v[56:59], v[224:227]
s_barrier
ds_read_b64_tr_b16 a[192:193], v244 offset:33792
v_mfma_f32_16x16x32_bf16 v[228:231], a[196:199], v[56:59], v[228:231]
ds_read_b64_tr_b16 a[194:195], v244 offset:34048
s_add_u32 s30, s98, 32768
buffer_store_dwordx4 v[184:187], v251, s[76:79], s30 offen offset:3072 sc1
v_mfma_f32_16x16x32_bf16 v[212:215], a[196:199], v[48:51], v[212:215]
ds_read_b64_tr_b16 a[196:197], v244 offset:33824
v_mfma_f32_16x16x32_bf16 v[216:219], a[200:203], v[48:51], v[216:219]
ds_read_b64_tr_b16 a[198:199], v244 offset:34080
v_mfma_f32_16x16x32_bf16 v[232:235], a[200:203], v[56:59], v[232:235]
ds_read_b64_tr_b16 a[200:201], v244 offset:33856
s_waitcnt lgkmcnt(13)
v_mfma_f32_16x16x32_bf16 v[236:239], a[204:207], v[56:59], v[236:239]
ds_read_b64_tr_b16 a[202:203], v244 offset:34112
v_mfma_f32_16x16x32_bf16 v[220:223], a[204:207], v[48:51], v[220:223]
ds_read_b64_tr_b16 a[204:205], v244 offset:33888
s_waitcnt lgkmcnt(8)
v_mfma_f32_16x16x32_bf16 v[208:211], a[208:211], v[64:67], v[208:211]
ds_read_b64_tr_b16 a[206:207], v244 offset:34144
v_mfma_f32_16x16x32_bf16 v[224:227], a[208:211], v[72:75], v[224:227]
ds_read_b64_tr_b16 a[208:209], v244 offset:38016
v_mfma_f32_16x16x32_bf16 v[228:231], a[212:215], v[72:75], v[228:231]
ds_read_b64_tr_b16 a[210:211], v244 offset:38272
v_mfma_f32_16x16x32_bf16 v[212:215], a[212:215], v[64:67], v[212:215]
ds_read_b64_tr_b16 a[212:213], v244 offset:38048
v_mfma_f32_16x16x32_bf16 v[216:219], a[216:219], v[64:67], v[216:219]
ds_read_b64_tr_b16 a[214:215], v244 offset:38304
v_mfma_f32_16x16x32_bf16 v[232:235], a[216:219], v[72:75], v[232:235]
ds_read_b64_tr_b16 a[216:217], v244 offset:38080
s_add_u32 s30, s98, 49152
buffer_store_dwordx4 v[188:191], v251, s[76:79], s30 offen offset:3072 sc1
s_waitcnt lgkmcnt(13)
v_mfma_f32_16x16x32_bf16 v[236:239], a[220:223], v[72:75], v[236:239]
ds_read_b64_tr_b16 a[218:219], v244 offset:38336
v_mfma_f32_16x16x32_bf16 v[220:223], a[220:223], v[64:67], v[220:223]
ds_read_b64_tr_b16 a[220:221], v244 offset:38112
s_waitcnt lgkmcnt(8)
v_mfma_f32_16x16x32_bf16 v[208:211], a[192:195], v[80:83], v[208:211]
ds_read_b64_tr_b16 a[222:223], v244 offset:38368
v_mfma_f32_16x16x32_bf16 v[224:227], a[192:195], v[88:91], v[224:227]
s_waitcnt vmcnt(10)
s_barrier
ds_read_b64_tr_b16 a[192:193], v245 offset:0
v_mfma_f32_16x16x32_bf16 v[228:231], a[196:199], v[88:91], v[228:231]
ds_read_b64_tr_b16 a[194:195], v245 offset:256
v_mfma_f32_16x16x32_bf16 v[212:215], a[196:199], v[80:83], v[212:215]
ds_read_b64_tr_b16 a[196:197], v245 offset:32
v_mfma_f32_16x16x32_bf16 v[216:219], a[200:203], v[80:83], v[216:219]
ds_read_b64_tr_b16 a[198:199], v245 offset:288
v_mfma_f32_16x16x32_bf16 v[232:235], a[200:203], v[88:91], v[232:235]
ds_read_b64_tr_b16 a[200:201], v245 offset:64
s_waitcnt lgkmcnt(13)
v_mfma_f32_16x16x32_bf16 v[236:239], a[204:207], v[88:91], v[236:239]
ds_read_b64_tr_b16 a[202:203], v245 offset:320
v_mfma_f32_16x16x32_bf16 v[220:223], a[204:207], v[80:83], v[220:223]
ds_read_b64_tr_b16 a[204:205], v245 offset:96
s_waitcnt lgkmcnt(8)
v_mfma_f32_16x16x32_bf16 v[208:211], a[208:211], v[96:99], v[208:211]
ds_read_b64_tr_b16 a[206:207], v245 offset:352
v_mfma_f32_16x16x32_bf16 v[224:227], a[208:211], v[104:107], v[224:227]
ds_read_b64_tr_b16 a[208:209], v245 offset:4224
s_lshl_b32 s90, s17, 2
s_add_u32 s90, s90, s19
s_lshl_b32 s90, s90, 14
s_lshl_b32 s88, s18, 7
s_add_u32 s91, s90, s88
s_lshl_b32 s88, s18, 11
s_add_u32 s90, s90, s88
s_add_u32 s88, s90, 4194304
buffer_load_dwordx4 v[168:171], v251, s[76:79], s88 offen offset:0 sc1
v_mfma_f32_16x16x32_bf16 v[228:231], a[212:215], v[104:107], v[228:231]
ds_read_b64_tr_b16 a[210:211], v245 offset:4480
buffer_load_dwordx4 v[172:175], v251, s[76:79], s88 offen offset:1024 sc1
v_mfma_f32_16x16x32_bf16 v[212:215], a[212:215], v[96:99], v[212:215]
ds_read_b64_tr_b16 a[212:213], v245 offset:4256
v_lshrrev_b32 v10, 4, v0
v_xor_b32 v10, v10, v0
v_and_b32 v10, 7, v10
v_lshlrev_b32 v10, 4, v10
v_lshrrev_b32 v2, 3, v0
v_lshl_add_u32 v2, v2, 10, v10
v_xor_b32 v3, 64, v2
v_add_u32 v3, 7168, v3
s_lshl_b32 s99, s19, 11
v_mfma_f32_16x16x32_bf16 v[216:219], a[216:219], v[96:99], v[216:219]
ds_read_b64_tr_b16 a[214:215], v245 offset:4512
s_add_u32 s99, s99, 155648
s_mov_b32 m0, s99
s_nop 0
buffer_load_dwordx4 v2, s[36:39], s91 offen lds
v_mfma_f32_16x16x32_bf16 v[232:235], a[216:219], v[104:107], v[232:235]
ds_read_b64_tr_b16 a[216:217], v245 offset:4288
buffer_load_dwordx4 v3, s[36:39], s91 offen offset:1024 lds
v_and_b32 v10, 15, v0
s_waitcnt lgkmcnt(13)
v_mfma_f32_16x16x32_bf16 v[236:239], a[220:223], v[104:107], v[236:239]
ds_read_b64_tr_b16 a[218:219], v245 offset:4544
v_lshrrev_b32 v11, 1, v10
v_lshlrev_b32 v10, 7, v10
v_lshrrev_b32 v4, 5, v0
v_xor_b32 v11, v11, v4
v_lshl_add_u32 v10, v11, 4, v10
v_bfe_u32 v11, v0, 4, 1
v_lshl_add_u32 v10, v11, 3, v10
v_add_u32 v4, s99, v10
v_xor_b32 v5, 32, v4
v_xor_b32 v6, 64, v4
v_xor_b32 v7, 0x60, v4
v_mfma_f32_16x16x32_bf16 v[220:223], a[220:223], v[96:99], v[220:223]
ds_read_b64_tr_b16 a[220:221], v245 offset:4320
s_waitcnt lgkmcnt(8)
v_mfma_f32_16x16x32_bf16 v[208:211], a[192:195], v[112:115], v[208:211]
ds_read_b64_tr_b16 a[222:223], v245 offset:4576
s_mul_i32 s31, s92, 7
s_add_u32 s31, s31, s12
s_add_u32 m0, s96, 84480
s_nop 0
buffer_load_dwordx4 v240, s[68:71], s31 offen offset:0 lds
v_mfma_f32_16x16x32_bf16 v[224:227], a[192:195], v[120:123], v[224:227]
s_waitcnt vmcnt(11)
s_barrier
ds_read_b64_tr_b16 a[192:193], v245 offset:16896
v_mfma_f32_16x16x32_bf16 v[228:231], a[196:199], v[120:123], v[228:231]
ds_read_b64_tr_b16 a[194:195], v245 offset:17152
buffer_load_dwordx4 v241, s[68:71], s31 offen offset:1056 lds
v_mfma_f32_16x16x32_bf16 v[212:215], a[196:199], v[112:115], v[212:215]
ds_read_b64_tr_b16 a[196:197], v245 offset:16928
buffer_load_dwordx4 v242, s[68:71], s31 offen offset:2112 lds
v_mfma_f32_16x16x32_bf16 v[216:219], a[200:203], v[112:115], v[216:219]
ds_read_b64_tr_b16 a[198:199], v245 offset:17184
v_mfma_f32_16x16x32_bf16 v[232:235], a[200:203], v[120:123], v[232:235]
ds_read_b64_tr_b16 a[200:201], v245 offset:16960
buffer_load_dwordx4 v243, s[68:71], s31 offen offset:3168 lds
v_mov_b32 v1, s8
s_lshl_b32 s100, s2, 5
s_add_u32 s100, s100, s3
s_lshl_b32 s100, s100, 2
s_add_u32 s100, s100, 131152
s_waitcnt vmcnt(8)
s_mov_b64 exec, 1
buffer_store_dword v1, off, s[76:79], s100 sc1
s_mov_b64 exec, -1
s_waitcnt lgkmcnt(13)
v_mfma_f32_16x16x32_bf16 v[236:239], a[204:207], v[120:123], v[236:239]
ds_read_b64_tr_b16 a[202:203], v245 offset:17216
v_mfma_f32_16x16x32_bf16 v[220:223], a[204:207], v[112:115], v[220:223]
ds_read_b64_tr_b16 a[204:205], v245 offset:16992
s_waitcnt lgkmcnt(8)
v_mfma_f32_16x16x32_bf16 v[208:211], a[208:211], v[128:131], v[208:211]
ds_read_b64_tr_b16 a[206:207], v245 offset:17248
s_mul_i32 s31, s92, 8
s_add_u32 s31, s31, s12
s_add_u32 m0, s96, 101376
s_nop 0
buffer_load_dwordx4 v240, s[68:71], s31 offen offset:0 lds
v_mfma_f32_16x16x32_bf16 v[224:227], a[208:211], v[136:139], v[224:227]
ds_read_b64_tr_b16 a[208:209], v245 offset:21120
buffer_load_dwordx4 v241, s[68:71], s31 offen offset:1056 lds
v_mfma_f32_16x16x32_bf16 v[228:231], a[212:215], v[136:139], v[228:231]
ds_read_b64_tr_b16 a[210:211], v245 offset:21376
v_mfma_f32_16x16x32_bf16 v[212:215], a[212:215], v[128:131], v[212:215]
ds_read_b64_tr_b16 a[212:213], v245 offset:21152
buffer_load_dwordx4 v242, s[68:71], s31 offen offset:2112 lds
v_mfma_f32_16x16x32_bf16 v[216:219], a[216:219], v[128:131], v[216:219]
ds_read_b64_tr_b16 a[214:215], v245 offset:21408
buffer_load_dwordx4 v243, s[68:71], s31 offen offset:3168 lds
v_mfma_f32_16x16x32_bf16 v[232:235], a[216:219], v[136:139], v[232:235]
ds_read_b64_tr_b16 a[216:217], v245 offset:21184
s_waitcnt lgkmcnt(13)
v_mfma_f32_16x16x32_bf16 v[236:239], a[220:223], v[136:139], v[236:239]
ds_read_b64_tr_b16 a[218:219], v245 offset:21440
v_mfma_f32_16x16x32_bf16 v[220:223], a[220:223], v[128:131], v[220:223]
ds_read_b64_tr_b16 a[220:221], v245 offset:21216
s_mul_i32 s31, s92, 9
s_add_u32 s31, s31, s12
s_add_u32 m0, s96, 118272
s_nop 0
buffer_load_dwordx4 v240, s[68:71], s31 offen offset:0 lds
s_waitcnt lgkmcnt(8)
v_mfma_f32_16x16x32_bf16 v[208:211], a[192:195], a[128:131], v[208:211]
ds_read_b64_tr_b16 a[222:223], v245 offset:21472
v_mfma_f32_16x16x32_bf16 v[224:227], a[192:195], a[132:135], v[224:227]
s_waitcnt vmcnt(6)
s_barrier
ds_read_b64_tr_b16 a[192:193], v245 offset:33792
buffer_load_dwordx4 v241, s[68:71], s31 offen offset:1056 lds
v_mfma_f32_16x16x32_bf16 v[228:231], a[196:199], a[132:135], v[228:231]
ds_read_b64_tr_b16 a[194:195], v245 offset:34048
buffer_load_dwordx4 v242, s[68:71], s31 offen offset:2112 lds
v_mfma_f32_16x16x32_bf16 v[212:215], a[196:199], a[128:131], v[212:215]
ds_read_b64_tr_b16 a[196:197], v245 offset:33824
v_mfma_f32_16x16x32_bf16 v[216:219], a[200:203], a[128:131], v[216:219]
ds_read_b64_tr_b16 a[198:199], v245 offset:34080
buffer_load_dwordx4 v243, s[68:71], s31 offen offset:3168 lds
v_mfma_f32_16x16x32_bf16 v[232:235], a[200:203], a[132:135], v[232:235]
ds_read_b64_tr_b16 a[200:201], v245 offset:33856
s_waitcnt lgkmcnt(13)
v_mfma_f32_16x16x32_bf16 v[236:239], a[204:207], a[132:135], v[236:239]
ds_read_b64_tr_b16 a[202:203], v245 offset:34112
v_mfma_f32_16x16x32_bf16 v[220:223], a[204:207], a[128:131], v[220:223]
ds_read_b64_tr_b16 a[204:205], v245 offset:33888
s_mul_i32 s31, s92, 10
s_add_u32 s31, s31, s12
s_add_u32 m0, s96, 135168
s_nop 0
buffer_load_dwordx4 v240, s[68:71], s31 offen offset:0 lds
s_waitcnt lgkmcnt(8)
v_mfma_f32_16x16x32_bf16 v[208:211], a[208:211], a[136:139], v[208:211]
ds_read_b64_tr_b16 a[206:207], v245 offset:34144
v_mfma_f32_16x16x32_bf16 v[224:227], a[208:211], a[140:143], v[224:227]
ds_read_b64_tr_b16 a[208:209], v245 offset:38016
buffer_load_dwordx4 v241, s[68:71], s31 offen offset:1056 lds
v_mfma_f32_16x16x32_bf16 v[228:231], a[212:215], a[140:143], v[228:231]
ds_read_b64_tr_b16 a[210:211], v245 offset:38272
buffer_load_dwordx4 v242, s[68:71], s31 offen offset:2112 lds
v_mfma_f32_16x16x32_bf16 v[212:215], a[212:215], a[136:139], v[212:215]
ds_read_b64_tr_b16 a[212:213], v245 offset:38048
v_mfma_f32_16x16x32_bf16 v[216:219], a[216:219], a[136:139], v[216:219]
ds_read_b64_tr_b16 a[214:215], v245 offset:38304
buffer_load_dwordx4 v243, s[68:71], s31 offen offset:3168 lds
v_mfma_f32_16x16x32_bf16 v[232:235], a[216:219], a[140:143], v[232:235]
ds_read_b64_tr_b16 a[216:217], v245 offset:38080
s_waitcnt lgkmcnt(13)
v_mfma_f32_16x16x32_bf16 v[236:239], a[220:223], a[140:143], v[236:239]
ds_read_b64_tr_b16 a[218:219], v245 offset:38336
v_mfma_f32_16x16x32_bf16 v[220:223], a[220:223], a[136:139], v[220:223]
ds_read_b64_tr_b16 a[220:221], v245 offset:38112
s_add_u32 s20, s20, 4096
s_add_u32 s93, s93, 4096
buffer_load_dwordx4 a[0:3], v251, s[76:79], s20 offen offset:0 sc1
s_waitcnt lgkmcnt(8)
v_mfma_f32_16x16x32_bf16 v[208:211], a[192:195], a[144:147], v[208:211]
ds_read_b64_tr_b16 a[222:223], v245 offset:38368
buffer_load_dwordx4 a[4:7], v251, s[76:79], s93 offen offset:0 sc1
v_mfma_f32_16x16x32_bf16 v[224:227], a[192:195], a[148:151], v[224:227]
s_waitcnt vmcnt(10)
s_barrier
ds_read_b64_tr_b16 a[192:193], v246 offset:0
v_mfma_f32_16x16x32_bf16 v[228:231], a[196:199], a[148:151], v[228:231]
ds_read_b64_tr_b16 a[194:195], v246 offset:256
buffer_load_dwordx4 a[8:11], v251, s[76:79], s20 offen offset:1024 sc1
v_mfma_f32_16x16x32_bf16 v[212:215], a[196:199], a[144:147], v[212:215]
ds_read_b64_tr_b16 a[196:197], v246 offset:32
buffer_load_dwordx4 a[12:15], v251, s[76:79], s93 offen offset:1024 sc1
v_mfma_f32_16x16x32_bf16 v[216:219], a[200:203], a[144:147], v[216:219]
ds_read_b64_tr_b16 a[198:199], v246 offset:288
v_mfma_f32_16x16x32_bf16 v[232:235], a[200:203], a[148:151], v[232:235]
ds_read_b64_tr_b16 a[200:201], v246 offset:64
s_waitcnt lgkmcnt(13)
v_mfma_f32_16x16x32_bf16 v[236:239], a[204:207], a[148:151], v[236:239]
ds_read_b64_tr_b16 a[202:203], v246 offset:320
v_mfma_f32_16x16x32_bf16 v[220:223], a[204:207], a[144:147], v[220:223]
ds_read_b64_tr_b16 a[204:205], v246 offset:96
s_waitcnt lgkmcnt(8)
v_mfma_f32_16x16x32_bf16 v[208:211], a[208:211], a[152:155], v[208:211]
ds_read_b64_tr_b16 a[206:207], v246 offset:352
v_mfma_f32_16x16x32_bf16 v[224:227], a[208:211], a[156:159], v[224:227]
ds_read_b64_tr_b16 a[208:209], v246 offset:4224
v_mfma_f32_16x16x32_bf16 v[228:231], a[212:215], a[156:159], v[228:231]
ds_read_b64_tr_b16 a[210:211], v246 offset:4480
v_mfma_f32_16x16x32_bf16 v[212:215], a[212:215], a[152:155], v[212:215]
ds_read_b64_tr_b16 a[212:213], v246 offset:4256
v_mfma_f32_16x16x32_bf16 v[216:219], a[216:219], a[152:155], v[216:219]
ds_read_b64_tr_b16 a[214:215], v246 offset:4512
v_mfma_f32_16x16x32_bf16 v[232:235], a[216:219], a[156:159], v[232:235]
ds_read_b64_tr_b16 a[216:217], v246 offset:4288
s_waitcnt lgkmcnt(13)
v_mfma_f32_16x16x32_bf16 v[236:239], a[220:223], a[156:159], v[236:239]
ds_read_b64_tr_b16 a[218:219], v246 offset:4544
v_mfma_f32_16x16x32_bf16 v[220:223], a[220:223], a[152:155], v[220:223]
ds_read_b64_tr_b16 a[220:221], v246 offset:4320
s_waitcnt lgkmcnt(8)
v_mfma_f32_16x16x32_bf16 v[208:211], a[192:195], a[160:163], v[208:211]
ds_read_b64_tr_b16 a[222:223], v246 offset:4576
v_mfma_f32_16x16x32_bf16 v[224:227], a[192:195], a[164:167], v[224:227]
s_waitcnt vmcnt(8)
s_barrier
ds_read_b64_tr_b16 a[192:193], v246 offset:16896
v_mfma_f32_16x16x32_bf16 v[228:231], a[196:199], a[164:167], v[228:231]
ds_read_b64_tr_b16 a[194:195], v246 offset:17152
v_mfma_f32_16x16x32_bf16 v[212:215], a[196:199], a[160:163], v[212:215]
ds_read_b64_tr_b16 a[196:197], v246 offset:16928
v_mfma_f32_16x16x32_bf16 v[216:219], a[200:203], a[160:163], v[216:219]
ds_read_b64_tr_b16 a[198:199], v246 offset:17184
v_mfma_f32_16x16x32_bf16 v[232:235], a[200:203], a[164:167], v[232:235]
ds_read_b64_tr_b16 a[200:201], v246 offset:16960
s_waitcnt lgkmcnt(13)
v_mfma_f32_16x16x32_bf16 v[236:239], a[204:207], a[164:167], v[236:239]
ds_read_b64_tr_b16 a[202:203], v246 offset:17216
v_mfma_f32_16x16x32_bf16 v[220:223], a[204:207], a[160:163], v[220:223]
ds_read_b64_tr_b16 a[204:205], v246 offset:16992
s_waitcnt lgkmcnt(8)
v_mfma_f32_16x16x32_bf16 v[208:211], a[208:211], a[168:171], v[208:211]
ds_read_b64_tr_b16 a[206:207], v246 offset:17248
v_mfma_f32_16x16x32_bf16 v[224:227], a[208:211], a[172:175], v[224:227]
ds_read_b64_tr_b16 a[208:209], v246 offset:21120
v_mfma_f32_16x16x32_bf16 v[228:231], a[212:215], a[172:175], v[228:231]
ds_read_b64_tr_b16 a[210:211], v246 offset:21376
v_mfma_f32_16x16x32_bf16 v[212:215], a[212:215], a[168:171], v[212:215]
ds_read_b64_tr_b16 a[212:213], v246 offset:21152
v_mfma_f32_16x16x32_bf16 v[216:219], a[216:219], a[168:171], v[216:219]
ds_read_b64_tr_b16 a[214:215], v246 offset:21408
v_mfma_f32_16x16x32_bf16 v[232:235], a[216:219], a[172:175], v[232:235]
ds_read_b64_tr_b16 a[216:217], v246 offset:21184
s_waitcnt lgkmcnt(13)
v_mfma_f32_16x16x32_bf16 v[236:239], a[220:223], a[172:175], v[236:239]
ds_read_b64_tr_b16 a[218:219], v246 offset:21440
v_mfma_f32_16x16x32_bf16 v[220:223], a[220:223], a[168:171], v[220:223]
ds_read_b64_tr_b16 a[220:221], v246 offset:21216
s_waitcnt lgkmcnt(8)
v_mfma_f32_16x16x32_bf16 v[208:211], a[192:195], a[176:179], v[208:211]
ds_read_b64_tr_b16 a[222:223], v246 offset:21472
v_mfma_f32_16x16x32_bf16 v[224:227], a[192:195], a[180:183], v[224:227]
s_waitcnt vmcnt(4)
s_barrier
ds_read_b64_tr_b16 a[192:193], v246 offset:33792
v_mfma_f32_16x16x32_bf16 v[228:231], a[196:199], a[180:183], v[228:231]
ds_read_b64_tr_b16 a[194:195], v246 offset:34048
v_mfma_f32_16x16x32_bf16 v[212:215], a[196:199], a[176:179], v[212:215]
ds_read_b64_tr_b16 a[196:197], v246 offset:33824
v_mfma_f32_16x16x32_bf16 v[216:219], a[200:203], a[176:179], v[216:219]
ds_read_b64_tr_b16 a[198:199], v246 offset:34080
v_mfma_f32_16x16x32_bf16 v[232:235], a[200:203], a[180:183], v[232:235]
ds_read_b64_tr_b16 a[200:201], v246 offset:33856
s_waitcnt lgkmcnt(13)
v_mfma_f32_16x16x32_bf16 v[236:239], a[204:207], a[180:183], v[236:239]
ds_read_b64_tr_b16 a[202:203], v246 offset:34112
v_mfma_f32_16x16x32_bf16 v[220:223], a[204:207], a[176:179], v[220:223]
ds_read_b64_tr_b16 a[204:205], v246 offset:33888
s_waitcnt lgkmcnt(8)
v_mfma_f32_16x16x32_bf16 v[208:211], a[208:211], a[184:187], v[208:211]
ds_read_b64_tr_b16 a[206:207], v246 offset:34144
v_mfma_f32_16x16x32_bf16 v[224:227], a[208:211], a[188:191], v[224:227]
ds_read_b64_tr_b16 a[208:209], v246 offset:38016
s_lshl_b32 s88, s4, 2
s_lshr_b32 s89, s18, 1
s_xor_b32 s89, s89, 0
s_add_u32 s88, s88, s89
s_lshl_b32 s88, s88, 3
v_mfma_f32_16x16x32_bf16 v[228:231], a[212:215], a[188:191], v[228:231]
ds_read_b64_tr_b16 a[210:211], v246 offset:38272
v_and_b32 v14, 7, v0
v_add_u32 v14, s88, v14
s_and_b32 s89, s17, 3
s_lshl_b32 s89, s89, 2
s_and_b32 s88, s18, 1
v_mfma_f32_16x16x32_bf16 v[212:215], a[212:215], a[184:187], v[212:215]
ds_read_b64_tr_b16 a[212:213], v246 offset:38048
s_mul_i32 s88, s88, 32
s_add_u32 s89, s89, s88
v_mov_b32 v15, s89
v_lshrrev_b32 v252, 4, v14
v_mfma_f32_16x16x32_bf16 v[216:219], a[216:219], a[184:187], v[216:219]
ds_read_b64_tr_b16 a[214:215], v246 offset:38304
v_and_b32 v252, 12, v252
buffer_load_dword v252, v252, s[84:87], 0 offen sc1
v_mfma_f32_16x16x32_bf16 v[232:235], a[216:219], a[188:191], v[232:235]
ds_read_b64_tr_b16 a[216:217], v246 offset:38080
s_waitcnt lgkmcnt(13)
v_mfma_f32_16x16x32_bf16 v[236:239], a[220:223], a[188:191], v[236:239]
ds_read_b64_tr_b16 a[218:219], v246 offset:38336
v_lshl_add_u32 v14, v14, 7, v15
buffer_load_dword v15, v14, s[76:79], s24 offen offset:48 sc1
v_mfma_f32_16x16x32_bf16 v[220:223], a[220:223], a[184:187], v[220:223]
ds_read_b64_tr_b16 a[220:221], v246 offset:38112
s_waitcnt lgkmcnt(8)
s_waitcnt vmcnt(5)
v_mfma_f32_16x16x32_bf16 v[208:211], a[192:195], a[0:3], v[208:211]
ds_read_b64_tr_b16 a[222:223], v246 offset:38368
s_waitcnt vmcnt(4)
v_mfma_f32_16x16x32_bf16 v[224:227], a[192:195], a[4:7], v[224:227]
v_mfma_f32_16x16x32_bf16 v[228:231], a[196:199], a[4:7], v[228:231]
v_mfma_f32_16x16x32_bf16 v[212:215], a[196:199], a[0:3], v[212:215]
v_mfma_f32_16x16x32_bf16 v[216:219], a[200:203], a[0:3], v[216:219]
v_mfma_f32_16x16x32_bf16 v[232:235], a[200:203], a[4:7], v[232:235]
s_waitcnt lgkmcnt(8)
v_mfma_f32_16x16x32_bf16 v[236:239], a[204:207], a[4:7], v[236:239]
v_mfma_f32_16x16x32_bf16 v[220:223], a[204:207], a[0:3], v[220:223]
s_waitcnt vmcnt(3) lgkmcnt(6)
v_mfma_f32_16x16x32_bf16 v[208:211], a[208:211], a[8:11], v[208:211]
s_waitcnt vmcnt(2)
v_mfma_f32_16x16x32_bf16 v[224:227], a[208:211], a[12:15], v[224:227]
s_waitcnt lgkmcnt(4)
v_mfma_f32_16x16x32_bf16 v[228:231], a[212:215], a[12:15], v[228:231]
v_mfma_f32_16x16x32_bf16 v[212:215], a[212:215], a[8:11], v[212:215]
s_waitcnt lgkmcnt(2)
v_mfma_f32_16x16x32_bf16 v[216:219], a[216:219], a[8:11], v[216:219]
v_mfma_f32_16x16x32_bf16 v[232:235], a[216:219], a[12:15], v[232:235]
s_waitcnt lgkmcnt(0)
v_mfma_f32_16x16x32_bf16 v[236:239], a[220:223], a[12:15], v[236:239]
v_mfma_f32_16x16x32_bf16 v[220:223], a[220:223], a[8:11], v[220:223]
ds_write_b128 v8, v[224:227] offset:0
s_waitcnt vmcnt(0)
v_cmp_ne_u32 vcc, v252, v15
s_cbranch_vccnz reslow_75
reback_76:
s_add_u32 s29, s90, 33554432
s_lshl_b32 s28, s6, 21
s_add_u32 s28, s28, 2097152
s_and_b32 s28, s28, 14680064
s_add_u32 s30, s29, s28
buffer_load_dwordx4 a[64:67], v251, s[76:79], s30 offen offset:0 sc1
buffer_load_dwordx4 a[68:71], v251, s[76:79], s30 offen offset:1024 sc1
ds_write_b128 v8, v[228:231] offset:1024
s_add_u32 s28, s28, 2097152
s_and_b32 s28, s28, 14680064
s_add_u32 s30, s29, s28
buffer_load_dwordx4 a[72:75], v251, s[76:79], s30 offen offset:0 sc1
buffer_load_dwordx4 a[76:79], v251, s[76:79], s30 offen offset:1024 sc1
ds_write_b128 v8, v[232:235] offset:2048
s_add_u32 s28, s28, 2097152
s_and_b32 s28, s28, 14680064
s_add_u32 s30, s29, s28
buffer_load_dwordx4 a[80:83], v251, s[76:79], s30 offen offset:0 sc1
ds_write_b128 v8, v[236:239] offset:3072
buffer_load_dwordx4 a[84:87], v251, s[76:79], s30 offen offset:1024 sc1
s_add_u32 s28, s28, 2097152
s_and_b32 s28, s28, 14680064
s_add_u32 s30, s29, s28
buffer_load_dwordx4 a[88:91], v251, s[76:79], s30 offen offset:0 sc1
v_mfma_f32_16x16x32_bf16 v[208:211], v[160:163], v[168:171], v[208:211]
v_mfma_f32_16x16x32_bf16 v[212:215], v[164:167], v[168:171], v[212:215]
v_mfma_f32_16x16x32_bf16 v[216:219], v[160:163], v[172:175], v[216:219]
v_mfma_f32_16x16x32_bf16 v[220:223], v[164:167], v[172:175], v[220:223]
s_waitcnt lgkmcnt(0)
s_barrier
ds_read_b128 v[192:195], v9 offset:0
buffer_load_dwordx4 a[92:95], v251, s[76:79], s30 offen offset:1024 sc1
s_add_u32 s28, s28, 2097152
s_and_b32 s28, s28, 14680064
s_add_u32 s30, s29, s28
buffer_load_dwordx4 a[96:99], v251, s[76:79], s30 offen offset:0 sc1
ds_read_b128 v[196:199], v9 offset:1024
buffer_load_dwordx4 a[100:103], v251, s[76:79], s30 offen offset:1024 sc1
s_add_u32 s28, s28, 2097152
s_and_b32 s28, s28, 14680064
s_add_u32 s30, s29, s28
buffer_load_dwordx4 a[104:107], v251, s[76:79], s30 offen offset:0 sc1
ds_read_b128 v[200:203], v9 offset:2048
buffer_load_dwordx4 a[108:111], v251, s[76:79], s30 offen offset:1024 sc1
s_add_u32 s28, s28, 2097152
s_and_b32 s28, s28, 14680064
ds_read_b128 v[204:207], v9 offset:3072
s_add_u32 s30, s29, s28
buffer_load_dwordx4 a[112:115], v251, s[76:79], s30 offen offset:0 sc1
buffer_load_dwordx4 a[116:119], v251, s[76:79], s30 offen offset:1024 sc1
ds_read_b64 v[16:17], v4
ds_read_b64 v[18:19], v5
ds_read_b64 v[24:25], v6
ds_read_b64 v[26:27], v7
s_waitcnt lgkmcnt(7)
v_pk_add_f32 v[208:209], v[208:209], v[192:193]
v_pk_add_f32 v[210:211], v[210:211], v[194:195]
s_waitcnt lgkmcnt(6)
v_pk_add_f32 v[212:213], v[212:213], v[196:197]
v_pk_add_f32 v[214:215], v[214:215], v[198:199]
s_waitcnt lgkmcnt(5)
v_pk_add_f32 v[216:217], v[216:217], v[200:201]
v_pk_add_f32 v[218:219], v[218:219], v[202:203]
s_waitcnt lgkmcnt(4)
v_pk_add_f32 v[220:221], v[220:221], v[204:205]
v_pk_add_f32 v[222:223], v[222:223], v[206:207]
s_mov_b32 s88, 0xbfb8aa3b
v_mul_f32 v64, s88, v208
v_mul_f32 v65, s88, v209
v_mul_f32 v66, s88, v210
v_mul_f32 v67, s88, v211
v_mul_f32 v72, s88, v212
v_mul_f32 v73, s88, v213
v_mul_f32 v74, s88, v214
v_mul_f32 v75, s88, v215
v_mul_f32 v80, s88, v216
v_mul_f32 v81, s88, v217
v_mul_f32 v82, s88, v218
v_mul_f32 v83, s88, v219
v_mul_f32 v88, s88, v220
v_mul_f32 v89, s88, v221
v_mul_f32 v90, s88, v222
v_mul_f32 v91, s88, v223
v_exp_f32 v64, v64
v_exp_f32 v65, v65
v_exp_f32 v66, v66
v_exp_f32 v67, v67
v_exp_f32 v72, v72
v_exp_f32 v73, v73
v_exp_f32 v74, v74
v_exp_f32 v75, v75
v_exp_f32 v80, v80
v_exp_f32 v81, v81
v_exp_f32 v82, v82
v_exp_f32 v83, v83
v_exp_f32 v88, v88
v_exp_f32 v89, v89
v_exp_f32 v90, v90
v_exp_f32 v91, v91
v_pk_add_f32 v[64:65], v[64:65], 1.0 op_sel_hi:[1,0]
v_pk_add_f32 v[66:67], v[66:67], 1.0 op_sel_hi:[1,0]
v_pk_add_f32 v[72:73], v[72:73], 1.0 op_sel_hi:[1,0]
v_pk_add_f32 v[74:75], v[74:75], 1.0 op_sel_hi:[1,0]
v_pk_add_f32 v[80:81], v[80:81], 1.0 op_sel_hi:[1,0]
v_pk_add_f32 v[82:83], v[82:83], 1.0 op_sel_hi:[1,0]
v_pk_add_f32 v[88:89], v[88:89], 1.0 op_sel_hi:[1,0]
v_pk_add_f32 v[90:91], v[90:91], 1.0 op_sel_hi:[1,0]
v_rcp_f32 v64, v64
v_rcp_f32 v65, v65
v_rcp_f32 v66, v66
v_rcp_f32 v67, v67
v_rcp_f32 v72, v72
v_rcp_f32 v73, v73
v_rcp_f32 v74, v74
v_rcp_f32 v75, v75
v_rcp_f32 v80, v80
v_rcp_f32 v81, v81
v_rcp_f32 v82, v82
v_rcp_f32 v83, v83
v_rcp_f32 v88, v88
v_rcp_f32 v89, v89
v_rcp_f32 v90, v90
v_rcp_f32 v91, v91
v_pk_mul_f32 v[208:209], v[208:209], v[64:65]
v_pk_mul_f32 v[210:211], v[210:211], v[66:67]
v_pk_mul_f32 v[212:213], v[212:213], v[72:73]
v_pk_mul_f32 v[214:215], v[214:215], v[74:75]
v_pk_mul_f32 v[216:217], v[216:217], v[80:81]
v_pk_mul_f32 v[218:219], v[218:219], v[82:83]
v_pk_mul_f32 v[220:221], v[220:221], v[88:89]
v_pk_mul_f32 v[222:223], v[222:223], v[90:91]
s_mov_b32 s89, 0xffff0000
s_waitcnt lgkmcnt(3)
v_lshlrev_b32 v32, 16, v16
v_and_b32 v33, s89, v16
v_lshlrev_b32 v34, 16, v17
v_and_b32 v35, s89, v17
s_waitcnt lgkmcnt(2)
v_lshlrev_b32 v40, 16, v18
v_and_b32 v41, s89, v18
v_lshlrev_b32 v42, 16, v19
v_and_b32 v43, s89, v19
s_waitcnt lgkmcnt(1)
v_lshlrev_b32 v48, 16, v24
v_and_b32 v49, s89, v24
v_lshlrev_b32 v50, 16, v25
v_and_b32 v51, s89, v25
s_waitcnt lgkmcnt(0)
v_lshlrev_b32 v56, 16, v26
v_and_b32 v57, s89, v26
v_lshlrev_b32 v58, 16, v27
v_and_b32 v59, s89, v27
v_add_u32 v10, s99, v251
s_waitcnt vmcnt(13)
v_mfma_f32_16x16x32_bf16 v[96:99], v[160:163], a[64:67], 0
v_mfma_f32_16x16x32_bf16 v[104:107], v[164:167], a[64:67], 0
s_waitcnt vmcnt(12)
v_mfma_f32_16x16x32_bf16 v[112:115], v[160:163], a[68:71], 0
v_mfma_f32_16x16x32_bf16 v[120:123], v[164:167], a[68:71], 0
s_waitcnt vmcnt(11)
v_mfma_f32_16x16x32_bf16 v[96:99], v[160:163], a[72:75], v[96:99]
v_mfma_f32_16x16x32_bf16 v[104:107], v[164:167], a[72:75], v[104:107]
s_waitcnt vmcnt(10)
v_mfma_f32_16x16x32_bf16 v[112:115], v[160:163], a[76:79], v[112:115]
v_mfma_f32_16x16x32_bf16 v[120:123], v[164:167], a[76:79], v[120:123]
s_waitcnt vmcnt(9)
v_mfma_f32_16x16x32_bf16 v[96:99], v[160:163], a[80:83], v[96:99]
v_mfma_f32_16x16x32_bf16 v[104:107], v[164:167], a[80:83], v[104:107]
s_waitcnt vmcnt(8)
v_mfma_f32_16x16x32_bf16 v[112:115], v[160:163], a[84:87], v[112:115]
v_mfma_f32_16x16x32_bf16 v[120:123], v[164:167], a[84:87], v[120:123]
s_waitcnt vmcnt(7)
v_mfma_f32_16x16x32_bf16 v[96:99], v[160:163], a[88:91], v[96:99]
v_mfma_f32_16x16x32_bf16 v[104:107], v[164:167], a[88:91], v[104:107]
s_waitcnt vmcnt(6)
v_mfma_f32_16x16x32_bf16 v[112:115], v[160:163], a[92:95], v[112:115]
v_mfma_f32_16x16x32_bf16 v[120:123], v[164:167], a[92:95], v[120:123]
s_waitcnt vmcnt(5)
v_mfma_f32_16x16x32_bf16 v[96:99], v[160:163], a[96:99], v[96:99]
v_mfma_f32_16x16x32_bf16 v[104:107], v[164:167], a[96:99], v[104:107]
s_waitcnt vmcnt(4)
v_mfma_f32_16x16x32_bf16 v[112:115], v[160:163], a[100:103], v[112:115]
v_mfma_f32_16x16x32_bf16 v[120:123], v[164:167], a[100:103], v[120:123]
s_waitcnt vmcnt(3)
v_mfma_f32_16x16x32_bf16 v[96:99], v[160:163], a[104:107], v[96:99]
v_mfma_f32_16x16x32_bf16 v[104:107], v[164:167], a[104:107], v[104:107]
s_waitcnt vmcnt(2)
v_mfma_f32_16x16x32_bf16 v[112:115], v[160:163], a[108:111], v[112:115]
v_mfma_f32_16x16x32_bf16 v[120:123], v[164:167], a[108:111], v[120:123]
s_waitcnt vmcnt(1)
v_mfma_f32_16x16x32_bf16 v[96:99], v[160:163], a[112:115], v[96:99]
v_mfma_f32_16x16x32_bf16 v[104:107], v[164:167], a[112:115], v[104:107]
s_waitcnt vmcnt(0)
v_mfma_f32_16x16x32_bf16 v[112:115], v[160:163], a[116:119], v[112:115]
v_mfma_f32_16x16x32_bf16 v[120:123], v[164:167], a[116:119], v[120:123]
v_mfma_f32_16x16x32_bf16 v[96:99], v[160:163], a[120:123], v[96:99]
v_mfma_f32_16x16x32_bf16 v[104:107], v[164:167], a[120:123], v[104:107]
v_mfma_f32_16x16x32_bf16 v[112:115], v[160:163], a[124:127], v[112:115]
v_mfma_f32_16x16x32_bf16 v[120:123], v[164:167], a[124:127], v[120:123]
s_nop 4
v_pk_fma_f32 v[208:209], v[208:209], v[96:97], v[32:33]
v_pk_fma_f32 v[210:211], v[210:211], v[98:99], v[34:35]
v_pk_fma_f32 v[212:213], v[212:213], v[104:105], v[40:41]
v_pk_fma_f32 v[214:215], v[214:215], v[106:107], v[42:43]
v_pk_fma_f32 v[216:217], v[216:217], v[112:113], v[48:49]
v_pk_fma_f32 v[218:219], v[218:219], v[114:115], v[50:51]
v_pk_fma_f32 v[220:221], v[220:221], v[120:121], v[56:57]
v_pk_fma_f32 v[222:223], v[222:223], v[122:123], v[58:59]
v_cvt_pk_bf16_f32 v16, v208, v209
v_cvt_pk_bf16_f32 v17, v210, v211
v_cvt_pk_bf16_f32 v18, v212, v213
v_cvt_pk_bf16_f32 v19, v214, v215
v_cvt_pk_bf16_f32 v24, v216, v217
v_cvt_pk_bf16_f32 v25, v218, v219
v_cvt_pk_bf16_f32 v26, v220, v221
v_cvt_pk_bf16_f32 v27, v222, v223
ds_write_b64 v4, v[16:17]
ds_write_b64 v5, v[18:19]
ds_write_b64 v6, v[24:25]
ds_write_b64 v7, v[26:27]
s_waitcnt lgkmcnt(0)
ds_read_b128 v[208:211], v10 offset:0
ds_read_b128 v[212:215], v10 offset:1024
s_waitcnt lgkmcnt(1)
buffer_store_dwordx4 v[208:211], v2, s[72:75], s91 offen offset:0 nt
s_waitcnt lgkmcnt(0)
buffer_store_dwordx4 v[212:215], v3, s[72:75], s91 offen offset:1024 nt
recurrent_scan__sliding_block_cached__mixer_s_mlp__prompt_kernel_end:
s_endpgm
rexs_5:
v_add_u32 v181, 0, v181
ds_read_b64 a[76:77], v181 offset:0
ds_read_b64 a[78:79], v181 offset:2048
ds_read_b64 a[80:81], v181 offset:4096
ds_read_b64 a[82:83], v181 offset:6144
s_branch rexsb_6
rexs_7:
v_add_u32 v181, 51712, v181
ds_read_b64 a[76:77], v181 offset:0
ds_read_b64 a[78:79], v181 offset:2048
ds_read_b64 a[80:81], v181 offset:4096
ds_read_b64 a[82:83], v181 offset:6144
s_branch rexsb_8
rexs_9:
v_add_u32 v181, 103424, v181
ds_read_b64 a[76:77], v181 offset:0
ds_read_b64 a[78:79], v181 offset:2048
ds_read_b64 a[80:81], v181 offset:4096
ds_read_b64 a[82:83], v181 offset:6144
s_branch rexsb_10
reslow_12:
s_mov_b32 s21, 1048576
respin_14:
buffer_load_dword v247, v248, s[84:87], 0 offen sc1
s_waitcnt vmcnt(0)
v_cmp_eq_u32 vcc, 0, v247
s_nop 1
s_cbranch_vccz reback_13
s_sub_u32 s21, s21, 1
s_cmp_lg_u32 s21, 0
s_cbranch_scc1 respin_14
s_branch reback_13
rexs_15:
v_add_u32 v181, 0, v181
ds_read_b64 a[76:77], v181 offset:0
ds_read_b64 a[78:79], v181 offset:2048
ds_read_b64 a[80:81], v181 offset:4096
ds_read_b64 a[82:83], v181 offset:6144
s_branch rexsb_16
rexs_17:
v_add_u32 v181, 51712, v181
ds_read_b64 a[76:77], v181 offset:0
ds_read_b64 a[78:79], v181 offset:2048
ds_read_b64 a[80:81], v181 offset:4096
ds_read_b64 a[82:83], v181 offset:6144
s_branch rexsb_18
rexs_19:
v_add_u32 v181, 103424, v181
ds_read_b64 a[76:77], v181 offset:0
ds_read_b64 a[78:79], v181 offset:2048
ds_read_b64 a[80:81], v181 offset:4096
ds_read_b64 a[82:83], v181 offset:6144
s_branch rexsb_20
reslow_21:
s_mov_b32 s21, 1048576
respin_23:
buffer_load_dword v15, v14, s[76:79], s24 offen offset:64 sc1
s_waitcnt vmcnt(0)
v_cmp_ne_u32 vcc, v252, v15
s_nop 1
s_cbranch_vccz reback_22
s_sub_u32 s21, s21, 1
s_cmp_lg_u32 s21, 0
s_cbranch_scc1 respin_23
s_branch reback_22
rexs_24:
v_add_u32 v181, 0, v181
ds_read_b64 a[76:77], v181 offset:0
ds_read_b64 a[78:79], v181 offset:2048
ds_read_b64 a[80:81], v181 offset:4096
ds_read_b64 a[82:83], v181 offset:6144
s_branch rexsb_25
rexs_27:
v_add_u32 v181, 51712, v181
ds_read_b64 a[76:77], v181 offset:0
ds_read_b64 a[78:79], v181 offset:2048
ds_read_b64 a[80:81], v181 offset:4096
ds_read_b64 a[82:83], v181 offset:6144
s_branch rexsb_28
reslow_30:
s_mov_b32 s21, 1048576
respin_32:
buffer_load_dword v15, v14, s[76:79], s24 offen offset:0 sc1
s_waitcnt vmcnt(0)
v_cmp_ne_u32 vcc, v252, v15
s_nop 1
s_cbranch_vccz reback_31
s_sub_u32 s21, s21, 1
s_cmp_lg_u32 s21, 0
s_cbranch_scc1 respin_32
s_branch reback_31
reslow_33:
s_mov_b32 s21, 1048576
respin_35:
buffer_load_dword v15, v14, s[76:79], s24 offen offset:0 sc1
s_waitcnt vmcnt(0)
v_cmp_ne_u32 vcc, v252, v15
s_nop 1
s_cbranch_vccz reback_34
s_sub_u32 s21, s21, 1
s_cmp_lg_u32 s21, 0
s_cbranch_scc1 respin_35
s_branch reback_34
reslow_37:
s_mov_b32 s21, 1048576
respin_39:
buffer_load_dword v15, v14, s[76:79], s24 offen offset:32 sc1
s_waitcnt vmcnt(0)
v_cmp_ne_u32 vcc, v252, v15
s_nop 1
s_cbranch_vccz reback_38
s_sub_u32 s21, s21, 1
s_cmp_lg_u32 s21, 0
s_cbranch_scc1 respin_39
s_branch reback_38
reslow_40:
s_mov_b32 s21, 1048576
respin_42:
buffer_load_dword v15, v14, s[76:79], s24 offen offset:16 sc1
s_waitcnt vmcnt(0)
v_cmp_ne_u32 vcc, v252, v15
s_nop 1
s_cbranch_vccz reback_41
s_sub_u32 s21, s21, 1
s_cmp_lg_u32 s21, 0
s_cbranch_scc1 respin_42
s_branch reback_41
rekp_43:
ds_write_b128 v5, v[20:23] offset:0
ds_write_b128 v5, v[28:31] offset:2048
ds_write_b128 v5, v[36:39] offset:4096
ds_write_b128 v5, v[44:47] offset:6144
s_branch rekpb_44
rekp_45:
ds_write_b128 v5, v[84:87] offset:1024
ds_write_b128 v5, v[92:95] offset:3072
ds_write_b128 v5, v[100:103] offset:5120
ds_write_b128 v5, v[108:111] offset:7168
s_branch rekpb_46
rekp_47:
ds_write_b128 v5, v[144:147] offset:0
ds_write_b128 v5, v[148:151] offset:2048
ds_write_b128 v5, v[152:155] offset:4096
ds_write_b128 v5, v[156:159] offset:6144
s_branch rekpb_48
rekp_49:
ds_write_b128 v5, v[176:179] offset:1024
ds_write_b128 v5, v[180:183] offset:3072
ds_write_b128 v5, v[184:187] offset:5120
ds_write_b128 v5, v[188:191] offset:7168
s_branch rekpb_50
reslow_51:
s_mov_b32 s21, 1048576
respin_53:
buffer_load_dword v15, v14, s[76:79], s24 offen offset:0 sc1
s_waitcnt vmcnt(0)
v_cmp_ne_u32 vcc, v252, v15
s_nop 1
s_cbranch_vccz reback_52
s_sub_u32 s21, s21, 1
s_cmp_lg_u32 s21, 0
s_cbranch_scc1 respin_53
s_branch reback_52
reslow_54:
s_mov_b32 s21, 1048576
respin_56:
buffer_load_dword v15, v14, s[76:79], s24 offen offset:16 sc1
s_waitcnt vmcnt(0)
v_cmp_ne_u32 vcc, v252, v15
s_nop 1
s_cbranch_vccz reback_55
s_sub_u32 s21, s21, 1
s_cmp_lg_u32 s21, 0
s_cbranch_scc1 respin_56
s_branch reback_55
reslow_58:
s_mov_b32 s21, 1048576
respin_60:
buffer_load_dword v15, v14, s[76:79], s24 offen offset:32 sc1
s_waitcnt vmcnt(0)
v_cmp_ne_u32 vcc, v252, v15
s_nop 1
s_cbranch_vccz reback_59
s_sub_u32 s21, s21, 1
s_cmp_lg_u32 s21, 0
s_cbranch_scc1 respin_60
s_branch reback_59
reslow_61:
s_mov_b32 s21, 1048576
respin_63:
buffer_load_dword v15, v14, s[76:79], s24 offen offset:32 sc1
s_waitcnt vmcnt(0)
v_cmp_ne_u32 vcc, v252, v15
s_nop 1
s_cbranch_vccz reback_62
s_sub_u32 s21, s21, 1
s_cmp_lg_u32 s21, 0
s_cbranch_scc1 respin_63
s_branch reback_62
reslow_64:
s_mov_b32 s21, 1048576
respin_66:
buffer_load_dword v15, v14, s[76:79], s24 offen offset:16 sc1
s_waitcnt vmcnt(0)
v_cmp_ne_u32 vcc, v252, v15
s_nop 1
s_cbranch_vccz reback_65
s_sub_u32 s21, s21, 1
s_cmp_lg_u32 s21, 0
s_cbranch_scc1 respin_66
s_branch reback_65
rekp_67:
ds_write_b128 v5, v[20:23] offset:0
ds_write_b128 v5, v[28:31] offset:2048
ds_write_b128 v5, v[36:39] offset:4096
ds_write_b128 v5, v[44:47] offset:6144
s_branch rekpb_68
rekp_69:
ds_write_b128 v5, v[84:87] offset:1024
ds_write_b128 v5, v[92:95] offset:3072
ds_write_b128 v5, v[100:103] offset:5120
ds_write_b128 v5, v[108:111] offset:7168
s_branch rekpb_70
rekp_71:
ds_write_b128 v5, v[144:147] offset:0
ds_write_b128 v5, v[148:151] offset:2048
ds_write_b128 v5, v[152:155] offset:4096
ds_write_b128 v5, v[156:159] offset:6144
s_branch rekpb_72
rekp_73:
ds_write_b128 v5, v[176:179] offset:1024
ds_write_b128 v5, v[180:183] offset:3072
ds_write_b128 v5, v[184:187] offset:5120
ds_write_b128 v5, v[188:191] offset:7168
s_branch rekpb_74
reslow_75:
s_mov_b32 s21, 1048576
respin_77:
buffer_load_dword v15, v14, s[76:79], s24 offen offset:48 sc1
s_waitcnt vmcnt(0)
v_cmp_ne_u32 vcc, v252, v15
s_nop 1
s_cbranch_vccz reback_76
s_sub_u32 s21, s21, 1
s_cmp_lg_u32 s21, 0
s_cbranch_scc1 respin_77
s_branch reback_76
recurrent_scan__sliding_block_cached__mixer_s_mlp__prompt_kernel_fb:
s_waitcnt vmcnt(0) lgkmcnt(0)
s_mov_b32 s16, -1
v_mov_b32 v2, 0
v_mov_b32 v12, 0
v_mov_b32 v13, 0
v_mov_b32 v250, 0
v_accvgpr_write_b32 a108, 0
v_accvgpr_write_b32 a109, 0
v_accvgpr_write_b32 a110, 0
v_accvgpr_write_b32 a111, 0
v_accvgpr_write_b32 a112, 0
v_accvgpr_write_b32 a113, 0
v_accvgpr_write_b32 a114, 0
v_accvgpr_write_b32 a115, 0
v_accvgpr_write_b32 a116, 0
v_accvgpr_write_b32 a117, 0
v_accvgpr_write_b32 a118, 0
v_accvgpr_write_b32 a119, 0
v_accvgpr_write_b32 a120, 0
v_accvgpr_write_b32 a121, 0
v_accvgpr_write_b32 a122, 0
v_accvgpr_write_b32 a123, 0
v_mov_b32 v16, 0
v_mov_b32 v17, 0
v_mov_b32 v18, 0
v_mov_b32 v19, 0
v_mov_b32 v20, 0
v_mov_b32 v21, 0
v_mov_b32 v22, 0
v_mov_b32 v23, 0
v_mov_b32 v24, 0
v_mov_b32 v25, 0
v_mov_b32 v26, 0
v_mov_b32 v27, 0
v_mov_b32 v28, 0
v_mov_b32 v29, 0
v_mov_b32 v30, 0
v_mov_b32 v31, 0
v_mov_b32 v32, 0
v_mov_b32 v33, 0
v_mov_b32 v34, 0
v_mov_b32 v35, 0
v_mov_b32 v36, 0
v_mov_b32 v37, 0
v_mov_b32 v38, 0
v_mov_b32 v39, 0
v_mov_b32 v40, 0
v_mov_b32 v41, 0
v_mov_b32 v42, 0
v_mov_b32 v43, 0
v_mov_b32 v44, 0
v_mov_b32 v45, 0
v_mov_b32 v46, 0
v_mov_b32 v47, 0
v_mov_b32 v48, 0
v_mov_b32 v49, 0
v_mov_b32 v50, 0
v_mov_b32 v51, 0
v_mov_b32 v52, 0
v_mov_b32 v53, 0
v_mov_b32 v54, 0
v_mov_b32 v55, 0
v_mov_b32 v56, 0
v_mov_b32 v57, 0
v_mov_b32 v58, 0
v_mov_b32 v59, 0
v_mov_b32 v60, 0
v_mov_b32 v61, 0
v_mov_b32 v62, 0
v_mov_b32 v63, 0
v_mov_b32 v64, 0
v_mov_b32 v65, 0
v_mov_b32 v66, 0
v_mov_b32 v67, 0
v_mov_b32 v68, 0
v_mov_b32 v69, 0
v_mov_b32 v70, 0
v_mov_b32 v71, 0
v_mov_b32 v72, 0
v_mov_b32 v73, 0
v_mov_b32 v74, 0
v_mov_b32 v75, 0
v_mov_b32 v76, 0
v_mov_b32 v77, 0
v_mov_b32 v78, 0
v_mov_b32 v79, 0
v_mov_b32 v80, 0
v_mov_b32 v81, 0
v_mov_b32 v82, 0
v_mov_b32 v83, 0
v_mov_b32 v84, 0
v_mov_b32 v85, 0
v_mov_b32 v86, 0
v_mov_b32 v87, 0
v_mov_b32 v88, 0
v_mov_b32 v89, 0
v_mov_b32 v90, 0
v_mov_b32 v91, 0
v_mov_b32 v92, 0
v_mov_b32 v93, 0
v_mov_b32 v94, 0
v_mov_b32 v95, 0
v_mov_b32 v96, 0
v_mov_b32 v97, 0
v_mov_b32 v98, 0
v_mov_b32 v99, 0
v_mov_b32 v100, 0
v_mov_b32 v101, 0
v_mov_b32 v102, 0
v_mov_b32 v103, 0
v_mov_b32 v104, 0
v_mov_b32 v105, 0
v_mov_b32 v106, 0
v_mov_b32 v107, 0
v_mov_b32 v108, 0
v_mov_b32 v109, 0
v_mov_b32 v110, 0
v_mov_b32 v111, 0
v_mov_b32 v112, 0
v_mov_b32 v113, 0
v_mov_b32 v114, 0
v_mov_b32 v115, 0
v_mov_b32 v116, 0
v_mov_b32 v117, 0
v_mov_b32 v118, 0
v_mov_b32 v119, 0
v_mov_b32 v120, 0
v_mov_b32 v121, 0
v_mov_b32 v122, 0
v_mov_b32 v123, 0
v_mov_b32 v124, 0
v_mov_b32 v125, 0
v_mov_b32 v126, 0
v_mov_b32 v127, 0
v_mov_b32 v128, 0
v_mov_b32 v129, 0
v_mov_b32 v130, 0
v_mov_b32 v131, 0
v_mov_b32 v132, 0
v_mov_b32 v133, 0
v_mov_b32 v134, 0
v_mov_b32 v135, 0
v_mov_b32 v136, 0
v_mov_b32 v137, 0
v_mov_b32 v138, 0
v_mov_b32 v139, 0
v_mov_b32 v140, 0
v_mov_b32 v141, 0
v_mov_b32 v142, 0
v_mov_b32 v143, 0
v_subrev_u32 v14, 17408, v1
v_mov_b32 v15, 0xff800000
v_mov_b32 v252, 0xff800000
v_mov_b32 v253, 0xff800000
v_mov_b32 v2, 0xff800000
s_mov_b32 s21, 0
refbl_78:
s_barrier
s_add_u32 s95, s94, s21
s_add_u32 m0, s99, 86016
s_nop 0
buffer_load_dwordx4 v4, s[40:43], s95 offen offset:0 lds
buffer_load_dwordx4 v5, s[40:43], s95 offen offset:1088 lds
buffer_load_dwordx4 v6, s[40:43], s95 offen offset:2176 lds
buffer_load_dwordx4 v7, s[40:43], s95 offen offset:3264 lds
s_waitcnt vmcnt(0) lgkmcnt(0)
s_barrier
ds_read_b128 a[192:195], v14 offset:0
ds_read_b128 a[196:199], v14 offset:64
ds_read_b128 a[200:203], v14 offset:128
ds_read_b128 a[204:207], v14 offset:192
ds_read_b128 a[208:211], v14 offset:4352
ds_read_b128 a[212:215], v14 offset:4416
ds_read_b128 a[216:219], v14 offset:4480
ds_read_b128 a[220:223], v14 offset:4544
s_waitcnt lgkmcnt(7)
v_mfma_f32_16x16x32_bf16 v[144:147], a[192:195], a[128:131], 0
v_mfma_f32_16x16x32_bf16 v[152:155], a[192:195], a[144:147], 0
v_mfma_f32_16x16x32_bf16 v[160:163], a[192:195], a[160:163], 0
v_mfma_f32_16x16x32_bf16 v[168:171], a[192:195], a[176:179], 0
s_waitcnt lgkmcnt(6)
v_mfma_f32_16x16x32_bf16 v[168:171], a[196:199], a[180:183], v[168:171]
v_mfma_f32_16x16x32_bf16 v[160:163], a[196:199], a[164:167], v[160:163]
v_mfma_f32_16x16x32_bf16 v[152:155], a[196:199], a[148:151], v[152:155]
v_mfma_f32_16x16x32_bf16 v[144:147], a[196:199], a[132:135], v[144:147]
s_waitcnt lgkmcnt(5)
v_mfma_f32_16x16x32_bf16 v[144:147], a[200:203], a[136:139], v[144:147]
v_mfma_f32_16x16x32_bf16 v[152:155], a[200:203], a[152:155], v[152:155]
v_mfma_f32_16x16x32_bf16 v[160:163], a[200:203], a[168:171], v[160:163]
v_mfma_f32_16x16x32_bf16 v[168:171], a[200:203], a[184:187], v[168:171]
s_waitcnt lgkmcnt(4)
v_mfma_f32_16x16x32_bf16 v[168:171], a[204:207], a[188:191], v[168:171]
v_mfma_f32_16x16x32_bf16 v[160:163], a[204:207], a[172:175], v[160:163]
v_mfma_f32_16x16x32_bf16 v[152:155], a[204:207], a[156:159], v[152:155]
v_mfma_f32_16x16x32_bf16 v[144:147], a[204:207], a[140:143], v[144:147]
s_waitcnt lgkmcnt(3)
v_mfma_f32_16x16x32_bf16 v[148:151], a[208:211], a[128:131], 0
v_mfma_f32_16x16x32_bf16 v[156:159], a[208:211], a[144:147], 0
v_mfma_f32_16x16x32_bf16 v[164:167], a[208:211], a[160:163], 0
v_mfma_f32_16x16x32_bf16 v[172:175], a[208:211], a[176:179], 0
s_waitcnt lgkmcnt(2)
v_mfma_f32_16x16x32_bf16 v[172:175], a[212:215], a[180:183], v[172:175]
v_mfma_f32_16x16x32_bf16 v[164:167], a[212:215], a[164:167], v[164:167]
v_mfma_f32_16x16x32_bf16 v[156:159], a[212:215], a[148:151], v[156:159]
v_mfma_f32_16x16x32_bf16 v[148:151], a[212:215], a[132:135], v[148:151]
s_waitcnt lgkmcnt(1)
v_mfma_f32_16x16x32_bf16 v[148:151], a[216:219], a[136:139], v[148:151]
v_mfma_f32_16x16x32_bf16 v[156:159], a[216:219], a[152:155], v[156:159]
v_mfma_f32_16x16x32_bf16 v[164:167], a[216:219], a[168:171], v[164:167]
v_mfma_f32_16x16x32_bf16 v[172:175], a[216:219], a[184:187], v[172:175]
s_waitcnt lgkmcnt(0)
v_mfma_f32_16x16x32_bf16 v[172:175], a[220:223], a[188:191], v[172:175]
v_mfma_f32_16x16x32_bf16 v[164:167], a[220:223], a[172:175], v[164:167]
v_mfma_f32_16x16x32_bf16 v[156:159], a[220:223], a[156:159], v[156:159]
v_mfma_f32_16x16x32_bf16 v[148:151], a[220:223], a[140:143], v[148:151]
ds_read_b128 a[192:195], v14 offset:8704
ds_read_b128 a[196:199], v14 offset:8768
ds_read_b128 a[200:203], v14 offset:8832
ds_read_b128 a[204:207], v14 offset:8896
ds_read_b128 a[208:211], v14 offset:13056
ds_read_b128 a[212:215], v14 offset:13120
ds_read_b128 a[216:219], v14 offset:13184
ds_read_b128 a[220:223], v14 offset:13248
s_waitcnt lgkmcnt(7)
v_mfma_f32_16x16x32_bf16 v[176:179], a[192:195], a[128:131], 0
v_mfma_f32_16x16x32_bf16 v[184:187], a[192:195], a[144:147], 0
v_mfma_f32_16x16x32_bf16 v[192:195], a[192:195], a[160:163], 0
v_mfma_f32_16x16x32_bf16 v[200:203], a[192:195], a[176:179], 0
s_waitcnt lgkmcnt(6)
v_mfma_f32_16x16x32_bf16 v[200:203], a[196:199], a[180:183], v[200:203]
v_mfma_f32_16x16x32_bf16 v[192:195], a[196:199], a[164:167], v[192:195]
v_mfma_f32_16x16x32_bf16 v[184:187], a[196:199], a[148:151], v[184:187]
v_mfma_f32_16x16x32_bf16 v[176:179], a[196:199], a[132:135], v[176:179]
s_waitcnt lgkmcnt(5)
v_mfma_f32_16x16x32_bf16 v[176:179], a[200:203], a[136:139], v[176:179]
v_mfma_f32_16x16x32_bf16 v[184:187], a[200:203], a[152:155], v[184:187]
v_mfma_f32_16x16x32_bf16 v[192:195], a[200:203], a[168:171], v[192:195]
v_mfma_f32_16x16x32_bf16 v[200:203], a[200:203], a[184:187], v[200:203]
s_waitcnt lgkmcnt(4)
v_mfma_f32_16x16x32_bf16 v[200:203], a[204:207], a[188:191], v[200:203]
v_mfma_f32_16x16x32_bf16 v[192:195], a[204:207], a[172:175], v[192:195]
v_mfma_f32_16x16x32_bf16 v[184:187], a[204:207], a[156:159], v[184:187]
v_mfma_f32_16x16x32_bf16 v[176:179], a[204:207], a[140:143], v[176:179]
s_waitcnt lgkmcnt(3)
v_mfma_f32_16x16x32_bf16 v[180:183], a[208:211], a[128:131], 0
v_mfma_f32_16x16x32_bf16 v[188:191], a[208:211], a[144:147], 0
v_mfma_f32_16x16x32_bf16 v[196:199], a[208:211], a[160:163], 0
v_mfma_f32_16x16x32_bf16 v[204:207], a[208:211], a[176:179], 0
s_waitcnt lgkmcnt(2)
v_mfma_f32_16x16x32_bf16 v[204:207], a[212:215], a[180:183], v[204:207]
v_mfma_f32_16x16x32_bf16 v[196:199], a[212:215], a[164:167], v[196:199]
v_mfma_f32_16x16x32_bf16 v[188:191], a[212:215], a[148:151], v[188:191]
v_mfma_f32_16x16x32_bf16 v[180:183], a[212:215], a[132:135], v[180:183]
s_waitcnt lgkmcnt(1)
v_mfma_f32_16x16x32_bf16 v[180:183], a[216:219], a[136:139], v[180:183]
v_mfma_f32_16x16x32_bf16 v[188:191], a[216:219], a[152:155], v[188:191]
v_mfma_f32_16x16x32_bf16 v[196:199], a[216:219], a[168:171], v[196:199]
v_mfma_f32_16x16x32_bf16 v[204:207], a[216:219], a[184:187], v[204:207]
s_waitcnt lgkmcnt(0)
v_mfma_f32_16x16x32_bf16 v[204:207], a[220:223], a[188:191], v[204:207]
v_mfma_f32_16x16x32_bf16 v[196:199], a[220:223], a[172:175], v[196:199]
v_mfma_f32_16x16x32_bf16 v[188:191], a[220:223], a[156:159], v[188:191]
v_mfma_f32_16x16x32_bf16 v[180:183], a[220:223], a[140:143], v[180:183]
v_max_f32 v15, v15, v144
v_max_f32 v15, v15, v145
v_max_f32 v15, v15, v146
v_max_f32 v15, v15, v147
v_max_f32 v15, v15, v148
v_max_f32 v15, v15, v149
v_max_f32 v15, v15, v150
v_max_f32 v15, v15, v151
v_max_f32 v252, v252, v152
v_max_f32 v252, v252, v153
v_max_f32 v252, v252, v154
v_max_f32 v252, v252, v155
v_max_f32 v252, v252, v156
v_max_f32 v252, v252, v157
v_max_f32 v252, v252, v158
v_max_f32 v252, v252, v159
v_max_f32 v253, v253, v160
v_max_f32 v253, v253, v161
v_max_f32 v253, v253, v162
v_max_f32 v253, v253, v163
v_max_f32 v253, v253, v164
v_max_f32 v253, v253, v165
v_max_f32 v253, v253, v166
v_max_f32 v253, v253, v167
v_max_f32 v2, v2, v168
v_max_f32 v2, v2, v169
v_max_f32 v2, v2, v170
v_max_f32 v2, v2, v171
v_max_f32 v2, v2, v172
v_max_f32 v2, v2, v173
v_max_f32 v2, v2, v174
v_max_f32 v2, v2, v175
v_max_f32 v15, v15, v176
v_max_f32 v15, v15, v177
v_max_f32 v15, v15, v178
v_max_f32 v15, v15, v179
v_max_f32 v15, v15, v180
v_max_f32 v15, v15, v181
v_max_f32 v15, v15, v182
v_max_f32 v15, v15, v183
v_max_f32 v252, v252, v184
v_max_f32 v252, v252, v185
v_max_f32 v252, v252, v186
v_max_f32 v252, v252, v187
v_max_f32 v252, v252, v188
v_max_f32 v252, v252, v189
v_max_f32 v252, v252, v190
v_max_f32 v252, v252, v191
v_max_f32 v253, v253, v192
v_max_f32 v253, v253, v193
v_max_f32 v253, v253, v194
v_max_f32 v253, v253, v195
v_max_f32 v253, v253, v196
v_max_f32 v253, v253, v197
v_max_f32 v253, v253, v198
v_max_f32 v253, v253, v199
v_max_f32 v2, v2, v200
v_max_f32 v2, v2, v201
v_max_f32 v2, v2, v202
v_max_f32 v2, v2, v203
v_max_f32 v2, v2, v204
v_max_f32 v2, v2, v205
v_max_f32 v2, v2, v206
v_max_f32 v2, v2, v207
s_waitcnt vmcnt(0) lgkmcnt(0)
s_nop 15
s_add_u32 s21, s21, 16384
s_cmp_lt_u32 s21, 131072
s_cbranch_scc1 refbl_78
v_mov_b32 v208, v15
v_mov_b32 v209, v252
v_mov_b32 v210, v253
v_mov_b32 v211, v2
v_permlane16_swap_b32 v208, v15
v_permlane16_swap_b32 v209, v252
v_permlane16_swap_b32 v210, v253
v_permlane16_swap_b32 v211, v2
v_max_f32 v15, v15, v208
v_max_f32 v252, v252, v209
v_max_f32 v253, v253, v210
v_max_f32 v2, v2, v211
v_mov_b32 v208, v15
v_mov_b32 v209, v252
v_mov_b32 v210, v253
v_mov_b32 v211, v2
v_permlane32_swap_b32 v208, v15
v_permlane32_swap_b32 v209, v252
v_permlane32_swap_b32 v210, v253
v_permlane32_swap_b32 v211, v2
v_max_f32 v15, v15, v208
v_max_f32 v252, v252, v209
v_max_f32 v253, v253, v210
v_max_f32 v2, v2, v211
s_mov_b32 s21, 0
refbl_79:
s_barrier
s_add_u32 s95, s94, s21
s_add_u32 m0, s99, 86016
s_nop 0
buffer_load_dwordx4 v4, s[40:43], s95 offen offset:0 lds
buffer_load_dwordx4 v5, s[40:43], s95 offen offset:1088 lds
buffer_load_dwordx4 v6, s[40:43], s95 offen offset:2176 lds
buffer_load_dwordx4 v7, s[40:43], s95 offen offset:3264 lds
s_waitcnt vmcnt(0) lgkmcnt(0)
s_barrier
ds_read_b128 a[192:195], v14 offset:0
ds_read_b128 a[196:199], v14 offset:64
ds_read_b128 a[200:203], v14 offset:128
ds_read_b128 a[204:207], v14 offset:192
ds_read_b128 a[208:211], v14 offset:4352
ds_read_b128 a[212:215], v14 offset:4416
ds_read_b128 a[216:219], v14 offset:4480
ds_read_b128 a[220:223], v14 offset:4544
s_waitcnt lgkmcnt(7)
v_mfma_f32_16x16x32_bf16 v[144:147], a[192:195], a[128:131], 0
v_mfma_f32_16x16x32_bf16 v[152:155], a[192:195], a[144:147], 0
v_mfma_f32_16x16x32_bf16 v[160:163], a[192:195], a[160:163], 0
v_mfma_f32_16x16x32_bf16 v[168:171], a[192:195], a[176:179], 0
s_waitcnt lgkmcnt(6)
v_mfma_f32_16x16x32_bf16 v[168:171], a[196:199], a[180:183], v[168:171]
v_mfma_f32_16x16x32_bf16 v[160:163], a[196:199], a[164:167], v[160:163]
v_mfma_f32_16x16x32_bf16 v[152:155], a[196:199], a[148:151], v[152:155]
v_mfma_f32_16x16x32_bf16 v[144:147], a[196:199], a[132:135], v[144:147]
s_waitcnt lgkmcnt(5)
v_mfma_f32_16x16x32_bf16 v[144:147], a[200:203], a[136:139], v[144:147]
v_mfma_f32_16x16x32_bf16 v[152:155], a[200:203], a[152:155], v[152:155]
v_mfma_f32_16x16x32_bf16 v[160:163], a[200:203], a[168:171], v[160:163]
v_mfma_f32_16x16x32_bf16 v[168:171], a[200:203], a[184:187], v[168:171]
s_waitcnt lgkmcnt(4)
v_mfma_f32_16x16x32_bf16 v[168:171], a[204:207], a[188:191], v[168:171]
v_mfma_f32_16x16x32_bf16 v[160:163], a[204:207], a[172:175], v[160:163]
v_mfma_f32_16x16x32_bf16 v[152:155], a[204:207], a[156:159], v[152:155]
v_mfma_f32_16x16x32_bf16 v[144:147], a[204:207], a[140:143], v[144:147]
s_waitcnt lgkmcnt(3)
v_mfma_f32_16x16x32_bf16 v[148:151], a[208:211], a[128:131], 0
v_mfma_f32_16x16x32_bf16 v[156:159], a[208:211], a[144:147], 0
v_mfma_f32_16x16x32_bf16 v[164:167], a[208:211], a[160:163], 0
v_mfma_f32_16x16x32_bf16 v[172:175], a[208:211], a[176:179], 0
s_waitcnt lgkmcnt(2)
v_mfma_f32_16x16x32_bf16 v[172:175], a[212:215], a[180:183], v[172:175]
v_mfma_f32_16x16x32_bf16 v[164:167], a[212:215], a[164:167], v[164:167]
v_mfma_f32_16x16x32_bf16 v[156:159], a[212:215], a[148:151], v[156:159]
v_mfma_f32_16x16x32_bf16 v[148:151], a[212:215], a[132:135], v[148:151]
s_waitcnt lgkmcnt(1)
v_mfma_f32_16x16x32_bf16 v[148:151], a[216:219], a[136:139], v[148:151]
v_mfma_f32_16x16x32_bf16 v[156:159], a[216:219], a[152:155], v[156:159]
v_mfma_f32_16x16x32_bf16 v[164:167], a[216:219], a[168:171], v[164:167]
v_mfma_f32_16x16x32_bf16 v[172:175], a[216:219], a[184:187], v[172:175]
s_waitcnt lgkmcnt(0)
v_mfma_f32_16x16x32_bf16 v[172:175], a[220:223], a[188:191], v[172:175]
v_mfma_f32_16x16x32_bf16 v[164:167], a[220:223], a[172:175], v[164:167]
v_mfma_f32_16x16x32_bf16 v[156:159], a[220:223], a[156:159], v[156:159]
v_mfma_f32_16x16x32_bf16 v[148:151], a[220:223], a[140:143], v[148:151]
ds_read_b128 a[192:195], v14 offset:8704
ds_read_b128 a[196:199], v14 offset:8768
ds_read_b128 a[200:203], v14 offset:8832
ds_read_b128 a[204:207], v14 offset:8896
ds_read_b128 a[208:211], v14 offset:13056
ds_read_b128 a[212:215], v14 offset:13120
ds_read_b128 a[216:219], v14 offset:13184
ds_read_b128 a[220:223], v14 offset:13248
s_waitcnt lgkmcnt(7)
v_mfma_f32_16x16x32_bf16 v[176:179], a[192:195], a[128:131], 0
v_mfma_f32_16x16x32_bf16 v[184:187], a[192:195], a[144:147], 0
v_mfma_f32_16x16x32_bf16 v[192:195], a[192:195], a[160:163], 0
v_mfma_f32_16x16x32_bf16 v[200:203], a[192:195], a[176:179], 0
s_waitcnt lgkmcnt(6)
v_mfma_f32_16x16x32_bf16 v[200:203], a[196:199], a[180:183], v[200:203]
v_mfma_f32_16x16x32_bf16 v[192:195], a[196:199], a[164:167], v[192:195]
v_mfma_f32_16x16x32_bf16 v[184:187], a[196:199], a[148:151], v[184:187]
v_mfma_f32_16x16x32_bf16 v[176:179], a[196:199], a[132:135], v[176:179]
s_waitcnt lgkmcnt(5)
v_mfma_f32_16x16x32_bf16 v[176:179], a[200:203], a[136:139], v[176:179]
v_mfma_f32_16x16x32_bf16 v[184:187], a[200:203], a[152:155], v[184:187]
v_mfma_f32_16x16x32_bf16 v[192:195], a[200:203], a[168:171], v[192:195]
v_mfma_f32_16x16x32_bf16 v[200:203], a[200:203], a[184:187], v[200:203]
s_waitcnt lgkmcnt(4)
v_mfma_f32_16x16x32_bf16 v[200:203], a[204:207], a[188:191], v[200:203]
v_mfma_f32_16x16x32_bf16 v[192:195], a[204:207], a[172:175], v[192:195]
v_mfma_f32_16x16x32_bf16 v[184:187], a[204:207], a[156:159], v[184:187]
v_mfma_f32_16x16x32_bf16 v[176:179], a[204:207], a[140:143], v[176:179]
s_waitcnt lgkmcnt(3)
v_mfma_f32_16x16x32_bf16 v[180:183], a[208:211], a[128:131], 0
v_mfma_f32_16x16x32_bf16 v[188:191], a[208:211], a[144:147], 0
v_mfma_f32_16x16x32_bf16 v[196:199], a[208:211], a[160:163], 0
v_mfma_f32_16x16x32_bf16 v[204:207], a[208:211], a[176:179], 0
s_waitcnt lgkmcnt(2)
v_mfma_f32_16x16x32_bf16 v[204:207], a[212:215], a[180:183], v[204:207]
v_mfma_f32_16x16x32_bf16 v[196:199], a[212:215], a[164:167], v[196:199]
v_mfma_f32_16x16x32_bf16 v[188:191], a[212:215], a[148:151], v[188:191]
v_mfma_f32_16x16x32_bf16 v[180:183], a[212:215], a[132:135], v[180:183]
s_waitcnt lgkmcnt(1)
v_mfma_f32_16x16x32_bf16 v[180:183], a[216:219], a[136:139], v[180:183]
v_mfma_f32_16x16x32_bf16 v[188:191], a[216:219], a[152:155], v[188:191]
v_mfma_f32_16x16x32_bf16 v[196:199], a[216:219], a[168:171], v[196:199]
v_mfma_f32_16x16x32_bf16 v[204:207], a[216:219], a[184:187], v[204:207]
s_waitcnt lgkmcnt(0)
v_mfma_f32_16x16x32_bf16 v[204:207], a[220:223], a[188:191], v[204:207]
v_mfma_f32_16x16x32_bf16 v[196:199], a[220:223], a[172:175], v[196:199]
v_mfma_f32_16x16x32_bf16 v[188:191], a[220:223], a[156:159], v[188:191]
v_mfma_f32_16x16x32_bf16 v[180:183], a[220:223], a[140:143], v[180:183]
s_barrier
s_add_u32 m0, s96, 86016
s_nop 0
buffer_load_dwordx4 v8, s[44:47], s95 offen offset:0 lds
buffer_load_dwordx4 v9, s[44:47], s95 offen offset:1056 lds
buffer_load_dwordx4 v10, s[44:47], s95 offen offset:2112 lds
buffer_load_dwordx4 v11, s[44:47], s95 offen offset:3168 lds
v_sub_f32 v144, v144, v15
v_exp_f32 v144, v144
v_sub_f32 v145, v145, v15
v_exp_f32 v145, v145
s_nop 0
v_cvt_pk_bf16_f32 v208, v144, v145
v_sub_f32 v146, v146, v15
v_exp_f32 v146, v146
v_sub_f32 v147, v147, v15
v_exp_f32 v147, v147
s_nop 0
v_cvt_pk_bf16_f32 v209, v146, v147
v_sub_f32 v148, v148, v15
v_exp_f32 v148, v148
v_sub_f32 v149, v149, v15
v_exp_f32 v149, v149
s_nop 0
v_cvt_pk_bf16_f32 v210, v148, v149
v_sub_f32 v150, v150, v15
v_exp_f32 v150, v150
v_sub_f32 v151, v151, v15
v_exp_f32 v151, v151
s_nop 0
v_cvt_pk_bf16_f32 v211, v150, v151
v_sub_f32 v152, v152, v252
v_exp_f32 v152, v152
v_sub_f32 v153, v153, v252
v_exp_f32 v153, v153
s_nop 0
v_cvt_pk_bf16_f32 v212, v152, v153
v_sub_f32 v154, v154, v252
v_exp_f32 v154, v154
v_sub_f32 v155, v155, v252
v_exp_f32 v155, v155
s_nop 0
v_cvt_pk_bf16_f32 v213, v154, v155
v_sub_f32 v156, v156, v252
v_exp_f32 v156, v156
v_sub_f32 v157, v157, v252
v_exp_f32 v157, v157
s_nop 0
v_cvt_pk_bf16_f32 v214, v156, v157
v_sub_f32 v158, v158, v252
v_exp_f32 v158, v158
v_sub_f32 v159, v159, v252
v_exp_f32 v159, v159
s_nop 0
v_cvt_pk_bf16_f32 v215, v158, v159
v_sub_f32 v160, v160, v253
v_exp_f32 v160, v160
v_sub_f32 v161, v161, v253
v_exp_f32 v161, v161
s_nop 0
v_cvt_pk_bf16_f32 v216, v160, v161
v_sub_f32 v162, v162, v253
v_exp_f32 v162, v162
v_sub_f32 v163, v163, v253
v_exp_f32 v163, v163
s_nop 0
v_cvt_pk_bf16_f32 v217, v162, v163
v_sub_f32 v164, v164, v253
v_exp_f32 v164, v164
v_sub_f32 v165, v165, v253
v_exp_f32 v165, v165
s_nop 0
v_cvt_pk_bf16_f32 v218, v164, v165
v_sub_f32 v166, v166, v253
v_exp_f32 v166, v166
v_sub_f32 v167, v167, v253
v_exp_f32 v167, v167
s_nop 0
v_cvt_pk_bf16_f32 v219, v166, v167
v_sub_f32 v168, v168, v2
v_exp_f32 v168, v168
v_sub_f32 v169, v169, v2
v_exp_f32 v169, v169
s_nop 0
v_cvt_pk_bf16_f32 v220, v168, v169
v_sub_f32 v170, v170, v2
v_exp_f32 v170, v170
v_sub_f32 v171, v171, v2
v_exp_f32 v171, v171
s_nop 0
v_cvt_pk_bf16_f32 v221, v170, v171
v_sub_f32 v172, v172, v2
v_exp_f32 v172, v172
v_sub_f32 v173, v173, v2
v_exp_f32 v173, v173
s_nop 0
v_cvt_pk_bf16_f32 v222, v172, v173
v_sub_f32 v174, v174, v2
v_exp_f32 v174, v174
v_sub_f32 v175, v175, v2
v_exp_f32 v175, v175
s_nop 0
v_cvt_pk_bf16_f32 v223, v174, v175
v_sub_f32 v176, v176, v15
v_exp_f32 v176, v176
v_sub_f32 v177, v177, v15
v_exp_f32 v177, v177
s_nop 0
v_cvt_pk_bf16_f32 v224, v176, v177
v_sub_f32 v178, v178, v15
v_exp_f32 v178, v178
v_sub_f32 v179, v179, v15
v_exp_f32 v179, v179
s_nop 0
v_cvt_pk_bf16_f32 v225, v178, v179
v_sub_f32 v180, v180, v15
v_exp_f32 v180, v180
v_sub_f32 v181, v181, v15
v_exp_f32 v181, v181
s_nop 0
v_cvt_pk_bf16_f32 v226, v180, v181
v_sub_f32 v182, v182, v15
v_exp_f32 v182, v182
v_sub_f32 v183, v183, v15
v_exp_f32 v183, v183
s_nop 0
v_cvt_pk_bf16_f32 v227, v182, v183
v_sub_f32 v184, v184, v252
v_exp_f32 v184, v184
v_sub_f32 v185, v185, v252
v_exp_f32 v185, v185
s_nop 0
v_cvt_pk_bf16_f32 v228, v184, v185
v_sub_f32 v186, v186, v252
v_exp_f32 v186, v186
v_sub_f32 v187, v187, v252
v_exp_f32 v187, v187
s_nop 0
v_cvt_pk_bf16_f32 v229, v186, v187
v_sub_f32 v188, v188, v252
v_exp_f32 v188, v188
v_sub_f32 v189, v189, v252
v_exp_f32 v189, v189
s_nop 0
v_cvt_pk_bf16_f32 v230, v188, v189
v_sub_f32 v190, v190, v252
v_exp_f32 v190, v190
v_sub_f32 v191, v191, v252
v_exp_f32 v191, v191
s_nop 0
v_cvt_pk_bf16_f32 v231, v190, v191
v_sub_f32 v192, v192, v253
v_exp_f32 v192, v192
v_sub_f32 v193, v193, v253
v_exp_f32 v193, v193
s_nop 0
v_cvt_pk_bf16_f32 v232, v192, v193
v_sub_f32 v194, v194, v253
v_exp_f32 v194, v194
v_sub_f32 v195, v195, v253
v_exp_f32 v195, v195
s_nop 0
v_cvt_pk_bf16_f32 v233, v194, v195
v_sub_f32 v196, v196, v253
v_exp_f32 v196, v196
v_sub_f32 v197, v197, v253
v_exp_f32 v197, v197
s_nop 0
v_cvt_pk_bf16_f32 v234, v196, v197
v_sub_f32 v198, v198, v253
v_exp_f32 v198, v198
v_sub_f32 v199, v199, v253
v_exp_f32 v199, v199
s_nop 0
v_cvt_pk_bf16_f32 v235, v198, v199
v_sub_f32 v200, v200, v2
v_exp_f32 v200, v200
v_sub_f32 v201, v201, v2
v_exp_f32 v201, v201
s_nop 0
v_cvt_pk_bf16_f32 v236, v200, v201
v_sub_f32 v202, v202, v2
v_exp_f32 v202, v202
v_sub_f32 v203, v203, v2
v_exp_f32 v203, v203
s_nop 0
v_cvt_pk_bf16_f32 v237, v202, v203
v_sub_f32 v204, v204, v2
v_exp_f32 v204, v204
v_sub_f32 v205, v205, v2
v_exp_f32 v205, v205
s_nop 0
v_cvt_pk_bf16_f32 v238, v204, v205
v_sub_f32 v206, v206, v2
v_exp_f32 v206, v206
v_sub_f32 v207, v207, v2
v_exp_f32 v207, v207
s_nop 0
v_cvt_pk_bf16_f32 v239, v206, v207
s_waitcnt vmcnt(0) lgkmcnt(0)
s_barrier
ds_read_b64_tr_b16 a[224:225], v3 offset:0
ds_read_b64_tr_b16 a[226:227], v3 offset:512
ds_read_b64_tr_b16 a[228:229], v3 offset:32
ds_read_b64_tr_b16 a[230:231], v3 offset:544
ds_read_b64_tr_b16 a[232:233], v3 offset:64
ds_read_b64_tr_b16 a[234:235], v3 offset:576
ds_read_b64_tr_b16 a[236:237], v3 offset:96
ds_read_b64_tr_b16 a[238:239], v3 offset:608
ds_read_b64_tr_b16 a[240:241], v3 offset:128
ds_read_b64_tr_b16 a[242:243], v3 offset:640
ds_read_b64_tr_b16 a[244:245], v3 offset:160
ds_read_b64_tr_b16 a[246:247], v3 offset:672
ds_read_b64_tr_b16 a[248:249], v3 offset:192
ds_read_b64_tr_b16 a[250:251], v3 offset:704
ds_read_b64_tr_b16 a[252:253], v3 offset:224
ds_read_b64_tr_b16 a[254:255], v3 offset:736
s_waitcnt lgkmcnt(14)
v_mfma_f32_16x16x32_bf16 v[16:19], a[224:227], v[208:211], v[16:19]
v_mfma_f32_16x16x32_bf16 v[24:27], a[224:227], v[212:215], v[24:27]
v_mfma_f32_16x16x32_bf16 v[32:35], a[224:227], v[216:219], v[32:35]
v_mfma_f32_16x16x32_bf16 v[40:43], a[224:227], v[220:223], v[40:43]
s_waitcnt lgkmcnt(12)
v_mfma_f32_16x16x32_bf16 v[44:47], a[228:231], v[220:223], v[44:47]
v_mfma_f32_16x16x32_bf16 v[36:39], a[228:231], v[216:219], v[36:39]
v_mfma_f32_16x16x32_bf16 v[28:31], a[228:231], v[212:215], v[28:31]
v_mfma_f32_16x16x32_bf16 v[20:23], a[228:231], v[208:211], v[20:23]
s_waitcnt lgkmcnt(10)
v_mfma_f32_16x16x32_bf16 v[48:51], a[232:235], v[208:211], v[48:51]
v_mfma_f32_16x16x32_bf16 v[56:59], a[232:235], v[212:215], v[56:59]
v_mfma_f32_16x16x32_bf16 v[64:67], a[232:235], v[216:219], v[64:67]
v_mfma_f32_16x16x32_bf16 v[72:75], a[232:235], v[220:223], v[72:75]
s_waitcnt lgkmcnt(8)
v_mfma_f32_16x16x32_bf16 v[76:79], a[236:239], v[220:223], v[76:79]
v_mfma_f32_16x16x32_bf16 v[68:71], a[236:239], v[216:219], v[68:71]
v_mfma_f32_16x16x32_bf16 v[60:63], a[236:239], v[212:215], v[60:63]
v_mfma_f32_16x16x32_bf16 v[52:55], a[236:239], v[208:211], v[52:55]
s_waitcnt lgkmcnt(6)
v_mfma_f32_16x16x32_bf16 v[80:83], a[240:243], v[208:211], v[80:83]
v_mfma_f32_16x16x32_bf16 v[88:91], a[240:243], v[212:215], v[88:91]
v_mfma_f32_16x16x32_bf16 v[96:99], a[240:243], v[216:219], v[96:99]
v_mfma_f32_16x16x32_bf16 v[104:107], a[240:243], v[220:223], v[104:107]
s_waitcnt lgkmcnt(4)
v_mfma_f32_16x16x32_bf16 v[108:111], a[244:247], v[220:223], v[108:111]
v_mfma_f32_16x16x32_bf16 v[100:103], a[244:247], v[216:219], v[100:103]
v_mfma_f32_16x16x32_bf16 v[92:95], a[244:247], v[212:215], v[92:95]
v_mfma_f32_16x16x32_bf16 v[84:87], a[244:247], v[208:211], v[84:87]
s_waitcnt lgkmcnt(2)
v_mfma_f32_16x16x32_bf16 v[112:115], a[248:251], v[208:211], v[112:115]
v_mfma_f32_16x16x32_bf16 v[120:123], a[248:251], v[212:215], v[120:123]
v_mfma_f32_16x16x32_bf16 v[128:131], a[248:251], v[216:219], v[128:131]
v_mfma_f32_16x16x32_bf16 v[136:139], a[248:251], v[220:223], v[136:139]
s_waitcnt lgkmcnt(0)
v_mfma_f32_16x16x32_bf16 v[140:143], a[252:255], v[220:223], v[140:143]
v_mfma_f32_16x16x32_bf16 v[132:135], a[252:255], v[216:219], v[132:135]
v_mfma_f32_16x16x32_bf16 v[124:127], a[252:255], v[212:215], v[124:127]
v_mfma_f32_16x16x32_bf16 v[116:119], a[252:255], v[208:211], v[116:119]
v_mfma_f32_16x16x32_bf16 a[108:111], a[124:127], v[208:211], a[108:111]
v_mfma_f32_16x16x32_bf16 a[112:115], a[124:127], v[212:215], a[112:115]
v_mfma_f32_16x16x32_bf16 a[116:119], a[124:127], v[216:219], a[116:119]
v_mfma_f32_16x16x32_bf16 a[120:123], a[124:127], v[220:223], a[120:123]
ds_read_b64_tr_b16 a[224:225], v3 offset:8448
ds_read_b64_tr_b16 a[226:227], v3 offset:8960
ds_read_b64_tr_b16 a[228:229], v3 offset:8480
ds_read_b64_tr_b16 a[230:231], v3 offset:8992
ds_read_b64_tr_b16 a[232:233], v3 offset:8512
ds_read_b64_tr_b16 a[234:235], v3 offset:9024
ds_read_b64_tr_b16 a[236:237], v3 offset:8544
ds_read_b64_tr_b16 a[238:239], v3 offset:9056
ds_read_b64_tr_b16 a[240:241], v3 offset:8576
ds_read_b64_tr_b16 a[242:243], v3 offset:9088
ds_read_b64_tr_b16 a[244:245], v3 offset:8608
ds_read_b64_tr_b16 a[246:247], v3 offset:9120
ds_read_b64_tr_b16 a[248:249], v3 offset:8640
ds_read_b64_tr_b16 a[250:251], v3 offset:9152
ds_read_b64_tr_b16 a[252:253], v3 offset:8672
ds_read_b64_tr_b16 a[254:255], v3 offset:9184
s_waitcnt lgkmcnt(14)
v_mfma_f32_16x16x32_bf16 v[16:19], a[224:227], v[224:227], v[16:19]
v_mfma_f32_16x16x32_bf16 v[24:27], a[224:227], v[228:231], v[24:27]
v_mfma_f32_16x16x32_bf16 v[32:35], a[224:227], v[232:235], v[32:35]
v_mfma_f32_16x16x32_bf16 v[40:43], a[224:227], v[236:239], v[40:43]
s_waitcnt lgkmcnt(12)
v_mfma_f32_16x16x32_bf16 v[44:47], a[228:231], v[236:239], v[44:47]
v_mfma_f32_16x16x32_bf16 v[36:39], a[228:231], v[232:235], v[36:39]
v_mfma_f32_16x16x32_bf16 v[28:31], a[228:231], v[228:231], v[28:31]
v_mfma_f32_16x16x32_bf16 v[20:23], a[228:231], v[224:227], v[20:23]
s_waitcnt lgkmcnt(10)
v_mfma_f32_16x16x32_bf16 v[48:51], a[232:235], v[224:227], v[48:51]
v_mfma_f32_16x16x32_bf16 v[56:59], a[232:235], v[228:231], v[56:59]
v_mfma_f32_16x16x32_bf16 v[64:67], a[232:235], v[232:235], v[64:67]
v_mfma_f32_16x16x32_bf16 v[72:75], a[232:235], v[236:239], v[72:75]
s_waitcnt lgkmcnt(8)
v_mfma_f32_16x16x32_bf16 v[76:79], a[236:239], v[236:239], v[76:79]
v_mfma_f32_16x16x32_bf16 v[68:71], a[236:239], v[232:235], v[68:71]
v_mfma_f32_16x16x32_bf16 v[60:63], a[236:239], v[228:231], v[60:63]
v_mfma_f32_16x16x32_bf16 v[52:55], a[236:239], v[224:227], v[52:55]
s_waitcnt lgkmcnt(6)
v_mfma_f32_16x16x32_bf16 v[80:83], a[240:243], v[224:227], v[80:83]
v_mfma_f32_16x16x32_bf16 v[88:91], a[240:243], v[228:231], v[88:91]
v_mfma_f32_16x16x32_bf16 v[96:99], a[240:243], v[232:235], v[96:99]
v_mfma_f32_16x16x32_bf16 v[104:107], a[240:243], v[236:239], v[104:107]
s_waitcnt lgkmcnt(4)
v_mfma_f32_16x16x32_bf16 v[108:111], a[244:247], v[236:239], v[108:111]
v_mfma_f32_16x16x32_bf16 v[100:103], a[244:247], v[232:235], v[100:103]
v_mfma_f32_16x16x32_bf16 v[92:95], a[244:247], v[228:231], v[92:95]
v_mfma_f32_16x16x32_bf16 v[84:87], a[244:247], v[224:227], v[84:87]
s_waitcnt lgkmcnt(2)
v_mfma_f32_16x16x32_bf16 v[112:115], a[248:251], v[224:227], v[112:115]
v_mfma_f32_16x16x32_bf16 v[120:123], a[248:251], v[228:231], v[120:123]
v_mfma_f32_16x16x32_bf16 v[128:131], a[248:251], v[232:235], v[128:131]
v_mfma_f32_16x16x32_bf16 v[136:139], a[248:251], v[236:239], v[136:139]
s_waitcnt lgkmcnt(0)
v_mfma_f32_16x16x32_bf16 v[140:143], a[252:255], v[236:239], v[140:143]
v_mfma_f32_16x16x32_bf16 v[132:135], a[252:255], v[232:235], v[132:135]
v_mfma_f32_16x16x32_bf16 v[124:127], a[252:255], v[228:231], v[124:127]
v_mfma_f32_16x16x32_bf16 v[116:119], a[252:255], v[224:227], v[116:119]
v_mfma_f32_16x16x32_bf16 a[108:111], a[124:127], v[224:227], a[108:111]
v_mfma_f32_16x16x32_bf16 a[112:115], a[124:127], v[228:231], a[112:115]
v_mfma_f32_16x16x32_bf16 a[116:119], a[124:127], v[232:235], a[116:119]
v_mfma_f32_16x16x32_bf16 a[120:123], a[124:127], v[236:239], a[120:123]
s_waitcnt vmcnt(0) lgkmcnt(0)
s_nop 15
s_add_u32 s21, s21, 16384
s_cmp_lt_u32 s21, 131072
s_cbranch_scc1 refbl_79
v_mov_b32 v2, 0
s_cmp_eq_u32 s7, 0
s_cbranch_scc1 recurrent_scan__sliding_block_cached__mixer_s_mlp__prompt_kernel_redob
s_branch recurrent_scan__sliding_block_cached__mixer_s_mlp__prompt_kernel_redoc
recurrent_scan__sliding_block_cached__mixer_s_mlp__prompt_kernel_last:
.section .rodata,"a"
.p2align 6
.amdhsa_kernel recurrent_scan__sliding_block_cached__mixer_s_mlp__prompt_kernel
  .amdhsa_next_free_vgpr 512
  .amdhsa_next_free_sgpr 102
  .amdhsa_accum_offset 256
  .amdhsa_group_segment_fixed_size 0
  .amdhsa_kernarg_size 104
  .amdhsa_user_sgpr_count 2
  .amdhsa_user_sgpr_kernarg_segment_ptr 1
  .amdhsa_system_sgpr_workgroup_id_x 1
.end_amdhsa_kernel
```
